```python
import torch

def _softmax(x, axis=-1):
    return torch.softmax(x, dim=axis)
def _gelu(x):
    return torch.nn.functional.gelu(x, approximate="tanh")
def _silu(x):
    return torch.nn.functional.silu(x)
def _sigmoid(x):
    return torch.sigmoid(x)
def _layernorm(x, axis=-1, eps=1e-5):
    m = x.mean(dim=axis, keepdim=True)
    v = x.var(dim=axis, keepdim=True, unbiased=False)
    return (x - m) / torch.sqrt(v + eps)
def _scatter_add(tgt, idx, src, axis=0):
    return tgt.clone().index_add_(axis, idx, src)
def _segment_sum(src, seg, n):
    out = torch.zeros((n,) + src.shape[1:], dtype=src.dtype)
    return out.index_add_(0, seg, src)
def _pad(x, pw):
    flat = tuple(v for pair in reversed(pw) for v in pair)
    return torch.nn.functional.pad(x, flat)

kernel_name = 'gated_mix__grouped_kv_mqa__glu_gated_reglu__prompt'

def setup_inputs():

    _w = (lambda a: (lambda t: t.to(torch.bfloat16) if t.is_floating_point() else t)(torch.as_tensor(a)))
    def _A_setup():
        B, S, D, H = 1, 2048, 1024, 32
        Dh = D // H
        return {
            "x": _w((lambda *s: torch.randn(*s, dtype=torch.bfloat16) * 0.05)(B, S, D)),
            "wq": _w((lambda *s: torch.randn(*s, dtype=torch.bfloat16) * 0.8)(D, H * Dh)),
            "wk": _w((lambda *s: torch.randn(*s, dtype=torch.bfloat16) * 0.8)(D, Dh)),
            "wv": _w((lambda *s: torch.randn(*s, dtype=torch.bfloat16) * 0.05)(D, Dh)),
            "wo": _w((lambda *s: torch.randn(*s, dtype=torch.bfloat16) * 0.05)(H * Dh, D)),
        }
    _A_in = _A_setup()

    def _B_setup():
        B, S, D, F = 1, 2048, 1024, 3584
        return {
            "x": _w((lambda *s: torch.randn(*s, dtype=torch.bfloat16) * 0.05)(B, S, D)),
            "W_gate": _w((lambda *s: torch.randn(*s, dtype=torch.bfloat16) * 1.6)(D, F) * (2.0 / D) ** 0.5),
            "W_up": _w((lambda *s: torch.randn(*s, dtype=torch.bfloat16) * 1.6)(D, F) * (2.0 / D) ** 0.5),
            "W_down": _w((lambda *s: torch.randn(*s, dtype=torch.bfloat16) * 1.6)(F, D) * (1.0 / F) ** 0.5),
        }
    _B_in = _B_setup()

    return {
        "A_x": _A_in["x"],
        "A_wq": _A_in["wq"],
        "A_wk": _A_in["wk"],
        "A_wv": _A_in["wv"],
        "A_wo": _A_in["wo"],
        "B_x": _B_in["x"],
        "B_W_gate": _B_in["W_gate"],
        "B_W_up": _B_in["W_up"],
        "B_W_down": _B_in["W_down"],
        "gate_w": _w((lambda *s: torch.randn(*s, dtype=torch.bfloat16) * 0.05)(1024) * 16.0),
    }

def reference(A_x, A_wq, A_wk, A_wv, A_wo, B_x, B_W_gate, B_W_up, B_W_down, gate_w):
    def _A_ref(x, wq, wk, wv, wo):
        B, S, D = x.shape
        H = 32
        Dh = D // H
        q = (lambda x, *d: x.permute(*d))((x @ wq).reshape(B, S, H, Dh), 0, 2, 1, 3)
        k = x @ wk
        v = x @ wv
        scores = torch.einsum("bhqd,bkd->bhqk", q, k) * (Dh ** -0.5)
        p = _softmax(scores, axis=-1)
        o = torch.einsum("bhqk,bkd->bhqd", p, v)
        return (lambda x, *d: x.permute(*d))(o, 0, 2, 1, 3).reshape(B, S, H * Dh) @ wo

    def _B_ref(x, W_gate, W_up, W_down):
        gate = torch.einsum("bsd,df->bsf", x, W_gate)
        up = torch.einsum("bsd,df->bsf", x, W_up)
        gate = gate * (lambda x, dt: x.to(dt))(gate > 0, gate.dtype)
        h = gate * up
        return torch.einsum("bsf,fd->bsd", h, W_down)

    x = A_x
    g = _sigmoid((x * gate_w).sum(-1, keepdims=True))
    a = _A_ref(x, A_wq, A_wk, A_wv, A_wo)
    b = _B_ref(x, B_W_gate, B_W_up, B_W_down)
    return g * a + (1 - g) * b
```

```asm
; @launch grid=(256,1,1) block=(256,1,1) lds=163840
.amdgcn_target "amdgcn-amd-amdhsa--gfx950"
.text
.globl gated_mix__grouped_kv_mqa__glu_gated_reglu__prompt_kernel
.p2align 8
.type gated_mix__grouped_kv_mqa__glu_gated_reglu__prompt_kernel,@function
gated_mix__grouped_kv_mqa__glu_gated_reglu__prompt_kernel:
    s_cmp_ge_u32 s2, 256
    s_cbranch_scc1 L_END
    s_load_dwordx8 s[4:11], s[0:1], 0
    s_load_dwordx2 s[12:13], s[0:1], 32
    s_load_dwordx8 s[16:23], s[0:1], 48
    s_load_dwordx4 s[24:27], s[0:1], 80
    s_load_dwordx2 s[28:29], s[0:1], 96
    s_memrealtime s[30:31]
    v_lshrrev_b32 v3, 6, v0
    v_and_b32 v1, 63, v0
    v_readfirstlane_b32 s56, v3
    v_lshlrev_b32 v2, 4, v1
    s_getpc_b64 s[100:101]
L_PCREF:
    v_lshrrev_b32 v0, 2, v0
    v_lshlrev_b32 v0, 7, v0
    s_sub_u32 s100, s100, L_PCREF-gated_mix__grouped_kv_mqa__glu_gated_reglu__prompt_kernel
    s_subb_u32 s101, s101, 0
    global_load_dword a253, v0, s[100:101]
    v_add_u32 v0, 0x2000, v0
    s_and_b32 s58, s2, 1
    s_lshl_b32 s58, s58, 2
    s_bfe_u32 s59, s2, 0x20003
    s_add_u32 s63, s58, s59
    s_bfe_u32 s58, s2, 0x20001
    s_lshl_b32 s58, s58, 3
    s_lshr_b32 s59, s2, 5
    s_add_u32 s64, s58, s59
    s_lshl_b32 s58, s56, 6
    v_lshrrev_b32 v24, 3, v1
    v_add_u32 v26, s58, v24
    v_lshlrev_b32 v26, 11, v26
    v_lshrrev_b32 v25, 4, v1
    v_and_b32 v27, 7, v1
    v_xor_b32 v28, v27, v25
    v_lshl_add_u32 v3, v28, 4, v26
    v_add_u32 v3, 0, v3
    v_xor_b32 v4, 64, v3
    s_mov_b32 s65, 15360
    s_mov_b32 s66, 30720
    s_mov_b32 s67, 46080
    s_mov_b32 s68, 65536
    s_mov_b32 s69, 80896
    s_mov_b32 s70, 96256
    s_mov_b32 s71, 111616
    s_lshl_b32 s76, s56, 13
    s_lshl_b32 s77, s56, 11
    s_add_u32 s78, s77, 147456
    s_add_u32 s77, s77, 65536
    s_and_b32 s59, s64, 3
    s_mov_b32 s15, 7168
    s_cmp_eq_u32 s59, 3
    s_cselect_b32 s15, 2048, s15
    s_lshl_b32 s58, s56, 3
    v_add_u32 v26, s58, v25
    v_mul_lo_u32 v26, v26, s15
    s_and_b32 s59, s56, 1
    s_lshl_b32 s60, s59, 3
    v_and_b32 v28, 15, v1
    v_lshl_or_b32 v29, v25, 1, s60
    v_xor_b32 v28, v28, v29
    v_lshl_add_u32 v6, v28, 4, v26
    v_add_u32 v26, s58, v24
    v_mul_u32_u24 v26, 7168, v26
    s_lshl_b32 s60, s59, 2
    v_and_b32 v28, 1, v25
    v_lshl_or_b32 v28, v28, 1, s60
    v_xor_b32 v28, v28, v27
    v_lshl_add_u32 v5, v28, 4, v26
    s_waitcnt lgkmcnt(0)
    s_lshl_b32 s58, s63, 19
    s_add_u32 s36, s4, s58
    s_addc_u32 s37, s5, 0
    s_mov_b32 s38, 0x80000
    s_mov_b32 s39, 0x20000
    s_mov_b32 s35, 0x20000
    s_or_b32 s58, s2, s56
    s_cmp_lg_u32 s58, 0
    s_cbranch_scc1 P1_NONONCE
    s_or_b32 s30, s30, 1
    s_mov_b32 s32, s26
    s_mov_b32 s33, s27
    s_mov_b32 s34, 256
    v_mov_b32 v30, s30
    v_mov_b32 v31, 0
    s_mov_b64 exec, 1
    buffer_store_dword v30, v31, s[32:35], 0 offen sc1
    s_mov_b64 exec, -1
P1_NONONCE:
    s_add_u32 m0, s76, 0
    s_nop 0
    buffer_load_dwordx4 v3, s[36:39], 0 offen offset:0  lds
    buffer_load_dwordx4 v4, s[36:39], s65 offen offset:1024  lds
    buffer_load_dwordx4 v3, s[36:39], s66 offen offset:2048  lds
    buffer_load_dwordx4 v4, s[36:39], s67 offen offset:3072  lds
    s_add_u32 m0, m0, 4096
    s_nop 0
    buffer_load_dwordx4 v3, s[36:39], s68 offen offset:0  lds
    buffer_load_dwordx4 v4, s[36:39], s69 offen offset:1024  lds
    buffer_load_dwordx4 v3, s[36:39], s70 offen offset:2048  lds
    buffer_load_dwordx4 v4, s[36:39], s71 offen offset:3072  lds
    s_lshr_b32 s58, s64, 2
    s_and_b32 s59, s64, 3
    s_mul_i32 s60, s58, 896
    s_lshl_b32 s61, s59, 8
    s_add_u32 s60, s60, s61
    s_add_u32 s40, s16, s60
    s_addc_u32 s41, s17, 0
    s_sub_u32 s42, 7340032, s60
    s_mov_b32 s43, 0x20000
    s_mov_b32 s47, 0x20000
    s_mov_b32 s55, 0x20000
    s_mov_b32 s72, 229376
    s_cmp_eq_u32 s59, 3
    s_cbranch_scc1 P1_SRDB
    s_add_u32 s52, s40, 27648
    s_addc_u32 s53, s41, 0
    s_sub_u32 s54, s42, 27648
    s_add_u32 s44, s18, s60
    s_addc_u32 s45, s19, 0
    s_mov_b32 s46, s42
    v_mov_b32 v5, v6
    s_branch P1_SRDD
P1_SRDB:
    s_add_u32 s52, s18, s60
    s_addc_u32 s53, s19, 0
    s_sub_u32 s52, s52, 1024
    s_subb_u32 s53, s53, 0
    s_add_u32 s54, s42, 1024
    s_lshl_b32 s58, s58, 8
    s_add_u32 s44, s6, s58
    s_addc_u32 s45, s7, 0
    s_sub_u32 s46, 2097152, s58
P1_SRDD:
    s_lshl_b32 s73, s15, 2
    s_sub_u32 s73, s73, 1024
    s_lshl_b32 s74, s15, 5
    s_add_u32 s75, s74, s73
    s_lshl_b32 s15, s15, 6
    s_add_u32 m0, s77, 0
    s_nop 0
    buffer_load_dwordx4 v5, s[40:43], 0 offen  lds
    buffer_load_dwordx4 v5, s[52:55], 0 offen offset:1024  lds
    s_add_u32 m0, m0, 40960
    s_nop 0
    buffer_load_dwordx4 v6, s[44:47], 0 offen  lds
    buffer_load_dwordx4 v6, s[44:47], s73 offen offset:1024  lds
    s_add_u32 m0, s77, 8192
    s_nop 0
    buffer_load_dwordx4 v5, s[40:43], s72 offen  lds
    buffer_load_dwordx4 v5, s[52:55], s72 offen offset:1024  lds
    s_add_u32 m0, m0, 40960
    s_nop 0
    buffer_load_dwordx4 v6, s[44:47], s74 offen  lds
    buffer_load_dwordx4 v6, s[44:47], s75 offen offset:1024  lds
    v_add_u32 v3, 0x80, v3
    v_add_u32 v4, 0x80, v4
    v_add_u32 v5, 458752, v5
    v_add_u32 v6, s15, v6
    s_bfe_u32 s58, s64, 0x10001
    s_and_b32 s59, s56, 1
    s_bitcmp1_b32 s64, 0
    s_cselect_b32 s48, s10, s8
    s_cselect_b32 s49, s11, s9
    s_cselect_b32 s3, s59, s58
    s_cselect_b32 s31, s58, s59
    s_mov_b32 s50, 65536
    s_mov_b32 s51, 0x20000
    s_and_b32 s9, s64, 3
    s_cmp_eq_u32 s9, 3
    s_cselect_b32 s9, 1, 0
    v_lshrrev_b32 v26, 5, v1
    v_lshlrev_b32 v26, 1, v26
    v_xor_b32 v26, v26, v1
    v_lshlrev_b32 v26, 4, v26
    s_lshr_b32 s60, s56, 1
    s_lshl_b32 s58, s60, 15
    s_lshl_b32 s59, s59, 11
    s_add_u32 s58, s58, s59
    v_add_u32 v7, s58, v26
    s_lshr_b32 s58, s64, 2
    s_lshl_b32 s58, s58, 1
    s_add_u32 s58, s58, s3
    s_lshl_b32 s58, s58, 15
    s_lshl_b32 s60, s60, 10
    s_add_u32 s58, s58, s60
    v_and_b32 v26, 15, v1
    v_lshlrev_b32 v26, 11, v26
    v_lshl_add_u32 v26, v25, 4, v26
    v_add_u32 v8, s58, v26
    s_add_u32 m0, s78, 0
    s_nop 0
    buffer_load_dwordx4 v7, s[48:51], 0 offen lds
    buffer_load_dwordx4 v7, s[48:51], 0 offen offset:1024 lds
    buffer_load_dwordx4 a[180:183], v8, s[36:39], 0 offen offset:0
    buffer_load_dwordx4 a[184:187], v8, s[36:39], 0 offen offset:64
    v_add_u32 v7, 4096, v7
    v_add_u32 v8, 128, v8
    s_mov_b32 s32, s28
    s_mov_b32 s33, s29
    s_mov_b32 s34, 80740352
    v_and_b32 v24, 15, v1
    v_lshrrev_b32 v26, 1, v24
    v_xor_b32 v26, v26, v25
    v_lshlrev_b32 v26, 4, v26
    v_lshl_add_u32 v26, v24, 7, v26
    s_lshr_b32 s58, s56, 1
    s_lshl_b32 s59, s58, 14
    v_add_u32 v9, s59, v26
    v_xor_b32 v10, 64, v9
    v_bfe_u32 v24, v1, 2, 2
    v_lshl_add_u32 v26, v25, 3, v24
    v_and_b32 v27, 1, v25
    v_lshl_or_b32 v29, v27, 2, v24
    v_and_b32 v28, 3, v1
    v_lshlrev_b32 v28, 3, v28
    v_lshl_add_u32 v30, v26, 8, v28
    v_add_u32 v30, 106496, v30
    s_and_b32 s58, s56, 1
    s_lshl_b32 s59, s58, 2
    s_add_u32 s60, s59, 0
    v_xor_b32 v31, s60, v29
    v_lshl_add_u32 v19, v31, 5, v30
    s_add_u32 s60, s59, 1
    v_xor_b32 v31, s60, v29
    v_lshl_add_u32 v20, v31, 5, v30
    s_add_u32 s60, s59, 2
    v_xor_b32 v31, s60, v29
    v_lshl_add_u32 v21, v31, 5, v30
    s_add_u32 s60, s59, 3
    v_xor_b32 v31, s60, v29
    v_lshl_add_u32 v22, v31, 5, v30
    v_lshl_add_u32 v26, v26, 6, v28
    v_xor_b32 v31, s31, v27
    v_lshl_add_u32 v31, v31, 5, v26
    s_lshr_b32 s60, s56, 1
    s_lshl_b32 s60, s60, 12
    s_add_u32 s60, s60, 147456
    v_add_u32 v23, s60, v31
    s_mov_b32 s30, 16384
    s_cmp_eq_u32 s9, 1
    s_cbranch_scc1 P1_ADB
    v_subrev_u32 v11, 40960, v19
    v_subrev_u32 v12, 39936, v19
    v_subrev_u32 v13, 40960, v20
    v_subrev_u32 v14, 39936, v20
    v_subrev_u32 v15, 40960, v21
    v_subrev_u32 v16, 39936, v21
    v_subrev_u32 v17, 40960, v22
    v_subrev_u32 v18, 39936, v22
    s_branch P1_ADD
P1_ADB:
    v_lshl_add_u32 v28, v25, 11, v28
    v_lshl_add_u32 v28, v24, 7, v28
    v_add_u32 v28, 65536, v28
    v_lshrrev_b32 v24, 1, v24
    v_lshl_or_b32 v24, v27, 1, v24
    s_lshl_b32 s59, s58, 1
    s_add_u32 s60, s59, 0
    v_xor_b32 v31, s60, v24
    v_lshl_add_u32 v11, v31, 5, v28
    v_add_u32 v12, 512, v11
    v_add_u32 v15, 1024, v11
    v_add_u32 v16, 1536, v11
    s_add_u32 s60, s59, 1
    v_xor_b32 v31, s60, v24
    v_lshl_add_u32 v13, v31, 5, v28
    v_add_u32 v14, 512, v13
    v_add_u32 v17, 1024, v13
    v_add_u32 v18, 1536, v13
P1_ADD:
    s_bitcmp1_b32 s64, 0
    s_cbranch_scc1 P1_KVAV
    v_bfe_u32 v26, v1, 3, 1
    v_lshlrev_b32 v26, 4, v26
    v_and_b32 v27, 7, v1
    v_add_u32 v26, v26, v27
    v_bfe_u32 v27, v1, 4, 1
    v_lshl_add_u32 v26, v27, 5, v26
    v_lshlrev_b32 v26, 4, v26
    v_lshrrev_b32 v27, 5, v1
    v_lshl_add_u32 v26, v27, 10, v26
    s_lshl_b32 s10, s3, 7
    s_lshl_b32 s11, s31, 3
P1_KVAD:
    s_add_u32 s10, s10, s11
    s_add_u32 s10, s10, 147456
    v_add_u32 v26, s10, v26
    s_lshl_b32 s60, s2, 2
    s_add_u32 s60, s60, s56
    s_mul_i32 s61, s60, 7
    v_lshrrev_b32 v24, 3, v1
    v_and_b32 v25, 7, v1
    v_lshlrev_b32 v25, 4, v25
    v_add_u32 v27, s61, v24
    v_and_b32 v31, 1, v27
    v_lshrrev_b32 v27, 1, v27
    v_lshl_add_u32 v29, v27, 8, v25
    v_mul_u32_u24 v30, 1179648, v31
    v_add_u32 v29, v29, v30
    v_add_u32 v29, 28311552, v29
    v_lshl_add_u32 v27, v27, 11, v25
    v_lshl_add_u32 v27, v31, 10, v27
    v_cmp_gt_u32 vcc, 56, v1
    v_mov_b32 v31, 1073741824
    v_add_u32 v27, 384, v27
    v_cndmask_b32 v27, v31, v27, vcc
    v_cndmask_b32 v29, v31, v29, vcc
    v_mul_u32_u24 v30, 1179648, v24
    v_add_u32 v30, v30, v25
    s_lshl_b32 s61, s60, 8
    s_add_u32 s61, s61, 29229056
    v_add_u32 v30, s61, v30
    v_lshl_add_u32 v28, v24, 10, v25
    s_lshl_b32 s61, s60, 11
    s_add_u32 s61, s61, 384
    v_cmp_gt_u32 vcc, 16, v1
    v_add_u32 v28, s61, v28
    s_nop 0
    v_cndmask_b32 v28, v31, v28, vcc
    v_cndmask_b32 v30, v31, v30, vcc
    s_add_u32 m0, s76, 32768
    v_mov_b32 v32, 0
    v_mov_b32 v33, 0
    v_mov_b32 v34, 0
    v_mov_b32 v35, 0
    v_mov_b32 v36, 0
    v_mov_b32 v37, 0
    v_mov_b32 v38, 0
    v_mov_b32 v39, 0
    v_mov_b32 v40, 0
    v_mov_b32 v41, 0
    v_mov_b32 v42, 0
    v_mov_b32 v43, 0
    v_mov_b32 v44, 0
    v_mov_b32 v45, 0
    buffer_load_dwordx4 v3, s[36:39], 0 offen offset:0  lds
    v_mov_b32 v46, 0
    v_mov_b32 v47, 0
    v_mov_b32 v48, 0
    v_mov_b32 v49, 0
    v_mov_b32 v50, 0
    v_mov_b32 v51, 0
    v_mov_b32 v52, 0
    v_mov_b32 v53, 0
    v_mov_b32 v54, 0
    v_mov_b32 v55, 0
    v_mov_b32 v56, 0
    v_mov_b32 v57, 0
    v_mov_b32 v58, 0
    v_mov_b32 v59, 0
    buffer_load_dwordx4 v4, s[36:39], s65 offen offset:1024  lds
    v_mov_b32 v60, 0
    v_mov_b32 v61, 0
    v_mov_b32 v62, 0
    v_mov_b32 v63, 0
    v_mov_b32 v64, 0
    v_mov_b32 v65, 0
    v_mov_b32 v66, 0
    v_mov_b32 v67, 0
    v_mov_b32 v68, 0
    v_mov_b32 v69, 0
    v_mov_b32 v70, 0
    v_mov_b32 v71, 0
    v_mov_b32 v72, 0
    v_mov_b32 v73, 0
    buffer_load_dwordx4 v3, s[36:39], s66 offen offset:2048  lds
    v_mov_b32 v74, 0
    v_mov_b32 v75, 0
    v_mov_b32 v76, 0
    v_mov_b32 v77, 0
    v_mov_b32 v78, 0
    v_mov_b32 v79, 0
    v_mov_b32 v80, 0
    v_mov_b32 v81, 0
    v_mov_b32 v82, 0
    v_mov_b32 v83, 0
    v_mov_b32 v84, 0
    v_mov_b32 v85, 0
    v_mov_b32 v86, 0
    v_mov_b32 v87, 0
    buffer_load_dwordx4 v4, s[36:39], s67 offen offset:3072  lds
    s_add_u32 m0, m0, 4096
    v_mov_b32 v88, 0
    v_mov_b32 v89, 0
    v_mov_b32 v90, 0
    v_mov_b32 v91, 0
    v_mov_b32 v92, 0
    v_mov_b32 v93, 0
    v_mov_b32 v94, 0
    v_mov_b32 v95, 0
    v_mov_b32 v96, 0
    v_mov_b32 v97, 0
    v_mov_b32 v98, 0
    v_mov_b32 v99, 0
    v_mov_b32 v100, 0
    v_mov_b32 v101, 0
    buffer_load_dwordx4 v3, s[36:39], s68 offen offset:0  lds
    v_mov_b32 v102, 0
    v_mov_b32 v103, 0
    v_mov_b32 v104, 0
    v_mov_b32 v105, 0
    v_mov_b32 v106, 0
    v_mov_b32 v107, 0
    v_mov_b32 v108, 0
    v_mov_b32 v109, 0
    v_mov_b32 v110, 0
    v_mov_b32 v111, 0
    v_mov_b32 v112, 0
    v_mov_b32 v113, 0
    v_mov_b32 v114, 0
    v_mov_b32 v115, 0
    buffer_load_dwordx4 v4, s[36:39], s69 offen offset:1024  lds
    v_mov_b32 v116, 0
    v_mov_b32 v117, 0
    v_mov_b32 v118, 0
    v_mov_b32 v119, 0
    v_mov_b32 v120, 0
    v_mov_b32 v121, 0
    v_mov_b32 v122, 0
    v_mov_b32 v123, 0
    v_mov_b32 v124, 0
    v_mov_b32 v125, 0
    v_mov_b32 v126, 0
    v_mov_b32 v127, 0
    v_mov_b32 v128, 0
    v_mov_b32 v129, 0
    buffer_load_dwordx4 v3, s[36:39], s70 offen offset:2048  lds
    v_mov_b32 v130, 0
    v_mov_b32 v131, 0
    v_mov_b32 v132, 0
    v_mov_b32 v133, 0
    v_mov_b32 v134, 0
    v_mov_b32 v135, 0
    v_mov_b32 v136, 0
    v_mov_b32 v137, 0
    v_mov_b32 v138, 0
    v_mov_b32 v139, 0
    v_mov_b32 v140, 0
    v_mov_b32 v141, 0
    v_mov_b32 v142, 0
    v_mov_b32 v143, 0
    buffer_load_dwordx4 v4, s[36:39], s71 offen offset:3072  lds
    s_add_u32 m0, s77, 16384
    v_mov_b32 v144, 0
    v_mov_b32 v145, 0
    v_mov_b32 v146, 0
    v_mov_b32 v147, 0
    v_mov_b32 v148, 0
    v_mov_b32 v149, 0
    v_mov_b32 v150, 0
    v_mov_b32 v151, 0
    v_mov_b32 v152, 0
    v_mov_b32 v153, 0
    v_mov_b32 v154, 0
    v_mov_b32 v155, 0
    v_mov_b32 v156, 0
    v_mov_b32 v157, 0
    buffer_load_dwordx4 v5, s[40:43], 0 offen  lds
    v_mov_b32 v158, 0
    v_mov_b32 v159, 0
    v_mov_b32 v160, 0
    v_mov_b32 v161, 0
    v_mov_b32 v162, 0
    v_mov_b32 v163, 0
    v_mov_b32 v164, 0
    v_mov_b32 v165, 0
    v_mov_b32 v166, 0
    v_mov_b32 v167, 0
    v_mov_b32 v168, 0
    v_mov_b32 v169, 0
    v_mov_b32 v170, 0
    v_mov_b32 v171, 0
    buffer_load_dwordx4 v5, s[52:55], 0 offen offset:1024  lds
    s_add_u32 m0, m0, 40960
    v_mov_b32 v172, 0
    v_mov_b32 v173, 0
    v_mov_b32 v174, 0
    v_mov_b32 v175, 0
    v_mov_b32 v176, 0
    v_mov_b32 v177, 0
    v_mov_b32 v178, 0
    v_mov_b32 v179, 0
    v_mov_b32 v180, 0
    v_mov_b32 v181, 0
    v_mov_b32 v182, 0
    v_mov_b32 v183, 0
    v_mov_b32 v184, 0
    v_mov_b32 v185, 0
    buffer_load_dwordx4 v6, s[44:47], 0 offen  lds
    v_mov_b32 v186, 0
    v_mov_b32 v187, 0
    v_mov_b32 v188, 0
    v_mov_b32 v189, 0
    v_mov_b32 v190, 0
    v_mov_b32 v191, 0
    v_mov_b32 v192, 0
    v_mov_b32 v193, 0
    v_mov_b32 v194, 0
    v_mov_b32 v195, 0
    v_mov_b32 v196, 0
    v_mov_b32 v197, 0
    v_mov_b32 v198, 0
    v_mov_b32 v199, 0
    buffer_load_dwordx4 v6, s[44:47], s73 offen offset:1024  lds
    s_add_u32 m0, s78, 8192
    v_mov_b32 v200, 0
    v_mov_b32 v201, 0
    v_mov_b32 v202, 0
    v_mov_b32 v203, 0
    v_mov_b32 v204, 0
    v_mov_b32 v205, 0
    v_mov_b32 v206, 0
    v_mov_b32 v207, 0
    v_mov_b32 v208, 0
    v_mov_b32 v209, 0
    v_mov_b32 v210, 0
    v_mov_b32 v211, 0
    v_mov_b32 v212, 0
    v_mov_b32 v213, 0
    buffer_load_dwordx4 v7, s[48:51], 0 offen lds
    v_mov_b32 v214, 0
    v_mov_b32 v215, 0
    v_mov_b32 v216, 0
    v_mov_b32 v217, 0
    v_mov_b32 v218, 0
    v_mov_b32 v219, 0
    v_mov_b32 v220, 0
    v_mov_b32 v221, 0
    v_mov_b32 v222, 0
    v_mov_b32 v223, 0
    v_mov_b32 v224, 0
    v_mov_b32 v225, 0
    v_mov_b32 v226, 0
    v_mov_b32 v227, 0
    buffer_load_dwordx4 v7, s[48:51], 0 offen offset:1024 lds
    s_add_u32 m0, s77, 24576
    v_mov_b32 v228, 0
    v_mov_b32 v229, 0
    v_mov_b32 v230, 0
    v_mov_b32 v231, 0
    v_mov_b32 v232, 0
    v_mov_b32 v233, 0
    v_mov_b32 v234, 0
    v_mov_b32 v235, 0
    v_mov_b32 v236, 0
    v_mov_b32 v237, 0
    v_mov_b32 v238, 0
    v_mov_b32 v239, 0
    v_mov_b32 v240, 0
    v_mov_b32 v241, 0
    buffer_load_dwordx4 v5, s[40:43], s72 offen  lds
    v_mov_b32 v242, 0
    v_mov_b32 v243, 0
    v_mov_b32 v244, 0
    v_mov_b32 v245, 0
    v_mov_b32 v246, 0
    v_mov_b32 v247, 0
    v_mov_b32 v248, 0
    v_mov_b32 v249, 0
    v_mov_b32 v250, 0
    v_mov_b32 v251, 0
    v_mov_b32 v252, 0
    v_mov_b32 v253, 0
    v_mov_b32 v254, 0
    v_mov_b32 v255, 0
    buffer_load_dwordx4 v5, s[52:55], s72 offen offset:1024  lds
    s_add_u32 m0, m0, 40960
    v_accvgpr_write_b32 a148, 0
    v_accvgpr_write_b32 a149, 0
    v_accvgpr_write_b32 a150, 0
    v_accvgpr_write_b32 a151, 0
    v_accvgpr_write_b32 a152, 0
    v_accvgpr_write_b32 a153, 0
    v_accvgpr_write_b32 a154, 0
    v_accvgpr_write_b32 a155, 0
    v_accvgpr_write_b32 a156, 0
    v_accvgpr_write_b32 a157, 0
    v_accvgpr_write_b32 a158, 0
    v_accvgpr_write_b32 a159, 0
    v_accvgpr_write_b32 a160, 0
    v_accvgpr_write_b32 a161, 0
    buffer_load_dwordx4 v6, s[44:47], s74 offen  lds
    v_accvgpr_write_b32 a162, 0
    v_accvgpr_write_b32 a163, 0
    v_accvgpr_write_b32 a164, 0
    v_accvgpr_write_b32 a165, 0
    v_accvgpr_write_b32 a166, 0
    v_accvgpr_write_b32 a167, 0
    v_accvgpr_write_b32 a168, 0
    v_accvgpr_write_b32 a169, 0
    v_accvgpr_write_b32 a170, 0
    v_accvgpr_write_b32 a171, 0
    v_accvgpr_write_b32 a172, 0
    v_accvgpr_write_b32 a173, 0
    v_accvgpr_write_b32 a174, 0
    v_accvgpr_write_b32 a175, 0
    buffer_load_dwordx4 v6, s[44:47], s75 offen offset:1024  lds
    v_accvgpr_write_b32 a176, 0
    v_accvgpr_write_b32 a177, 0
    v_accvgpr_write_b32 a178, 0
    v_accvgpr_write_b32 a179, 0
    v_accvgpr_write_b32 a144, 0
    v_accvgpr_write_b32 a145, 0
    v_accvgpr_write_b32 a146, 0
    v_accvgpr_write_b32 a147, 0
    v_add_u32 v3, 0x80, v3
    v_add_u32 v4, 0x80, v4
    v_add_u32 v5, 458752, v5
    v_add_u32 v6, s15, v6
    v_add_u32 v7, 4096, v7
    s_waitcnt vmcnt(18) lgkmcnt(0)
    s_barrier
    ds_read_b128 a[32:35], v9 offset:0
    ds_read_b128 a[36:39], v9 offset:2048
    ds_read_b128 a[40:43], v9 offset:4096
    ds_read_b128 a[44:47], v9 offset:6144
    ds_read_b128 a[48:51], v9 offset:8192
    ds_read_b128 a[52:55], v9 offset:10240
    ds_read_b128 a[56:59], v9 offset:12288
    ds_read_b128 a[60:63], v9 offset:14336
    ds_read_b64_tr_b16 a[0:1], v11 offset:0
    ds_read_b64_tr_b16 a[2:3], v12 offset:0
    ds_read_b64_tr_b16 a[4:5], v13 offset:0
    ds_read_b64_tr_b16 a[6:7], v14 offset:0
    ds_read_b64_tr_b16 a[8:9], v15 offset:0
    ds_read_b64_tr_b16 a[10:11], v16 offset:0
    ds_read_b64_tr_b16 a[12:13], v17 offset:0
    ds_read_b64_tr_b16 a[14:15], v18 offset:0
    ds_read_b64_tr_b16 a[16:17], v19 offset:0
    ds_read_b64_tr_b16 a[18:19], v19 offset:1024
    ds_read_b64_tr_b16 a[20:21], v20 offset:0
    ds_read_b64_tr_b16 a[22:23], v20 offset:1024
    ds_read_b64_tr_b16 a[24:25], v21 offset:0
    ds_read_b64_tr_b16 a[26:27], v21 offset:1024
    ds_read_b64_tr_b16 a[28:29], v22 offset:0
    ds_read_b64_tr_b16 a[30:31], v22 offset:1024
    ds_read_b64_tr_b16 a[128:129], v23 offset:0
    ds_read_b64_tr_b16 a[130:131], v23 offset:256
    s_waitcnt lgkmcnt(0)
    s_barrier
    v_mfma_f32_16x16x32_bf16 v[32:35], a[0:3], a[32:35], v[32:35]
    ds_read_b128 a[96:99], v10 offset:0
    v_mfma_f32_16x16x32_bf16 v[36:39], a[0:3], a[36:39], v[36:39]
    buffer_load_dwordx4 a[188:191], v8, s[36:39], 0 offen offset:0
    v_mfma_f32_16x16x32_bf16 v[40:43], a[0:3], a[40:43], v[40:43]
    ds_read_b128 a[100:103], v10 offset:2048
    v_mfma_f32_16x16x32_bf16 v[44:47], a[0:3], a[44:47], v[44:47]
    v_mfma_f32_16x16x32_bf16 v[48:51], a[0:3], a[48:51], v[48:51]
    ds_read_b128 a[104:107], v10 offset:4096
    global_load_dword a253, v0, s[100:101]
    v_add_u32 v0, 0x2000, v0
    v_mfma_f32_16x16x32_bf16 v[52:55], a[0:3], a[52:55], v[52:55]
    v_mfma_f32_16x16x32_bf16 v[56:59], a[0:3], a[56:59], v[56:59]
    ds_read_b128 a[108:111], v10 offset:6144
    v_mfma_f32_16x16x32_bf16 v[60:63], a[0:3], a[60:63], v[60:63]
    buffer_load_dwordx4 a[192:195], v8, s[36:39], 0 offen offset:64
    v_mfma_f32_16x16x32_bf16 v[92:95], a[4:7], a[60:63], v[92:95]
    ds_read_b128 a[112:115], v10 offset:8192
    v_mfma_f32_16x16x32_bf16 v[88:91], a[4:7], a[56:59], v[88:91]
    v_add_u32 v8, 128, v8
    v_mfma_f32_16x16x32_bf16 v[84:87], a[4:7], a[52:55], v[84:87]
    ds_read_b128 a[116:119], v10 offset:10240
    v_mfma_f32_16x16x32_bf16 v[80:83], a[4:7], a[48:51], v[80:83]
    v_mfma_f32_16x16x32_bf16 v[76:79], a[4:7], a[44:47], v[76:79]
    ds_read_b128 a[120:123], v10 offset:12288
    s_add_u32 m0, s77, 32768
    v_mfma_f32_16x16x32_bf16 v[72:75], a[4:7], a[40:43], v[72:75]
    buffer_load_dwordx4 v5, s[40:43], 0 offen  lds
    v_mfma_f32_16x16x32_bf16 v[68:71], a[4:7], a[36:39], v[68:71]
    ds_read_b128 a[124:127], v10 offset:14336
    v_mfma_f32_16x16x32_bf16 v[64:67], a[4:7], a[32:35], v[64:67]
    v_mfma_f32_16x16x32_bf16 v[96:99], a[8:11], a[32:35], v[96:99]
    ds_read_b64_tr_b16 a[64:65], v11 offset:8192
    v_mfma_f32_16x16x32_bf16 v[100:103], a[8:11], a[36:39], v[100:103]
    v_mfma_f32_16x16x32_bf16 v[104:107], a[8:11], a[40:43], v[104:107]
    ds_read_b64_tr_b16 a[66:67], v12 offset:8192
    v_mfma_f32_16x16x32_bf16 v[108:111], a[8:11], a[44:47], v[108:111]
    buffer_load_dwordx4 v5, s[52:55], 0 offen offset:1024  lds
    v_mfma_f32_16x16x32_bf16 v[112:115], a[8:11], a[48:51], v[112:115]
    ds_read_b64_tr_b16 a[68:69], v13 offset:8192
    v_mfma_f32_16x16x32_bf16 v[116:119], a[8:11], a[52:55], v[116:119]
    v_mfma_f32_16x16x32_bf16 v[120:123], a[8:11], a[56:59], v[120:123]
    ds_read_b64_tr_b16 a[70:71], v14 offset:8192
    v_mfma_f32_16x16x32_bf16 v[124:127], a[8:11], a[60:63], v[124:127]
    v_mfma_f32_16x16x32_bf16 v[156:159], a[12:15], a[60:63], v[156:159]
    ds_read_b64_tr_b16 a[72:73], v15 offset:8192
    s_add_u32 m0, m0, 40960
    v_mfma_f32_16x16x32_bf16 v[152:155], a[12:15], a[56:59], v[152:155]
    buffer_load_dwordx4 v6, s[44:47], 0 offen  lds
    v_mfma_f32_16x16x32_bf16 v[148:151], a[12:15], a[52:55], v[148:151]
    ds_read_b64_tr_b16 a[74:75], v16 offset:8192
    v_mfma_f32_16x16x32_bf16 v[144:147], a[12:15], a[48:51], v[144:147]
    v_mfma_f32_16x16x32_bf16 v[140:143], a[12:15], a[44:47], v[140:143]
    ds_read_b64_tr_b16 a[76:77], v17 offset:8192
    v_mfma_f32_16x16x32_bf16 v[136:139], a[12:15], a[40:43], v[136:139]
    v_mfma_f32_16x16x32_bf16 v[132:135], a[12:15], a[36:39], v[132:135]
    ds_read_b64_tr_b16 a[78:79], v18 offset:8192
    v_mfma_f32_16x16x32_bf16 v[128:131], a[12:15], a[32:35], v[128:131]
    buffer_load_dwordx4 v6, s[44:47], s73 offen offset:1024  lds
    v_mfma_f32_16x16x32_bf16 a[144:147], a[128:131], a[180:183], a[144:147]
    ds_read_b64_tr_b16 a[80:81], v19 offset:8192
    v_mfma_f32_16x16x32_bf16 v[160:163], a[16:19], a[32:35], v[160:163]
    v_mfma_f32_16x16x32_bf16 v[164:167], a[16:19], a[36:39], v[164:167]
    ds_read_b64_tr_b16 a[82:83], v19 offset:9216
    v_mfma_f32_16x16x32_bf16 v[168:171], a[16:19], a[40:43], v[168:171]
    v_mfma_f32_16x16x32_bf16 v[172:175], a[16:19], a[44:47], v[172:175]
    ds_read_b64_tr_b16 a[84:85], v20 offset:8192
    s_add_u32 m0, s77, 0
    v_mfma_f32_16x16x32_bf16 v[176:179], a[16:19], a[48:51], v[176:179]
    buffer_load_dwordx4 v5, s[40:43], s72 offen  lds
    v_mfma_f32_16x16x32_bf16 v[180:183], a[16:19], a[52:55], v[180:183]
    ds_read_b64_tr_b16 a[86:87], v20 offset:9216
    v_mfma_f32_16x16x32_bf16 v[184:187], a[16:19], a[56:59], v[184:187]
    v_mfma_f32_16x16x32_bf16 v[188:191], a[16:19], a[60:63], v[188:191]
    ds_read_b64_tr_b16 a[88:89], v21 offset:8192
    v_mfma_f32_16x16x32_bf16 v[220:223], a[20:23], a[60:63], v[220:223]
    v_mfma_f32_16x16x32_bf16 v[216:219], a[20:23], a[56:59], v[216:219]
    ds_read_b64_tr_b16 a[90:91], v21 offset:9216
    v_mfma_f32_16x16x32_bf16 v[212:215], a[20:23], a[52:55], v[212:215]
    buffer_load_dwordx4 v5, s[52:55], s72 offen offset:1024  lds
    v_mfma_f32_16x16x32_bf16 v[208:211], a[20:23], a[48:51], v[208:211]
    ds_read_b64_tr_b16 a[92:93], v22 offset:8192
    v_mfma_f32_16x16x32_bf16 v[204:207], a[20:23], a[44:47], v[204:207]
    v_mfma_f32_16x16x32_bf16 v[200:203], a[20:23], a[40:43], v[200:203]
    ds_read_b64_tr_b16 a[94:95], v22 offset:9216
    v_mfma_f32_16x16x32_bf16 v[196:199], a[20:23], a[36:39], v[196:199]
    v_mfma_f32_16x16x32_bf16 v[192:195], a[20:23], a[32:35], v[192:195]
    ds_read_b64_tr_b16 a[132:133], v23 offset:2048
    s_add_u32 m0, m0, 40960
    v_mfma_f32_16x16x32_bf16 v[224:227], a[24:27], a[32:35], v[224:227]
    buffer_load_dwordx4 v6, s[44:47], s74 offen  lds
    v_mfma_f32_16x16x32_bf16 v[228:231], a[24:27], a[36:39], v[228:231]
    ds_read_b64_tr_b16 a[134:135], v23 offset:2304
    v_mfma_f32_16x16x32_bf16 v[232:235], a[24:27], a[40:43], v[232:235]
    v_mfma_f32_16x16x32_bf16 v[236:239], a[24:27], a[44:47], v[236:239]
    v_mfma_f32_16x16x32_bf16 v[240:243], a[24:27], a[48:51], v[240:243]
    v_mfma_f32_16x16x32_bf16 v[244:247], a[24:27], a[52:55], v[244:247]
    v_mfma_f32_16x16x32_bf16 v[248:251], a[24:27], a[56:59], v[248:251]
    buffer_load_dwordx4 v6, s[44:47], s75 offen offset:1024  lds
    v_mfma_f32_16x16x32_bf16 v[252:255], a[24:27], a[60:63], v[252:255]
    v_mfma_f32_16x16x32_bf16 a[176:179], a[28:31], a[60:63], a[176:179]
    v_add_u32 v5, 0xe0000, v5
    v_mfma_f32_16x16x32_bf16 a[172:175], a[28:31], a[56:59], a[172:175]
    s_mul_i32 s61, s15, 2
    v_add_u32 v6, s61, v6
    v_mfma_f32_16x16x32_bf16 a[168:171], a[28:31], a[52:55], a[168:171]
    v_mfma_f32_16x16x32_bf16 a[164:167], a[28:31], a[48:51], a[164:167]
    v_mfma_f32_16x16x32_bf16 a[160:163], a[28:31], a[44:47], a[160:163]
    s_waitcnt vmcnt(15) lgkmcnt(0)
    s_barrier
    v_mfma_f32_16x16x32_bf16 a[156:159], a[28:31], a[40:43], a[156:159]
    v_mfma_f32_16x16x32_bf16 a[152:155], a[28:31], a[36:39], a[152:155]
    v_mfma_f32_16x16x32_bf16 a[148:151], a[28:31], a[32:35], a[148:151]
    v_mfma_f32_16x16x32_bf16 v[32:35], a[64:67], a[96:99], v[32:35]
    ds_read_b128 a[32:35], v9 offset:32768
    s_add_u32 m0, s78, 0
    v_mfma_f32_16x16x32_bf16 v[36:39], a[64:67], a[100:103], v[36:39]
    buffer_load_dwordx4 v7, s[48:51], 0 offen lds
    v_mfma_f32_16x16x32_bf16 v[40:43], a[64:67], a[104:107], v[40:43]
    ds_read_b128 a[36:39], v9 offset:34816
    v_mfma_f32_16x16x32_bf16 v[44:47], a[64:67], a[108:111], v[44:47]
    v_mfma_f32_16x16x32_bf16 v[48:51], a[64:67], a[112:115], v[48:51]
    ds_read_b128 a[40:43], v9 offset:36864
    v_mfma_f32_16x16x32_bf16 v[52:55], a[64:67], a[116:119], v[52:55]
    v_mfma_f32_16x16x32_bf16 v[56:59], a[64:67], a[120:123], v[56:59]
    ds_read_b128 a[44:47], v9 offset:38912
    v_mfma_f32_16x16x32_bf16 v[60:63], a[64:67], a[124:127], v[60:63]
    buffer_load_dwordx4 v7, s[48:51], 0 offen offset:1024 lds
    v_mfma_f32_16x16x32_bf16 v[92:95], a[68:71], a[124:127], v[92:95]
    ds_read_b128 a[48:51], v9 offset:40960
    v_mfma_f32_16x16x32_bf16 v[88:91], a[68:71], a[120:123], v[88:91]
    v_add_u32 v7, 4096, v7
    v_mfma_f32_16x16x32_bf16 v[84:87], a[68:71], a[116:119], v[84:87]
    ds_read_b128 a[52:55], v9 offset:43008
    v_mfma_f32_16x16x32_bf16 v[80:83], a[68:71], a[112:115], v[80:83]
    v_mfma_f32_16x16x32_bf16 v[76:79], a[68:71], a[108:111], v[76:79]
    ds_read_b128 a[56:59], v9 offset:45056
    s_add_u32 m0, s76, 0
    v_mfma_f32_16x16x32_bf16 v[72:75], a[68:71], a[104:107], v[72:75]
    buffer_load_dwordx4 v3, s[36:39], 0 offen offset:0  lds
    v_mfma_f32_16x16x32_bf16 v[68:71], a[68:71], a[100:103], v[68:71]
    ds_read_b128 a[60:63], v9 offset:47104
    v_mfma_f32_16x16x32_bf16 v[64:67], a[68:71], a[96:99], v[64:67]
    v_mfma_f32_16x16x32_bf16 v[96:99], a[72:75], a[96:99], v[96:99]
    ds_read_b64_tr_b16 a[0:1], v11 offset:16384
    v_mfma_f32_16x16x32_bf16 v[100:103], a[72:75], a[100:103], v[100:103]
    v_mfma_f32_16x16x32_bf16 v[104:107], a[72:75], a[104:107], v[104:107]
    ds_read_b64_tr_b16 a[2:3], v12 offset:16384
    v_mfma_f32_16x16x32_bf16 v[108:111], a[72:75], a[108:111], v[108:111]
    buffer_load_dwordx4 v4, s[36:39], s65 offen offset:1024  lds
    v_mfma_f32_16x16x32_bf16 v[112:115], a[72:75], a[112:115], v[112:115]
    ds_read_b64_tr_b16 a[4:5], v13 offset:16384
    v_mfma_f32_16x16x32_bf16 v[116:119], a[72:75], a[116:119], v[116:119]
    v_mfma_f32_16x16x32_bf16 v[120:123], a[72:75], a[120:123], v[120:123]
    ds_read_b64_tr_b16 a[6:7], v14 offset:16384
    v_mfma_f32_16x16x32_bf16 v[124:127], a[72:75], a[124:127], v[124:127]
    v_mfma_f32_16x16x32_bf16 v[156:159], a[76:79], a[124:127], v[156:159]
    ds_read_b64_tr_b16 a[8:9], v15 offset:16384
    v_mfma_f32_16x16x32_bf16 v[152:155], a[76:79], a[120:123], v[152:155]
    buffer_load_dwordx4 v3, s[36:39], s66 offen offset:2048  lds
    v_mfma_f32_16x16x32_bf16 v[148:151], a[76:79], a[116:119], v[148:151]
    ds_read_b64_tr_b16 a[10:11], v16 offset:16384
    v_mfma_f32_16x16x32_bf16 v[144:147], a[76:79], a[112:115], v[144:147]
    v_mfma_f32_16x16x32_bf16 v[140:143], a[76:79], a[108:111], v[140:143]
    ds_read_b64_tr_b16 a[12:13], v17 offset:16384
    v_mfma_f32_16x16x32_bf16 v[136:139], a[76:79], a[104:107], v[136:139]
    v_mfma_f32_16x16x32_bf16 v[132:135], a[76:79], a[100:103], v[132:135]
    ds_read_b64_tr_b16 a[14:15], v18 offset:16384
    v_mfma_f32_16x16x32_bf16 v[128:131], a[76:79], a[96:99], v[128:131]
    buffer_load_dwordx4 v4, s[36:39], s67 offen offset:3072  lds
    v_mfma_f32_16x16x32_bf16 a[144:147], a[132:135], a[184:187], a[144:147]
    ds_read_b64_tr_b16 a[16:17], v19 offset:16384
    v_mfma_f32_16x16x32_bf16 v[160:163], a[80:83], a[96:99], v[160:163]
    v_mfma_f32_16x16x32_bf16 v[164:167], a[80:83], a[100:103], v[164:167]
    ds_read_b64_tr_b16 a[18:19], v19 offset:17408
    v_mfma_f32_16x16x32_bf16 v[168:171], a[80:83], a[104:107], v[168:171]
    v_mfma_f32_16x16x32_bf16 v[172:175], a[80:83], a[108:111], v[172:175]
    ds_read_b64_tr_b16 a[20:21], v20 offset:16384
    s_add_u32 m0, m0, 4096
    v_mfma_f32_16x16x32_bf16 v[176:179], a[80:83], a[112:115], v[176:179]
    buffer_load_dwordx4 v3, s[36:39], s68 offen offset:0  lds
    v_mfma_f32_16x16x32_bf16 v[180:183], a[80:83], a[116:119], v[180:183]
    ds_read_b64_tr_b16 a[22:23], v20 offset:17408
    v_mfma_f32_16x16x32_bf16 v[184:187], a[80:83], a[120:123], v[184:187]
    v_mfma_f32_16x16x32_bf16 v[188:191], a[80:83], a[124:127], v[188:191]
    ds_read_b64_tr_b16 a[24:25], v21 offset:16384
    v_mfma_f32_16x16x32_bf16 v[220:223], a[84:87], a[124:127], v[220:223]
    v_mfma_f32_16x16x32_bf16 v[216:219], a[84:87], a[120:123], v[216:219]
    ds_read_b64_tr_b16 a[26:27], v21 offset:17408
    v_mfma_f32_16x16x32_bf16 v[212:215], a[84:87], a[116:119], v[212:215]
    buffer_load_dwordx4 v4, s[36:39], s69 offen offset:1024  lds
    v_mfma_f32_16x16x32_bf16 v[208:211], a[84:87], a[112:115], v[208:211]
    ds_read_b64_tr_b16 a[28:29], v22 offset:16384
    v_mfma_f32_16x16x32_bf16 v[204:207], a[84:87], a[108:111], v[204:207]
    v_mfma_f32_16x16x32_bf16 v[200:203], a[84:87], a[104:107], v[200:203]
    ds_read_b64_tr_b16 a[30:31], v22 offset:17408
    v_mfma_f32_16x16x32_bf16 v[196:199], a[84:87], a[100:103], v[196:199]
    v_mfma_f32_16x16x32_bf16 v[192:195], a[84:87], a[96:99], v[192:195]
    ds_read_b64_tr_b16 a[128:129], v23 offset:8192
    v_mfma_f32_16x16x32_bf16 v[224:227], a[88:91], a[96:99], v[224:227]
    buffer_load_dwordx4 v3, s[36:39], s70 offen offset:2048  lds
    v_mfma_f32_16x16x32_bf16 v[228:231], a[88:91], a[100:103], v[228:231]
    ds_read_b64_tr_b16 a[130:131], v23 offset:8448
    v_mfma_f32_16x16x32_bf16 v[232:235], a[88:91], a[104:107], v[232:235]
    v_mfma_f32_16x16x32_bf16 v[236:239], a[88:91], a[108:111], v[236:239]
    v_mfma_f32_16x16x32_bf16 v[240:243], a[88:91], a[112:115], v[240:243]
    v_mfma_f32_16x16x32_bf16 v[244:247], a[88:91], a[116:119], v[244:247]
    v_mfma_f32_16x16x32_bf16 v[248:251], a[88:91], a[120:123], v[248:251]
    buffer_load_dwordx4 v4, s[36:39], s71 offen offset:3072  lds
    v_mfma_f32_16x16x32_bf16 v[252:255], a[88:91], a[124:127], v[252:255]
    v_mfma_f32_16x16x32_bf16 a[176:179], a[92:95], a[124:127], a[176:179]
    v_add_u32 v3, 0x100, v3
    v_mfma_f32_16x16x32_bf16 a[172:175], a[92:95], a[120:123], a[172:175]
    v_mfma_f32_16x16x32_bf16 a[168:171], a[92:95], a[116:119], a[168:171]
    v_add_u32 v4, 0x100, v4
    v_mfma_f32_16x16x32_bf16 a[164:167], a[92:95], a[112:115], a[164:167]
    v_mfma_f32_16x16x32_bf16 a[160:163], a[92:95], a[108:111], a[160:163]
    s_waitcnt vmcnt(18) lgkmcnt(0)
    s_barrier
    v_mfma_f32_16x16x32_bf16 a[156:159], a[92:95], a[104:107], a[156:159]
    v_mfma_f32_16x16x32_bf16 a[152:155], a[92:95], a[100:103], a[152:155]
    v_mfma_f32_16x16x32_bf16 a[148:151], a[92:95], a[96:99], a[148:151]
    v_mfma_f32_16x16x32_bf16 v[32:35], a[0:3], a[32:35], v[32:35]
    ds_read_b128 a[96:99], v10 offset:32768
    v_mfma_f32_16x16x32_bf16 v[36:39], a[0:3], a[36:39], v[36:39]
    buffer_load_dwordx4 a[180:183], v8, s[36:39], 0 offen offset:0
    v_mfma_f32_16x16x32_bf16 v[40:43], a[0:3], a[40:43], v[40:43]
    ds_read_b128 a[100:103], v10 offset:34816
    v_mfma_f32_16x16x32_bf16 v[44:47], a[0:3], a[44:47], v[44:47]
    v_mfma_f32_16x16x32_bf16 v[48:51], a[0:3], a[48:51], v[48:51]
    ds_read_b128 a[104:107], v10 offset:36864
    v_mfma_f32_16x16x32_bf16 v[52:55], a[0:3], a[52:55], v[52:55]
    v_mfma_f32_16x16x32_bf16 v[56:59], a[0:3], a[56:59], v[56:59]
    ds_read_b128 a[108:111], v10 offset:38912
    v_mfma_f32_16x16x32_bf16 v[60:63], a[0:3], a[60:63], v[60:63]
    buffer_load_dwordx4 a[184:187], v8, s[36:39], 0 offen offset:64
    v_mfma_f32_16x16x32_bf16 v[92:95], a[4:7], a[60:63], v[92:95]
    ds_read_b128 a[112:115], v10 offset:40960
    v_mfma_f32_16x16x32_bf16 v[88:91], a[4:7], a[56:59], v[88:91]
    v_add_u32 v8, 128, v8
    v_mfma_f32_16x16x32_bf16 v[84:87], a[4:7], a[52:55], v[84:87]
    ds_read_b128 a[116:119], v10 offset:43008
    v_mfma_f32_16x16x32_bf16 v[80:83], a[4:7], a[48:51], v[80:83]
    v_mfma_f32_16x16x32_bf16 v[76:79], a[4:7], a[44:47], v[76:79]
    ds_read_b128 a[120:123], v10 offset:45056
    s_add_u32 m0, s77, 8192
    v_mfma_f32_16x16x32_bf16 v[72:75], a[4:7], a[40:43], v[72:75]
    buffer_load_dwordx4 v5, s[40:43], 0 offen  lds
    v_mfma_f32_16x16x32_bf16 v[68:71], a[4:7], a[36:39], v[68:71]
    ds_read_b128 a[124:127], v10 offset:47104
    v_mfma_f32_16x16x32_bf16 v[64:67], a[4:7], a[32:35], v[64:67]
    v_mfma_f32_16x16x32_bf16 v[96:99], a[8:11], a[32:35], v[96:99]
    ds_read_b64_tr_b16 a[64:65], v11 offset:24576
    v_mfma_f32_16x16x32_bf16 v[100:103], a[8:11], a[36:39], v[100:103]
    v_mfma_f32_16x16x32_bf16 v[104:107], a[8:11], a[40:43], v[104:107]
    ds_read_b64_tr_b16 a[66:67], v12 offset:24576
    v_mfma_f32_16x16x32_bf16 v[108:111], a[8:11], a[44:47], v[108:111]
    buffer_load_dwordx4 v5, s[52:55], 0 offen offset:1024  lds
    v_mfma_f32_16x16x32_bf16 v[112:115], a[8:11], a[48:51], v[112:115]
    ds_read_b64_tr_b16 a[68:69], v13 offset:24576
    v_mfma_f32_16x16x32_bf16 v[116:119], a[8:11], a[52:55], v[116:119]
    v_mfma_f32_16x16x32_bf16 v[120:123], a[8:11], a[56:59], v[120:123]
    ds_read_b64_tr_b16 a[70:71], v14 offset:24576
    v_mfma_f32_16x16x32_bf16 v[124:127], a[8:11], a[60:63], v[124:127]
    v_mfma_f32_16x16x32_bf16 v[156:159], a[12:15], a[60:63], v[156:159]
    ds_read_b64_tr_b16 a[72:73], v15 offset:24576
    s_add_u32 m0, m0, 40960
    v_mfma_f32_16x16x32_bf16 v[152:155], a[12:15], a[56:59], v[152:155]
    buffer_load_dwordx4 v6, s[44:47], 0 offen  lds
    v_mfma_f32_16x16x32_bf16 v[148:151], a[12:15], a[52:55], v[148:151]
    ds_read_b64_tr_b16 a[74:75], v16 offset:24576
    v_mfma_f32_16x16x32_bf16 v[144:147], a[12:15], a[48:51], v[144:147]
    v_mfma_f32_16x16x32_bf16 v[140:143], a[12:15], a[44:47], v[140:143]
    ds_read_b64_tr_b16 a[76:77], v17 offset:24576
    v_mfma_f32_16x16x32_bf16 v[136:139], a[12:15], a[40:43], v[136:139]
    v_mfma_f32_16x16x32_bf16 v[132:135], a[12:15], a[36:39], v[132:135]
    ds_read_b64_tr_b16 a[78:79], v18 offset:24576
    v_mfma_f32_16x16x32_bf16 v[128:131], a[12:15], a[32:35], v[128:131]
    buffer_load_dwordx4 v6, s[44:47], s73 offen offset:1024  lds
    v_mfma_f32_16x16x32_bf16 a[144:147], a[128:131], a[188:191], a[144:147]
    ds_read_b64_tr_b16 a[80:81], v19 offset:24576
    v_mfma_f32_16x16x32_bf16 v[160:163], a[16:19], a[32:35], v[160:163]
    v_mfma_f32_16x16x32_bf16 v[164:167], a[16:19], a[36:39], v[164:167]
    ds_read_b64_tr_b16 a[82:83], v19 offset:25600
    v_mfma_f32_16x16x32_bf16 v[168:171], a[16:19], a[40:43], v[168:171]
    v_mfma_f32_16x16x32_bf16 v[172:175], a[16:19], a[44:47], v[172:175]
    ds_read_b64_tr_b16 a[84:85], v20 offset:24576
    s_add_u32 m0, s77, 16384
    v_mfma_f32_16x16x32_bf16 v[176:179], a[16:19], a[48:51], v[176:179]
    buffer_load_dwordx4 v5, s[40:43], s72 offen  lds
    v_mfma_f32_16x16x32_bf16 v[180:183], a[16:19], a[52:55], v[180:183]
    ds_read_b64_tr_b16 a[86:87], v20 offset:25600
    v_mfma_f32_16x16x32_bf16 v[184:187], a[16:19], a[56:59], v[184:187]
    v_mfma_f32_16x16x32_bf16 v[188:191], a[16:19], a[60:63], v[188:191]
    ds_read_b64_tr_b16 a[88:89], v21 offset:24576
    v_mfma_f32_16x16x32_bf16 v[220:223], a[20:23], a[60:63], v[220:223]
    v_mfma_f32_16x16x32_bf16 v[216:219], a[20:23], a[56:59], v[216:219]
    ds_read_b64_tr_b16 a[90:91], v21 offset:25600
    v_mfma_f32_16x16x32_bf16 v[212:215], a[20:23], a[52:55], v[212:215]
    buffer_load_dwordx4 v5, s[52:55], s72 offen offset:1024  lds
    v_mfma_f32_16x16x32_bf16 v[208:211], a[20:23], a[48:51], v[208:211]
    ds_read_b64_tr_b16 a[92:93], v22 offset:24576
    v_mfma_f32_16x16x32_bf16 v[204:207], a[20:23], a[44:47], v[204:207]
    v_mfma_f32_16x16x32_bf16 v[200:203], a[20:23], a[40:43], v[200:203]
    ds_read_b64_tr_b16 a[94:95], v22 offset:25600
    v_mfma_f32_16x16x32_bf16 v[196:199], a[20:23], a[36:39], v[196:199]
    v_mfma_f32_16x16x32_bf16 v[192:195], a[20:23], a[32:35], v[192:195]
    ds_read_b64_tr_b16 a[132:133], v23 offset:10240
    s_add_u32 m0, m0, 40960
    v_mfma_f32_16x16x32_bf16 v[224:227], a[24:27], a[32:35], v[224:227]
    buffer_load_dwordx4 v6, s[44:47], s74 offen  lds
    v_mfma_f32_16x16x32_bf16 v[228:231], a[24:27], a[36:39], v[228:231]
    ds_read_b64_tr_b16 a[134:135], v23 offset:10496
    v_mfma_f32_16x16x32_bf16 v[232:235], a[24:27], a[40:43], v[232:235]
    v_mfma_f32_16x16x32_bf16 v[236:239], a[24:27], a[44:47], v[236:239]
    v_mfma_f32_16x16x32_bf16 v[240:243], a[24:27], a[48:51], v[240:243]
    v_mfma_f32_16x16x32_bf16 v[244:247], a[24:27], a[52:55], v[244:247]
    v_mfma_f32_16x16x32_bf16 v[248:251], a[24:27], a[56:59], v[248:251]
    buffer_load_dwordx4 v6, s[44:47], s75 offen offset:1024  lds
    v_mfma_f32_16x16x32_bf16 v[252:255], a[24:27], a[60:63], v[252:255]
    v_mfma_f32_16x16x32_bf16 a[176:179], a[28:31], a[60:63], a[176:179]
    v_add_u32 v5, 458752, v5
    v_mfma_f32_16x16x32_bf16 a[172:175], a[28:31], a[56:59], a[172:175]
    v_add_u32 v6, s15, v6
    v_mfma_f32_16x16x32_bf16 a[168:171], a[28:31], a[52:55], a[168:171]
    v_mfma_f32_16x16x32_bf16 a[164:167], a[28:31], a[48:51], a[164:167]
    v_mfma_f32_16x16x32_bf16 a[160:163], a[28:31], a[44:47], a[160:163]
    s_waitcnt vmcnt(10) lgkmcnt(0)
    s_barrier
    v_mfma_f32_16x16x32_bf16 a[156:159], a[28:31], a[40:43], a[156:159]
    v_mfma_f32_16x16x32_bf16 a[152:155], a[28:31], a[36:39], a[152:155]
    v_mfma_f32_16x16x32_bf16 a[148:151], a[28:31], a[32:35], a[148:151]
    v_mfma_f32_16x16x32_bf16 v[32:35], a[64:67], a[96:99], v[32:35]
    ds_read_b128 a[32:35], v9 offset:0
    s_add_u32 m0, s78, 8192
    v_mfma_f32_16x16x32_bf16 v[36:39], a[64:67], a[100:103], v[36:39]
    buffer_load_dwordx4 v7, s[48:51], 0 offen lds
    v_mfma_f32_16x16x32_bf16 v[40:43], a[64:67], a[104:107], v[40:43]
    ds_read_b128 a[36:39], v9 offset:2048
    v_mfma_f32_16x16x32_bf16 v[44:47], a[64:67], a[108:111], v[44:47]
    v_mfma_f32_16x16x32_bf16 v[48:51], a[64:67], a[112:115], v[48:51]
    ds_read_b128 a[40:43], v9 offset:4096
    v_mfma_f32_16x16x32_bf16 v[52:55], a[64:67], a[116:119], v[52:55]
    v_mfma_f32_16x16x32_bf16 v[56:59], a[64:67], a[120:123], v[56:59]
    ds_read_b128 a[44:47], v9 offset:6144
    v_mfma_f32_16x16x32_bf16 v[60:63], a[64:67], a[124:127], v[60:63]
    buffer_load_dwordx4 v7, s[48:51], 0 offen offset:1024 lds
    v_mfma_f32_16x16x32_bf16 v[92:95], a[68:71], a[124:127], v[92:95]
    ds_read_b128 a[48:51], v9 offset:8192
    v_mfma_f32_16x16x32_bf16 v[88:91], a[68:71], a[120:123], v[88:91]
    v_add_u32 v7, 4096, v7
    v_mfma_f32_16x16x32_bf16 v[84:87], a[68:71], a[116:119], v[84:87]
    ds_read_b128 a[52:55], v9 offset:10240
    v_mfma_f32_16x16x32_bf16 v[80:83], a[68:71], a[112:115], v[80:83]
    v_mfma_f32_16x16x32_bf16 v[76:79], a[68:71], a[108:111], v[76:79]
    ds_read_b128 a[56:59], v9 offset:12288
    s_add_u32 m0, s76, 32768
    v_mfma_f32_16x16x32_bf16 v[72:75], a[68:71], a[104:107], v[72:75]
    buffer_load_dwordx4 v3, s[36:39], 0 offen offset:0  lds
    v_mfma_f32_16x16x32_bf16 v[68:71], a[68:71], a[100:103], v[68:71]
    ds_read_b128 a[60:63], v9 offset:14336
    v_mfma_f32_16x16x32_bf16 v[64:67], a[68:71], a[96:99], v[64:67]
    v_mfma_f32_16x16x32_bf16 v[96:99], a[72:75], a[96:99], v[96:99]
    ds_read_b64_tr_b16 a[0:1], v11 offset:32768
    v_mfma_f32_16x16x32_bf16 v[100:103], a[72:75], a[100:103], v[100:103]
    v_mfma_f32_16x16x32_bf16 v[104:107], a[72:75], a[104:107], v[104:107]
    ds_read_b64_tr_b16 a[2:3], v12 offset:32768
    v_mfma_f32_16x16x32_bf16 v[108:111], a[72:75], a[108:111], v[108:111]
    buffer_load_dwordx4 v4, s[36:39], s65 offen offset:1024  lds
    v_mfma_f32_16x16x32_bf16 v[112:115], a[72:75], a[112:115], v[112:115]
    ds_read_b64_tr_b16 a[4:5], v13 offset:32768
    v_mfma_f32_16x16x32_bf16 v[116:119], a[72:75], a[116:119], v[116:119]
    v_mfma_f32_16x16x32_bf16 v[120:123], a[72:75], a[120:123], v[120:123]
    ds_read_b64_tr_b16 a[6:7], v14 offset:32768
    v_mfma_f32_16x16x32_bf16 v[124:127], a[72:75], a[124:127], v[124:127]
    v_mfma_f32_16x16x32_bf16 v[156:159], a[76:79], a[124:127], v[156:159]
    ds_read_b64_tr_b16 a[8:9], v15 offset:32768
    v_mfma_f32_16x16x32_bf16 v[152:155], a[76:79], a[120:123], v[152:155]
    buffer_load_dwordx4 v3, s[36:39], s66 offen offset:2048  lds
    v_mfma_f32_16x16x32_bf16 v[148:151], a[76:79], a[116:119], v[148:151]
    ds_read_b64_tr_b16 a[10:11], v16 offset:32768
    v_mfma_f32_16x16x32_bf16 v[144:147], a[76:79], a[112:115], v[144:147]
    v_mfma_f32_16x16x32_bf16 v[140:143], a[76:79], a[108:111], v[140:143]
    ds_read_b64_tr_b16 a[12:13], v17 offset:32768
    v_mfma_f32_16x16x32_bf16 v[136:139], a[76:79], a[104:107], v[136:139]
    v_mfma_f32_16x16x32_bf16 v[132:135], a[76:79], a[100:103], v[132:135]
    ds_read_b64_tr_b16 a[14:15], v18 offset:32768
    v_mfma_f32_16x16x32_bf16 v[128:131], a[76:79], a[96:99], v[128:131]
    buffer_load_dwordx4 v4, s[36:39], s67 offen offset:3072  lds
    v_mfma_f32_16x16x32_bf16 a[144:147], a[132:135], a[192:195], a[144:147]
    ds_read_b64_tr_b16 a[16:17], v19 offset:32768
    v_mfma_f32_16x16x32_bf16 v[160:163], a[80:83], a[96:99], v[160:163]
    v_mfma_f32_16x16x32_bf16 v[164:167], a[80:83], a[100:103], v[164:167]
    ds_read_b64_tr_b16 a[18:19], v19 offset:33792
    v_mfma_f32_16x16x32_bf16 v[168:171], a[80:83], a[104:107], v[168:171]
    v_mfma_f32_16x16x32_bf16 v[172:175], a[80:83], a[108:111], v[172:175]
    ds_read_b64_tr_b16 a[20:21], v20 offset:32768
    s_add_u32 m0, m0, 4096
    v_mfma_f32_16x16x32_bf16 v[176:179], a[80:83], a[112:115], v[176:179]
    buffer_load_dwordx4 v3, s[36:39], s68 offen offset:0  lds
    v_mfma_f32_16x16x32_bf16 v[180:183], a[80:83], a[116:119], v[180:183]
    ds_read_b64_tr_b16 a[22:23], v20 offset:33792
    v_mfma_f32_16x16x32_bf16 v[184:187], a[80:83], a[120:123], v[184:187]
    v_mfma_f32_16x16x32_bf16 v[188:191], a[80:83], a[124:127], v[188:191]
    ds_read_b64_tr_b16 a[24:25], v21 offset:32768
    v_mfma_f32_16x16x32_bf16 v[220:223], a[84:87], a[124:127], v[220:223]
    v_mfma_f32_16x16x32_bf16 v[216:219], a[84:87], a[120:123], v[216:219]
    ds_read_b64_tr_b16 a[26:27], v21 offset:33792
    v_mfma_f32_16x16x32_bf16 v[212:215], a[84:87], a[116:119], v[212:215]
    buffer_load_dwordx4 v4, s[36:39], s69 offen offset:1024  lds
    v_mfma_f32_16x16x32_bf16 v[208:211], a[84:87], a[112:115], v[208:211]
    ds_read_b64_tr_b16 a[28:29], v22 offset:32768
    v_mfma_f32_16x16x32_bf16 v[204:207], a[84:87], a[108:111], v[204:207]
    v_mfma_f32_16x16x32_bf16 v[200:203], a[84:87], a[104:107], v[200:203]
    ds_read_b64_tr_b16 a[30:31], v22 offset:33792
    v_mfma_f32_16x16x32_bf16 v[196:199], a[84:87], a[100:103], v[196:199]
    v_mfma_f32_16x16x32_bf16 v[192:195], a[84:87], a[96:99], v[192:195]
    ds_read_b64_tr_b16 a[128:129], v23 offset:0
    v_mfma_f32_16x16x32_bf16 v[224:227], a[88:91], a[96:99], v[224:227]
    buffer_load_dwordx4 v3, s[36:39], s70 offen offset:2048  lds
    v_mfma_f32_16x16x32_bf16 v[228:231], a[88:91], a[100:103], v[228:231]
    ds_read_b64_tr_b16 a[130:131], v23 offset:256
    v_mfma_f32_16x16x32_bf16 v[232:235], a[88:91], a[104:107], v[232:235]
    v_mfma_f32_16x16x32_bf16 v[236:239], a[88:91], a[108:111], v[236:239]
    v_mfma_f32_16x16x32_bf16 v[240:243], a[88:91], a[112:115], v[240:243]
    v_mfma_f32_16x16x32_bf16 v[244:247], a[88:91], a[116:119], v[244:247]
    v_mfma_f32_16x16x32_bf16 v[248:251], a[88:91], a[120:123], v[248:251]
    buffer_load_dwordx4 v4, s[36:39], s71 offen offset:3072  lds
    v_mfma_f32_16x16x32_bf16 v[252:255], a[88:91], a[124:127], v[252:255]
    v_mfma_f32_16x16x32_bf16 a[176:179], a[92:95], a[124:127], a[176:179]
    v_add_u32 v3, 0x80, v3
    v_mfma_f32_16x16x32_bf16 a[172:175], a[92:95], a[120:123], a[172:175]
    v_mfma_f32_16x16x32_bf16 a[168:171], a[92:95], a[116:119], a[168:171]
    v_add_u32 v4, 0x80, v4
    v_mfma_f32_16x16x32_bf16 a[164:167], a[92:95], a[112:115], a[164:167]
    v_mfma_f32_16x16x32_bf16 a[160:163], a[92:95], a[108:111], a[160:163]
    s_waitcnt vmcnt(18) lgkmcnt(0)
    s_barrier
    v_mfma_f32_16x16x32_bf16 a[156:159], a[92:95], a[104:107], a[156:159]
    v_mfma_f32_16x16x32_bf16 a[152:155], a[92:95], a[100:103], a[152:155]
    v_mfma_f32_16x16x32_bf16 a[148:151], a[92:95], a[96:99], a[148:151]
    v_mfma_f32_16x16x32_bf16 v[32:35], a[0:3], a[32:35], v[32:35]
    ds_read_b128 a[96:99], v10 offset:0
    v_mfma_f32_16x16x32_bf16 v[36:39], a[0:3], a[36:39], v[36:39]
    buffer_load_dwordx4 a[188:191], v8, s[36:39], 0 offen offset:0
    v_mfma_f32_16x16x32_bf16 v[40:43], a[0:3], a[40:43], v[40:43]
    ds_read_b128 a[100:103], v10 offset:2048
    v_mfma_f32_16x16x32_bf16 v[44:47], a[0:3], a[44:47], v[44:47]
    v_mfma_f32_16x16x32_bf16 v[48:51], a[0:3], a[48:51], v[48:51]
    ds_read_b128 a[104:107], v10 offset:4096
    v_mfma_f32_16x16x32_bf16 v[52:55], a[0:3], a[52:55], v[52:55]
    v_mfma_f32_16x16x32_bf16 v[56:59], a[0:3], a[56:59], v[56:59]
    ds_read_b128 a[108:111], v10 offset:6144
    v_mfma_f32_16x16x32_bf16 v[60:63], a[0:3], a[60:63], v[60:63]
    buffer_load_dwordx4 a[192:195], v8, s[36:39], 0 offen offset:64
    v_mfma_f32_16x16x32_bf16 v[92:95], a[4:7], a[60:63], v[92:95]
    ds_read_b128 a[112:115], v10 offset:8192
    v_mfma_f32_16x16x32_bf16 v[88:91], a[4:7], a[56:59], v[88:91]
    v_add_u32 v8, 128, v8
    v_mfma_f32_16x16x32_bf16 v[84:87], a[4:7], a[52:55], v[84:87]
    ds_read_b128 a[116:119], v10 offset:10240
    v_mfma_f32_16x16x32_bf16 v[80:83], a[4:7], a[48:51], v[80:83]
    v_mfma_f32_16x16x32_bf16 v[76:79], a[4:7], a[44:47], v[76:79]
    ds_read_b128 a[120:123], v10 offset:12288
    s_add_u32 m0, s77, 24576
    v_mfma_f32_16x16x32_bf16 v[72:75], a[4:7], a[40:43], v[72:75]
    buffer_load_dwordx4 v5, s[40:43], 0 offen  lds
    v_mfma_f32_16x16x32_bf16 v[68:71], a[4:7], a[36:39], v[68:71]
    ds_read_b128 a[124:127], v10 offset:14336
    v_mfma_f32_16x16x32_bf16 v[64:67], a[4:7], a[32:35], v[64:67]
    v_mfma_f32_16x16x32_bf16 v[96:99], a[8:11], a[32:35], v[96:99]
    ds_read_b64_tr_b16 a[64:65], v11 offset:0
    v_mfma_f32_16x16x32_bf16 v[100:103], a[8:11], a[36:39], v[100:103]
    v_mfma_f32_16x16x32_bf16 v[104:107], a[8:11], a[40:43], v[104:107]
    ds_read_b64_tr_b16 a[66:67], v12 offset:0
    v_mfma_f32_16x16x32_bf16 v[108:111], a[8:11], a[44:47], v[108:111]
    buffer_load_dwordx4 v5, s[52:55], 0 offen offset:1024  lds
    v_mfma_f32_16x16x32_bf16 v[112:115], a[8:11], a[48:51], v[112:115]
    ds_read_b64_tr_b16 a[68:69], v13 offset:0
    v_mfma_f32_16x16x32_bf16 v[116:119], a[8:11], a[52:55], v[116:119]
    v_mfma_f32_16x16x32_bf16 v[120:123], a[8:11], a[56:59], v[120:123]
    ds_read_b64_tr_b16 a[70:71], v14 offset:0
    v_mfma_f32_16x16x32_bf16 v[124:127], a[8:11], a[60:63], v[124:127]
    v_mfma_f32_16x16x32_bf16 v[156:159], a[12:15], a[60:63], v[156:159]
    ds_read_b64_tr_b16 a[72:73], v15 offset:0
    s_add_u32 m0, m0, 40960
    v_mfma_f32_16x16x32_bf16 v[152:155], a[12:15], a[56:59], v[152:155]
    buffer_load_dwordx4 v6, s[44:47], 0 offen  lds
    v_mfma_f32_16x16x32_bf16 v[148:151], a[12:15], a[52:55], v[148:151]
    ds_read_b64_tr_b16 a[74:75], v16 offset:0
    v_mfma_f32_16x16x32_bf16 v[144:147], a[12:15], a[48:51], v[144:147]
    v_mfma_f32_16x16x32_bf16 v[140:143], a[12:15], a[44:47], v[140:143]
    ds_read_b64_tr_b16 a[76:77], v17 offset:0
    v_mfma_f32_16x16x32_bf16 v[136:139], a[12:15], a[40:43], v[136:139]
    v_mfma_f32_16x16x32_bf16 v[132:135], a[12:15], a[36:39], v[132:135]
    ds_read_b64_tr_b16 a[78:79], v18 offset:0
    v_mfma_f32_16x16x32_bf16 v[128:131], a[12:15], a[32:35], v[128:131]
    buffer_load_dwordx4 v6, s[44:47], s73 offen offset:1024  lds
    v_mfma_f32_16x16x32_bf16 a[144:147], a[128:131], a[180:183], a[144:147]
    ds_read_b64_tr_b16 a[80:81], v19 offset:0
    v_mfma_f32_16x16x32_bf16 v[160:163], a[16:19], a[32:35], v[160:163]
    v_mfma_f32_16x16x32_bf16 v[164:167], a[16:19], a[36:39], v[164:167]
    ds_read_b64_tr_b16 a[82:83], v19 offset:1024
    v_mfma_f32_16x16x32_bf16 v[168:171], a[16:19], a[40:43], v[168:171]
    v_mfma_f32_16x16x32_bf16 v[172:175], a[16:19], a[44:47], v[172:175]
    ds_read_b64_tr_b16 a[84:85], v20 offset:0
    s_add_u32 m0, s77, 32768
    v_mfma_f32_16x16x32_bf16 v[176:179], a[16:19], a[48:51], v[176:179]
    buffer_load_dwordx4 v5, s[40:43], s72 offen  lds
    v_mfma_f32_16x16x32_bf16 v[180:183], a[16:19], a[52:55], v[180:183]
    ds_read_b64_tr_b16 a[86:87], v20 offset:1024
    v_mfma_f32_16x16x32_bf16 v[184:187], a[16:19], a[56:59], v[184:187]
    v_mfma_f32_16x16x32_bf16 v[188:191], a[16:19], a[60:63], v[188:191]
    ds_read_b64_tr_b16 a[88:89], v21 offset:0
    v_mfma_f32_16x16x32_bf16 v[220:223], a[20:23], a[60:63], v[220:223]
    v_mfma_f32_16x16x32_bf16 v[216:219], a[20:23], a[56:59], v[216:219]
    ds_read_b64_tr_b16 a[90:91], v21 offset:1024
    v_mfma_f32_16x16x32_bf16 v[212:215], a[20:23], a[52:55], v[212:215]
    buffer_load_dwordx4 v5, s[52:55], s72 offen offset:1024  lds
    v_mfma_f32_16x16x32_bf16 v[208:211], a[20:23], a[48:51], v[208:211]
    ds_read_b64_tr_b16 a[92:93], v22 offset:0
    v_mfma_f32_16x16x32_bf16 v[204:207], a[20:23], a[44:47], v[204:207]
    v_mfma_f32_16x16x32_bf16 v[200:203], a[20:23], a[40:43], v[200:203]
    ds_read_b64_tr_b16 a[94:95], v22 offset:1024
    v_mfma_f32_16x16x32_bf16 v[196:199], a[20:23], a[36:39], v[196:199]
    v_mfma_f32_16x16x32_bf16 v[192:195], a[20:23], a[32:35], v[192:195]
    ds_read_b64_tr_b16 a[132:133], v23 offset:2048
    s_add_u32 m0, m0, 40960
    v_mfma_f32_16x16x32_bf16 v[224:227], a[24:27], a[32:35], v[224:227]
    buffer_load_dwordx4 v6, s[44:47], s74 offen  lds
    v_mfma_f32_16x16x32_bf16 v[228:231], a[24:27], a[36:39], v[228:231]
    ds_read_b64_tr_b16 a[134:135], v23 offset:2304
    v_mfma_f32_16x16x32_bf16 v[232:235], a[24:27], a[40:43], v[232:235]
    v_mfma_f32_16x16x32_bf16 v[236:239], a[24:27], a[44:47], v[236:239]
    v_mfma_f32_16x16x32_bf16 v[240:243], a[24:27], a[48:51], v[240:243]
    v_mfma_f32_16x16x32_bf16 v[244:247], a[24:27], a[52:55], v[244:247]
    v_mfma_f32_16x16x32_bf16 v[248:251], a[24:27], a[56:59], v[248:251]
    buffer_load_dwordx4 v6, s[44:47], s75 offen offset:1024  lds
    v_mfma_f32_16x16x32_bf16 v[252:255], a[24:27], a[60:63], v[252:255]
    v_mfma_f32_16x16x32_bf16 a[176:179], a[28:31], a[60:63], a[176:179]
    v_add_u32 v5, 458752, v5
    v_mfma_f32_16x16x32_bf16 a[172:175], a[28:31], a[56:59], a[172:175]
    v_add_u32 v6, s15, v6
    v_mfma_f32_16x16x32_bf16 a[168:171], a[28:31], a[52:55], a[168:171]
    v_mfma_f32_16x16x32_bf16 a[164:167], a[28:31], a[48:51], a[164:167]
    v_mfma_f32_16x16x32_bf16 a[160:163], a[28:31], a[44:47], a[160:163]
    s_waitcnt vmcnt(10) lgkmcnt(0)
    s_barrier
    v_mfma_f32_16x16x32_bf16 a[156:159], a[28:31], a[40:43], a[156:159]
    v_mfma_f32_16x16x32_bf16 a[152:155], a[28:31], a[36:39], a[152:155]
    v_mfma_f32_16x16x32_bf16 a[148:151], a[28:31], a[32:35], a[148:151]
    v_mfma_f32_16x16x32_bf16 v[32:35], a[64:67], a[96:99], v[32:35]
    ds_read_b128 a[32:35], v9 offset:32768
    s_add_u32 m0, s78, 0
    v_mfma_f32_16x16x32_bf16 v[36:39], a[64:67], a[100:103], v[36:39]
    buffer_load_dwordx4 v7, s[48:51], 0 offen lds
    v_mfma_f32_16x16x32_bf16 v[40:43], a[64:67], a[104:107], v[40:43]
    ds_read_b128 a[36:39], v9 offset:34816
    v_mfma_f32_16x16x32_bf16 v[44:47], a[64:67], a[108:111], v[44:47]
    v_mfma_f32_16x16x32_bf16 v[48:51], a[64:67], a[112:115], v[48:51]
    ds_read_b128 a[40:43], v9 offset:36864
    v_mfma_f32_16x16x32_bf16 v[52:55], a[64:67], a[116:119], v[52:55]
    v_mfma_f32_16x16x32_bf16 v[56:59], a[64:67], a[120:123], v[56:59]
    ds_read_b128 a[44:47], v9 offset:38912
    v_mfma_f32_16x16x32_bf16 v[60:63], a[64:67], a[124:127], v[60:63]
    buffer_load_dwordx4 v7, s[48:51], 0 offen offset:1024 lds
    v_mfma_f32_16x16x32_bf16 v[92:95], a[68:71], a[124:127], v[92:95]
    ds_read_b128 a[48:51], v9 offset:40960
    v_mfma_f32_16x16x32_bf16 v[88:91], a[68:71], a[120:123], v[88:91]
    v_add_u32 v7, 4096, v7
    v_mfma_f32_16x16x32_bf16 v[84:87], a[68:71], a[116:119], v[84:87]
    ds_read_b128 a[52:55], v9 offset:43008
    v_mfma_f32_16x16x32_bf16 v[80:83], a[68:71], a[112:115], v[80:83]
    v_mfma_f32_16x16x32_bf16 v[76:79], a[68:71], a[108:111], v[76:79]
    ds_read_b128 a[56:59], v9 offset:45056
    s_add_u32 m0, s76, 0
    v_mfma_f32_16x16x32_bf16 v[72:75], a[68:71], a[104:107], v[72:75]
    buffer_load_dwordx4 v3, s[36:39], 0 offen offset:0  lds
    v_mfma_f32_16x16x32_bf16 v[68:71], a[68:71], a[100:103], v[68:71]
    ds_read_b128 a[60:63], v9 offset:47104
    v_mfma_f32_16x16x32_bf16 v[64:67], a[68:71], a[96:99], v[64:67]
    v_mfma_f32_16x16x32_bf16 v[96:99], a[72:75], a[96:99], v[96:99]
    ds_read_b64_tr_b16 a[0:1], v11 offset:8192
    v_mfma_f32_16x16x32_bf16 v[100:103], a[72:75], a[100:103], v[100:103]
    v_mfma_f32_16x16x32_bf16 v[104:107], a[72:75], a[104:107], v[104:107]
    ds_read_b64_tr_b16 a[2:3], v12 offset:8192
    v_mfma_f32_16x16x32_bf16 v[108:111], a[72:75], a[108:111], v[108:111]
    buffer_load_dwordx4 v4, s[36:39], s65 offen offset:1024  lds
    v_mfma_f32_16x16x32_bf16 v[112:115], a[72:75], a[112:115], v[112:115]
    ds_read_b64_tr_b16 a[4:5], v13 offset:8192
    v_mfma_f32_16x16x32_bf16 v[116:119], a[72:75], a[116:119], v[116:119]
    v_mfma_f32_16x16x32_bf16 v[120:123], a[72:75], a[120:123], v[120:123]
    ds_read_b64_tr_b16 a[6:7], v14 offset:8192
    v_mfma_f32_16x16x32_bf16 v[124:127], a[72:75], a[124:127], v[124:127]
    v_mfma_f32_16x16x32_bf16 v[156:159], a[76:79], a[124:127], v[156:159]
    ds_read_b64_tr_b16 a[8:9], v15 offset:8192
    v_mfma_f32_16x16x32_bf16 v[152:155], a[76:79], a[120:123], v[152:155]
    buffer_load_dwordx4 v3, s[36:39], s66 offen offset:2048  lds
    v_mfma_f32_16x16x32_bf16 v[148:151], a[76:79], a[116:119], v[148:151]
    ds_read_b64_tr_b16 a[10:11], v16 offset:8192
    v_mfma_f32_16x16x32_bf16 v[144:147], a[76:79], a[112:115], v[144:147]
    v_mfma_f32_16x16x32_bf16 v[140:143], a[76:79], a[108:111], v[140:143]
    ds_read_b64_tr_b16 a[12:13], v17 offset:8192
    v_mfma_f32_16x16x32_bf16 v[136:139], a[76:79], a[104:107], v[136:139]
    v_mfma_f32_16x16x32_bf16 v[132:135], a[76:79], a[100:103], v[132:135]
    ds_read_b64_tr_b16 a[14:15], v18 offset:8192
    v_mfma_f32_16x16x32_bf16 v[128:131], a[76:79], a[96:99], v[128:131]
    buffer_load_dwordx4 v4, s[36:39], s67 offen offset:3072  lds
    v_mfma_f32_16x16x32_bf16 a[144:147], a[132:135], a[184:187], a[144:147]
    ds_read_b64_tr_b16 a[16:17], v19 offset:8192
    v_mfma_f32_16x16x32_bf16 v[160:163], a[80:83], a[96:99], v[160:163]
    v_mfma_f32_16x16x32_bf16 v[164:167], a[80:83], a[100:103], v[164:167]
    ds_read_b64_tr_b16 a[18:19], v19 offset:9216
    v_mfma_f32_16x16x32_bf16 v[168:171], a[80:83], a[104:107], v[168:171]
    v_mfma_f32_16x16x32_bf16 v[172:175], a[80:83], a[108:111], v[172:175]
    ds_read_b64_tr_b16 a[20:21], v20 offset:8192
    s_add_u32 m0, m0, 4096
    v_mfma_f32_16x16x32_bf16 v[176:179], a[80:83], a[112:115], v[176:179]
    buffer_load_dwordx4 v3, s[36:39], s68 offen offset:0  lds
    v_mfma_f32_16x16x32_bf16 v[180:183], a[80:83], a[116:119], v[180:183]
    ds_read_b64_tr_b16 a[22:23], v20 offset:9216
    v_mfma_f32_16x16x32_bf16 v[184:187], a[80:83], a[120:123], v[184:187]
    v_mfma_f32_16x16x32_bf16 v[188:191], a[80:83], a[124:127], v[188:191]
    ds_read_b64_tr_b16 a[24:25], v21 offset:8192
    v_mfma_f32_16x16x32_bf16 v[220:223], a[84:87], a[124:127], v[220:223]
    v_mfma_f32_16x16x32_bf16 v[216:219], a[84:87], a[120:123], v[216:219]
    ds_read_b64_tr_b16 a[26:27], v21 offset:9216
    v_mfma_f32_16x16x32_bf16 v[212:215], a[84:87], a[116:119], v[212:215]
    buffer_load_dwordx4 v4, s[36:39], s69 offen offset:1024  lds
    v_mfma_f32_16x16x32_bf16 v[208:211], a[84:87], a[112:115], v[208:211]
    ds_read_b64_tr_b16 a[28:29], v22 offset:8192
    v_mfma_f32_16x16x32_bf16 v[204:207], a[84:87], a[108:111], v[204:207]
    v_mfma_f32_16x16x32_bf16 v[200:203], a[84:87], a[104:107], v[200:203]
    ds_read_b64_tr_b16 a[30:31], v22 offset:9216
    v_mfma_f32_16x16x32_bf16 v[196:199], a[84:87], a[100:103], v[196:199]
    v_mfma_f32_16x16x32_bf16 v[192:195], a[84:87], a[96:99], v[192:195]
    ds_read_b64_tr_b16 a[128:129], v23 offset:8192
    v_mfma_f32_16x16x32_bf16 v[224:227], a[88:91], a[96:99], v[224:227]
    buffer_load_dwordx4 v3, s[36:39], s70 offen offset:2048  lds
    v_mfma_f32_16x16x32_bf16 v[228:231], a[88:91], a[100:103], v[228:231]
    ds_read_b64_tr_b16 a[130:131], v23 offset:8448
    v_mfma_f32_16x16x32_bf16 v[232:235], a[88:91], a[104:107], v[232:235]
    v_mfma_f32_16x16x32_bf16 v[236:239], a[88:91], a[108:111], v[236:239]
    v_mfma_f32_16x16x32_bf16 v[240:243], a[88:91], a[112:115], v[240:243]
    v_mfma_f32_16x16x32_bf16 v[244:247], a[88:91], a[116:119], v[244:247]
    v_mfma_f32_16x16x32_bf16 v[248:251], a[88:91], a[120:123], v[248:251]
    buffer_load_dwordx4 v4, s[36:39], s71 offen offset:3072  lds
    v_mfma_f32_16x16x32_bf16 v[252:255], a[88:91], a[124:127], v[252:255]
    v_mfma_f32_16x16x32_bf16 a[176:179], a[92:95], a[124:127], a[176:179]
    v_add_u32 v3, 0x80, v3
    v_mfma_f32_16x16x32_bf16 a[172:175], a[92:95], a[120:123], a[172:175]
    v_mfma_f32_16x16x32_bf16 a[168:171], a[92:95], a[116:119], a[168:171]
    v_add_u32 v4, 0x80, v4
    v_mfma_f32_16x16x32_bf16 a[164:167], a[92:95], a[112:115], a[164:167]
    v_mfma_f32_16x16x32_bf16 a[160:163], a[92:95], a[108:111], a[160:163]
    s_waitcnt vmcnt(18) lgkmcnt(0)
    s_barrier
    v_mfma_f32_16x16x32_bf16 a[156:159], a[92:95], a[104:107], a[156:159]
    v_mfma_f32_16x16x32_bf16 a[152:155], a[92:95], a[100:103], a[152:155]
    v_mfma_f32_16x16x32_bf16 a[148:151], a[92:95], a[96:99], a[148:151]
    v_mfma_f32_16x16x32_bf16 v[32:35], a[0:3], a[32:35], v[32:35]
    ds_read_b128 a[96:99], v10 offset:32768
    v_mfma_f32_16x16x32_bf16 v[36:39], a[0:3], a[36:39], v[36:39]
    buffer_load_dwordx4 a[180:183], v8, s[36:39], 0 offen offset:0
    v_mfma_f32_16x16x32_bf16 v[40:43], a[0:3], a[40:43], v[40:43]
    ds_read_b128 a[100:103], v10 offset:34816
    v_mfma_f32_16x16x32_bf16 v[44:47], a[0:3], a[44:47], v[44:47]
    v_mfma_f32_16x16x32_bf16 v[48:51], a[0:3], a[48:51], v[48:51]
    ds_read_b128 a[104:107], v10 offset:36864
    global_load_dword a253, v0, s[100:101]
    v_add_u32 v0, 0x2000, v0
    v_mfma_f32_16x16x32_bf16 v[52:55], a[0:3], a[52:55], v[52:55]
    v_mfma_f32_16x16x32_bf16 v[56:59], a[0:3], a[56:59], v[56:59]
    ds_read_b128 a[108:111], v10 offset:38912
    v_mfma_f32_16x16x32_bf16 v[60:63], a[0:3], a[60:63], v[60:63]
    buffer_load_dwordx4 a[184:187], v8, s[36:39], 0 offen offset:64
    v_mfma_f32_16x16x32_bf16 v[92:95], a[4:7], a[60:63], v[92:95]
    ds_read_b128 a[112:115], v10 offset:40960
    v_mfma_f32_16x16x32_bf16 v[88:91], a[4:7], a[56:59], v[88:91]
    v_add_u32 v8, 128, v8
    v_mfma_f32_16x16x32_bf16 v[84:87], a[4:7], a[52:55], v[84:87]
    ds_read_b128 a[116:119], v10 offset:43008
    v_mfma_f32_16x16x32_bf16 v[80:83], a[4:7], a[48:51], v[80:83]
    v_mfma_f32_16x16x32_bf16 v[76:79], a[4:7], a[44:47], v[76:79]
    ds_read_b128 a[120:123], v10 offset:45056
    s_add_u32 m0, s77, 0
    v_mfma_f32_16x16x32_bf16 v[72:75], a[4:7], a[40:43], v[72:75]
    buffer_load_dwordx4 v5, s[40:43], 0 offen  lds
    v_mfma_f32_16x16x32_bf16 v[68:71], a[4:7], a[36:39], v[68:71]
    ds_read_b128 a[124:127], v10 offset:47104
    v_mfma_f32_16x16x32_bf16 v[64:67], a[4:7], a[32:35], v[64:67]
    v_mfma_f32_16x16x32_bf16 v[96:99], a[8:11], a[32:35], v[96:99]
    ds_read_b64_tr_b16 a[64:65], v11 offset:16384
    v_mfma_f32_16x16x32_bf16 v[100:103], a[8:11], a[36:39], v[100:103]
    v_mfma_f32_16x16x32_bf16 v[104:107], a[8:11], a[40:43], v[104:107]
    ds_read_b64_tr_b16 a[66:67], v12 offset:16384
    v_mfma_f32_16x16x32_bf16 v[108:111], a[8:11], a[44:47], v[108:111]
    buffer_load_dwordx4 v5, s[52:55], 0 offen offset:1024  lds
    v_mfma_f32_16x16x32_bf16 v[112:115], a[8:11], a[48:51], v[112:115]
    ds_read_b64_tr_b16 a[68:69], v13 offset:16384
    v_mfma_f32_16x16x32_bf16 v[116:119], a[8:11], a[52:55], v[116:119]
    v_mfma_f32_16x16x32_bf16 v[120:123], a[8:11], a[56:59], v[120:123]
    ds_read_b64_tr_b16 a[70:71], v14 offset:16384
    v_mfma_f32_16x16x32_bf16 v[124:127], a[8:11], a[60:63], v[124:127]
    v_mfma_f32_16x16x32_bf16 v[156:159], a[12:15], a[60:63], v[156:159]
    ds_read_b64_tr_b16 a[72:73], v15 offset:16384
    s_add_u32 m0, m0, 40960
    v_mfma_f32_16x16x32_bf16 v[152:155], a[12:15], a[56:59], v[152:155]
    buffer_load_dwordx4 v6, s[44:47], 0 offen  lds
    v_mfma_f32_16x16x32_bf16 v[148:151], a[12:15], a[52:55], v[148:151]
    ds_read_b64_tr_b16 a[74:75], v16 offset:16384
    v_mfma_f32_16x16x32_bf16 v[144:147], a[12:15], a[48:51], v[144:147]
    v_mfma_f32_16x16x32_bf16 v[140:143], a[12:15], a[44:47], v[140:143]
    ds_read_b64_tr_b16 a[76:77], v17 offset:16384
    v_mfma_f32_16x16x32_bf16 v[136:139], a[12:15], a[40:43], v[136:139]
    v_mfma_f32_16x16x32_bf16 v[132:135], a[12:15], a[36:39], v[132:135]
    ds_read_b64_tr_b16 a[78:79], v18 offset:16384
    v_mfma_f32_16x16x32_bf16 v[128:131], a[12:15], a[32:35], v[128:131]
    buffer_load_dwordx4 v6, s[44:47], s73 offen offset:1024  lds
    v_mfma_f32_16x16x32_bf16 a[144:147], a[128:131], a[188:191], a[144:147]
    ds_read_b64_tr_b16 a[80:81], v19 offset:16384
    v_mfma_f32_16x16x32_bf16 v[160:163], a[16:19], a[32:35], v[160:163]
    v_mfma_f32_16x16x32_bf16 v[164:167], a[16:19], a[36:39], v[164:167]
    ds_read_b64_tr_b16 a[82:83], v19 offset:17408
    v_mfma_f32_16x16x32_bf16 v[168:171], a[16:19], a[40:43], v[168:171]
    v_mfma_f32_16x16x32_bf16 v[172:175], a[16:19], a[44:47], v[172:175]
    ds_read_b64_tr_b16 a[84:85], v20 offset:16384
    s_add_u32 m0, s77, 8192
    v_mfma_f32_16x16x32_bf16 v[176:179], a[16:19], a[48:51], v[176:179]
    buffer_load_dwordx4 v5, s[40:43], s72 offen  lds
    v_mfma_f32_16x16x32_bf16 v[180:183], a[16:19], a[52:55], v[180:183]
    ds_read_b64_tr_b16 a[86:87], v20 offset:17408
    v_mfma_f32_16x16x32_bf16 v[184:187], a[16:19], a[56:59], v[184:187]
    v_mfma_f32_16x16x32_bf16 v[188:191], a[16:19], a[60:63], v[188:191]
    ds_read_b64_tr_b16 a[88:89], v21 offset:16384
    v_mfma_f32_16x16x32_bf16 v[220:223], a[20:23], a[60:63], v[220:223]
    v_mfma_f32_16x16x32_bf16 v[216:219], a[20:23], a[56:59], v[216:219]
    ds_read_b64_tr_b16 a[90:91], v21 offset:17408
    v_mfma_f32_16x16x32_bf16 v[212:215], a[20:23], a[52:55], v[212:215]
    buffer_load_dwordx4 v5, s[52:55], s72 offen offset:1024  lds
    v_mfma_f32_16x16x32_bf16 v[208:211], a[20:23], a[48:51], v[208:211]
    ds_read_b64_tr_b16 a[92:93], v22 offset:16384
    v_mfma_f32_16x16x32_bf16 v[204:207], a[20:23], a[44:47], v[204:207]
    v_mfma_f32_16x16x32_bf16 v[200:203], a[20:23], a[40:43], v[200:203]
    ds_read_b64_tr_b16 a[94:95], v22 offset:17408
    v_mfma_f32_16x16x32_bf16 v[196:199], a[20:23], a[36:39], v[196:199]
    v_mfma_f32_16x16x32_bf16 v[192:195], a[20:23], a[32:35], v[192:195]
    ds_read_b64_tr_b16 a[132:133], v23 offset:10240
    s_add_u32 m0, m0, 40960
    v_mfma_f32_16x16x32_bf16 v[224:227], a[24:27], a[32:35], v[224:227]
    buffer_load_dwordx4 v6, s[44:47], s74 offen  lds
    v_mfma_f32_16x16x32_bf16 v[228:231], a[24:27], a[36:39], v[228:231]
    ds_read_b64_tr_b16 a[134:135], v23 offset:10496
    v_mfma_f32_16x16x32_bf16 v[232:235], a[24:27], a[40:43], v[232:235]
    v_mfma_f32_16x16x32_bf16 v[236:239], a[24:27], a[44:47], v[236:239]
    v_mfma_f32_16x16x32_bf16 v[240:243], a[24:27], a[48:51], v[240:243]
    v_mfma_f32_16x16x32_bf16 v[244:247], a[24:27], a[52:55], v[244:247]
    v_mfma_f32_16x16x32_bf16 v[248:251], a[24:27], a[56:59], v[248:251]
    buffer_load_dwordx4 v6, s[44:47], s75 offen offset:1024  lds
    v_mfma_f32_16x16x32_bf16 v[252:255], a[24:27], a[60:63], v[252:255]
    v_mfma_f32_16x16x32_bf16 a[176:179], a[28:31], a[60:63], a[176:179]
    v_add_u32 v5, 458752, v5
    v_mfma_f32_16x16x32_bf16 a[172:175], a[28:31], a[56:59], a[172:175]
    v_add_u32 v6, s15, v6
    v_mfma_f32_16x16x32_bf16 a[168:171], a[28:31], a[52:55], a[168:171]
    v_mfma_f32_16x16x32_bf16 a[164:167], a[28:31], a[48:51], a[164:167]
    v_mfma_f32_16x16x32_bf16 a[160:163], a[28:31], a[44:47], a[160:163]
    s_waitcnt vmcnt(11) lgkmcnt(0)
    s_barrier
    v_mfma_f32_16x16x32_bf16 a[156:159], a[28:31], a[40:43], a[156:159]
    v_mfma_f32_16x16x32_bf16 a[152:155], a[28:31], a[36:39], a[152:155]
    v_mfma_f32_16x16x32_bf16 a[148:151], a[28:31], a[32:35], a[148:151]
    v_mfma_f32_16x16x32_bf16 v[32:35], a[64:67], a[96:99], v[32:35]
    ds_read_b128 a[32:35], v9 offset:0
    s_add_u32 m0, s78, 8192
    v_mfma_f32_16x16x32_bf16 v[36:39], a[64:67], a[100:103], v[36:39]
    buffer_load_dwordx4 v7, s[48:51], 0 offen lds
    v_mfma_f32_16x16x32_bf16 v[40:43], a[64:67], a[104:107], v[40:43]
    ds_read_b128 a[36:39], v9 offset:2048
    v_mfma_f32_16x16x32_bf16 v[44:47], a[64:67], a[108:111], v[44:47]
    v_mfma_f32_16x16x32_bf16 v[48:51], a[64:67], a[112:115], v[48:51]
    ds_read_b128 a[40:43], v9 offset:4096
    v_mfma_f32_16x16x32_bf16 v[52:55], a[64:67], a[116:119], v[52:55]
    v_mfma_f32_16x16x32_bf16 v[56:59], a[64:67], a[120:123], v[56:59]
    ds_read_b128 a[44:47], v9 offset:6144
    v_mfma_f32_16x16x32_bf16 v[60:63], a[64:67], a[124:127], v[60:63]
    buffer_load_dwordx4 v7, s[48:51], 0 offen offset:1024 lds
    v_mfma_f32_16x16x32_bf16 v[92:95], a[68:71], a[124:127], v[92:95]
    ds_read_b128 a[48:51], v9 offset:8192
    v_mfma_f32_16x16x32_bf16 v[88:91], a[68:71], a[120:123], v[88:91]
    v_add_u32 v7, 4096, v7
    v_mfma_f32_16x16x32_bf16 v[84:87], a[68:71], a[116:119], v[84:87]
    ds_read_b128 a[52:55], v9 offset:10240
    v_mfma_f32_16x16x32_bf16 v[80:83], a[68:71], a[112:115], v[80:83]
    v_mfma_f32_16x16x32_bf16 v[76:79], a[68:71], a[108:111], v[76:79]
    ds_read_b128 a[56:59], v9 offset:12288
    s_add_u32 m0, s76, 32768
    v_mfma_f32_16x16x32_bf16 v[72:75], a[68:71], a[104:107], v[72:75]
    buffer_load_dwordx4 v3, s[36:39], 0 offen offset:0  lds
    v_mfma_f32_16x16x32_bf16 v[68:71], a[68:71], a[100:103], v[68:71]
    ds_read_b128 a[60:63], v9 offset:14336
    v_mfma_f32_16x16x32_bf16 v[64:67], a[68:71], a[96:99], v[64:67]
    v_mfma_f32_16x16x32_bf16 v[96:99], a[72:75], a[96:99], v[96:99]
    ds_read_b64_tr_b16 a[0:1], v11 offset:24576
    v_mfma_f32_16x16x32_bf16 v[100:103], a[72:75], a[100:103], v[100:103]
    v_mfma_f32_16x16x32_bf16 v[104:107], a[72:75], a[104:107], v[104:107]
    ds_read_b64_tr_b16 a[2:3], v12 offset:24576
    v_mfma_f32_16x16x32_bf16 v[108:111], a[72:75], a[108:111], v[108:111]
    buffer_load_dwordx4 v4, s[36:39], s65 offen offset:1024  lds
    v_mfma_f32_16x16x32_bf16 v[112:115], a[72:75], a[112:115], v[112:115]
    ds_read_b64_tr_b16 a[4:5], v13 offset:24576
    v_mfma_f32_16x16x32_bf16 v[116:119], a[72:75], a[116:119], v[116:119]
    v_mfma_f32_16x16x32_bf16 v[120:123], a[72:75], a[120:123], v[120:123]
    ds_read_b64_tr_b16 a[6:7], v14 offset:24576
    v_mfma_f32_16x16x32_bf16 v[124:127], a[72:75], a[124:127], v[124:127]
    v_mfma_f32_16x16x32_bf16 v[156:159], a[76:79], a[124:127], v[156:159]
    ds_read_b64_tr_b16 a[8:9], v15 offset:24576
    v_mfma_f32_16x16x32_bf16 v[152:155], a[76:79], a[120:123], v[152:155]
    buffer_load_dwordx4 v3, s[36:39], s66 offen offset:2048  lds
    v_mfma_f32_16x16x32_bf16 v[148:151], a[76:79], a[116:119], v[148:151]
    ds_read_b64_tr_b16 a[10:11], v16 offset:24576
    v_mfma_f32_16x16x32_bf16 v[144:147], a[76:79], a[112:115], v[144:147]
    v_mfma_f32_16x16x32_bf16 v[140:143], a[76:79], a[108:111], v[140:143]
    ds_read_b64_tr_b16 a[12:13], v17 offset:24576
    v_mfma_f32_16x16x32_bf16 v[136:139], a[76:79], a[104:107], v[136:139]
    v_mfma_f32_16x16x32_bf16 v[132:135], a[76:79], a[100:103], v[132:135]
    ds_read_b64_tr_b16 a[14:15], v18 offset:24576
    v_mfma_f32_16x16x32_bf16 v[128:131], a[76:79], a[96:99], v[128:131]
    buffer_load_dwordx4 v4, s[36:39], s67 offen offset:3072  lds
    v_mfma_f32_16x16x32_bf16 a[144:147], a[132:135], a[192:195], a[144:147]
    ds_read_b64_tr_b16 a[16:17], v19 offset:24576
    v_mfma_f32_16x16x32_bf16 v[160:163], a[80:83], a[96:99], v[160:163]
    v_mfma_f32_16x16x32_bf16 v[164:167], a[80:83], a[100:103], v[164:167]
    ds_read_b64_tr_b16 a[18:19], v19 offset:25600
    v_mfma_f32_16x16x32_bf16 v[168:171], a[80:83], a[104:107], v[168:171]
    v_mfma_f32_16x16x32_bf16 v[172:175], a[80:83], a[108:111], v[172:175]
    ds_read_b64_tr_b16 a[20:21], v20 offset:24576
    s_add_u32 m0, m0, 4096
    v_mfma_f32_16x16x32_bf16 v[176:179], a[80:83], a[112:115], v[176:179]
    buffer_load_dwordx4 v3, s[36:39], s68 offen offset:0  lds
    v_mfma_f32_16x16x32_bf16 v[180:183], a[80:83], a[116:119], v[180:183]
    ds_read_b64_tr_b16 a[22:23], v20 offset:25600
    v_mfma_f32_16x16x32_bf16 v[184:187], a[80:83], a[120:123], v[184:187]
    v_mfma_f32_16x16x32_bf16 v[188:191], a[80:83], a[124:127], v[188:191]
    ds_read_b64_tr_b16 a[24:25], v21 offset:24576
    v_mfma_f32_16x16x32_bf16 v[220:223], a[84:87], a[124:127], v[220:223]
    v_mfma_f32_16x16x32_bf16 v[216:219], a[84:87], a[120:123], v[216:219]
    ds_read_b64_tr_b16 a[26:27], v21 offset:25600
    v_mfma_f32_16x16x32_bf16 v[212:215], a[84:87], a[116:119], v[212:215]
    buffer_load_dwordx4 v4, s[36:39], s69 offen offset:1024  lds
    v_mfma_f32_16x16x32_bf16 v[208:211], a[84:87], a[112:115], v[208:211]
    ds_read_b64_tr_b16 a[28:29], v22 offset:24576
    v_mfma_f32_16x16x32_bf16 v[204:207], a[84:87], a[108:111], v[204:207]
    v_mfma_f32_16x16x32_bf16 v[200:203], a[84:87], a[104:107], v[200:203]
    ds_read_b64_tr_b16 a[30:31], v22 offset:25600
    v_mfma_f32_16x16x32_bf16 v[196:199], a[84:87], a[100:103], v[196:199]
    v_mfma_f32_16x16x32_bf16 v[192:195], a[84:87], a[96:99], v[192:195]
    ds_read_b64_tr_b16 a[128:129], v23 offset:0
    v_mfma_f32_16x16x32_bf16 v[224:227], a[88:91], a[96:99], v[224:227]
    buffer_load_dwordx4 v3, s[36:39], s70 offen offset:2048  lds
    v_mfma_f32_16x16x32_bf16 v[228:231], a[88:91], a[100:103], v[228:231]
    ds_read_b64_tr_b16 a[130:131], v23 offset:256
    v_mfma_f32_16x16x32_bf16 v[232:235], a[88:91], a[104:107], v[232:235]
    v_mfma_f32_16x16x32_bf16 v[236:239], a[88:91], a[108:111], v[236:239]
    v_mfma_f32_16x16x32_bf16 v[240:243], a[88:91], a[112:115], v[240:243]
    v_mfma_f32_16x16x32_bf16 v[244:247], a[88:91], a[116:119], v[244:247]
    v_mfma_f32_16x16x32_bf16 v[248:251], a[88:91], a[120:123], v[248:251]
    buffer_load_dwordx4 v4, s[36:39], s71 offen offset:3072  lds
    v_mfma_f32_16x16x32_bf16 v[252:255], a[88:91], a[124:127], v[252:255]
    v_mfma_f32_16x16x32_bf16 a[176:179], a[92:95], a[124:127], a[176:179]
    v_add_u32 v3, 0x80, v3
    v_mfma_f32_16x16x32_bf16 a[172:175], a[92:95], a[120:123], a[172:175]
    v_mfma_f32_16x16x32_bf16 a[168:171], a[92:95], a[116:119], a[168:171]
    v_add_u32 v4, 0x80, v4
    v_mfma_f32_16x16x32_bf16 a[164:167], a[92:95], a[112:115], a[164:167]
    v_mfma_f32_16x16x32_bf16 a[160:163], a[92:95], a[108:111], a[160:163]
    s_waitcnt vmcnt(18) lgkmcnt(0)
    s_barrier
    v_mfma_f32_16x16x32_bf16 a[156:159], a[92:95], a[104:107], a[156:159]
    v_mfma_f32_16x16x32_bf16 a[152:155], a[92:95], a[100:103], a[152:155]
    v_mfma_f32_16x16x32_bf16 a[148:151], a[92:95], a[96:99], a[148:151]
    v_mfma_f32_16x16x32_bf16 v[32:35], a[0:3], a[32:35], v[32:35]
    ds_read_b128 a[96:99], v10 offset:0
    v_mfma_f32_16x16x32_bf16 v[36:39], a[0:3], a[36:39], v[36:39]
    buffer_load_dwordx4 a[188:191], v8, s[36:39], 0 offen offset:0
    v_mfma_f32_16x16x32_bf16 v[40:43], a[0:3], a[40:43], v[40:43]
    ds_read_b128 a[100:103], v10 offset:2048
    v_mfma_f32_16x16x32_bf16 v[44:47], a[0:3], a[44:47], v[44:47]
    v_mfma_f32_16x16x32_bf16 v[48:51], a[0:3], a[48:51], v[48:51]
    ds_read_b128 a[104:107], v10 offset:4096
    v_mfma_f32_16x16x32_bf16 v[52:55], a[0:3], a[52:55], v[52:55]
    v_mfma_f32_16x16x32_bf16 v[56:59], a[0:3], a[56:59], v[56:59]
    ds_read_b128 a[108:111], v10 offset:6144
    v_mfma_f32_16x16x32_bf16 v[60:63], a[0:3], a[60:63], v[60:63]
    buffer_load_dwordx4 a[192:195], v8, s[36:39], 0 offen offset:64
    v_mfma_f32_16x16x32_bf16 v[92:95], a[4:7], a[60:63], v[92:95]
    ds_read_b128 a[112:115], v10 offset:8192
    v_mfma_f32_16x16x32_bf16 v[88:91], a[4:7], a[56:59], v[88:91]
    v_add_u32 v8, 128, v8
    v_mfma_f32_16x16x32_bf16 v[84:87], a[4:7], a[52:55], v[84:87]
    ds_read_b128 a[116:119], v10 offset:10240
    v_mfma_f32_16x16x32_bf16 v[80:83], a[4:7], a[48:51], v[80:83]
    v_mfma_f32_16x16x32_bf16 v[76:79], a[4:7], a[44:47], v[76:79]
    ds_read_b128 a[120:123], v10 offset:12288
    s_add_u32 m0, s77, 16384
    v_mfma_f32_16x16x32_bf16 v[72:75], a[4:7], a[40:43], v[72:75]
    buffer_load_dwordx4 v5, s[40:43], 0 offen  lds
    v_mfma_f32_16x16x32_bf16 v[68:71], a[4:7], a[36:39], v[68:71]
    ds_read_b128 a[124:127], v10 offset:14336
    v_mfma_f32_16x16x32_bf16 v[64:67], a[4:7], a[32:35], v[64:67]
    v_mfma_f32_16x16x32_bf16 v[96:99], a[8:11], a[32:35], v[96:99]
    ds_read_b64_tr_b16 a[64:65], v11 offset:32768
    v_mfma_f32_16x16x32_bf16 v[100:103], a[8:11], a[36:39], v[100:103]
    v_mfma_f32_16x16x32_bf16 v[104:107], a[8:11], a[40:43], v[104:107]
    ds_read_b64_tr_b16 a[66:67], v12 offset:32768
    v_mfma_f32_16x16x32_bf16 v[108:111], a[8:11], a[44:47], v[108:111]
    buffer_load_dwordx4 v5, s[52:55], 0 offen offset:1024  lds
    v_mfma_f32_16x16x32_bf16 v[112:115], a[8:11], a[48:51], v[112:115]
    ds_read_b64_tr_b16 a[68:69], v13 offset:32768
    v_mfma_f32_16x16x32_bf16 v[116:119], a[8:11], a[52:55], v[116:119]
    v_mfma_f32_16x16x32_bf16 v[120:123], a[8:11], a[56:59], v[120:123]
    ds_read_b64_tr_b16 a[70:71], v14 offset:32768
    v_mfma_f32_16x16x32_bf16 v[124:127], a[8:11], a[60:63], v[124:127]
    v_mfma_f32_16x16x32_bf16 v[156:159], a[12:15], a[60:63], v[156:159]
    ds_read_b64_tr_b16 a[72:73], v15 offset:32768
    s_add_u32 m0, m0, 40960
    v_mfma_f32_16x16x32_bf16 v[152:155], a[12:15], a[56:59], v[152:155]
    buffer_load_dwordx4 v6, s[44:47], 0 offen  lds
    v_mfma_f32_16x16x32_bf16 v[148:151], a[12:15], a[52:55], v[148:151]
    ds_read_b64_tr_b16 a[74:75], v16 offset:32768
    v_mfma_f32_16x16x32_bf16 v[144:147], a[12:15], a[48:51], v[144:147]
    v_mfma_f32_16x16x32_bf16 v[140:143], a[12:15], a[44:47], v[140:143]
    ds_read_b64_tr_b16 a[76:77], v17 offset:32768
    v_mfma_f32_16x16x32_bf16 v[136:139], a[12:15], a[40:43], v[136:139]
    v_mfma_f32_16x16x32_bf16 v[132:135], a[12:15], a[36:39], v[132:135]
    ds_read_b64_tr_b16 a[78:79], v18 offset:32768
    v_mfma_f32_16x16x32_bf16 v[128:131], a[12:15], a[32:35], v[128:131]
    buffer_load_dwordx4 v6, s[44:47], s73 offen offset:1024  lds
    v_mfma_f32_16x16x32_bf16 a[144:147], a[128:131], a[180:183], a[144:147]
    ds_read_b64_tr_b16 a[80:81], v19 offset:32768
    v_mfma_f32_16x16x32_bf16 v[160:163], a[16:19], a[32:35], v[160:163]
    v_mfma_f32_16x16x32_bf16 v[164:167], a[16:19], a[36:39], v[164:167]
    ds_read_b64_tr_b16 a[82:83], v19 offset:33792
    v_mfma_f32_16x16x32_bf16 v[168:171], a[16:19], a[40:43], v[168:171]
    v_mfma_f32_16x16x32_bf16 v[172:175], a[16:19], a[44:47], v[172:175]
    ds_read_b64_tr_b16 a[84:85], v20 offset:32768
    s_add_u32 m0, s77, 24576
    v_mfma_f32_16x16x32_bf16 v[176:179], a[16:19], a[48:51], v[176:179]
    buffer_load_dwordx4 v5, s[40:43], s72 offen  lds
    v_mfma_f32_16x16x32_bf16 v[180:183], a[16:19], a[52:55], v[180:183]
    ds_read_b64_tr_b16 a[86:87], v20 offset:33792
    v_mfma_f32_16x16x32_bf16 v[184:187], a[16:19], a[56:59], v[184:187]
    v_mfma_f32_16x16x32_bf16 v[188:191], a[16:19], a[60:63], v[188:191]
    ds_read_b64_tr_b16 a[88:89], v21 offset:32768
    v_mfma_f32_16x16x32_bf16 v[220:223], a[20:23], a[60:63], v[220:223]
    v_mfma_f32_16x16x32_bf16 v[216:219], a[20:23], a[56:59], v[216:219]
    ds_read_b64_tr_b16 a[90:91], v21 offset:33792
    v_mfma_f32_16x16x32_bf16 v[212:215], a[20:23], a[52:55], v[212:215]
    buffer_load_dwordx4 v5, s[52:55], s72 offen offset:1024  lds
    v_mfma_f32_16x16x32_bf16 v[208:211], a[20:23], a[48:51], v[208:211]
    ds_read_b64_tr_b16 a[92:93], v22 offset:32768
    v_mfma_f32_16x16x32_bf16 v[204:207], a[20:23], a[44:47], v[204:207]
    v_mfma_f32_16x16x32_bf16 v[200:203], a[20:23], a[40:43], v[200:203]
    ds_read_b64_tr_b16 a[94:95], v22 offset:33792
    v_mfma_f32_16x16x32_bf16 v[196:199], a[20:23], a[36:39], v[196:199]
    v_mfma_f32_16x16x32_bf16 v[192:195], a[20:23], a[32:35], v[192:195]
    ds_read_b64_tr_b16 a[132:133], v23 offset:2048
    s_add_u32 m0, m0, 40960
    v_mfma_f32_16x16x32_bf16 v[224:227], a[24:27], a[32:35], v[224:227]
    buffer_load_dwordx4 v6, s[44:47], s74 offen  lds
    v_mfma_f32_16x16x32_bf16 v[228:231], a[24:27], a[36:39], v[228:231]
    ds_read_b64_tr_b16 a[134:135], v23 offset:2304
    v_mfma_f32_16x16x32_bf16 v[232:235], a[24:27], a[40:43], v[232:235]
    v_mfma_f32_16x16x32_bf16 v[236:239], a[24:27], a[44:47], v[236:239]
    v_mfma_f32_16x16x32_bf16 v[240:243], a[24:27], a[48:51], v[240:243]
    v_mfma_f32_16x16x32_bf16 v[244:247], a[24:27], a[52:55], v[244:247]
    v_mfma_f32_16x16x32_bf16 v[248:251], a[24:27], a[56:59], v[248:251]
    buffer_load_dwordx4 v6, s[44:47], s75 offen offset:1024  lds
    v_mfma_f32_16x16x32_bf16 v[252:255], a[24:27], a[60:63], v[252:255]
    v_mfma_f32_16x16x32_bf16 a[176:179], a[28:31], a[60:63], a[176:179]
    v_add_u32 v5, 458752, v5
    v_mfma_f32_16x16x32_bf16 a[172:175], a[28:31], a[56:59], a[172:175]
    v_add_u32 v6, s15, v6
    v_mfma_f32_16x16x32_bf16 a[168:171], a[28:31], a[52:55], a[168:171]
    v_mfma_f32_16x16x32_bf16 a[164:167], a[28:31], a[48:51], a[164:167]
    v_mfma_f32_16x16x32_bf16 a[160:163], a[28:31], a[44:47], a[160:163]
    s_waitcnt vmcnt(10) lgkmcnt(0)
    s_barrier
    v_mfma_f32_16x16x32_bf16 a[156:159], a[28:31], a[40:43], a[156:159]
    v_mfma_f32_16x16x32_bf16 a[152:155], a[28:31], a[36:39], a[152:155]
    v_mfma_f32_16x16x32_bf16 a[148:151], a[28:31], a[32:35], a[148:151]
    v_mfma_f32_16x16x32_bf16 v[32:35], a[64:67], a[96:99], v[32:35]
    ds_read_b128 a[32:35], v9 offset:32768
    s_add_u32 m0, s78, 0
    v_mfma_f32_16x16x32_bf16 v[36:39], a[64:67], a[100:103], v[36:39]
    buffer_load_dwordx4 v7, s[48:51], 0 offen lds
    v_mfma_f32_16x16x32_bf16 v[40:43], a[64:67], a[104:107], v[40:43]
    ds_read_b128 a[36:39], v9 offset:34816
    v_mfma_f32_16x16x32_bf16 v[44:47], a[64:67], a[108:111], v[44:47]
    v_mfma_f32_16x16x32_bf16 v[48:51], a[64:67], a[112:115], v[48:51]
    ds_read_b128 a[40:43], v9 offset:36864
    v_mfma_f32_16x16x32_bf16 v[52:55], a[64:67], a[116:119], v[52:55]
    v_mfma_f32_16x16x32_bf16 v[56:59], a[64:67], a[120:123], v[56:59]
    ds_read_b128 a[44:47], v9 offset:38912
    v_mfma_f32_16x16x32_bf16 v[60:63], a[64:67], a[124:127], v[60:63]
    buffer_load_dwordx4 v7, s[48:51], 0 offen offset:1024 lds
    v_mfma_f32_16x16x32_bf16 v[92:95], a[68:71], a[124:127], v[92:95]
    ds_read_b128 a[48:51], v9 offset:40960
    v_mfma_f32_16x16x32_bf16 v[88:91], a[68:71], a[120:123], v[88:91]
    v_add_u32 v7, 4096, v7
    v_mfma_f32_16x16x32_bf16 v[84:87], a[68:71], a[116:119], v[84:87]
    ds_read_b128 a[52:55], v9 offset:43008
    v_mfma_f32_16x16x32_bf16 v[80:83], a[68:71], a[112:115], v[80:83]
    v_mfma_f32_16x16x32_bf16 v[76:79], a[68:71], a[108:111], v[76:79]
    ds_read_b128 a[56:59], v9 offset:45056
    s_add_u32 m0, s76, 0
    v_mfma_f32_16x16x32_bf16 v[72:75], a[68:71], a[104:107], v[72:75]
    buffer_load_dwordx4 v3, s[36:39], 0 offen offset:0  lds
    v_mfma_f32_16x16x32_bf16 v[68:71], a[68:71], a[100:103], v[68:71]
    ds_read_b128 a[60:63], v9 offset:47104
    v_mfma_f32_16x16x32_bf16 v[64:67], a[68:71], a[96:99], v[64:67]
    v_mfma_f32_16x16x32_bf16 v[96:99], a[72:75], a[96:99], v[96:99]
    ds_read_b64_tr_b16 a[0:1], v11 offset:0
    v_mfma_f32_16x16x32_bf16 v[100:103], a[72:75], a[100:103], v[100:103]
    v_mfma_f32_16x16x32_bf16 v[104:107], a[72:75], a[104:107], v[104:107]
    ds_read_b64_tr_b16 a[2:3], v12 offset:0
    v_mfma_f32_16x16x32_bf16 v[108:111], a[72:75], a[108:111], v[108:111]
    buffer_load_dwordx4 v4, s[36:39], s65 offen offset:1024  lds
    v_mfma_f32_16x16x32_bf16 v[112:115], a[72:75], a[112:115], v[112:115]
    ds_read_b64_tr_b16 a[4:5], v13 offset:0
    v_mfma_f32_16x16x32_bf16 v[116:119], a[72:75], a[116:119], v[116:119]
    v_mfma_f32_16x16x32_bf16 v[120:123], a[72:75], a[120:123], v[120:123]
    ds_read_b64_tr_b16 a[6:7], v14 offset:0
    v_mfma_f32_16x16x32_bf16 v[124:127], a[72:75], a[124:127], v[124:127]
    v_mfma_f32_16x16x32_bf16 v[156:159], a[76:79], a[124:127], v[156:159]
    ds_read_b64_tr_b16 a[8:9], v15 offset:0
    v_mfma_f32_16x16x32_bf16 v[152:155], a[76:79], a[120:123], v[152:155]
    buffer_load_dwordx4 v3, s[36:39], s66 offen offset:2048  lds
    v_mfma_f32_16x16x32_bf16 v[148:151], a[76:79], a[116:119], v[148:151]
    ds_read_b64_tr_b16 a[10:11], v16 offset:0
    v_mfma_f32_16x16x32_bf16 v[144:147], a[76:79], a[112:115], v[144:147]
    v_mfma_f32_16x16x32_bf16 v[140:143], a[76:79], a[108:111], v[140:143]
    ds_read_b64_tr_b16 a[12:13], v17 offset:0
    v_mfma_f32_16x16x32_bf16 v[136:139], a[76:79], a[104:107], v[136:139]
    v_mfma_f32_16x16x32_bf16 v[132:135], a[76:79], a[100:103], v[132:135]
    ds_read_b64_tr_b16 a[14:15], v18 offset:0
    v_mfma_f32_16x16x32_bf16 v[128:131], a[76:79], a[96:99], v[128:131]
    buffer_load_dwordx4 v4, s[36:39], s67 offen offset:3072  lds
    v_mfma_f32_16x16x32_bf16 a[144:147], a[132:135], a[184:187], a[144:147]
    ds_read_b64_tr_b16 a[16:17], v19 offset:0
    v_mfma_f32_16x16x32_bf16 v[160:163], a[80:83], a[96:99], v[160:163]
    v_mfma_f32_16x16x32_bf16 v[164:167], a[80:83], a[100:103], v[164:167]
    ds_read_b64_tr_b16 a[18:19], v19 offset:1024
    v_mfma_f32_16x16x32_bf16 v[168:171], a[80:83], a[104:107], v[168:171]
    v_mfma_f32_16x16x32_bf16 v[172:175], a[80:83], a[108:111], v[172:175]
    ds_read_b64_tr_b16 a[20:21], v20 offset:0
    s_add_u32 m0, m0, 4096
    v_mfma_f32_16x16x32_bf16 v[176:179], a[80:83], a[112:115], v[176:179]
    buffer_load_dwordx4 v3, s[36:39], s68 offen offset:0  lds
    v_mfma_f32_16x16x32_bf16 v[180:183], a[80:83], a[116:119], v[180:183]
    ds_read_b64_tr_b16 a[22:23], v20 offset:1024
    v_mfma_f32_16x16x32_bf16 v[184:187], a[80:83], a[120:123], v[184:187]
    v_mfma_f32_16x16x32_bf16 v[188:191], a[80:83], a[124:127], v[188:191]
    ds_read_b64_tr_b16 a[24:25], v21 offset:0
    v_mfma_f32_16x16x32_bf16 v[220:223], a[84:87], a[124:127], v[220:223]
    v_mfma_f32_16x16x32_bf16 v[216:219], a[84:87], a[120:123], v[216:219]
    ds_read_b64_tr_b16 a[26:27], v21 offset:1024
    v_mfma_f32_16x16x32_bf16 v[212:215], a[84:87], a[116:119], v[212:215]
    buffer_load_dwordx4 v4, s[36:39], s69 offen offset:1024  lds
    v_mfma_f32_16x16x32_bf16 v[208:211], a[84:87], a[112:115], v[208:211]
    ds_read_b64_tr_b16 a[28:29], v22 offset:0
    v_mfma_f32_16x16x32_bf16 v[204:207], a[84:87], a[108:111], v[204:207]
    v_mfma_f32_16x16x32_bf16 v[200:203], a[84:87], a[104:107], v[200:203]
    ds_read_b64_tr_b16 a[30:31], v22 offset:1024
    v_mfma_f32_16x16x32_bf16 v[196:199], a[84:87], a[100:103], v[196:199]
    v_mfma_f32_16x16x32_bf16 v[192:195], a[84:87], a[96:99], v[192:195]
    ds_read_b64_tr_b16 a[128:129], v23 offset:8192
    v_mfma_f32_16x16x32_bf16 v[224:227], a[88:91], a[96:99], v[224:227]
    buffer_load_dwordx4 v3, s[36:39], s70 offen offset:2048  lds
    v_mfma_f32_16x16x32_bf16 v[228:231], a[88:91], a[100:103], v[228:231]
    ds_read_b64_tr_b16 a[130:131], v23 offset:8448
    v_mfma_f32_16x16x32_bf16 v[232:235], a[88:91], a[104:107], v[232:235]
    v_mfma_f32_16x16x32_bf16 v[236:239], a[88:91], a[108:111], v[236:239]
    v_mfma_f32_16x16x32_bf16 v[240:243], a[88:91], a[112:115], v[240:243]
    v_mfma_f32_16x16x32_bf16 v[244:247], a[88:91], a[116:119], v[244:247]
    v_mfma_f32_16x16x32_bf16 v[248:251], a[88:91], a[120:123], v[248:251]
    buffer_load_dwordx4 v4, s[36:39], s71 offen offset:3072  lds
    v_mfma_f32_16x16x32_bf16 v[252:255], a[88:91], a[124:127], v[252:255]
    v_mfma_f32_16x16x32_bf16 a[176:179], a[92:95], a[124:127], a[176:179]
    v_add_u32 v3, 0x80, v3
    v_mfma_f32_16x16x32_bf16 a[172:175], a[92:95], a[120:123], a[172:175]
    v_mfma_f32_16x16x32_bf16 a[168:171], a[92:95], a[116:119], a[168:171]
    v_add_u32 v4, 0x80, v4
    v_mfma_f32_16x16x32_bf16 a[164:167], a[92:95], a[112:115], a[164:167]
    v_mfma_f32_16x16x32_bf16 a[160:163], a[92:95], a[108:111], a[160:163]
    s_waitcnt vmcnt(18) lgkmcnt(0)
    s_barrier
    v_mfma_f32_16x16x32_bf16 a[156:159], a[92:95], a[104:107], a[156:159]
    v_mfma_f32_16x16x32_bf16 a[152:155], a[92:95], a[100:103], a[152:155]
    v_mfma_f32_16x16x32_bf16 a[148:151], a[92:95], a[96:99], a[148:151]
    v_mfma_f32_16x16x32_bf16 v[32:35], a[0:3], a[32:35], v[32:35]
    ds_read_b128 a[96:99], v10 offset:32768
    v_mfma_f32_16x16x32_bf16 v[36:39], a[0:3], a[36:39], v[36:39]
    buffer_load_dwordx4 a[180:183], v8, s[36:39], 0 offen offset:0
    v_mfma_f32_16x16x32_bf16 v[40:43], a[0:3], a[40:43], v[40:43]
    ds_read_b128 a[100:103], v10 offset:34816
    v_mfma_f32_16x16x32_bf16 v[44:47], a[0:3], a[44:47], v[44:47]
    v_mfma_f32_16x16x32_bf16 v[48:51], a[0:3], a[48:51], v[48:51]
    ds_read_b128 a[104:107], v10 offset:36864
    v_mfma_f32_16x16x32_bf16 v[52:55], a[0:3], a[52:55], v[52:55]
    v_mfma_f32_16x16x32_bf16 v[56:59], a[0:3], a[56:59], v[56:59]
    ds_read_b128 a[108:111], v10 offset:38912
    v_mfma_f32_16x16x32_bf16 v[60:63], a[0:3], a[60:63], v[60:63]
    buffer_load_dwordx4 a[184:187], v8, s[36:39], 0 offen offset:64
    v_mfma_f32_16x16x32_bf16 v[92:95], a[4:7], a[60:63], v[92:95]
    ds_read_b128 a[112:115], v10 offset:40960
    v_mfma_f32_16x16x32_bf16 v[88:91], a[4:7], a[56:59], v[88:91]
    v_add_u32 v8, 128, v8
    v_mfma_f32_16x16x32_bf16 v[84:87], a[4:7], a[52:55], v[84:87]
    ds_read_b128 a[116:119], v10 offset:43008
    v_mfma_f32_16x16x32_bf16 v[80:83], a[4:7], a[48:51], v[80:83]
    v_mfma_f32_16x16x32_bf16 v[76:79], a[4:7], a[44:47], v[76:79]
    ds_read_b128 a[120:123], v10 offset:45056
    s_add_u32 m0, s77, 32768
    v_mfma_f32_16x16x32_bf16 v[72:75], a[4:7], a[40:43], v[72:75]
    buffer_load_dwordx4 v5, s[40:43], 0 offen  lds
    v_mfma_f32_16x16x32_bf16 v[68:71], a[4:7], a[36:39], v[68:71]
    ds_read_b128 a[124:127], v10 offset:47104
    v_mfma_f32_16x16x32_bf16 v[64:67], a[4:7], a[32:35], v[64:67]
    v_mfma_f32_16x16x32_bf16 v[96:99], a[8:11], a[32:35], v[96:99]
    ds_read_b64_tr_b16 a[64:65], v11 offset:8192
    v_mfma_f32_16x16x32_bf16 v[100:103], a[8:11], a[36:39], v[100:103]
    v_mfma_f32_16x16x32_bf16 v[104:107], a[8:11], a[40:43], v[104:107]
    ds_read_b64_tr_b16 a[66:67], v12 offset:8192
    v_mfma_f32_16x16x32_bf16 v[108:111], a[8:11], a[44:47], v[108:111]
    buffer_load_dwordx4 v5, s[52:55], 0 offen offset:1024  lds
    v_mfma_f32_16x16x32_bf16 v[112:115], a[8:11], a[48:51], v[112:115]
    ds_read_b64_tr_b16 a[68:69], v13 offset:8192
    v_mfma_f32_16x16x32_bf16 v[116:119], a[8:11], a[52:55], v[116:119]
    v_mfma_f32_16x16x32_bf16 v[120:123], a[8:11], a[56:59], v[120:123]
    ds_read_b64_tr_b16 a[70:71], v14 offset:8192
    v_mfma_f32_16x16x32_bf16 v[124:127], a[8:11], a[60:63], v[124:127]
    v_mfma_f32_16x16x32_bf16 v[156:159], a[12:15], a[60:63], v[156:159]
    ds_read_b64_tr_b16 a[72:73], v15 offset:8192
    s_add_u32 m0, m0, 40960
    v_mfma_f32_16x16x32_bf16 v[152:155], a[12:15], a[56:59], v[152:155]
    buffer_load_dwordx4 v6, s[44:47], 0 offen  lds
    v_mfma_f32_16x16x32_bf16 v[148:151], a[12:15], a[52:55], v[148:151]
    ds_read_b64_tr_b16 a[74:75], v16 offset:8192
    v_mfma_f32_16x16x32_bf16 v[144:147], a[12:15], a[48:51], v[144:147]
    v_mfma_f32_16x16x32_bf16 v[140:143], a[12:15], a[44:47], v[140:143]
    ds_read_b64_tr_b16 a[76:77], v17 offset:8192
    v_mfma_f32_16x16x32_bf16 v[136:139], a[12:15], a[40:43], v[136:139]
    v_mfma_f32_16x16x32_bf16 v[132:135], a[12:15], a[36:39], v[132:135]
    ds_read_b64_tr_b16 a[78:79], v18 offset:8192
    v_mfma_f32_16x16x32_bf16 v[128:131], a[12:15], a[32:35], v[128:131]
    buffer_load_dwordx4 v6, s[44:47], s73 offen offset:1024  lds
    v_mfma_f32_16x16x32_bf16 a[144:147], a[128:131], a[188:191], a[144:147]
    ds_read_b64_tr_b16 a[80:81], v19 offset:8192
    v_mfma_f32_16x16x32_bf16 v[160:163], a[16:19], a[32:35], v[160:163]
    v_mfma_f32_16x16x32_bf16 v[164:167], a[16:19], a[36:39], v[164:167]
    ds_read_b64_tr_b16 a[82:83], v19 offset:9216
    v_mfma_f32_16x16x32_bf16 v[168:171], a[16:19], a[40:43], v[168:171]
    v_mfma_f32_16x16x32_bf16 v[172:175], a[16:19], a[44:47], v[172:175]
    ds_read_b64_tr_b16 a[84:85], v20 offset:8192
    s_add_u32 m0, s77, 0
    v_mfma_f32_16x16x32_bf16 v[176:179], a[16:19], a[48:51], v[176:179]
    buffer_load_dwordx4 v5, s[40:43], s72 offen  lds
    v_mfma_f32_16x16x32_bf16 v[180:183], a[16:19], a[52:55], v[180:183]
    ds_read_b64_tr_b16 a[86:87], v20 offset:9216
    v_mfma_f32_16x16x32_bf16 v[184:187], a[16:19], a[56:59], v[184:187]
    v_mfma_f32_16x16x32_bf16 v[188:191], a[16:19], a[60:63], v[188:191]
    ds_read_b64_tr_b16 a[88:89], v21 offset:8192
    v_mfma_f32_16x16x32_bf16 v[220:223], a[20:23], a[60:63], v[220:223]
    v_mfma_f32_16x16x32_bf16 v[216:219], a[20:23], a[56:59], v[216:219]
    ds_read_b64_tr_b16 a[90:91], v21 offset:9216
    v_mfma_f32_16x16x32_bf16 v[212:215], a[20:23], a[52:55], v[212:215]
    buffer_load_dwordx4 v5, s[52:55], s72 offen offset:1024  lds
    v_mfma_f32_16x16x32_bf16 v[208:211], a[20:23], a[48:51], v[208:211]
    ds_read_b64_tr_b16 a[92:93], v22 offset:8192
    v_mfma_f32_16x16x32_bf16 v[204:207], a[20:23], a[44:47], v[204:207]
    v_mfma_f32_16x16x32_bf16 v[200:203], a[20:23], a[40:43], v[200:203]
    ds_read_b64_tr_b16 a[94:95], v22 offset:9216
    v_mfma_f32_16x16x32_bf16 v[196:199], a[20:23], a[36:39], v[196:199]
    v_mfma_f32_16x16x32_bf16 v[192:195], a[20:23], a[32:35], v[192:195]
    ds_read_b64_tr_b16 a[132:133], v23 offset:10240
    s_add_u32 m0, m0, 40960
    v_mfma_f32_16x16x32_bf16 v[224:227], a[24:27], a[32:35], v[224:227]
    buffer_load_dwordx4 v6, s[44:47], s74 offen  lds
    v_mfma_f32_16x16x32_bf16 v[228:231], a[24:27], a[36:39], v[228:231]
    ds_read_b64_tr_b16 a[134:135], v23 offset:10496
    v_mfma_f32_16x16x32_bf16 v[232:235], a[24:27], a[40:43], v[232:235]
    v_mfma_f32_16x16x32_bf16 v[236:239], a[24:27], a[44:47], v[236:239]
    v_mfma_f32_16x16x32_bf16 v[240:243], a[24:27], a[48:51], v[240:243]
    v_mfma_f32_16x16x32_bf16 v[244:247], a[24:27], a[52:55], v[244:247]
    v_mfma_f32_16x16x32_bf16 v[248:251], a[24:27], a[56:59], v[248:251]
    buffer_load_dwordx4 v6, s[44:47], s75 offen offset:1024  lds
    v_mfma_f32_16x16x32_bf16 v[252:255], a[24:27], a[60:63], v[252:255]
    v_mfma_f32_16x16x32_bf16 a[176:179], a[28:31], a[60:63], a[176:179]
    v_add_u32 v5, 458752, v5
    v_mfma_f32_16x16x32_bf16 a[172:175], a[28:31], a[56:59], a[172:175]
    v_add_u32 v6, s15, v6
    v_mfma_f32_16x16x32_bf16 a[168:171], a[28:31], a[52:55], a[168:171]
    v_mfma_f32_16x16x32_bf16 a[164:167], a[28:31], a[48:51], a[164:167]
    v_mfma_f32_16x16x32_bf16 a[160:163], a[28:31], a[44:47], a[160:163]
    s_waitcnt vmcnt(10) lgkmcnt(0)
    s_barrier
    v_mfma_f32_16x16x32_bf16 a[156:159], a[28:31], a[40:43], a[156:159]
    v_mfma_f32_16x16x32_bf16 a[152:155], a[28:31], a[36:39], a[152:155]
    v_mfma_f32_16x16x32_bf16 a[148:151], a[28:31], a[32:35], a[148:151]
    v_mfma_f32_16x16x32_bf16 v[32:35], a[64:67], a[96:99], v[32:35]
    ds_read_b128 a[32:35], v9 offset:0
    s_add_u32 m0, s78, 8192
    v_mfma_f32_16x16x32_bf16 v[36:39], a[64:67], a[100:103], v[36:39]
    buffer_load_dwordx4 v7, s[48:51], 0 offen lds
    v_mfma_f32_16x16x32_bf16 v[40:43], a[64:67], a[104:107], v[40:43]
    ds_read_b128 a[36:39], v9 offset:2048
    v_mfma_f32_16x16x32_bf16 v[44:47], a[64:67], a[108:111], v[44:47]
    v_mfma_f32_16x16x32_bf16 v[48:51], a[64:67], a[112:115], v[48:51]
    ds_read_b128 a[40:43], v9 offset:4096
    v_mfma_f32_16x16x32_bf16 v[52:55], a[64:67], a[116:119], v[52:55]
    v_mfma_f32_16x16x32_bf16 v[56:59], a[64:67], a[120:123], v[56:59]
    ds_read_b128 a[44:47], v9 offset:6144
    v_mfma_f32_16x16x32_bf16 v[60:63], a[64:67], a[124:127], v[60:63]
    buffer_load_dwordx4 v7, s[48:51], 0 offen offset:1024 lds
    v_mfma_f32_16x16x32_bf16 v[92:95], a[68:71], a[124:127], v[92:95]
    ds_read_b128 a[48:51], v9 offset:8192
    v_mfma_f32_16x16x32_bf16 v[88:91], a[68:71], a[120:123], v[88:91]
    v_add_u32 v7, 4096, v7
    v_mfma_f32_16x16x32_bf16 v[84:87], a[68:71], a[116:119], v[84:87]
    ds_read_b128 a[52:55], v9 offset:10240
    v_mfma_f32_16x16x32_bf16 v[80:83], a[68:71], a[112:115], v[80:83]
    v_mfma_f32_16x16x32_bf16 v[76:79], a[68:71], a[108:111], v[76:79]
    ds_read_b128 a[56:59], v9 offset:12288
    s_add_u32 m0, s76, 32768
    v_mfma_f32_16x16x32_bf16 v[72:75], a[68:71], a[104:107], v[72:75]
    buffer_load_dwordx4 v3, s[36:39], 0 offen offset:0  lds
    v_mfma_f32_16x16x32_bf16 v[68:71], a[68:71], a[100:103], v[68:71]
    ds_read_b128 a[60:63], v9 offset:14336
    v_mfma_f32_16x16x32_bf16 v[64:67], a[68:71], a[96:99], v[64:67]
    v_mfma_f32_16x16x32_bf16 v[96:99], a[72:75], a[96:99], v[96:99]
    ds_read_b64_tr_b16 a[0:1], v11 offset:16384
    v_mfma_f32_16x16x32_bf16 v[100:103], a[72:75], a[100:103], v[100:103]
    v_mfma_f32_16x16x32_bf16 v[104:107], a[72:75], a[104:107], v[104:107]
    ds_read_b64_tr_b16 a[2:3], v12 offset:16384
    v_mfma_f32_16x16x32_bf16 v[108:111], a[72:75], a[108:111], v[108:111]
    buffer_load_dwordx4 v4, s[36:39], s65 offen offset:1024  lds
    v_mfma_f32_16x16x32_bf16 v[112:115], a[72:75], a[112:115], v[112:115]
    ds_read_b64_tr_b16 a[4:5], v13 offset:16384
    v_mfma_f32_16x16x32_bf16 v[116:119], a[72:75], a[116:119], v[116:119]
    v_mfma_f32_16x16x32_bf16 v[120:123], a[72:75], a[120:123], v[120:123]
    ds_read_b64_tr_b16 a[6:7], v14 offset:16384
    v_mfma_f32_16x16x32_bf16 v[124:127], a[72:75], a[124:127], v[124:127]
    v_mfma_f32_16x16x32_bf16 v[156:159], a[76:79], a[124:127], v[156:159]
    ds_read_b64_tr_b16 a[8:9], v15 offset:16384
    v_mfma_f32_16x16x32_bf16 v[152:155], a[76:79], a[120:123], v[152:155]
    buffer_load_dwordx4 v3, s[36:39], s66 offen offset:2048  lds
    v_mfma_f32_16x16x32_bf16 v[148:151], a[76:79], a[116:119], v[148:151]
    ds_read_b64_tr_b16 a[10:11], v16 offset:16384
    v_mfma_f32_16x16x32_bf16 v[144:147], a[76:79], a[112:115], v[144:147]
    v_mfma_f32_16x16x32_bf16 v[140:143], a[76:79], a[108:111], v[140:143]
    ds_read_b64_tr_b16 a[12:13], v17 offset:16384
    v_mfma_f32_16x16x32_bf16 v[136:139], a[76:79], a[104:107], v[136:139]
    v_mfma_f32_16x16x32_bf16 v[132:135], a[76:79], a[100:103], v[132:135]
    ds_read_b64_tr_b16 a[14:15], v18 offset:16384
    v_mfma_f32_16x16x32_bf16 v[128:131], a[76:79], a[96:99], v[128:131]
    buffer_load_dwordx4 v4, s[36:39], s67 offen offset:3072  lds
    v_mfma_f32_16x16x32_bf16 a[144:147], a[132:135], a[192:195], a[144:147]
    ds_read_b64_tr_b16 a[16:17], v19 offset:16384
    v_mfma_f32_16x16x32_bf16 v[160:163], a[80:83], a[96:99], v[160:163]
    v_mfma_f32_16x16x32_bf16 v[164:167], a[80:83], a[100:103], v[164:167]
    ds_read_b64_tr_b16 a[18:19], v19 offset:17408
    v_mfma_f32_16x16x32_bf16 v[168:171], a[80:83], a[104:107], v[168:171]
    v_mfma_f32_16x16x32_bf16 v[172:175], a[80:83], a[108:111], v[172:175]
    ds_read_b64_tr_b16 a[20:21], v20 offset:16384
    s_add_u32 m0, m0, 4096
    v_mfma_f32_16x16x32_bf16 v[176:179], a[80:83], a[112:115], v[176:179]
    buffer_load_dwordx4 v3, s[36:39], s68 offen offset:0  lds
    v_mfma_f32_16x16x32_bf16 v[180:183], a[80:83], a[116:119], v[180:183]
    ds_read_b64_tr_b16 a[22:23], v20 offset:17408
    v_mfma_f32_16x16x32_bf16 v[184:187], a[80:83], a[120:123], v[184:187]
    v_mfma_f32_16x16x32_bf16 v[188:191], a[80:83], a[124:127], v[188:191]
    ds_read_b64_tr_b16 a[24:25], v21 offset:16384
    v_mfma_f32_16x16x32_bf16 v[220:223], a[84:87], a[124:127], v[220:223]
    v_mfma_f32_16x16x32_bf16 v[216:219], a[84:87], a[120:123], v[216:219]
    ds_read_b64_tr_b16 a[26:27], v21 offset:17408
    v_mfma_f32_16x16x32_bf16 v[212:215], a[84:87], a[116:119], v[212:215]
    buffer_load_dwordx4 v4, s[36:39], s69 offen offset:1024  lds
    v_mfma_f32_16x16x32_bf16 v[208:211], a[84:87], a[112:115], v[208:211]
    ds_read_b64_tr_b16 a[28:29], v22 offset:16384
    v_mfma_f32_16x16x32_bf16 v[204:207], a[84:87], a[108:111], v[204:207]
    v_mfma_f32_16x16x32_bf16 v[200:203], a[84:87], a[104:107], v[200:203]
    ds_read_b64_tr_b16 a[30:31], v22 offset:17408
    v_mfma_f32_16x16x32_bf16 v[196:199], a[84:87], a[100:103], v[196:199]
    v_mfma_f32_16x16x32_bf16 v[192:195], a[84:87], a[96:99], v[192:195]
    ds_read_b64_tr_b16 a[128:129], v23 offset:0
    v_mfma_f32_16x16x32_bf16 v[224:227], a[88:91], a[96:99], v[224:227]
    buffer_load_dwordx4 v3, s[36:39], s70 offen offset:2048  lds
    v_mfma_f32_16x16x32_bf16 v[228:231], a[88:91], a[100:103], v[228:231]
    ds_read_b64_tr_b16 a[130:131], v23 offset:256
    v_mfma_f32_16x16x32_bf16 v[232:235], a[88:91], a[104:107], v[232:235]
    v_mfma_f32_16x16x32_bf16 v[236:239], a[88:91], a[108:111], v[236:239]
    v_mfma_f32_16x16x32_bf16 v[240:243], a[88:91], a[112:115], v[240:243]
    v_mfma_f32_16x16x32_bf16 v[244:247], a[88:91], a[116:119], v[244:247]
    v_mfma_f32_16x16x32_bf16 v[248:251], a[88:91], a[120:123], v[248:251]
    buffer_load_dwordx4 v4, s[36:39], s71 offen offset:3072  lds
    v_mfma_f32_16x16x32_bf16 v[252:255], a[88:91], a[124:127], v[252:255]
    v_mfma_f32_16x16x32_bf16 a[176:179], a[92:95], a[124:127], a[176:179]
    v_add_u32 v3, 0x80, v3
    v_mfma_f32_16x16x32_bf16 a[172:175], a[92:95], a[120:123], a[172:175]
    v_mfma_f32_16x16x32_bf16 a[168:171], a[92:95], a[116:119], a[168:171]
    v_add_u32 v4, 0x80, v4
    v_mfma_f32_16x16x32_bf16 a[164:167], a[92:95], a[112:115], a[164:167]
    v_mfma_f32_16x16x32_bf16 a[160:163], a[92:95], a[108:111], a[160:163]
    s_waitcnt vmcnt(18) lgkmcnt(0)
    s_barrier
    v_mfma_f32_16x16x32_bf16 a[156:159], a[92:95], a[104:107], a[156:159]
    v_mfma_f32_16x16x32_bf16 a[152:155], a[92:95], a[100:103], a[152:155]
    v_mfma_f32_16x16x32_bf16 a[148:151], a[92:95], a[96:99], a[148:151]
    v_mfma_f32_16x16x32_bf16 v[32:35], a[0:3], a[32:35], v[32:35]
    ds_read_b128 a[96:99], v10 offset:0
    v_mfma_f32_16x16x32_bf16 v[36:39], a[0:3], a[36:39], v[36:39]
    buffer_load_dwordx4 a[188:191], v8, s[36:39], 0 offen offset:0
    v_mfma_f32_16x16x32_bf16 v[40:43], a[0:3], a[40:43], v[40:43]
    ds_read_b128 a[100:103], v10 offset:2048
    s_mov_b32 s48, s20
    v_mfma_f32_16x16x32_bf16 v[44:47], a[0:3], a[44:47], v[44:47]
    s_mov_b32 s49, s21
    s_mov_b32 s50, 7340032
    v_mfma_f32_16x16x32_bf16 v[48:51], a[0:3], a[48:51], v[48:51]
    ds_read_b128 a[104:107], v10 offset:4096
    v_mfma_f32_16x16x32_bf16 v[52:55], a[0:3], a[52:55], v[52:55]
    buffer_load_dwordx4 a[136:139], v27, s[48:51], 0 offen
    v_mfma_f32_16x16x32_bf16 v[56:59], a[0:3], a[56:59], v[56:59]
    ds_read_b128 a[108:111], v10 offset:6144
    s_mov_b32 s48, s12
    v_mfma_f32_16x16x32_bf16 v[60:63], a[0:3], a[60:63], v[60:63]
    buffer_load_dwordx4 a[192:195], v8, s[36:39], 0 offen offset:64
    v_mfma_f32_16x16x32_bf16 v[92:95], a[4:7], a[60:63], v[92:95]
    ds_read_b128 a[112:115], v10 offset:8192
    s_mov_b32 s49, s13
    v_mfma_f32_16x16x32_bf16 v[88:91], a[4:7], a[56:59], v[88:91]
    v_add_u32 v8, 128, v8
    v_mfma_f32_16x16x32_bf16 v[84:87], a[4:7], a[52:55], v[84:87]
    ds_read_b128 a[116:119], v10 offset:10240
    s_mov_b32 s50, 2097152
    v_mfma_f32_16x16x32_bf16 v[80:83], a[4:7], a[48:51], v[80:83]
    buffer_load_dwordx4 a[140:143], v28, s[48:51], 0 offen
    v_mfma_f32_16x16x32_bf16 v[76:79], a[4:7], a[44:47], v[76:79]
    ds_read_b128 a[120:123], v10 offset:12288
    s_add_u32 m0, s77, 8192
    v_mfma_f32_16x16x32_bf16 v[72:75], a[4:7], a[40:43], v[72:75]
    buffer_load_dwordx4 v5, s[40:43], 0 offen  lds
    v_mfma_f32_16x16x32_bf16 v[68:71], a[4:7], a[36:39], v[68:71]
    ds_read_b128 a[124:127], v10 offset:14336
    v_mfma_f32_16x16x32_bf16 v[64:67], a[4:7], a[32:35], v[64:67]
    v_mfma_f32_16x16x32_bf16 v[96:99], a[8:11], a[32:35], v[96:99]
    ds_read_b64_tr_b16 a[64:65], v11 offset:24576
    v_mfma_f32_16x16x32_bf16 v[100:103], a[8:11], a[36:39], v[100:103]
    v_mfma_f32_16x16x32_bf16 v[104:107], a[8:11], a[40:43], v[104:107]
    ds_read_b64_tr_b16 a[66:67], v12 offset:24576
    v_mfma_f32_16x16x32_bf16 v[108:111], a[8:11], a[44:47], v[108:111]
    buffer_load_dwordx4 v5, s[52:55], 0 offen offset:1024  lds
    v_mfma_f32_16x16x32_bf16 v[112:115], a[8:11], a[48:51], v[112:115]
    ds_read_b64_tr_b16 a[68:69], v13 offset:24576
    v_mfma_f32_16x16x32_bf16 v[116:119], a[8:11], a[52:55], v[116:119]
    v_mfma_f32_16x16x32_bf16 v[120:123], a[8:11], a[56:59], v[120:123]
    ds_read_b64_tr_b16 a[70:71], v14 offset:24576
    v_mfma_f32_16x16x32_bf16 v[124:127], a[8:11], a[60:63], v[124:127]
    v_mfma_f32_16x16x32_bf16 v[156:159], a[12:15], a[60:63], v[156:159]
    ds_read_b64_tr_b16 a[72:73], v15 offset:24576
    s_add_u32 m0, m0, 40960
    v_mfma_f32_16x16x32_bf16 v[152:155], a[12:15], a[56:59], v[152:155]
    buffer_load_dwordx4 v6, s[44:47], 0 offen  lds
    v_mfma_f32_16x16x32_bf16 v[148:151], a[12:15], a[52:55], v[148:151]
    ds_read_b64_tr_b16 a[74:75], v16 offset:24576
    v_mfma_f32_16x16x32_bf16 v[144:147], a[12:15], a[48:51], v[144:147]
    v_mfma_f32_16x16x32_bf16 v[140:143], a[12:15], a[44:47], v[140:143]
    ds_read_b64_tr_b16 a[76:77], v17 offset:24576
    v_mfma_f32_16x16x32_bf16 v[136:139], a[12:15], a[40:43], v[136:139]
    v_mfma_f32_16x16x32_bf16 v[132:135], a[12:15], a[36:39], v[132:135]
    ds_read_b64_tr_b16 a[78:79], v18 offset:24576
    v_mfma_f32_16x16x32_bf16 v[128:131], a[12:15], a[32:35], v[128:131]
    buffer_load_dwordx4 v6, s[44:47], s73 offen offset:1024  lds
    v_mfma_f32_16x16x32_bf16 a[144:147], a[128:131], a[180:183], a[144:147]
    ds_read_b64_tr_b16 a[80:81], v19 offset:24576
    v_mfma_f32_16x16x32_bf16 v[160:163], a[16:19], a[32:35], v[160:163]
    v_mfma_f32_16x16x32_bf16 v[164:167], a[16:19], a[36:39], v[164:167]
    ds_read_b64_tr_b16 a[82:83], v19 offset:25600
    v_mfma_f32_16x16x32_bf16 v[168:171], a[16:19], a[40:43], v[168:171]
    v_mfma_f32_16x16x32_bf16 v[172:175], a[16:19], a[44:47], v[172:175]
    ds_read_b64_tr_b16 a[84:85], v20 offset:24576
    s_add_u32 m0, s77, 16384
    v_mfma_f32_16x16x32_bf16 v[176:179], a[16:19], a[48:51], v[176:179]
    buffer_load_dwordx4 v5, s[40:43], s72 offen  lds
    v_mfma_f32_16x16x32_bf16 v[180:183], a[16:19], a[52:55], v[180:183]
    ds_read_b64_tr_b16 a[86:87], v20 offset:25600
    v_mfma_f32_16x16x32_bf16 v[184:187], a[16:19], a[56:59], v[184:187]
    v_mfma_f32_16x16x32_bf16 v[188:191], a[16:19], a[60:63], v[188:191]
    ds_read_b64_tr_b16 a[88:89], v21 offset:24576
    v_mfma_f32_16x16x32_bf16 v[220:223], a[20:23], a[60:63], v[220:223]
    v_mfma_f32_16x16x32_bf16 v[216:219], a[20:23], a[56:59], v[216:219]
    ds_read_b64_tr_b16 a[90:91], v21 offset:25600
    v_mfma_f32_16x16x32_bf16 v[212:215], a[20:23], a[52:55], v[212:215]
    buffer_load_dwordx4 v5, s[52:55], s72 offen offset:1024  lds
    v_mfma_f32_16x16x32_bf16 v[208:211], a[20:23], a[48:51], v[208:211]
    ds_read_b64_tr_b16 a[92:93], v22 offset:24576
    v_mfma_f32_16x16x32_bf16 v[204:207], a[20:23], a[44:47], v[204:207]
    v_mfma_f32_16x16x32_bf16 v[200:203], a[20:23], a[40:43], v[200:203]
    ds_read_b64_tr_b16 a[94:95], v22 offset:25600
    v_mfma_f32_16x16x32_bf16 v[196:199], a[20:23], a[36:39], v[196:199]
    v_mfma_f32_16x16x32_bf16 v[192:195], a[20:23], a[32:35], v[192:195]
    ds_read_b64_tr_b16 a[132:133], v23 offset:2048
    s_add_u32 m0, m0, 40960
    v_mfma_f32_16x16x32_bf16 v[224:227], a[24:27], a[32:35], v[224:227]
    buffer_load_dwordx4 v6, s[44:47], s74 offen  lds
    v_mfma_f32_16x16x32_bf16 v[228:231], a[24:27], a[36:39], v[228:231]
    ds_read_b64_tr_b16 a[134:135], v23 offset:2304
    v_mfma_f32_16x16x32_bf16 v[232:235], a[24:27], a[40:43], v[232:235]
    v_mfma_f32_16x16x32_bf16 v[236:239], a[24:27], a[44:47], v[236:239]
    v_mfma_f32_16x16x32_bf16 v[240:243], a[24:27], a[48:51], v[240:243]
    v_mfma_f32_16x16x32_bf16 v[244:247], a[24:27], a[52:55], v[244:247]
    v_mfma_f32_16x16x32_bf16 v[248:251], a[24:27], a[56:59], v[248:251]
    buffer_load_dwordx4 v6, s[44:47], s75 offen offset:1024  lds
    v_mfma_f32_16x16x32_bf16 v[252:255], a[24:27], a[60:63], v[252:255]
    v_mfma_f32_16x16x32_bf16 a[176:179], a[28:31], a[60:63], a[176:179]
    v_add_u32 v5, 458752, v5
    v_mfma_f32_16x16x32_bf16 a[172:175], a[28:31], a[56:59], a[172:175]
    v_add_u32 v6, s15, v6
    v_mfma_f32_16x16x32_bf16 a[168:171], a[28:31], a[52:55], a[168:171]
    v_mfma_f32_16x16x32_bf16 a[164:167], a[28:31], a[48:51], a[164:167]
    v_mfma_f32_16x16x32_bf16 a[160:163], a[28:31], a[44:47], a[160:163]
    s_waitcnt vmcnt(12) lgkmcnt(0)
    s_barrier
    v_mfma_f32_16x16x32_bf16 a[156:159], a[28:31], a[40:43], a[156:159]
    v_mfma_f32_16x16x32_bf16 a[152:155], a[28:31], a[36:39], a[152:155]
    v_mfma_f32_16x16x32_bf16 a[148:151], a[28:31], a[32:35], a[148:151]
    v_mfma_f32_16x16x32_bf16 v[32:35], a[64:67], a[96:99], v[32:35]
    ds_read_b128 a[32:35], v9 offset:32768
    s_add_u32 m0, s76, 0
    v_mfma_f32_16x16x32_bf16 v[36:39], a[64:67], a[100:103], v[36:39]
    buffer_load_dwordx4 v3, s[36:39], 0 offen offset:0  lds
    v_mfma_f32_16x16x32_bf16 v[40:43], a[64:67], a[104:107], v[40:43]
    ds_read_b128 a[36:39], v9 offset:34816
    v_mfma_f32_16x16x32_bf16 v[44:47], a[64:67], a[108:111], v[44:47]
    v_mfma_f32_16x16x32_bf16 v[48:51], a[64:67], a[112:115], v[48:51]
    ds_read_b128 a[40:43], v9 offset:36864
    v_mfma_f32_16x16x32_bf16 v[52:55], a[64:67], a[116:119], v[52:55]
    v_mfma_f32_16x16x32_bf16 v[56:59], a[64:67], a[120:123], v[56:59]
    ds_read_b128 a[44:47], v9 offset:38912
    v_mfma_f32_16x16x32_bf16 v[60:63], a[64:67], a[124:127], v[60:63]
    v_mfma_f32_16x16x32_bf16 v[92:95], a[68:71], a[124:127], v[92:95]
    ds_read_b128 a[48:51], v9 offset:40960
    v_mfma_f32_16x16x32_bf16 v[88:91], a[68:71], a[120:123], v[88:91]
    buffer_load_dwordx4 v4, s[36:39], s65 offen offset:1024  lds
    v_mfma_f32_16x16x32_bf16 v[84:87], a[68:71], a[116:119], v[84:87]
    ds_read_b128 a[52:55], v9 offset:43008
    v_mfma_f32_16x16x32_bf16 v[80:83], a[68:71], a[112:115], v[80:83]
    v_mfma_f32_16x16x32_bf16 v[76:79], a[68:71], a[108:111], v[76:79]
    ds_read_b128 a[56:59], v9 offset:45056
    v_mfma_f32_16x16x32_bf16 v[72:75], a[68:71], a[104:107], v[72:75]
    v_mfma_f32_16x16x32_bf16 v[68:71], a[68:71], a[100:103], v[68:71]
    ds_read_b128 a[60:63], v9 offset:47104
    v_mfma_f32_16x16x32_bf16 v[64:67], a[68:71], a[96:99], v[64:67]
    v_mfma_f32_16x16x32_bf16 v[96:99], a[72:75], a[96:99], v[96:99]
    ds_read_b64_tr_b16 a[0:1], v11 offset:32768
    v_mfma_f32_16x16x32_bf16 v[100:103], a[72:75], a[100:103], v[100:103]
    buffer_load_dwordx4 v3, s[36:39], s66 offen offset:2048  lds
    v_mfma_f32_16x16x32_bf16 v[104:107], a[72:75], a[104:107], v[104:107]
    ds_read_b64_tr_b16 a[2:3], v12 offset:32768
    v_mfma_f32_16x16x32_bf16 v[108:111], a[72:75], a[108:111], v[108:111]
    v_mfma_f32_16x16x32_bf16 v[112:115], a[72:75], a[112:115], v[112:115]
    ds_read_b64_tr_b16 a[4:5], v13 offset:32768
    v_mfma_f32_16x16x32_bf16 v[116:119], a[72:75], a[116:119], v[116:119]
    v_mfma_f32_16x16x32_bf16 v[120:123], a[72:75], a[120:123], v[120:123]
    ds_read_b64_tr_b16 a[6:7], v14 offset:32768
    v_mfma_f32_16x16x32_bf16 v[124:127], a[72:75], a[124:127], v[124:127]
    v_mfma_f32_16x16x32_bf16 v[156:159], a[76:79], a[124:127], v[156:159]
    ds_read_b64_tr_b16 a[8:9], v15 offset:32768
    v_mfma_f32_16x16x32_bf16 v[152:155], a[76:79], a[120:123], v[152:155]
    buffer_load_dwordx4 v4, s[36:39], s67 offen offset:3072  lds
    v_mfma_f32_16x16x32_bf16 v[148:151], a[76:79], a[116:119], v[148:151]
    ds_read_b64_tr_b16 a[10:11], v16 offset:32768
    v_mfma_f32_16x16x32_bf16 v[144:147], a[76:79], a[112:115], v[144:147]
    v_mfma_f32_16x16x32_bf16 v[140:143], a[76:79], a[108:111], v[140:143]
    ds_read_b64_tr_b16 a[12:13], v17 offset:32768
    v_mfma_f32_16x16x32_bf16 v[136:139], a[76:79], a[104:107], v[136:139]
    v_mfma_f32_16x16x32_bf16 v[132:135], a[76:79], a[100:103], v[132:135]
    ds_read_b64_tr_b16 a[14:15], v18 offset:32768
    v_mfma_f32_16x16x32_bf16 v[128:131], a[76:79], a[96:99], v[128:131]
    v_mfma_f32_16x16x32_bf16 a[144:147], a[132:135], a[184:187], a[144:147]
    ds_read_b64_tr_b16 a[16:17], v19 offset:32768
    s_add_u32 m0, m0, 4096
    v_mfma_f32_16x16x32_bf16 v[160:163], a[80:83], a[96:99], v[160:163]
    buffer_load_dwordx4 v3, s[36:39], s68 offen offset:0  lds
    v_mfma_f32_16x16x32_bf16 v[164:167], a[80:83], a[100:103], v[164:167]
    ds_read_b64_tr_b16 a[18:19], v19 offset:33792
    v_mfma_f32_16x16x32_bf16 v[168:171], a[80:83], a[104:107], v[168:171]
    v_mfma_f32_16x16x32_bf16 v[172:175], a[80:83], a[108:111], v[172:175]
    ds_read_b64_tr_b16 a[20:21], v20 offset:32768
    v_mfma_f32_16x16x32_bf16 v[176:179], a[80:83], a[112:115], v[176:179]
    v_mfma_f32_16x16x32_bf16 v[180:183], a[80:83], a[116:119], v[180:183]
    ds_read_b64_tr_b16 a[22:23], v20 offset:33792
    v_mfma_f32_16x16x32_bf16 v[184:187], a[80:83], a[120:123], v[184:187]
    v_mfma_f32_16x16x32_bf16 v[188:191], a[80:83], a[124:127], v[188:191]
    ds_read_b64_tr_b16 a[24:25], v21 offset:32768
    v_mfma_f32_16x16x32_bf16 v[220:223], a[84:87], a[124:127], v[220:223]
    buffer_load_dwordx4 v4, s[36:39], s69 offen offset:1024  lds
    v_mfma_f32_16x16x32_bf16 v[216:219], a[84:87], a[120:123], v[216:219]
    ds_read_b64_tr_b16 a[26:27], v21 offset:33792
    v_mfma_f32_16x16x32_bf16 v[212:215], a[84:87], a[116:119], v[212:215]
    v_mfma_f32_16x16x32_bf16 v[208:211], a[84:87], a[112:115], v[208:211]
    ds_read_b64_tr_b16 a[28:29], v22 offset:32768
    v_mfma_f32_16x16x32_bf16 v[204:207], a[84:87], a[108:111], v[204:207]
    v_mfma_f32_16x16x32_bf16 v[200:203], a[84:87], a[104:107], v[200:203]
    ds_read_b64_tr_b16 a[30:31], v22 offset:33792
    v_mfma_f32_16x16x32_bf16 v[196:199], a[84:87], a[100:103], v[196:199]
    buffer_load_dwordx4 v3, s[36:39], s70 offen offset:2048  lds
    v_mfma_f32_16x16x32_bf16 v[192:195], a[84:87], a[96:99], v[192:195]
    ds_read_b64_tr_b16 a[128:129], v23 offset:8192
    v_mfma_f32_16x16x32_bf16 v[224:227], a[88:91], a[96:99], v[224:227]
    v_mfma_f32_16x16x32_bf16 v[228:231], a[88:91], a[100:103], v[228:231]
    ds_read_b64_tr_b16 a[130:131], v23 offset:8448
    v_mfma_f32_16x16x32_bf16 v[232:235], a[88:91], a[104:107], v[232:235]
    v_mfma_f32_16x16x32_bf16 v[236:239], a[88:91], a[108:111], v[236:239]
    v_mfma_f32_16x16x32_bf16 v[240:243], a[88:91], a[112:115], v[240:243]
    v_mfma_f32_16x16x32_bf16 v[244:247], a[88:91], a[116:119], v[244:247]
    v_mfma_f32_16x16x32_bf16 v[248:251], a[88:91], a[120:123], v[248:251]
    buffer_load_dwordx4 v4, s[36:39], s71 offen offset:3072  lds
    v_mfma_f32_16x16x32_bf16 v[252:255], a[88:91], a[124:127], v[252:255]
    v_mfma_f32_16x16x32_bf16 a[176:179], a[92:95], a[124:127], a[176:179]
    v_add_u32 v3, 0x80, v3
    v_mfma_f32_16x16x32_bf16 a[172:175], a[92:95], a[120:123], a[172:175]
    v_mfma_f32_16x16x32_bf16 a[168:171], a[92:95], a[116:119], a[168:171]
    v_add_u32 v4, 0x80, v4
    v_mfma_f32_16x16x32_bf16 a[164:167], a[92:95], a[112:115], a[164:167]
    v_mfma_f32_16x16x32_bf16 a[160:163], a[92:95], a[108:111], a[160:163]
    s_waitcnt vmcnt(17) lgkmcnt(0)
    s_barrier
    v_mfma_f32_16x16x32_bf16 a[156:159], a[92:95], a[104:107], a[156:159]
    v_mfma_f32_16x16x32_bf16 a[152:155], a[92:95], a[100:103], a[152:155]
    v_mfma_f32_16x16x32_bf16 a[148:151], a[92:95], a[96:99], a[148:151]
    v_mfma_f32_16x16x32_bf16 v[32:35], a[0:3], a[32:35], v[32:35]
    ds_read_b128 a[96:99], v10 offset:32768
    s_add_u32 m0, s77, 24576
    v_mfma_f32_16x16x32_bf16 v[36:39], a[0:3], a[36:39], v[36:39]
    buffer_load_dwordx4 v5, s[40:43], 0 offen  lds
    v_mfma_f32_16x16x32_bf16 v[40:43], a[0:3], a[40:43], v[40:43]
    ds_read_b128 a[100:103], v10 offset:34816
    v_mfma_f32_16x16x32_bf16 v[44:47], a[0:3], a[44:47], v[44:47]
    v_mfma_f32_16x16x32_bf16 v[48:51], a[0:3], a[48:51], v[48:51]
    ds_read_b128 a[104:107], v10 offset:36864
    global_load_dword a253, v0, s[100:101]
    v_add_u32 v0, 0x2000, v0
    v_mfma_f32_16x16x32_bf16 v[52:55], a[0:3], a[52:55], v[52:55]
    v_mfma_f32_16x16x32_bf16 v[56:59], a[0:3], a[56:59], v[56:59]
    ds_read_b128 a[108:111], v10 offset:38912
    v_mfma_f32_16x16x32_bf16 v[60:63], a[0:3], a[60:63], v[60:63]
    v_mfma_f32_16x16x32_bf16 v[92:95], a[4:7], a[60:63], v[92:95]
    ds_read_b128 a[112:115], v10 offset:40960
    v_mfma_f32_16x16x32_bf16 v[88:91], a[4:7], a[56:59], v[88:91]
    buffer_load_dwordx4 v5, s[52:55], 0 offen offset:1024  lds
    v_mfma_f32_16x16x32_bf16 v[84:87], a[4:7], a[52:55], v[84:87]
    ds_read_b128 a[116:119], v10 offset:43008
    v_mfma_f32_16x16x32_bf16 v[80:83], a[4:7], a[48:51], v[80:83]
    v_mfma_f32_16x16x32_bf16 v[76:79], a[4:7], a[44:47], v[76:79]
    ds_read_b128 a[120:123], v10 offset:45056
    v_mfma_f32_16x16x32_bf16 v[72:75], a[4:7], a[40:43], v[72:75]
    v_mfma_f32_16x16x32_bf16 v[68:71], a[4:7], a[36:39], v[68:71]
    ds_read_b128 a[124:127], v10 offset:47104
    v_mfma_f32_16x16x32_bf16 v[64:67], a[4:7], a[32:35], v[64:67]
    v_mfma_f32_16x16x32_bf16 v[96:99], a[8:11], a[32:35], v[96:99]
    ds_read_b64_tr_b16 a[64:65], v11 offset:0
    s_add_u32 m0, m0, 40960
    v_mfma_f32_16x16x32_bf16 v[100:103], a[8:11], a[36:39], v[100:103]
    buffer_load_dwordx4 v6, s[44:47], 0 offen  lds
    v_mfma_f32_16x16x32_bf16 v[104:107], a[8:11], a[40:43], v[104:107]
    ds_read_b64_tr_b16 a[66:67], v12 offset:0
    v_mfma_f32_16x16x32_bf16 v[108:111], a[8:11], a[44:47], v[108:111]
    v_mfma_f32_16x16x32_bf16 v[112:115], a[8:11], a[48:51], v[112:115]
    ds_read_b64_tr_b16 a[68:69], v13 offset:0
    v_mfma_f32_16x16x32_bf16 v[116:119], a[8:11], a[52:55], v[116:119]
    v_mfma_f32_16x16x32_bf16 v[120:123], a[8:11], a[56:59], v[120:123]
    ds_read_b64_tr_b16 a[70:71], v14 offset:0
    v_mfma_f32_16x16x32_bf16 v[124:127], a[8:11], a[60:63], v[124:127]
    v_mfma_f32_16x16x32_bf16 v[156:159], a[12:15], a[60:63], v[156:159]
    ds_read_b64_tr_b16 a[72:73], v15 offset:0
    v_mfma_f32_16x16x32_bf16 v[152:155], a[12:15], a[56:59], v[152:155]
    buffer_load_dwordx4 v6, s[44:47], s73 offen offset:1024  lds
    v_mfma_f32_16x16x32_bf16 v[148:151], a[12:15], a[52:55], v[148:151]
    ds_read_b64_tr_b16 a[74:75], v16 offset:0
    v_mfma_f32_16x16x32_bf16 v[144:147], a[12:15], a[48:51], v[144:147]
    v_mfma_f32_16x16x32_bf16 v[140:143], a[12:15], a[44:47], v[140:143]
    ds_read_b64_tr_b16 a[76:77], v17 offset:0
    v_mfma_f32_16x16x32_bf16 v[136:139], a[12:15], a[40:43], v[136:139]
    v_mfma_f32_16x16x32_bf16 v[132:135], a[12:15], a[36:39], v[132:135]
    ds_read_b64_tr_b16 a[78:79], v18 offset:0
    v_mfma_f32_16x16x32_bf16 v[128:131], a[12:15], a[32:35], v[128:131]
    v_mfma_f32_16x16x32_bf16 a[144:147], a[128:131], a[188:191], a[144:147]
    ds_read_b64_tr_b16 a[80:81], v19 offset:0
    s_add_u32 m0, s77, 32768
    v_mfma_f32_16x16x32_bf16 v[160:163], a[16:19], a[32:35], v[160:163]
    buffer_load_dwordx4 v5, s[40:43], s72 offen  lds
    v_mfma_f32_16x16x32_bf16 v[164:167], a[16:19], a[36:39], v[164:167]
    ds_read_b64_tr_b16 a[82:83], v19 offset:1024
    v_mfma_f32_16x16x32_bf16 v[168:171], a[16:19], a[40:43], v[168:171]
    v_mfma_f32_16x16x32_bf16 v[172:175], a[16:19], a[44:47], v[172:175]
    ds_read_b64_tr_b16 a[84:85], v20 offset:0
    v_mfma_f32_16x16x32_bf16 v[176:179], a[16:19], a[48:51], v[176:179]
    v_mfma_f32_16x16x32_bf16 v[180:183], a[16:19], a[52:55], v[180:183]
    ds_read_b64_tr_b16 a[86:87], v20 offset:1024
    v_mfma_f32_16x16x32_bf16 v[184:187], a[16:19], a[56:59], v[184:187]
    buffer_load_dwordx4 v5, s[52:55], s72 offen offset:1024  lds
    v_mfma_f32_16x16x32_bf16 v[188:191], a[16:19], a[60:63], v[188:191]
    ds_read_b64_tr_b16 a[88:89], v21 offset:0
    v_mfma_f32_16x16x32_bf16 v[220:223], a[20:23], a[60:63], v[220:223]
    v_mfma_f32_16x16x32_bf16 v[216:219], a[20:23], a[56:59], v[216:219]
    ds_read_b64_tr_b16 a[90:91], v21 offset:1024
    v_mfma_f32_16x16x32_bf16 v[212:215], a[20:23], a[52:55], v[212:215]
    v_mfma_f32_16x16x32_bf16 v[208:211], a[20:23], a[48:51], v[208:211]
    ds_read_b64_tr_b16 a[92:93], v22 offset:0
    v_mfma_f32_16x16x32_bf16 v[204:207], a[20:23], a[44:47], v[204:207]
    v_mfma_f32_16x16x32_bf16 v[200:203], a[20:23], a[40:43], v[200:203]
    ds_read_b64_tr_b16 a[94:95], v22 offset:1024
    s_add_u32 m0, m0, 40960
    v_mfma_f32_16x16x32_bf16 v[196:199], a[20:23], a[36:39], v[196:199]
    buffer_load_dwordx4 v6, s[44:47], s74 offen  lds
    v_mfma_f32_16x16x32_bf16 v[192:195], a[20:23], a[32:35], v[192:195]
    ds_read_b64_tr_b16 a[132:133], v23 offset:10240
    v_mfma_f32_16x16x32_bf16 v[224:227], a[24:27], a[32:35], v[224:227]
    v_mfma_f32_16x16x32_bf16 v[228:231], a[24:27], a[36:39], v[228:231]
    ds_read_b64_tr_b16 a[134:135], v23 offset:10496
    v_mfma_f32_16x16x32_bf16 v[232:235], a[24:27], a[40:43], v[232:235]
    v_mfma_f32_16x16x32_bf16 v[236:239], a[24:27], a[44:47], v[236:239]
    v_mfma_f32_16x16x32_bf16 v[240:243], a[24:27], a[48:51], v[240:243]
    v_mfma_f32_16x16x32_bf16 v[244:247], a[24:27], a[52:55], v[244:247]
    v_mfma_f32_16x16x32_bf16 v[248:251], a[24:27], a[56:59], v[248:251]
    buffer_load_dwordx4 v6, s[44:47], s75 offen offset:1024  lds
    v_mfma_f32_16x16x32_bf16 v[252:255], a[24:27], a[60:63], v[252:255]
    v_mfma_f32_16x16x32_bf16 a[176:179], a[28:31], a[60:63], a[176:179]
    v_add_u32 v5, 0xe0000, v5
    v_mfma_f32_16x16x32_bf16 a[172:175], a[28:31], a[56:59], a[172:175]
    s_mul_i32 s61, s15, 2
    v_add_u32 v6, s61, v6
    v_mfma_f32_16x16x32_bf16 a[168:171], a[28:31], a[52:55], a[168:171]
    v_mfma_f32_16x16x32_bf16 a[164:167], a[28:31], a[48:51], a[164:167]
    v_mfma_f32_16x16x32_bf16 a[160:163], a[28:31], a[44:47], a[160:163]
    s_waitcnt vmcnt(9) lgkmcnt(0)
    s_barrier
    v_mfma_f32_16x16x32_bf16 a[156:159], a[28:31], a[40:43], a[156:159]
    v_mfma_f32_16x16x32_bf16 a[152:155], a[28:31], a[36:39], a[152:155]
    v_mfma_f32_16x16x32_bf16 a[148:151], a[28:31], a[32:35], a[148:151]
    v_mfma_f32_16x16x32_bf16 v[32:35], a[64:67], a[96:99], v[32:35]
    ds_read_b128 a[32:35], v9 offset:0
    s_add_u32 m0, s76, 32768
    v_mfma_f32_16x16x32_bf16 v[36:39], a[64:67], a[100:103], v[36:39]
    buffer_load_dwordx4 v3, s[36:39], 0 offen offset:0  lds
    v_mfma_f32_16x16x32_bf16 v[40:43], a[64:67], a[104:107], v[40:43]
    ds_read_b128 a[36:39], v9 offset:2048
    v_mfma_f32_16x16x32_bf16 v[44:47], a[64:67], a[108:111], v[44:47]
    v_mfma_f32_16x16x32_bf16 v[48:51], a[64:67], a[112:115], v[48:51]
    ds_read_b128 a[40:43], v9 offset:4096
    v_mfma_f32_16x16x32_bf16 v[52:55], a[64:67], a[116:119], v[52:55]
    s_waitcnt vmcnt(26)
    buffer_store_dwordx4 a[136:139], v29, s[32:35], 0 offen sc1
    v_mfma_f32_16x16x32_bf16 v[56:59], a[64:67], a[120:123], v[56:59]
    ds_read_b128 a[44:47], v9 offset:6144
    v_mfma_f32_16x16x32_bf16 v[60:63], a[64:67], a[124:127], v[60:63]
    v_mfma_f32_16x16x32_bf16 v[92:95], a[68:71], a[124:127], v[92:95]
    ds_read_b128 a[48:51], v9 offset:8192
    v_mfma_f32_16x16x32_bf16 v[88:91], a[68:71], a[120:123], v[88:91]
    buffer_load_dwordx4 v4, s[36:39], s65 offen offset:1024  lds
    v_mfma_f32_16x16x32_bf16 v[84:87], a[68:71], a[116:119], v[84:87]
    ds_read_b128 a[52:55], v9 offset:10240
    v_mfma_f32_16x16x32_bf16 v[80:83], a[68:71], a[112:115], v[80:83]
    v_mfma_f32_16x16x32_bf16 v[76:79], a[68:71], a[108:111], v[76:79]
    ds_read_b128 a[56:59], v9 offset:12288
    v_mfma_f32_16x16x32_bf16 v[72:75], a[68:71], a[104:107], v[72:75]
    buffer_store_dwordx4 a[140:143], v30, s[32:35], 0 offen sc1
    v_mfma_f32_16x16x32_bf16 v[68:71], a[68:71], a[100:103], v[68:71]
    ds_read_b128 a[60:63], v9 offset:14336
    v_mfma_f32_16x16x32_bf16 v[64:67], a[68:71], a[96:99], v[64:67]
    v_mfma_f32_16x16x32_bf16 v[96:99], a[72:75], a[96:99], v[96:99]
    ds_read_b64_tr_b16 a[0:1], v11 offset:8192
    v_mfma_f32_16x16x32_bf16 v[100:103], a[72:75], a[100:103], v[100:103]
    buffer_load_dwordx4 v3, s[36:39], s66 offen offset:2048  lds
    v_mfma_f32_16x16x32_bf16 v[104:107], a[72:75], a[104:107], v[104:107]
    ds_read_b64_tr_b16 a[2:3], v12 offset:8192
    v_mfma_f32_16x16x32_bf16 v[108:111], a[72:75], a[108:111], v[108:111]
    v_mfma_f32_16x16x32_bf16 v[112:115], a[72:75], a[112:115], v[112:115]
    ds_read_b64_tr_b16 a[4:5], v13 offset:8192
    v_mfma_f32_16x16x32_bf16 v[116:119], a[72:75], a[116:119], v[116:119]
    v_mfma_f32_16x16x32_bf16 v[120:123], a[72:75], a[120:123], v[120:123]
    ds_read_b64_tr_b16 a[6:7], v14 offset:8192
    v_mfma_f32_16x16x32_bf16 v[124:127], a[72:75], a[124:127], v[124:127]
    v_mfma_f32_16x16x32_bf16 v[156:159], a[76:79], a[124:127], v[156:159]
    ds_read_b64_tr_b16 a[8:9], v15 offset:8192
    v_mfma_f32_16x16x32_bf16 v[152:155], a[76:79], a[120:123], v[152:155]
    buffer_load_dwordx4 v4, s[36:39], s67 offen offset:3072  lds
    v_mfma_f32_16x16x32_bf16 v[148:151], a[76:79], a[116:119], v[148:151]
    ds_read_b64_tr_b16 a[10:11], v16 offset:8192
    v_mfma_f32_16x16x32_bf16 v[144:147], a[76:79], a[112:115], v[144:147]
    v_mfma_f32_16x16x32_bf16 v[140:143], a[76:79], a[108:111], v[140:143]
    ds_read_b64_tr_b16 a[12:13], v17 offset:8192
    v_mfma_f32_16x16x32_bf16 v[136:139], a[76:79], a[104:107], v[136:139]
    v_mfma_f32_16x16x32_bf16 v[132:135], a[76:79], a[100:103], v[132:135]
    ds_read_b64_tr_b16 a[14:15], v18 offset:8192
    v_mfma_f32_16x16x32_bf16 v[128:131], a[76:79], a[96:99], v[128:131]
    v_mfma_f32_16x16x32_bf16 a[144:147], a[132:135], a[192:195], a[144:147]
    ds_read_b64_tr_b16 a[16:17], v19 offset:8192
    s_add_u32 m0, m0, 4096
    v_mfma_f32_16x16x32_bf16 v[160:163], a[80:83], a[96:99], v[160:163]
    buffer_load_dwordx4 v3, s[36:39], s68 offen offset:0  lds
    v_mfma_f32_16x16x32_bf16 v[164:167], a[80:83], a[100:103], v[164:167]
    ds_read_b64_tr_b16 a[18:19], v19 offset:9216
    v_mfma_f32_16x16x32_bf16 v[168:171], a[80:83], a[104:107], v[168:171]
    v_mfma_f32_16x16x32_bf16 v[172:175], a[80:83], a[108:111], v[172:175]
    ds_read_b64_tr_b16 a[20:21], v20 offset:8192
    v_mfma_f32_16x16x32_bf16 v[176:179], a[80:83], a[112:115], v[176:179]
    v_mfma_f32_16x16x32_bf16 v[180:183], a[80:83], a[116:119], v[180:183]
    ds_read_b64_tr_b16 a[22:23], v20 offset:9216
    v_mfma_f32_16x16x32_bf16 v[184:187], a[80:83], a[120:123], v[184:187]
    v_mfma_f32_16x16x32_bf16 v[188:191], a[80:83], a[124:127], v[188:191]
    ds_read_b64_tr_b16 a[24:25], v21 offset:8192
    v_mfma_f32_16x16x32_bf16 v[220:223], a[84:87], a[124:127], v[220:223]
    buffer_load_dwordx4 v4, s[36:39], s69 offen offset:1024  lds
    v_mfma_f32_16x16x32_bf16 v[216:219], a[84:87], a[120:123], v[216:219]
    ds_read_b64_tr_b16 a[26:27], v21 offset:9216
    v_mfma_f32_16x16x32_bf16 v[212:215], a[84:87], a[116:119], v[212:215]
    v_mfma_f32_16x16x32_bf16 v[208:211], a[84:87], a[112:115], v[208:211]
    ds_read_b64_tr_b16 a[28:29], v22 offset:8192
    v_mfma_f32_16x16x32_bf16 v[204:207], a[84:87], a[108:111], v[204:207]
    v_mfma_f32_16x16x32_bf16 v[200:203], a[84:87], a[104:107], v[200:203]
    ds_read_b64_tr_b16 a[30:31], v22 offset:9216
    v_mfma_f32_16x16x32_bf16 v[196:199], a[84:87], a[100:103], v[196:199]
    buffer_load_dwordx4 v3, s[36:39], s70 offen offset:2048  lds
    v_mfma_f32_16x16x32_bf16 v[192:195], a[84:87], a[96:99], v[192:195]
    v_mfma_f32_16x16x32_bf16 v[224:227], a[88:91], a[96:99], v[224:227]
    v_mfma_f32_16x16x32_bf16 v[228:231], a[88:91], a[100:103], v[228:231]
    v_mfma_f32_16x16x32_bf16 v[232:235], a[88:91], a[104:107], v[232:235]
    v_mfma_f32_16x16x32_bf16 v[236:239], a[88:91], a[108:111], v[236:239]
    v_mfma_f32_16x16x32_bf16 v[240:243], a[88:91], a[112:115], v[240:243]
    v_mfma_f32_16x16x32_bf16 v[244:247], a[88:91], a[116:119], v[244:247]
    v_mfma_f32_16x16x32_bf16 v[248:251], a[88:91], a[120:123], v[248:251]
    buffer_load_dwordx4 v4, s[36:39], s71 offen offset:3072  lds
    v_mfma_f32_16x16x32_bf16 v[252:255], a[88:91], a[124:127], v[252:255]
    v_mfma_f32_16x16x32_bf16 a[176:179], a[92:95], a[124:127], a[176:179]
    v_add_u32 v3, 0x100, v3
    v_mfma_f32_16x16x32_bf16 a[172:175], a[92:95], a[120:123], a[172:175]
    v_mfma_f32_16x16x32_bf16 a[168:171], a[92:95], a[116:119], a[168:171]
    v_add_u32 v4, 0x100, v4
    v_mfma_f32_16x16x32_bf16 a[164:167], a[92:95], a[112:115], a[164:167]
    v_mfma_f32_16x16x32_bf16 a[160:163], a[92:95], a[108:111], a[160:163]
    s_waitcnt lgkmcnt(0)
    s_barrier
    v_mfma_f32_16x16x32_bf16 a[156:159], a[92:95], a[104:107], a[156:159]
    v_mfma_f32_16x16x32_bf16 a[152:155], a[92:95], a[100:103], a[152:155]
    v_mfma_f32_16x16x32_bf16 a[148:151], a[92:95], a[96:99], a[148:151]
    v_mfma_f32_16x16x32_bf16 v[32:35], a[0:3], a[32:35], v[32:35]
    ds_read_b128 a[96:99], v10 offset:0
    s_add_u32 m0, s77, 0
    v_mfma_f32_16x16x32_bf16 v[36:39], a[0:3], a[36:39], v[36:39]
    buffer_load_dwordx4 v5, s[40:43], 0 offen  lds
    v_mfma_f32_16x16x32_bf16 v[40:43], a[0:3], a[40:43], v[40:43]
    ds_read_b128 a[100:103], v10 offset:2048
    v_mfma_f32_16x16x32_bf16 v[44:47], a[0:3], a[44:47], v[44:47]
    v_mfma_f32_16x16x32_bf16 v[48:51], a[0:3], a[48:51], v[48:51]
    ds_read_b128 a[104:107], v10 offset:4096
    v_mfma_f32_16x16x32_bf16 v[52:55], a[0:3], a[52:55], v[52:55]
    v_mfma_f32_16x16x32_bf16 v[56:59], a[0:3], a[56:59], v[56:59]
    ds_read_b128 a[108:111], v10 offset:6144
    v_mfma_f32_16x16x32_bf16 v[60:63], a[0:3], a[60:63], v[60:63]
    v_mfma_f32_16x16x32_bf16 v[92:95], a[4:7], a[60:63], v[92:95]
    ds_read_b128 a[112:115], v10 offset:8192
    v_mfma_f32_16x16x32_bf16 v[88:91], a[4:7], a[56:59], v[88:91]
    buffer_load_dwordx4 v5, s[52:55], 0 offen offset:1024  lds
    v_mfma_f32_16x16x32_bf16 v[84:87], a[4:7], a[52:55], v[84:87]
    ds_read_b128 a[116:119], v10 offset:10240
    v_mfma_f32_16x16x32_bf16 v[80:83], a[4:7], a[48:51], v[80:83]
    v_mfma_f32_16x16x32_bf16 v[76:79], a[4:7], a[44:47], v[76:79]
    ds_read_b128 a[120:123], v10 offset:12288
    v_mfma_f32_16x16x32_bf16 v[72:75], a[4:7], a[40:43], v[72:75]
    v_mfma_f32_16x16x32_bf16 v[68:71], a[4:7], a[36:39], v[68:71]
    ds_read_b128 a[124:127], v10 offset:14336
    v_mfma_f32_16x16x32_bf16 v[64:67], a[4:7], a[32:35], v[64:67]
    v_mfma_f32_16x16x32_bf16 v[96:99], a[8:11], a[32:35], v[96:99]
    ds_read_b64_tr_b16 a[64:65], v11 offset:16384
    s_add_u32 m0, m0, 40960
    v_mfma_f32_16x16x32_bf16 v[100:103], a[8:11], a[36:39], v[100:103]
    buffer_load_dwordx4 v6, s[44:47], 0 offen  lds
    v_mfma_f32_16x16x32_bf16 v[104:107], a[8:11], a[40:43], v[104:107]
    ds_read_b64_tr_b16 a[66:67], v12 offset:16384
    v_mfma_f32_16x16x32_bf16 v[108:111], a[8:11], a[44:47], v[108:111]
    v_mfma_f32_16x16x32_bf16 v[112:115], a[8:11], a[48:51], v[112:115]
    ds_read_b64_tr_b16 a[68:69], v13 offset:16384
    v_mfma_f32_16x16x32_bf16 v[116:119], a[8:11], a[52:55], v[116:119]
    s_lshl_b32 s60, s56, 10
    s_add_u32 s60, s60, 151552
    v_mfma_f32_16x16x32_bf16 v[120:123], a[8:11], a[56:59], v[120:123]
    ds_read_b64_tr_b16 a[70:71], v14 offset:16384
    v_mfma_f32_16x16x32_bf16 v[124:127], a[8:11], a[60:63], v[124:127]
    v_add_u32 v8, s60, v2
    v_mfma_f32_16x16x32_bf16 v[156:159], a[12:15], a[60:63], v[156:159]
    ds_read_b64_tr_b16 a[72:73], v15 offset:16384
    v_mfma_f32_16x16x32_bf16 v[152:155], a[12:15], a[56:59], v[152:155]
    buffer_load_dwordx4 v6, s[44:47], s73 offen offset:1024  lds
    s_mov_b32 s48, s26
    v_mfma_f32_16x16x32_bf16 v[148:151], a[12:15], a[52:55], v[148:151]
    ds_read_b64_tr_b16 a[74:75], v16 offset:16384
    v_mfma_f32_16x16x32_bf16 v[144:147], a[12:15], a[48:51], v[144:147]
    s_mov_b32 s49, s27
    v_mfma_f32_16x16x32_bf16 v[140:143], a[12:15], a[44:47], v[140:143]
    ds_read_b64_tr_b16 a[76:77], v17 offset:16384
    v_mfma_f32_16x16x32_bf16 v[136:139], a[12:15], a[40:43], v[136:139]
    s_mov_b32 s50, 256
    v_mfma_f32_16x16x32_bf16 v[132:135], a[12:15], a[36:39], v[132:135]
    ds_read_b64_tr_b16 a[78:79], v18 offset:16384
    v_mfma_f32_16x16x32_bf16 v[128:131], a[12:15], a[32:35], v[128:131]
    v_mov_b32 v25, 0
    v_mfma_f32_16x16x32_bf16 v[160:163], a[16:19], a[32:35], v[160:163]
    ds_read_b64_tr_b16 a[80:81], v19 offset:16384
    s_add_u32 m0, s77, 8192
    v_mfma_f32_16x16x32_bf16 v[164:167], a[16:19], a[36:39], v[164:167]
    buffer_load_dwordx4 v5, s[40:43], s72 offen  lds
    v_mfma_f32_16x16x32_bf16 v[168:171], a[16:19], a[40:43], v[168:171]
    ds_read_b64_tr_b16 a[82:83], v19 offset:17408
    v_mfma_f32_16x16x32_bf16 v[172:175], a[16:19], a[44:47], v[172:175]
    v_mfma_f32_16x16x32_bf16 v[176:179], a[16:19], a[48:51], v[176:179]
    ds_read_b64_tr_b16 a[84:85], v20 offset:16384
    v_mfma_f32_16x16x32_bf16 v[180:183], a[16:19], a[52:55], v[180:183]
    v_mfma_f32_16x16x32_bf16 v[184:187], a[16:19], a[56:59], v[184:187]
    ds_read_b64_tr_b16 a[86:87], v20 offset:17408
    v_mfma_f32_16x16x32_bf16 v[188:191], a[16:19], a[60:63], v[188:191]
    buffer_load_dwordx4 v5, s[52:55], s72 offen offset:1024  lds
    v_mfma_f32_16x16x32_bf16 v[220:223], a[20:23], a[60:63], v[220:223]
    ds_read_b64_tr_b16 a[88:89], v21 offset:16384
    v_mfma_f32_16x16x32_bf16 v[216:219], a[20:23], a[56:59], v[216:219]
    v_mfma_f32_16x16x32_bf16 v[212:215], a[20:23], a[52:55], v[212:215]
    ds_read_b64_tr_b16 a[90:91], v21 offset:17408
    v_mfma_f32_16x16x32_bf16 v[208:211], a[20:23], a[48:51], v[208:211]
    v_mfma_f32_16x16x32_bf16 v[204:207], a[20:23], a[44:47], v[204:207]
    ds_read_b64_tr_b16 a[92:93], v22 offset:16384
    v_mfma_f32_16x16x32_bf16 v[200:203], a[20:23], a[40:43], v[200:203]
    v_mfma_f32_16x16x32_bf16 v[196:199], a[20:23], a[36:39], v[196:199]
    ds_read_b64_tr_b16 a[94:95], v22 offset:17408
    s_add_u32 m0, m0, 40960
    v_mfma_f32_16x16x32_bf16 v[192:195], a[20:23], a[32:35], v[192:195]
    buffer_load_dwordx4 v6, s[44:47], s74 offen  lds
    v_mfma_f32_16x16x32_bf16 v[224:227], a[24:27], a[32:35], v[224:227]
    v_mfma_f32_16x16x32_bf16 v[228:231], a[24:27], a[36:39], v[228:231]
    v_mfma_f32_16x16x32_bf16 v[232:235], a[24:27], a[40:43], v[232:235]
    v_mfma_f32_16x16x32_bf16 v[236:239], a[24:27], a[44:47], v[236:239]
    v_mfma_f32_16x16x32_bf16 v[240:243], a[24:27], a[48:51], v[240:243]
    v_mfma_f32_16x16x32_bf16 v[244:247], a[24:27], a[52:55], v[244:247]
    v_mfma_f32_16x16x32_bf16 v[248:251], a[24:27], a[56:59], v[248:251]
    v_mfma_f32_16x16x32_bf16 v[252:255], a[24:27], a[60:63], v[252:255]
    buffer_load_dwordx4 v6, s[44:47], s75 offen offset:1024  lds
    v_mfma_f32_16x16x32_bf16 a[176:179], a[28:31], a[60:63], a[176:179]
    v_mfma_f32_16x16x32_bf16 a[172:175], a[28:31], a[56:59], a[172:175]
    v_add_u32 v5, 458752, v5
    v_mfma_f32_16x16x32_bf16 a[168:171], a[28:31], a[52:55], a[168:171]
    v_add_u32 v6, s15, v6
    v_mfma_f32_16x16x32_bf16 a[164:167], a[28:31], a[48:51], a[164:167]
    v_mfma_f32_16x16x32_bf16 a[160:163], a[28:31], a[44:47], a[160:163]
    s_waitcnt vmcnt(8) lgkmcnt(0)
    s_barrier
    v_mfma_f32_16x16x32_bf16 a[156:159], a[28:31], a[40:43], a[156:159]
    v_mfma_f32_16x16x32_bf16 a[152:155], a[28:31], a[36:39], a[152:155]
    v_mfma_f32_16x16x32_bf16 a[148:151], a[28:31], a[32:35], a[148:151]
    v_mfma_f32_16x16x32_bf16 v[32:35], a[64:67], a[96:99], v[32:35]
    ds_read_b128 a[32:35], v9 offset:32768
    s_add_u32 m0, s76, 0
    v_mfma_f32_16x16x32_bf16 v[36:39], a[64:67], a[100:103], v[36:39]
    buffer_load_dwordx4 v3, s[36:39], 0 offen offset:0  lds
    v_mfma_f32_16x16x32_bf16 v[40:43], a[64:67], a[104:107], v[40:43]
    ds_read_b128 a[36:39], v9 offset:34816
    v_mfma_f32_16x16x32_bf16 v[44:47], a[64:67], a[108:111], v[44:47]
    ds_write_b128 v8, a[144:147]
    v_mfma_f32_16x16x32_bf16 v[48:51], a[64:67], a[112:115], v[48:51]
    ds_read_b128 a[40:43], v9 offset:36864
    v_mfma_f32_16x16x32_bf16 v[52:55], a[64:67], a[116:119], v[52:55]
    buffer_load_dword v24, v25, s[48:51], 0 offen sc1
    v_mfma_f32_16x16x32_bf16 v[56:59], a[64:67], a[120:123], v[56:59]
    ds_read_b128 a[44:47], v9 offset:38912
    v_mfma_f32_16x16x32_bf16 v[60:63], a[64:67], a[124:127], v[60:63]
    v_mfma_f32_16x16x32_bf16 v[92:95], a[68:71], a[124:127], v[92:95]
    ds_read_b128 a[48:51], v9 offset:40960
    v_mfma_f32_16x16x32_bf16 v[88:91], a[68:71], a[120:123], v[88:91]
    buffer_load_dwordx4 v4, s[36:39], s65 offen offset:1024  lds
    v_mfma_f32_16x16x32_bf16 v[84:87], a[68:71], a[116:119], v[84:87]
    ds_read_b128 a[52:55], v9 offset:43008
    v_mfma_f32_16x16x32_bf16 v[80:83], a[68:71], a[112:115], v[80:83]
    v_xor_b32 v8, 0x800, v8
    v_mfma_f32_16x16x32_bf16 v[76:79], a[68:71], a[108:111], v[76:79]
    ds_read_b128 a[56:59], v9 offset:45056
    v_mfma_f32_16x16x32_bf16 v[72:75], a[68:71], a[104:107], v[72:75]
    v_accvgpr_read_b32 v28, a144
    v_mfma_f32_16x16x32_bf16 v[68:71], a[68:71], a[100:103], v[68:71]
    ds_read_b128 a[60:63], v9 offset:47104
    v_mfma_f32_16x16x32_bf16 v[64:67], a[68:71], a[96:99], v[64:67]
    v_accvgpr_read_b32 v29, a145
    v_mfma_f32_16x16x32_bf16 v[96:99], a[72:75], a[96:99], v[96:99]
    ds_read_b64_tr_b16 a[0:1], v11 offset:24576
    v_mfma_f32_16x16x32_bf16 v[100:103], a[72:75], a[100:103], v[100:103]
    buffer_load_dwordx4 v3, s[36:39], s66 offen offset:2048  lds
    v_accvgpr_read_b32 v30, a146
    v_mfma_f32_16x16x32_bf16 v[104:107], a[72:75], a[104:107], v[104:107]
    ds_read_b64_tr_b16 a[2:3], v12 offset:24576
    v_mfma_f32_16x16x32_bf16 v[108:111], a[72:75], a[108:111], v[108:111]
    v_accvgpr_read_b32 v31, a147
    v_mfma_f32_16x16x32_bf16 v[112:115], a[72:75], a[112:115], v[112:115]
    ds_read_b64_tr_b16 a[4:5], v13 offset:24576
    v_mfma_f32_16x16x32_bf16 v[116:119], a[72:75], a[116:119], v[116:119]
    v_mfma_f32_16x16x32_bf16 v[120:123], a[72:75], a[120:123], v[120:123]
    ds_read_b64_tr_b16 a[6:7], v14 offset:24576
    v_mfma_f32_16x16x32_bf16 v[124:127], a[72:75], a[124:127], v[124:127]
    v_mfma_f32_16x16x32_bf16 v[156:159], a[76:79], a[124:127], v[156:159]
    ds_read_b64_tr_b16 a[8:9], v15 offset:24576
    v_mfma_f32_16x16x32_bf16 v[152:155], a[76:79], a[120:123], v[152:155]
    buffer_load_dwordx4 v4, s[36:39], s67 offen offset:3072  lds
    v_mfma_f32_16x16x32_bf16 v[148:151], a[76:79], a[116:119], v[148:151]
    ds_read_b64_tr_b16 a[10:11], v16 offset:24576
    v_mfma_f32_16x16x32_bf16 v[144:147], a[76:79], a[112:115], v[144:147]
    v_mfma_f32_16x16x32_bf16 v[140:143], a[76:79], a[108:111], v[140:143]
    ds_read_b64_tr_b16 a[12:13], v17 offset:24576
    v_mfma_f32_16x16x32_bf16 v[136:139], a[76:79], a[104:107], v[136:139]
    v_mfma_f32_16x16x32_bf16 v[132:135], a[76:79], a[100:103], v[132:135]
    ds_read_b64_tr_b16 a[14:15], v18 offset:24576
    v_mfma_f32_16x16x32_bf16 v[128:131], a[76:79], a[96:99], v[128:131]
    v_mfma_f32_16x16x32_bf16 v[160:163], a[80:83], a[96:99], v[160:163]
    ds_read_b64_tr_b16 a[16:17], v19 offset:24576
    s_add_u32 m0, m0, 4096
    v_mfma_f32_16x16x32_bf16 v[164:167], a[80:83], a[100:103], v[164:167]
    buffer_load_dwordx4 v3, s[36:39], s68 offen offset:0  lds
    v_mfma_f32_16x16x32_bf16 v[168:171], a[80:83], a[104:107], v[168:171]
    ds_read_b64_tr_b16 a[18:19], v19 offset:25600
    v_mfma_f32_16x16x32_bf16 v[172:175], a[80:83], a[108:111], v[172:175]
    v_mfma_f32_16x16x32_bf16 v[176:179], a[80:83], a[112:115], v[176:179]
    ds_read_b64_tr_b16 a[20:21], v20 offset:24576
    v_mfma_f32_16x16x32_bf16 v[180:183], a[80:83], a[116:119], v[180:183]
    v_mfma_f32_16x16x32_bf16 v[184:187], a[80:83], a[120:123], v[184:187]
    ds_read_b64_tr_b16 a[22:23], v20 offset:25600
    v_mfma_f32_16x16x32_bf16 v[188:191], a[80:83], a[124:127], v[188:191]
    v_mfma_f32_16x16x32_bf16 v[220:223], a[84:87], a[124:127], v[220:223]
    ds_read_b64_tr_b16 a[24:25], v21 offset:24576
    v_mfma_f32_16x16x32_bf16 v[216:219], a[84:87], a[120:123], v[216:219]
    buffer_load_dwordx4 v4, s[36:39], s69 offen offset:1024  lds
    v_mfma_f32_16x16x32_bf16 v[212:215], a[84:87], a[116:119], v[212:215]
    ds_read_b64_tr_b16 a[26:27], v21 offset:25600
    v_mfma_f32_16x16x32_bf16 v[208:211], a[84:87], a[112:115], v[208:211]
    v_mfma_f32_16x16x32_bf16 v[204:207], a[84:87], a[108:111], v[204:207]
    ds_read_b64_tr_b16 a[28:29], v22 offset:24576
    v_mfma_f32_16x16x32_bf16 v[200:203], a[84:87], a[104:107], v[200:203]
    v_mfma_f32_16x16x32_bf16 v[196:199], a[84:87], a[100:103], v[196:199]
    ds_read_b64_tr_b16 a[30:31], v22 offset:25600
    v_mfma_f32_16x16x32_bf16 v[192:195], a[84:87], a[96:99], v[192:195]
    buffer_load_dwordx4 v3, s[36:39], s70 offen offset:2048  lds
    v_mfma_f32_16x16x32_bf16 v[224:227], a[88:91], a[96:99], v[224:227]
    v_mfma_f32_16x16x32_bf16 v[228:231], a[88:91], a[100:103], v[228:231]
    v_mfma_f32_16x16x32_bf16 v[232:235], a[88:91], a[104:107], v[232:235]
    v_mfma_f32_16x16x32_bf16 v[236:239], a[88:91], a[108:111], v[236:239]
    v_mfma_f32_16x16x32_bf16 v[240:243], a[88:91], a[112:115], v[240:243]
    v_mfma_f32_16x16x32_bf16 v[244:247], a[88:91], a[116:119], v[244:247]
    v_mfma_f32_16x16x32_bf16 v[248:251], a[88:91], a[120:123], v[248:251]
    v_mfma_f32_16x16x32_bf16 v[252:255], a[88:91], a[124:127], v[252:255]
    buffer_load_dwordx4 v4, s[36:39], s71 offen offset:3072  lds
    v_mfma_f32_16x16x32_bf16 a[176:179], a[92:95], a[124:127], a[176:179]
    v_mfma_f32_16x16x32_bf16 a[172:175], a[92:95], a[120:123], a[172:175]
    v_add_u32 v3, 0x80, v3
    v_mfma_f32_16x16x32_bf16 a[168:171], a[92:95], a[116:119], a[168:171]
    v_mfma_f32_16x16x32_bf16 a[164:167], a[92:95], a[112:115], a[164:167]
    v_add_u32 v4, 0x80, v4
    v_mfma_f32_16x16x32_bf16 a[160:163], a[92:95], a[108:111], a[160:163]
    s_waitcnt lgkmcnt(0)
    s_barrier
    v_mfma_f32_16x16x32_bf16 a[156:159], a[92:95], a[104:107], a[156:159]
    v_mfma_f32_16x16x32_bf16 a[152:155], a[92:95], a[100:103], a[152:155]
    v_mfma_f32_16x16x32_bf16 a[148:151], a[92:95], a[96:99], a[148:151]
    v_mfma_f32_16x16x32_bf16 v[32:35], a[0:3], a[32:35], v[32:35]
    ds_read_b128 a[96:99], v10 offset:32768
    s_add_u32 m0, s77, 16384
    v_mfma_f32_16x16x32_bf16 v[36:39], a[0:3], a[36:39], v[36:39]
    buffer_load_dwordx4 v5, s[40:43], 0 offen  lds
    ds_read_b128 a[132:135], v8
    v_mfma_f32_16x16x32_bf16 v[40:43], a[0:3], a[40:43], v[40:43]
    ds_read_b128 a[100:103], v10 offset:34816
    v_mfma_f32_16x16x32_bf16 v[44:47], a[0:3], a[44:47], v[44:47]
    v_mfma_f32_16x16x32_bf16 v[48:51], a[0:3], a[48:51], v[48:51]
    ds_read_b128 a[104:107], v10 offset:36864
    v_mfma_f32_16x16x32_bf16 v[52:55], a[0:3], a[52:55], v[52:55]
    v_mfma_f32_16x16x32_bf16 v[56:59], a[0:3], a[56:59], v[56:59]
    ds_read_b128 a[108:111], v10 offset:38912
    v_mfma_f32_16x16x32_bf16 v[60:63], a[0:3], a[60:63], v[60:63]
    v_mfma_f32_16x16x32_bf16 v[92:95], a[4:7], a[60:63], v[92:95]
    ds_read_b128 a[112:115], v10 offset:40960
    v_mfma_f32_16x16x32_bf16 v[88:91], a[4:7], a[56:59], v[88:91]
    buffer_load_dwordx4 v5, s[52:55], 0 offen offset:1024  lds
    v_mfma_f32_16x16x32_bf16 v[84:87], a[4:7], a[52:55], v[84:87]
    ds_read_b128 a[116:119], v10 offset:43008
    v_mfma_f32_16x16x32_bf16 v[80:83], a[4:7], a[48:51], v[80:83]
    s_waitcnt lgkmcnt(5)
    v_accvgpr_read_b32 v27, a132
    v_mfma_f32_16x16x32_bf16 v[76:79], a[4:7], a[44:47], v[76:79]
    ds_read_b128 a[120:123], v10 offset:45056
    v_add_f32 v28, v28, v27
    v_mfma_f32_16x16x32_bf16 v[72:75], a[4:7], a[40:43], v[72:75]
    v_accvgpr_read_b32 v27, a133
    v_mfma_f32_16x16x32_bf16 v[68:71], a[4:7], a[36:39], v[68:71]
    ds_read_b128 a[124:127], v10 offset:47104
    v_add_f32 v29, v29, v27
    v_mfma_f32_16x16x32_bf16 v[64:67], a[4:7], a[32:35], v[64:67]
    v_accvgpr_read_b32 v27, a134
    v_mfma_f32_16x16x32_bf16 v[96:99], a[8:11], a[32:35], v[96:99]
    ds_read_b64_tr_b16 a[64:65], v11 offset:32768
    s_add_u32 m0, m0, 40960
    v_add_f32 v30, v30, v27
    v_mfma_f32_16x16x32_bf16 v[100:103], a[8:11], a[36:39], v[100:103]
    buffer_load_dwordx4 v6, s[44:47], 0 offen  lds
    v_accvgpr_read_b32 v27, a135
    v_mfma_f32_16x16x32_bf16 v[104:107], a[8:11], a[40:43], v[104:107]
    ds_read_b64_tr_b16 a[66:67], v12 offset:32768
    v_add_f32 v31, v31, v27
    v_mfma_f32_16x16x32_bf16 v[108:111], a[8:11], a[44:47], v[108:111]
    v_mfma_f32_16x16x32_bf16 v[112:115], a[8:11], a[48:51], v[112:115]
    ds_read_b64_tr_b16 a[68:69], v13 offset:32768
    v_mfma_f32_16x16x32_bf16 v[116:119], a[8:11], a[52:55], v[116:119]
    v_cvt_pk_bf16_f32 v28, v28, v29
    v_mfma_f32_16x16x32_bf16 v[120:123], a[8:11], a[56:59], v[120:123]
    ds_read_b64_tr_b16 a[70:71], v14 offset:32768
    v_mfma_f32_16x16x32_bf16 v[124:127], a[8:11], a[60:63], v[124:127]
    v_cvt_pk_bf16_f32 v29, v30, v31
    v_mfma_f32_16x16x32_bf16 v[156:159], a[12:15], a[60:63], v[156:159]
    ds_read_b64_tr_b16 a[72:73], v15 offset:32768
    v_mfma_f32_16x16x32_bf16 v[152:155], a[12:15], a[56:59], v[152:155]
    buffer_load_dwordx4 v6, s[44:47], s73 offen offset:1024  lds
    v_mfma_f32_16x16x32_bf16 v[148:151], a[12:15], a[52:55], v[148:151]
    ds_read_b64_tr_b16 a[74:75], v16 offset:32768
    v_mfma_f32_16x16x32_bf16 v[144:147], a[12:15], a[48:51], v[144:147]
    s_bitcmp1_b32 s64, 0
    s_cbranch_scc1 P1_KVWV
    ds_write_b64 v26, v[28:29]
P1_KVWD:
    v_mfma_f32_16x16x32_bf16 v[140:143], a[12:15], a[44:47], v[140:143]
    ds_read_b64_tr_b16 a[76:77], v17 offset:32768
    v_mfma_f32_16x16x32_bf16 v[136:139], a[12:15], a[40:43], v[136:139]
    v_lshrrev_b32 v8, 3, v1
    v_mfma_f32_16x16x32_bf16 v[132:135], a[12:15], a[36:39], v[132:135]
    ds_read_b64_tr_b16 a[78:79], v18 offset:32768
    v_mfma_f32_16x16x32_bf16 v[128:131], a[12:15], a[32:35], v[128:131]
    v_and_b32 v27, 7, v1
    v_mfma_f32_16x16x32_bf16 v[160:163], a[16:19], a[32:35], v[160:163]
    ds_read_b64_tr_b16 a[80:81], v19 offset:32768
    s_add_u32 m0, s77, 24576
    v_mfma_f32_16x16x32_bf16 v[164:167], a[16:19], a[36:39], v[164:167]
    buffer_load_dwordx4 v5, s[40:43], s72 offen  lds
    v_mfma_f32_16x16x32_bf16 v[168:171], a[16:19], a[40:43], v[168:171]
    ds_read_b64_tr_b16 a[82:83], v19 offset:33792
    v_mfma_f32_16x16x32_bf16 v[172:175], a[16:19], a[44:47], v[172:175]
    v_lshlrev_b32 v27, 4, v27
    v_mfma_f32_16x16x32_bf16 v[176:179], a[16:19], a[48:51], v[176:179]
    ds_read_b64_tr_b16 a[84:85], v20 offset:32768
    v_mfma_f32_16x16x32_bf16 v[180:183], a[16:19], a[52:55], v[180:183]
    v_lshl_add_u32 v8, v8, 8, v27
    v_mfma_f32_16x16x32_bf16 v[184:187], a[16:19], a[56:59], v[184:187]
    ds_read_b64_tr_b16 a[86:87], v20 offset:33792
    v_mfma_f32_16x16x32_bf16 v[188:191], a[16:19], a[60:63], v[188:191]
    buffer_load_dwordx4 v5, s[52:55], s72 offen offset:1024  lds
    v_mfma_f32_16x16x32_bf16 v[220:223], a[20:23], a[60:63], v[220:223]
    ds_read_b64_tr_b16 a[88:89], v21 offset:32768
    v_mfma_f32_16x16x32_bf16 v[216:219], a[20:23], a[56:59], v[216:219]
    s_bfe_u32 s60, s64, 0x10001
    s_lshl_b32 s60, s60, 7
    v_mfma_f32_16x16x32_bf16 v[212:215], a[20:23], a[52:55], v[212:215]
    ds_read_b64_tr_b16 a[90:91], v21 offset:33792
    v_mfma_f32_16x16x32_bf16 v[208:211], a[20:23], a[48:51], v[208:211]
    v_add_u32 v8, s60, v8
    v_mfma_f32_16x16x32_bf16 v[204:207], a[20:23], a[44:47], v[204:207]
    ds_read_b64_tr_b16 a[92:93], v22 offset:32768
    v_add_u32 v26, 147456, v8
    v_mfma_f32_16x16x32_bf16 v[200:203], a[20:23], a[40:43], v[200:203]
    v_mfma_f32_16x16x32_bf16 v[196:199], a[20:23], a[36:39], v[196:199]
    ds_read_b64_tr_b16 a[94:95], v22 offset:33792
    s_add_u32 m0, m0, 40960
    v_mfma_f32_16x16x32_bf16 v[192:195], a[20:23], a[32:35], v[192:195]
    buffer_load_dwordx4 v6, s[44:47], s74 offen  lds
    v_mfma_f32_16x16x32_bf16 v[224:227], a[24:27], a[32:35], v[224:227]
    v_mfma_f32_16x16x32_bf16 v[228:231], a[24:27], a[36:39], v[228:231]
    v_mfma_f32_16x16x32_bf16 v[232:235], a[24:27], a[40:43], v[232:235]
    v_mfma_f32_16x16x32_bf16 v[236:239], a[24:27], a[44:47], v[236:239]
    v_mfma_f32_16x16x32_bf16 v[240:243], a[24:27], a[48:51], v[240:243]
    v_mfma_f32_16x16x32_bf16 v[244:247], a[24:27], a[52:55], v[244:247]
    v_mfma_f32_16x16x32_bf16 v[248:251], a[24:27], a[56:59], v[248:251]
    v_mfma_f32_16x16x32_bf16 v[252:255], a[24:27], a[60:63], v[252:255]
    buffer_load_dwordx4 v6, s[44:47], s75 offen offset:1024  lds
    v_mfma_f32_16x16x32_bf16 a[176:179], a[28:31], a[60:63], a[176:179]
    v_mfma_f32_16x16x32_bf16 a[172:175], a[28:31], a[56:59], a[172:175]
    v_add_u32 v5, 458752, v5
    v_mfma_f32_16x16x32_bf16 a[168:171], a[28:31], a[52:55], a[168:171]
    v_add_u32 v6, s15, v6
    v_mfma_f32_16x16x32_bf16 a[164:167], a[28:31], a[48:51], a[164:167]
    v_mfma_f32_16x16x32_bf16 a[160:163], a[28:31], a[44:47], a[160:163]
    s_waitcnt vmcnt(8) lgkmcnt(0)
    s_barrier
    v_mfma_f32_16x16x32_bf16 a[156:159], a[28:31], a[40:43], a[156:159]
    v_mfma_f32_16x16x32_bf16 a[152:155], a[28:31], a[36:39], a[152:155]
    v_mfma_f32_16x16x32_bf16 a[148:151], a[28:31], a[32:35], a[148:151]
    v_mfma_f32_16x16x32_bf16 v[32:35], a[64:67], a[96:99], v[32:35]
    ds_read_b128 a[32:35], v9 offset:0
    s_add_u32 m0, s76, 32768
    v_mfma_f32_16x16x32_bf16 v[36:39], a[64:67], a[100:103], v[36:39]
    buffer_load_dwordx4 v3, s[36:39], 0 offen offset:0  lds
    v_mfma_f32_16x16x32_bf16 v[40:43], a[64:67], a[104:107], v[40:43]
    ds_read_b128 a[36:39], v9 offset:2048
    v_mfma_f32_16x16x32_bf16 v[44:47], a[64:67], a[108:111], v[44:47]
    ds_read_b128 a[128:131], v26
    v_mfma_f32_16x16x32_bf16 v[48:51], a[64:67], a[112:115], v[48:51]
    ds_read_b128 a[40:43], v9 offset:4096
    v_mfma_f32_16x16x32_bf16 v[52:55], a[64:67], a[116:119], v[52:55]
    s_lshl_b32 s10, s63, 3
    s_lshr_b32 s60, s64, 2
    s_add_u32 s10, s10, s60
    v_mfma_f32_16x16x32_bf16 v[56:59], a[64:67], a[120:123], v[56:59]
    ds_read_b128 a[44:47], v9 offset:6144
    v_mfma_f32_16x16x32_bf16 v[60:63], a[64:67], a[124:127], v[60:63]
    s_lshl_b32 s10, s10, 1
    s_and_b32 s60, s64, 1
    s_add_u32 s10, s10, s60
    v_mfma_f32_16x16x32_bf16 v[92:95], a[68:71], a[124:127], v[92:95]
    ds_read_b128 a[48:51], v9 offset:8192
    v_mfma_f32_16x16x32_bf16 v[88:91], a[68:71], a[120:123], v[88:91]
    buffer_load_dwordx4 v4, s[36:39], s65 offen offset:1024  lds
    v_mfma_f32_16x16x32_bf16 v[84:87], a[68:71], a[116:119], v[84:87]
    ds_read_b128 a[52:55], v9 offset:10240
    v_mfma_f32_16x16x32_bf16 v[80:83], a[68:71], a[112:115], v[80:83]
    s_lshl_b32 s10, s10, 11
    s_add_u32 s10, s10, 23068672
    s_lshl_b32 s11, s63, 5
    v_mfma_f32_16x16x32_bf16 v[76:79], a[68:71], a[108:111], v[76:79]
    ds_read_b128 a[56:59], v9 offset:12288
    v_mfma_f32_16x16x32_bf16 v[72:75], a[68:71], a[104:107], v[72:75]
    s_add_u32 s11, s11, s64
    s_lshl_b32 s11, s11, 2
    s_add_u32 s11, s11, 23396352
    v_mfma_f32_16x16x32_bf16 v[68:71], a[68:71], a[100:103], v[68:71]
    ds_read_b128 a[60:63], v9 offset:14336
    v_mfma_f32_16x16x32_bf16 v[64:67], a[68:71], a[96:99], v[64:67]
    s_cmp_eq_u32 s56, 0
    s_cselect_b32 s10, s10, 1073741824
    s_cselect_b32 s11, s11, 1073741824
    v_mfma_f32_16x16x32_bf16 v[96:99], a[72:75], a[96:99], v[96:99]
    ds_read_b64_tr_b16 a[0:1], v11 offset:0
    v_mfma_f32_16x16x32_bf16 v[100:103], a[72:75], a[100:103], v[100:103]
    buffer_load_dwordx4 v3, s[36:39], s66 offen offset:2048  lds
    v_mfma_f32_16x16x32_bf16 v[104:107], a[72:75], a[104:107], v[104:107]
    ds_read_b64_tr_b16 a[2:3], v12 offset:0
    v_mfma_f32_16x16x32_bf16 v[108:111], a[72:75], a[108:111], v[108:111]
    v_mul_u32_u24 v27, 4352, v1
    v_mfma_f32_16x16x32_bf16 v[112:115], a[72:75], a[112:115], v[112:115]
    ds_read_b64_tr_b16 a[4:5], v13 offset:0
    v_mfma_f32_16x16x32_bf16 v[116:119], a[72:75], a[116:119], v[116:119]
    s_waitcnt lgkmcnt(9)
    buffer_store_dwordx4 a[128:131], v8, s[32:35], s10 offen sc1
    v_mfma_f32_16x16x32_bf16 v[120:123], a[72:75], a[120:123], v[120:123]
    ds_read_b64_tr_b16 a[6:7], v14 offset:0
    v_mfma_f32_16x16x32_bf16 v[124:127], a[72:75], a[124:127], v[124:127]
    v_mfma_f32_16x16x32_bf16 v[156:159], a[76:79], a[124:127], v[156:159]
    ds_read_b64_tr_b16 a[8:9], v15 offset:0
    v_mfma_f32_16x16x32_bf16 v[152:155], a[76:79], a[120:123], v[152:155]
    buffer_load_dwordx4 v4, s[36:39], s67 offen offset:3072  lds
    v_mfma_f32_16x16x32_bf16 v[148:151], a[76:79], a[116:119], v[148:151]
    ds_read_b64_tr_b16 a[10:11], v16 offset:0
    v_mfma_f32_16x16x32_bf16 v[144:147], a[76:79], a[112:115], v[144:147]
    v_mfma_f32_16x16x32_bf16 v[140:143], a[76:79], a[108:111], v[140:143]
    ds_read_b64_tr_b16 a[12:13], v17 offset:0
    v_mfma_f32_16x16x32_bf16 v[136:139], a[76:79], a[104:107], v[136:139]
    v_mfma_f32_16x16x32_bf16 v[132:135], a[76:79], a[100:103], v[132:135]
    ds_read_b64_tr_b16 a[14:15], v18 offset:0
    v_mfma_f32_16x16x32_bf16 v[128:131], a[76:79], a[96:99], v[128:131]
    v_mfma_f32_16x16x32_bf16 v[160:163], a[80:83], a[96:99], v[160:163]
    ds_read_b64_tr_b16 a[16:17], v19 offset:0
    s_add_u32 m0, m0, 4096
    v_mfma_f32_16x16x32_bf16 v[164:167], a[80:83], a[100:103], v[164:167]
    buffer_load_dwordx4 v3, s[36:39], s68 offen offset:0  lds
    v_mfma_f32_16x16x32_bf16 v[168:171], a[80:83], a[104:107], v[168:171]
    ds_read_b64_tr_b16 a[18:19], v19 offset:1024
    v_mfma_f32_16x16x32_bf16 v[172:175], a[80:83], a[108:111], v[172:175]
    v_mfma_f32_16x16x32_bf16 v[176:179], a[80:83], a[112:115], v[176:179]
    ds_read_b64_tr_b16 a[20:21], v20 offset:0
    v_mfma_f32_16x16x32_bf16 v[180:183], a[80:83], a[116:119], v[180:183]
    v_mfma_f32_16x16x32_bf16 v[184:187], a[80:83], a[120:123], v[184:187]
    ds_read_b64_tr_b16 a[22:23], v20 offset:1024
    v_mfma_f32_16x16x32_bf16 v[188:191], a[80:83], a[124:127], v[188:191]
    v_mfma_f32_16x16x32_bf16 v[220:223], a[84:87], a[124:127], v[220:223]
    ds_read_b64_tr_b16 a[24:25], v21 offset:0
    v_mfma_f32_16x16x32_bf16 v[216:219], a[84:87], a[120:123], v[216:219]
    buffer_load_dwordx4 v4, s[36:39], s69 offen offset:1024  lds
    v_mfma_f32_16x16x32_bf16 v[212:215], a[84:87], a[116:119], v[212:215]
    ds_read_b64_tr_b16 a[26:27], v21 offset:1024
    v_mfma_f32_16x16x32_bf16 v[208:211], a[84:87], a[112:115], v[208:211]
    v_mfma_f32_16x16x32_bf16 v[204:207], a[84:87], a[108:111], v[204:207]
    ds_read_b64_tr_b16 a[28:29], v22 offset:0
    v_mfma_f32_16x16x32_bf16 v[200:203], a[84:87], a[104:107], v[200:203]
    v_mfma_f32_16x16x32_bf16 v[196:199], a[84:87], a[100:103], v[196:199]
    ds_read_b64_tr_b16 a[30:31], v22 offset:1024
    v_mfma_f32_16x16x32_bf16 v[192:195], a[84:87], a[96:99], v[192:195]
    buffer_load_dwordx4 v3, s[36:39], s70 offen offset:2048  lds
    v_mfma_f32_16x16x32_bf16 v[224:227], a[88:91], a[96:99], v[224:227]
    v_mfma_f32_16x16x32_bf16 v[228:231], a[88:91], a[100:103], v[228:231]
    v_mfma_f32_16x16x32_bf16 v[232:235], a[88:91], a[104:107], v[232:235]
    v_mfma_f32_16x16x32_bf16 v[236:239], a[88:91], a[108:111], v[236:239]
    v_mfma_f32_16x16x32_bf16 v[240:243], a[88:91], a[112:115], v[240:243]
    v_mfma_f32_16x16x32_bf16 v[244:247], a[88:91], a[116:119], v[244:247]
    v_mfma_f32_16x16x32_bf16 v[248:251], a[88:91], a[120:123], v[248:251]
    v_mfma_f32_16x16x32_bf16 v[252:255], a[88:91], a[124:127], v[252:255]
    buffer_load_dwordx4 v4, s[36:39], s71 offen offset:3072  lds
    v_mfma_f32_16x16x32_bf16 a[176:179], a[92:95], a[124:127], a[176:179]
    v_mfma_f32_16x16x32_bf16 a[172:175], a[92:95], a[120:123], a[172:175]
    v_add_u32 v3, 0x80, v3
    v_mfma_f32_16x16x32_bf16 a[168:171], a[92:95], a[116:119], a[168:171]
    v_mfma_f32_16x16x32_bf16 a[164:167], a[92:95], a[112:115], a[164:167]
    v_add_u32 v4, 0x80, v4
    v_mfma_f32_16x16x32_bf16 a[160:163], a[92:95], a[108:111], a[160:163]
    s_waitcnt lgkmcnt(0)
    s_barrier
    v_mfma_f32_16x16x32_bf16 a[156:159], a[92:95], a[104:107], a[156:159]
    v_mfma_f32_16x16x32_bf16 a[152:155], a[92:95], a[100:103], a[152:155]
    v_mfma_f32_16x16x32_bf16 a[148:151], a[92:95], a[96:99], a[148:151]
    v_mfma_f32_16x16x32_bf16 v[32:35], a[0:3], a[32:35], v[32:35]
    ds_read_b128 a[96:99], v10 offset:0
    s_add_u32 m0, s77, 32768
    v_mfma_f32_16x16x32_bf16 v[36:39], a[0:3], a[36:39], v[36:39]
    buffer_load_dwordx4 v5, s[40:43], 0 offen  lds
    v_mfma_f32_16x16x32_bf16 v[40:43], a[0:3], a[40:43], v[40:43]
    ds_read_b128 a[100:103], v10 offset:2048
    v_mfma_f32_16x16x32_bf16 v[44:47], a[0:3], a[44:47], v[44:47]
    v_mfma_f32_16x16x32_bf16 v[48:51], a[0:3], a[48:51], v[48:51]
    ds_read_b128 a[104:107], v10 offset:4096
    v_mfma_f32_16x16x32_bf16 v[52:55], a[0:3], a[52:55], v[52:55]
    v_mfma_f32_16x16x32_bf16 v[56:59], a[0:3], a[56:59], v[56:59]
    ds_read_b128 a[108:111], v10 offset:6144
    v_mfma_f32_16x16x32_bf16 v[60:63], a[0:3], a[60:63], v[60:63]
    v_mfma_f32_16x16x32_bf16 v[92:95], a[4:7], a[60:63], v[92:95]
    ds_read_b128 a[112:115], v10 offset:8192
    v_mfma_f32_16x16x32_bf16 v[88:91], a[4:7], a[56:59], v[88:91]
    buffer_load_dwordx4 v5, s[52:55], 0 offen offset:1024  lds
    v_mfma_f32_16x16x32_bf16 v[84:87], a[4:7], a[52:55], v[84:87]
    ds_read_b128 a[116:119], v10 offset:10240
    v_mfma_f32_16x16x32_bf16 v[80:83], a[4:7], a[48:51], v[80:83]
    v_mfma_f32_16x16x32_bf16 v[76:79], a[4:7], a[44:47], v[76:79]
    ds_read_b128 a[120:123], v10 offset:12288
    v_mfma_f32_16x16x32_bf16 v[72:75], a[4:7], a[40:43], v[72:75]
    v_mfma_f32_16x16x32_bf16 v[68:71], a[4:7], a[36:39], v[68:71]
    ds_read_b128 a[124:127], v10 offset:14336
    v_mfma_f32_16x16x32_bf16 v[64:67], a[4:7], a[32:35], v[64:67]
    v_mfma_f32_16x16x32_bf16 v[96:99], a[8:11], a[32:35], v[96:99]
    ds_read_b64_tr_b16 a[64:65], v11 offset:8192
    s_add_u32 m0, m0, 40960
    v_mfma_f32_16x16x32_bf16 v[100:103], a[8:11], a[36:39], v[100:103]
    buffer_load_dwordx4 v6, s[44:47], 0 offen  lds
    v_mfma_f32_16x16x32_bf16 v[104:107], a[8:11], a[40:43], v[104:107]
    ds_read_b64_tr_b16 a[66:67], v12 offset:8192
    v_mfma_f32_16x16x32_bf16 v[108:111], a[8:11], a[44:47], v[108:111]
    v_mfma_f32_16x16x32_bf16 v[112:115], a[8:11], a[48:51], v[112:115]
    ds_read_b64_tr_b16 a[68:69], v13 offset:8192
    v_mfma_f32_16x16x32_bf16 v[116:119], a[8:11], a[52:55], v[116:119]
    v_mfma_f32_16x16x32_bf16 v[120:123], a[8:11], a[56:59], v[120:123]
    ds_read_b64_tr_b16 a[70:71], v14 offset:8192
    v_mfma_f32_16x16x32_bf16 v[124:127], a[8:11], a[60:63], v[124:127]
    v_mfma_f32_16x16x32_bf16 v[156:159], a[12:15], a[60:63], v[156:159]
    ds_read_b64_tr_b16 a[72:73], v15 offset:8192
    v_mfma_f32_16x16x32_bf16 v[152:155], a[12:15], a[56:59], v[152:155]
    buffer_load_dwordx4 v6, s[44:47], s73 offen offset:1024  lds
    v_mfma_f32_16x16x32_bf16 v[148:151], a[12:15], a[52:55], v[148:151]
    ds_read_b64_tr_b16 a[74:75], v16 offset:8192
    v_mfma_f32_16x16x32_bf16 v[144:147], a[12:15], a[48:51], v[144:147]
    v_mfma_f32_16x16x32_bf16 v[140:143], a[12:15], a[44:47], v[140:143]
    ds_read_b64_tr_b16 a[76:77], v17 offset:8192
    v_mfma_f32_16x16x32_bf16 v[136:139], a[12:15], a[40:43], v[136:139]
    v_mfma_f32_16x16x32_bf16 v[132:135], a[12:15], a[36:39], v[132:135]
    ds_read_b64_tr_b16 a[78:79], v18 offset:8192
    v_mfma_f32_16x16x32_bf16 v[128:131], a[12:15], a[32:35], v[128:131]
    v_mfma_f32_16x16x32_bf16 v[160:163], a[16:19], a[32:35], v[160:163]
    ds_read_b64_tr_b16 a[80:81], v19 offset:8192
    s_add_u32 m0, s77, 0
    v_mfma_f32_16x16x32_bf16 v[164:167], a[16:19], a[36:39], v[164:167]
    buffer_load_dwordx4 v5, s[40:43], s72 offen  lds
    v_mfma_f32_16x16x32_bf16 v[168:171], a[16:19], a[40:43], v[168:171]
    ds_read_b64_tr_b16 a[82:83], v19 offset:9216
    v_mfma_f32_16x16x32_bf16 v[172:175], a[16:19], a[44:47], v[172:175]
    v_mfma_f32_16x16x32_bf16 v[176:179], a[16:19], a[48:51], v[176:179]
    ds_read_b64_tr_b16 a[84:85], v20 offset:8192
    v_mfma_f32_16x16x32_bf16 v[180:183], a[16:19], a[52:55], v[180:183]
    v_mfma_f32_16x16x32_bf16 v[184:187], a[16:19], a[56:59], v[184:187]
    ds_read_b64_tr_b16 a[86:87], v20 offset:9216
    v_mfma_f32_16x16x32_bf16 v[188:191], a[16:19], a[60:63], v[188:191]
    buffer_load_dwordx4 v5, s[52:55], s72 offen offset:1024  lds
    v_mfma_f32_16x16x32_bf16 v[220:223], a[20:23], a[60:63], v[220:223]
    ds_read_b64_tr_b16 a[88:89], v21 offset:8192
    v_mfma_f32_16x16x32_bf16 v[216:219], a[20:23], a[56:59], v[216:219]
    v_mfma_f32_16x16x32_bf16 v[212:215], a[20:23], a[52:55], v[212:215]
    ds_read_b64_tr_b16 a[90:91], v21 offset:9216
    v_mfma_f32_16x16x32_bf16 v[208:211], a[20:23], a[48:51], v[208:211]
    v_mfma_f32_16x16x32_bf16 v[204:207], a[20:23], a[44:47], v[204:207]
    ds_read_b64_tr_b16 a[92:93], v22 offset:8192
    v_mfma_f32_16x16x32_bf16 v[200:203], a[20:23], a[40:43], v[200:203]
    v_mfma_f32_16x16x32_bf16 v[196:199], a[20:23], a[36:39], v[196:199]
    ds_read_b64_tr_b16 a[94:95], v22 offset:9216
    s_add_u32 m0, m0, 40960
    v_mfma_f32_16x16x32_bf16 v[192:195], a[20:23], a[32:35], v[192:195]
    buffer_load_dwordx4 v6, s[44:47], s74 offen  lds
    v_mfma_f32_16x16x32_bf16 v[224:227], a[24:27], a[32:35], v[224:227]
    v_mfma_f32_16x16x32_bf16 v[228:231], a[24:27], a[36:39], v[228:231]
    v_mfma_f32_16x16x32_bf16 v[232:235], a[24:27], a[40:43], v[232:235]
    v_mfma_f32_16x16x32_bf16 v[236:239], a[24:27], a[44:47], v[236:239]
    v_mfma_f32_16x16x32_bf16 v[240:243], a[24:27], a[48:51], v[240:243]
    v_mfma_f32_16x16x32_bf16 v[244:247], a[24:27], a[52:55], v[244:247]
    v_mfma_f32_16x16x32_bf16 v[248:251], a[24:27], a[56:59], v[248:251]
    v_mfma_f32_16x16x32_bf16 v[252:255], a[24:27], a[60:63], v[252:255]
    buffer_load_dwordx4 v6, s[44:47], s75 offen offset:1024  lds
    v_mfma_f32_16x16x32_bf16 a[176:179], a[28:31], a[60:63], a[176:179]
    v_mfma_f32_16x16x32_bf16 a[172:175], a[28:31], a[56:59], a[172:175]
    v_add_u32 v5, 458752, v5
    v_mfma_f32_16x16x32_bf16 a[168:171], a[28:31], a[52:55], a[168:171]
    v_add_u32 v6, s15, v6
    v_mfma_f32_16x16x32_bf16 a[164:167], a[28:31], a[48:51], a[164:167]
    v_mfma_f32_16x16x32_bf16 a[160:163], a[28:31], a[44:47], a[160:163]
    s_waitcnt vmcnt(8) lgkmcnt(0)
    s_barrier
    v_mfma_f32_16x16x32_bf16 a[156:159], a[28:31], a[40:43], a[156:159]
    v_mfma_f32_16x16x32_bf16 a[152:155], a[28:31], a[36:39], a[152:155]
    v_mfma_f32_16x16x32_bf16 a[148:151], a[28:31], a[32:35], a[148:151]
    v_mfma_f32_16x16x32_bf16 v[32:35], a[64:67], a[96:99], v[32:35]
    ds_read_b128 a[32:35], v9 offset:32768
    s_add_u32 m0, s76, 0
    v_mfma_f32_16x16x32_bf16 v[36:39], a[64:67], a[100:103], v[36:39]
    buffer_load_dwordx4 v3, s[36:39], 0 offen offset:0  lds
    v_mfma_f32_16x16x32_bf16 v[40:43], a[64:67], a[104:107], v[40:43]
    ds_read_b128 a[36:39], v9 offset:34816
    v_mfma_f32_16x16x32_bf16 v[44:47], a[64:67], a[108:111], v[44:47]
    v_mfma_f32_16x16x32_bf16 v[48:51], a[64:67], a[112:115], v[48:51]
    ds_read_b128 a[40:43], v9 offset:36864
    v_mfma_f32_16x16x32_bf16 v[52:55], a[64:67], a[116:119], v[52:55]
    v_mfma_f32_16x16x32_bf16 v[56:59], a[64:67], a[120:123], v[56:59]
    ds_read_b128 a[44:47], v9 offset:38912
    v_mfma_f32_16x16x32_bf16 v[60:63], a[64:67], a[124:127], v[60:63]
    v_mfma_f32_16x16x32_bf16 v[92:95], a[68:71], a[124:127], v[92:95]
    ds_read_b128 a[48:51], v9 offset:40960
    v_mfma_f32_16x16x32_bf16 v[88:91], a[68:71], a[120:123], v[88:91]
    buffer_load_dwordx4 v4, s[36:39], s65 offen offset:1024  lds
    v_mfma_f32_16x16x32_bf16 v[84:87], a[68:71], a[116:119], v[84:87]
    ds_read_b128 a[52:55], v9 offset:43008
    v_mfma_f32_16x16x32_bf16 v[80:83], a[68:71], a[112:115], v[80:83]
    v_mfma_f32_16x16x32_bf16 v[76:79], a[68:71], a[108:111], v[76:79]
    ds_read_b128 a[56:59], v9 offset:45056
    v_mfma_f32_16x16x32_bf16 v[72:75], a[68:71], a[104:107], v[72:75]
    v_mfma_f32_16x16x32_bf16 v[68:71], a[68:71], a[100:103], v[68:71]
    ds_read_b128 a[60:63], v9 offset:47104
    v_mfma_f32_16x16x32_bf16 v[64:67], a[68:71], a[96:99], v[64:67]
    v_mfma_f32_16x16x32_bf16 v[96:99], a[72:75], a[96:99], v[96:99]
    ds_read_b64_tr_b16 a[0:1], v11 offset:16384
    v_mfma_f32_16x16x32_bf16 v[100:103], a[72:75], a[100:103], v[100:103]
    buffer_load_dwordx4 v3, s[36:39], s66 offen offset:2048  lds
    v_mfma_f32_16x16x32_bf16 v[104:107], a[72:75], a[104:107], v[104:107]
    ds_read_b64_tr_b16 a[2:3], v12 offset:16384
    v_mfma_f32_16x16x32_bf16 v[108:111], a[72:75], a[108:111], v[108:111]
    v_mfma_f32_16x16x32_bf16 v[112:115], a[72:75], a[112:115], v[112:115]
    ds_read_b64_tr_b16 a[4:5], v13 offset:16384
    v_mfma_f32_16x16x32_bf16 v[116:119], a[72:75], a[116:119], v[116:119]
    v_mfma_f32_16x16x32_bf16 v[120:123], a[72:75], a[120:123], v[120:123]
    ds_read_b64_tr_b16 a[6:7], v14 offset:16384
    v_mfma_f32_16x16x32_bf16 v[124:127], a[72:75], a[124:127], v[124:127]
    v_mfma_f32_16x16x32_bf16 v[156:159], a[76:79], a[124:127], v[156:159]
    ds_read_b64_tr_b16 a[8:9], v15 offset:16384
    v_mfma_f32_16x16x32_bf16 v[152:155], a[76:79], a[120:123], v[152:155]
    buffer_load_dwordx4 v4, s[36:39], s67 offen offset:3072  lds
    v_mfma_f32_16x16x32_bf16 v[148:151], a[76:79], a[116:119], v[148:151]
    ds_read_b64_tr_b16 a[10:11], v16 offset:16384
    v_mfma_f32_16x16x32_bf16 v[144:147], a[76:79], a[112:115], v[144:147]
    s_waitcnt vmcnt(17)
    v_readfirstlane_b32 s57, v24
    s_cmp_eq_u32 s57, 0
    s_cbranch_scc1 P1_SLOWN
P1_NOK:
    s_mov_b64 exec, 0xff
    buffer_store_dword v24, v27, s[32:35], s11 offen sc1
    s_mov_b64 exec, -1
    s_nop 2
    v_mfma_f32_16x16x32_bf16 v[140:143], a[76:79], a[108:111], v[140:143]
    ds_read_b64_tr_b16 a[12:13], v17 offset:16384
    s_mov_b32 s48, s22
    v_mfma_f32_16x16x32_bf16 v[136:139], a[76:79], a[104:107], v[136:139]
    s_mov_b32 s49, s23
    s_mov_b32 s50, 2048
    v_mfma_f32_16x16x32_bf16 v[132:135], a[76:79], a[100:103], v[132:135]
    ds_read_b64_tr_b16 a[14:15], v18 offset:16384
    v_mfma_f32_16x16x32_bf16 v[128:131], a[76:79], a[96:99], v[128:131]
    buffer_load_dwordx4 a[212:215], v2, s[48:51], 0 offen
    v_mfma_f32_16x16x32_bf16 v[160:163], a[80:83], a[96:99], v[160:163]
    ds_read_b64_tr_b16 a[16:17], v19 offset:16384
    s_add_u32 m0, m0, 4096
    v_mfma_f32_16x16x32_bf16 v[164:167], a[80:83], a[100:103], v[164:167]
    buffer_load_dwordx4 v3, s[36:39], s68 offen offset:0  lds
    v_mfma_f32_16x16x32_bf16 v[168:171], a[80:83], a[104:107], v[168:171]
    ds_read_b64_tr_b16 a[18:19], v19 offset:17408
    v_mfma_f32_16x16x32_bf16 v[172:175], a[80:83], a[108:111], v[172:175]
    buffer_load_dwordx4 a[216:219], v2, s[48:51], 0 offen offset:1024
    v_mfma_f32_16x16x32_bf16 v[176:179], a[80:83], a[112:115], v[176:179]
    ds_read_b64_tr_b16 a[20:21], v20 offset:16384
    s_mov_b32 s48, s4
    v_mfma_f32_16x16x32_bf16 v[180:183], a[80:83], a[116:119], v[180:183]
    s_mov_b32 s49, s5
    s_mov_b32 s50, 0x400000
    s_lshl_b32 s60, s63, 5
    v_mfma_f32_16x16x32_bf16 v[184:187], a[80:83], a[120:123], v[184:187]
    ds_read_b64_tr_b16 a[22:23], v20 offset:17408
    s_add_u32 s60, s60, s64
    v_mfma_f32_16x16x32_bf16 v[188:191], a[80:83], a[124:127], v[188:191]
    s_lshl_b32 s60, s60, 2
    s_add_u32 s60, s60, s56
    s_lshl_b32 s59, s60, 3
    v_mfma_f32_16x16x32_bf16 v[220:223], a[84:87], a[124:127], v[220:223]
    ds_read_b64_tr_b16 a[24:25], v21 offset:16384
    s_lshl_b32 s60, s60, 12
    v_mfma_f32_16x16x32_bf16 v[216:219], a[84:87], a[120:123], v[216:219]
    buffer_load_dwordx4 v4, s[36:39], s69 offen offset:1024  lds
    v_mfma_f32_16x16x32_bf16 v[212:215], a[84:87], a[116:119], v[212:215]
    ds_read_b64_tr_b16 a[26:27], v21 offset:17408
    s_add_u32 s59, s59, 23330816
    v_mfma_f32_16x16x32_bf16 v[208:211], a[84:87], a[112:115], v[208:211]
    buffer_load_dwordx4 a[196:199], v2, s[48:51], s60 offen offset:0
    v_mfma_f32_16x16x32_bf16 v[204:207], a[84:87], a[108:111], v[204:207]
    ds_read_b64_tr_b16 a[28:29], v22 offset:16384
    v_mfma_f32_16x16x32_bf16 v[200:203], a[84:87], a[104:107], v[200:203]
    buffer_load_dwordx4 a[200:203], v2, s[48:51], s60 offen offset:1024
    v_mfma_f32_16x16x32_bf16 v[196:199], a[84:87], a[100:103], v[196:199]
    ds_read_b64_tr_b16 a[30:31], v22 offset:17408
    v_mfma_f32_16x16x32_bf16 v[192:195], a[84:87], a[96:99], v[192:195]
    buffer_load_dwordx4 v3, s[36:39], s70 offen offset:2048  lds
    v_mfma_f32_16x16x32_bf16 v[224:227], a[88:91], a[96:99], v[224:227]
    v_mfma_f32_16x16x32_bf16 v[228:231], a[88:91], a[100:103], v[228:231]
    v_mfma_f32_16x16x32_bf16 v[232:235], a[88:91], a[104:107], v[232:235]
    v_mfma_f32_16x16x32_bf16 v[236:239], a[88:91], a[108:111], v[236:239]
    buffer_load_dwordx4 a[204:207], v2, s[48:51], s60 offen offset:2048
    v_mfma_f32_16x16x32_bf16 v[240:243], a[88:91], a[112:115], v[240:243]
    v_mfma_f32_16x16x32_bf16 v[244:247], a[88:91], a[116:119], v[244:247]
    buffer_load_dwordx4 a[208:211], v2, s[48:51], s60 offen offset:3072
    v_mfma_f32_16x16x32_bf16 v[248:251], a[88:91], a[120:123], v[248:251]
    v_mfma_f32_16x16x32_bf16 v[252:255], a[88:91], a[124:127], v[252:255]
    buffer_load_dwordx4 v4, s[36:39], s71 offen offset:3072  lds
    v_mfma_f32_16x16x32_bf16 a[176:179], a[92:95], a[124:127], a[176:179]
    v_mfma_f32_16x16x32_bf16 a[172:175], a[92:95], a[120:123], a[172:175]
    v_add_u32 v3, 0x80, v3
    v_mfma_f32_16x16x32_bf16 a[168:171], a[92:95], a[116:119], a[168:171]
    v_mfma_f32_16x16x32_bf16 a[164:167], a[92:95], a[112:115], a[164:167]
    v_add_u32 v4, 0x80, v4
    v_mfma_f32_16x16x32_bf16 a[160:163], a[92:95], a[108:111], a[160:163]
    s_waitcnt lgkmcnt(0)
    s_barrier
    v_mfma_f32_16x16x32_bf16 a[156:159], a[92:95], a[104:107], a[156:159]
    v_mfma_f32_16x16x32_bf16 a[152:155], a[92:95], a[100:103], a[152:155]
    v_mfma_f32_16x16x32_bf16 a[148:151], a[92:95], a[96:99], a[148:151]
    s_branch P1_CONT
P1_KVAV:
    v_lshrrev_b32 v26, 5, v1
    v_lshlrev_b32 v26, 4, v26
    v_bfe_u32 v27, v1, 4, 1
    v_lshl_add_u32 v26, v27, 2, v26
    v_bfe_u32 v27, v1, 2, 1
    v_lshl_add_u32 v26, v27, 5, v26
    v_lshlrev_b32 v26, 4, v26
    v_bfe_u32 v27, v1, 3, 1
    v_lshl_add_u32 v26, v27, 10, v26
    v_and_b32 v27, 3, v1
    v_lshl_add_u32 v26, v27, 1, v26
    s_lshl_b32 s10, s31, 7
    s_lshl_b32 s11, s3, 3
    s_branch P1_KVAD
P1_KVWV:
    ds_write_b16 v26, v28
    ds_write_b16_d16_hi v26, v28 offset:16
    ds_write_b16 v26, v29 offset:32
    ds_write_b16_d16_hi v26, v29 offset:48
    s_branch P1_KVWD
P1_CONT:
    v_mfma_f32_16x16x32_bf16 v[32:35], a[0:3], a[32:35], v[32:35]
    ds_read_b128 a[96:99], v10 offset:32768
    s_add_u32 m0, s77, 8192
    v_mfma_f32_16x16x32_bf16 v[36:39], a[0:3], a[36:39], v[36:39]
    buffer_load_dwordx4 v5, s[40:43], 0 offen  lds
    v_mfma_f32_16x16x32_bf16 v[40:43], a[0:3], a[40:43], v[40:43]
    ds_read_b128 a[100:103], v10 offset:34816
    v_mfma_f32_16x16x32_bf16 v[44:47], a[0:3], a[44:47], v[44:47]
    v_mfma_f32_16x16x32_bf16 v[48:51], a[0:3], a[48:51], v[48:51]
    ds_read_b128 a[104:107], v10 offset:36864
    global_load_dword a253, v0, s[100:101]
    v_add_u32 v0, 0x2000, v0
    v_mfma_f32_16x16x32_bf16 v[52:55], a[0:3], a[52:55], v[52:55]
    v_mfma_f32_16x16x32_bf16 v[56:59], a[0:3], a[56:59], v[56:59]
    ds_read_b128 a[108:111], v10 offset:38912
    v_mfma_f32_16x16x32_bf16 v[60:63], a[0:3], a[60:63], v[60:63]
    v_mfma_f32_16x16x32_bf16 v[92:95], a[4:7], a[60:63], v[92:95]
    ds_read_b128 a[112:115], v10 offset:40960
    v_mfma_f32_16x16x32_bf16 v[88:91], a[4:7], a[56:59], v[88:91]
    buffer_load_dwordx4 v5, s[52:55], 0 offen offset:1024  lds
    v_mfma_f32_16x16x32_bf16 v[84:87], a[4:7], a[52:55], v[84:87]
    ds_read_b128 a[116:119], v10 offset:43008
    v_mfma_f32_16x16x32_bf16 v[80:83], a[4:7], a[48:51], v[80:83]
    v_mfma_f32_16x16x32_bf16 v[76:79], a[4:7], a[44:47], v[76:79]
    ds_read_b128 a[120:123], v10 offset:45056
    v_mfma_f32_16x16x32_bf16 v[72:75], a[4:7], a[40:43], v[72:75]
    v_mfma_f32_16x16x32_bf16 v[68:71], a[4:7], a[36:39], v[68:71]
    ds_read_b128 a[124:127], v10 offset:47104
    v_mfma_f32_16x16x32_bf16 v[64:67], a[4:7], a[32:35], v[64:67]
    v_mfma_f32_16x16x32_bf16 v[96:99], a[8:11], a[32:35], v[96:99]
    ds_read_b64_tr_b16 a[64:65], v11 offset:24576
    s_add_u32 m0, m0, 40960
    v_mfma_f32_16x16x32_bf16 v[100:103], a[8:11], a[36:39], v[100:103]
    buffer_load_dwordx4 v6, s[44:47], 0 offen  lds
    v_mfma_f32_16x16x32_bf16 v[104:107], a[8:11], a[40:43], v[104:107]
    ds_read_b64_tr_b16 a[66:67], v12 offset:24576
    v_mfma_f32_16x16x32_bf16 v[108:111], a[8:11], a[44:47], v[108:111]
    v_mfma_f32_16x16x32_bf16 v[112:115], a[8:11], a[48:51], v[112:115]
    ds_read_b64_tr_b16 a[68:69], v13 offset:24576
    v_mfma_f32_16x16x32_bf16 v[116:119], a[8:11], a[52:55], v[116:119]
    v_mfma_f32_16x16x32_bf16 v[120:123], a[8:11], a[56:59], v[120:123]
    ds_read_b64_tr_b16 a[70:71], v14 offset:24576
    v_mfma_f32_16x16x32_bf16 v[124:127], a[8:11], a[60:63], v[124:127]
    v_mfma_f32_16x16x32_bf16 v[156:159], a[12:15], a[60:63], v[156:159]
    ds_read_b64_tr_b16 a[72:73], v15 offset:24576
    v_mfma_f32_16x16x32_bf16 v[152:155], a[12:15], a[56:59], v[152:155]
    buffer_load_dwordx4 v6, s[44:47], s73 offen offset:1024  lds
    v_mfma_f32_16x16x32_bf16 v[148:151], a[12:15], a[52:55], v[148:151]
    ds_read_b64_tr_b16 a[74:75], v16 offset:24576
    v_mfma_f32_16x16x32_bf16 v[144:147], a[12:15], a[48:51], v[144:147]
    v_mfma_f32_16x16x32_bf16 v[140:143], a[12:15], a[44:47], v[140:143]
    ds_read_b64_tr_b16 a[76:77], v17 offset:24576
    v_mfma_f32_16x16x32_bf16 v[136:139], a[12:15], a[40:43], v[136:139]
    v_mfma_f32_16x16x32_bf16 v[132:135], a[12:15], a[36:39], v[132:135]
    ds_read_b64_tr_b16 a[78:79], v18 offset:24576
    v_mfma_f32_16x16x32_bf16 v[128:131], a[12:15], a[32:35], v[128:131]
    v_mfma_f32_16x16x32_bf16 v[160:163], a[16:19], a[32:35], v[160:163]
    ds_read_b64_tr_b16 a[80:81], v19 offset:24576
    s_add_u32 m0, s77, 16384
    v_mfma_f32_16x16x32_bf16 v[164:167], a[16:19], a[36:39], v[164:167]
    buffer_load_dwordx4 v5, s[40:43], s72 offen  lds
    v_mfma_f32_16x16x32_bf16 v[168:171], a[16:19], a[40:43], v[168:171]
    ds_read_b64_tr_b16 a[82:83], v19 offset:25600
    v_mfma_f32_16x16x32_bf16 v[172:175], a[16:19], a[44:47], v[172:175]
    v_mfma_f32_16x16x32_bf16 v[176:179], a[16:19], a[48:51], v[176:179]
    ds_read_b64_tr_b16 a[84:85], v20 offset:24576
    v_mfma_f32_16x16x32_bf16 v[180:183], a[16:19], a[52:55], v[180:183]
    v_mfma_f32_16x16x32_bf16 v[184:187], a[16:19], a[56:59], v[184:187]
    ds_read_b64_tr_b16 a[86:87], v20 offset:25600
    v_mfma_f32_16x16x32_bf16 v[188:191], a[16:19], a[60:63], v[188:191]
    buffer_load_dwordx4 v5, s[52:55], s72 offen offset:1024  lds
    v_mfma_f32_16x16x32_bf16 v[220:223], a[20:23], a[60:63], v[220:223]
    ds_read_b64_tr_b16 a[88:89], v21 offset:24576
    v_mfma_f32_16x16x32_bf16 v[216:219], a[20:23], a[56:59], v[216:219]
    v_mfma_f32_16x16x32_bf16 v[212:215], a[20:23], a[52:55], v[212:215]
    ds_read_b64_tr_b16 a[90:91], v21 offset:25600
    v_mfma_f32_16x16x32_bf16 v[208:211], a[20:23], a[48:51], v[208:211]
    v_mfma_f32_16x16x32_bf16 v[204:207], a[20:23], a[44:47], v[204:207]
    ds_read_b64_tr_b16 a[92:93], v22 offset:24576
    v_mfma_f32_16x16x32_bf16 v[200:203], a[20:23], a[40:43], v[200:203]
    v_mfma_f32_16x16x32_bf16 v[196:199], a[20:23], a[36:39], v[196:199]
    ds_read_b64_tr_b16 a[94:95], v22 offset:25600
    s_add_u32 m0, m0, 40960
    v_mfma_f32_16x16x32_bf16 v[192:195], a[20:23], a[32:35], v[192:195]
    buffer_load_dwordx4 v6, s[44:47], s74 offen  lds
    v_mfma_f32_16x16x32_bf16 v[224:227], a[24:27], a[32:35], v[224:227]
    v_mfma_f32_16x16x32_bf16 v[228:231], a[24:27], a[36:39], v[228:231]
    v_mfma_f32_16x16x32_bf16 v[232:235], a[24:27], a[40:43], v[232:235]
    v_mfma_f32_16x16x32_bf16 v[236:239], a[24:27], a[44:47], v[236:239]
    v_mfma_f32_16x16x32_bf16 v[240:243], a[24:27], a[48:51], v[240:243]
    v_mfma_f32_16x16x32_bf16 v[244:247], a[24:27], a[52:55], v[244:247]
    v_mfma_f32_16x16x32_bf16 v[248:251], a[24:27], a[56:59], v[248:251]
    v_mfma_f32_16x16x32_bf16 v[252:255], a[24:27], a[60:63], v[252:255]
    buffer_load_dwordx4 v6, s[44:47], s75 offen offset:1024  lds
    v_mfma_f32_16x16x32_bf16 a[176:179], a[28:31], a[60:63], a[176:179]
    v_mfma_f32_16x16x32_bf16 a[172:175], a[28:31], a[56:59], a[172:175]
    v_add_u32 v5, 0xffac0000, v5
    v_mfma_f32_16x16x32_bf16 a[168:171], a[28:31], a[52:55], a[168:171]
    s_mul_i32 s61, s15, -12
    v_add_u32 v6, s61, v6
    v_mfma_f32_16x16x32_bf16 a[164:167], a[28:31], a[48:51], a[164:167]
    v_mfma_f32_16x16x32_bf16 a[160:163], a[28:31], a[44:47], a[160:163]
    s_waitcnt vmcnt(9) lgkmcnt(0)
    s_barrier
    v_mfma_f32_16x16x32_bf16 a[156:159], a[28:31], a[40:43], a[156:159]
    v_mfma_f32_16x16x32_bf16 a[152:155], a[28:31], a[36:39], a[152:155]
    v_mfma_f32_16x16x32_bf16 a[148:151], a[28:31], a[32:35], a[148:151]
    v_mfma_f32_16x16x32_bf16 v[32:35], a[64:67], a[96:99], v[32:35]
    ds_read_b128 a[32:35], v9 offset:0
    s_add_u32 m0, s76, 32768
    v_mfma_f32_16x16x32_bf16 v[36:39], a[64:67], a[100:103], v[36:39]
    buffer_load_dwordx4 v3, s[36:39], 0 offen offset:0  lds
    v_mfma_f32_16x16x32_bf16 v[40:43], a[64:67], a[104:107], v[40:43]
    ds_read_b128 a[36:39], v9 offset:2048
    v_mov_b32 v23, 0x3f803f80
    v_mfma_f32_16x16x32_bf16 v[44:47], a[64:67], a[108:111], v[44:47]
    v_mov_b32 v7, 0
    v_mfma_f32_16x16x32_bf16 v[48:51], a[64:67], a[112:115], v[48:51]
    ds_read_b128 a[40:43], v9 offset:4096
    v_mov_b32 v8, 0
    v_mfma_f32_16x16x32_bf16 v[52:55], a[64:67], a[116:119], v[52:55]
    v_mfma_f32_16x16x32_bf16 v[56:59], a[64:67], a[120:123], v[56:59]
    ds_read_b128 a[44:47], v9 offset:6144
    v_accvgpr_read_b32 v26, a212
    v_mfma_f32_16x16x32_bf16 v[60:63], a[64:67], a[124:127], v[60:63]
    v_accvgpr_read_b32 v28, a196
    v_mfma_f32_16x16x32_bf16 v[92:95], a[68:71], a[124:127], v[92:95]
    ds_read_b128 a[48:51], v9 offset:8192
    v_accvgpr_read_b32 v30, a204
    v_mfma_f32_16x16x32_bf16 v[88:91], a[68:71], a[120:123], v[88:91]
    buffer_load_dwordx4 v4, s[36:39], s65 offen offset:1024  lds
    v_mfma_f32_16x16x32_bf16 v[84:87], a[68:71], a[116:119], v[84:87]
    ds_read_b128 a[52:55], v9 offset:10240
    v_and_b32 v27, 0xffff0000, v26
    v_mfma_f32_16x16x32_bf16 v[80:83], a[68:71], a[112:115], v[80:83]
    v_and_b32 v29, 0xffff0000, v28
    v_mfma_f32_16x16x32_bf16 v[76:79], a[68:71], a[108:111], v[76:79]
    ds_read_b128 a[56:59], v9 offset:12288
    v_and_b32 v31, 0xffff0000, v30
    v_mfma_f32_16x16x32_bf16 v[72:75], a[68:71], a[104:107], v[72:75]
    v_lshlrev_b32 v26, 16, v26
    v_mfma_f32_16x16x32_bf16 v[68:71], a[68:71], a[100:103], v[68:71]
    ds_read_b128 a[60:63], v9 offset:14336
    v_lshlrev_b32 v28, 16, v28
    v_mfma_f32_16x16x32_bf16 v[64:67], a[68:71], a[96:99], v[64:67]
    v_lshlrev_b32 v30, 16, v30
    v_mfma_f32_16x16x32_bf16 v[96:99], a[72:75], a[96:99], v[96:99]
    ds_read_b64_tr_b16 a[0:1], v11 offset:32768
    v_mul_f32 v29, v29, v27
    v_mfma_f32_16x16x32_bf16 v[100:103], a[72:75], a[100:103], v[100:103]
    buffer_load_dwordx4 v3, s[36:39], s66 offen offset:2048  lds
    v_mfma_f32_16x16x32_bf16 v[104:107], a[72:75], a[104:107], v[104:107]
    ds_read_b64_tr_b16 a[2:3], v12 offset:32768
    v_mul_f32 v31, v31, v27
    v_mfma_f32_16x16x32_bf16 v[108:111], a[72:75], a[108:111], v[108:111]
    v_mul_f32 v28, v28, v26
    v_mfma_f32_16x16x32_bf16 v[112:115], a[72:75], a[112:115], v[112:115]
    ds_read_b64_tr_b16 a[4:5], v13 offset:32768
    v_mul_f32 v30, v30, v26
    v_mfma_f32_16x16x32_bf16 v[116:119], a[72:75], a[116:119], v[116:119]
    v_cvt_pk_bf16_f32 v28, v28, v29
    v_mfma_f32_16x16x32_bf16 v[120:123], a[72:75], a[120:123], v[120:123]
    ds_read_b64_tr_b16 a[6:7], v14 offset:32768
    v_cvt_pk_bf16_f32 v30, v30, v31
    v_mfma_f32_16x16x32_bf16 v[124:127], a[72:75], a[124:127], v[124:127]
    v_dot2_f32_bf16 v7, v28, v23, v7
    v_mfma_f32_16x16x32_bf16 v[156:159], a[76:79], a[124:127], v[156:159]
    ds_read_b64_tr_b16 a[8:9], v15 offset:32768
    v_dot2_f32_bf16 v8, v30, v23, v8
    v_mfma_f32_16x16x32_bf16 v[152:155], a[76:79], a[120:123], v[152:155]
    buffer_load_dwordx4 v4, s[36:39], s67 offen offset:3072  lds
    v_mfma_f32_16x16x32_bf16 v[148:151], a[76:79], a[116:119], v[148:151]
    ds_read_b64_tr_b16 a[10:11], v16 offset:32768
    v_accvgpr_read_b32 v26, a213
    v_mfma_f32_16x16x32_bf16 v[144:147], a[76:79], a[112:115], v[144:147]
    v_accvgpr_read_b32 v28, a197
    v_mfma_f32_16x16x32_bf16 v[140:143], a[76:79], a[108:111], v[140:143]
    ds_read_b64_tr_b16 a[12:13], v17 offset:32768
    v_accvgpr_read_b32 v30, a205
    v_mfma_f32_16x16x32_bf16 v[136:139], a[76:79], a[104:107], v[136:139]
    v_and_b32 v27, 0xffff0000, v26
    v_mfma_f32_16x16x32_bf16 v[132:135], a[76:79], a[100:103], v[132:135]
    ds_read_b64_tr_b16 a[14:15], v18 offset:32768
    v_and_b32 v29, 0xffff0000, v28
    v_mfma_f32_16x16x32_bf16 v[128:131], a[76:79], a[96:99], v[128:131]
    v_and_b32 v31, 0xffff0000, v30
    v_mfma_f32_16x16x32_bf16 v[160:163], a[80:83], a[96:99], v[160:163]
    ds_read_b64_tr_b16 a[16:17], v19 offset:32768
    s_add_u32 m0, m0, 4096
    v_mfma_f32_16x16x32_bf16 v[164:167], a[80:83], a[100:103], v[164:167]
    buffer_load_dwordx4 v3, s[36:39], s68 offen offset:0  lds
    v_mfma_f32_16x16x32_bf16 v[168:171], a[80:83], a[104:107], v[168:171]
    ds_read_b64_tr_b16 a[18:19], v19 offset:33792
    v_lshlrev_b32 v26, 16, v26
    v_mfma_f32_16x16x32_bf16 v[172:175], a[80:83], a[108:111], v[172:175]
    v_lshlrev_b32 v28, 16, v28
    v_mfma_f32_16x16x32_bf16 v[176:179], a[80:83], a[112:115], v[176:179]
    ds_read_b64_tr_b16 a[20:21], v20 offset:32768
    v_lshlrev_b32 v30, 16, v30
    v_mfma_f32_16x16x32_bf16 v[180:183], a[80:83], a[116:119], v[180:183]
    v_mul_f32 v29, v29, v27
    v_mfma_f32_16x16x32_bf16 v[184:187], a[80:83], a[120:123], v[184:187]
    ds_read_b64_tr_b16 a[22:23], v20 offset:33792
    v_mul_f32 v31, v31, v27
    v_mfma_f32_16x16x32_bf16 v[188:191], a[80:83], a[124:127], v[188:191]
    v_mul_f32 v28, v28, v26
    v_mfma_f32_16x16x32_bf16 v[220:223], a[84:87], a[124:127], v[220:223]
    ds_read_b64_tr_b16 a[24:25], v21 offset:32768
    v_mul_f32 v30, v30, v26
    v_mfma_f32_16x16x32_bf16 v[216:219], a[84:87], a[120:123], v[216:219]
    buffer_load_dwordx4 v4, s[36:39], s69 offen offset:1024  lds
    v_mfma_f32_16x16x32_bf16 v[212:215], a[84:87], a[116:119], v[212:215]
    ds_read_b64_tr_b16 a[26:27], v21 offset:33792
    v_cvt_pk_bf16_f32 v28, v28, v29
    v_mfma_f32_16x16x32_bf16 v[208:211], a[84:87], a[112:115], v[208:211]
    v_cvt_pk_bf16_f32 v30, v30, v31
    v_mfma_f32_16x16x32_bf16 v[204:207], a[84:87], a[108:111], v[204:207]
    ds_read_b64_tr_b16 a[28:29], v22 offset:32768
    v_dot2_f32_bf16 v7, v28, v23, v7
    v_mfma_f32_16x16x32_bf16 v[200:203], a[84:87], a[104:107], v[200:203]
    v_dot2_f32_bf16 v8, v30, v23, v8
    v_mfma_f32_16x16x32_bf16 v[196:199], a[84:87], a[100:103], v[196:199]
    ds_read_b64_tr_b16 a[30:31], v22 offset:33792
    v_accvgpr_read_b32 v26, a214
    v_mfma_f32_16x16x32_bf16 v[192:195], a[84:87], a[96:99], v[192:195]
    buffer_load_dwordx4 v3, s[36:39], s70 offen offset:2048  lds
    v_mfma_f32_16x16x32_bf16 v[224:227], a[88:91], a[96:99], v[224:227]
    v_accvgpr_read_b32 v28, a198
    v_mfma_f32_16x16x32_bf16 v[228:231], a[88:91], a[100:103], v[228:231]
    v_accvgpr_read_b32 v30, a206
    v_mfma_f32_16x16x32_bf16 v[232:235], a[88:91], a[104:107], v[232:235]
    v_and_b32 v27, 0xffff0000, v26
    v_mfma_f32_16x16x32_bf16 v[236:239], a[88:91], a[108:111], v[236:239]
    v_and_b32 v29, 0xffff0000, v28
    v_mfma_f32_16x16x32_bf16 v[240:243], a[88:91], a[112:115], v[240:243]
    v_and_b32 v31, 0xffff0000, v30
    v_mfma_f32_16x16x32_bf16 v[244:247], a[88:91], a[116:119], v[244:247]
    v_lshlrev_b32 v26, 16, v26
    v_mfma_f32_16x16x32_bf16 v[248:251], a[88:91], a[120:123], v[248:251]
    v_lshlrev_b32 v28, 16, v28
    v_mfma_f32_16x16x32_bf16 v[252:255], a[88:91], a[124:127], v[252:255]
    buffer_load_dwordx4 v4, s[36:39], s71 offen offset:3072  lds
    v_mfma_f32_16x16x32_bf16 a[176:179], a[92:95], a[124:127], a[176:179]
    v_lshlrev_b32 v30, 16, v30
    v_mfma_f32_16x16x32_bf16 a[172:175], a[92:95], a[120:123], a[172:175]
    v_add_u32 v3, 0xfffffa00, v3
    v_mfma_f32_16x16x32_bf16 a[168:171], a[92:95], a[116:119], a[168:171]
    v_mul_f32 v29, v29, v27
    v_mfma_f32_16x16x32_bf16 a[164:167], a[92:95], a[112:115], a[164:167]
    v_add_u32 v4, 0xfffffa00, v4
    v_mfma_f32_16x16x32_bf16 a[160:163], a[92:95], a[108:111], a[160:163]
    s_waitcnt lgkmcnt(0)
    s_barrier
    v_mfma_f32_16x16x32_bf16 a[156:159], a[92:95], a[104:107], a[156:159]
    v_mfma_f32_16x16x32_bf16 a[152:155], a[92:95], a[100:103], a[152:155]
    v_mfma_f32_16x16x32_bf16 a[148:151], a[92:95], a[96:99], a[148:151]
    v_mfma_f32_16x16x32_bf16 v[32:35], a[0:3], a[32:35], v[32:35]
    ds_read_b128 a[96:99], v10 offset:0
    s_add_u32 m0, s77, 24576
    v_mfma_f32_16x16x32_bf16 v[36:39], a[0:3], a[36:39], v[36:39]
    buffer_load_dwordx4 v5, s[40:43], 0 offen  lds
    v_mfma_f32_16x16x32_bf16 v[40:43], a[0:3], a[40:43], v[40:43]
    ds_read_b128 a[100:103], v10 offset:2048
    v_mul_f32 v31, v31, v27
    v_mfma_f32_16x16x32_bf16 v[44:47], a[0:3], a[44:47], v[44:47]
    v_mul_f32 v28, v28, v26
    v_mfma_f32_16x16x32_bf16 v[48:51], a[0:3], a[48:51], v[48:51]
    ds_read_b128 a[104:107], v10 offset:4096
    v_mul_f32 v30, v30, v26
    v_mfma_f32_16x16x32_bf16 v[52:55], a[0:3], a[52:55], v[52:55]
    v_cvt_pk_bf16_f32 v28, v28, v29
    v_mfma_f32_16x16x32_bf16 v[56:59], a[0:3], a[56:59], v[56:59]
    ds_read_b128 a[108:111], v10 offset:6144
    v_cvt_pk_bf16_f32 v30, v30, v31
    v_mfma_f32_16x16x32_bf16 v[60:63], a[0:3], a[60:63], v[60:63]
    v_dot2_f32_bf16 v7, v28, v23, v7
    v_mfma_f32_16x16x32_bf16 v[92:95], a[4:7], a[60:63], v[92:95]
    ds_read_b128 a[112:115], v10 offset:8192
    v_dot2_f32_bf16 v8, v30, v23, v8
    v_mfma_f32_16x16x32_bf16 v[88:91], a[4:7], a[56:59], v[88:91]
    buffer_load_dwordx4 v5, s[52:55], 0 offen offset:1024  lds
    v_mfma_f32_16x16x32_bf16 v[84:87], a[4:7], a[52:55], v[84:87]
    ds_read_b128 a[116:119], v10 offset:10240
    v_accvgpr_read_b32 v26, a215
    v_mfma_f32_16x16x32_bf16 v[80:83], a[4:7], a[48:51], v[80:83]
    v_accvgpr_read_b32 v28, a199
    v_mfma_f32_16x16x32_bf16 v[76:79], a[4:7], a[44:47], v[76:79]
    ds_read_b128 a[120:123], v10 offset:12288
    v_accvgpr_read_b32 v30, a207
    v_mfma_f32_16x16x32_bf16 v[72:75], a[4:7], a[40:43], v[72:75]
    v_and_b32 v27, 0xffff0000, v26
    v_mfma_f32_16x16x32_bf16 v[68:71], a[4:7], a[36:39], v[68:71]
    ds_read_b128 a[124:127], v10 offset:14336
    v_and_b32 v29, 0xffff0000, v28
    v_mfma_f32_16x16x32_bf16 v[64:67], a[4:7], a[32:35], v[64:67]
    v_and_b32 v31, 0xffff0000, v30
    v_mfma_f32_16x16x32_bf16 v[96:99], a[8:11], a[32:35], v[96:99]
    ds_read_b64_tr_b16 a[64:65], v11 offset:0
    s_add_u32 m0, m0, 40960
    v_mfma_f32_16x16x32_bf16 v[100:103], a[8:11], a[36:39], v[100:103]
    buffer_load_dwordx4 v6, s[44:47], 0 offen  lds
    v_mfma_f32_16x16x32_bf16 v[104:107], a[8:11], a[40:43], v[104:107]
    ds_read_b64_tr_b16 a[66:67], v12 offset:0
    v_lshlrev_b32 v26, 16, v26
    v_mfma_f32_16x16x32_bf16 v[108:111], a[8:11], a[44:47], v[108:111]
    v_lshlrev_b32 v28, 16, v28
    v_mfma_f32_16x16x32_bf16 v[112:115], a[8:11], a[48:51], v[112:115]
    ds_read_b64_tr_b16 a[68:69], v13 offset:0
    v_lshlrev_b32 v30, 16, v30
    v_mfma_f32_16x16x32_bf16 v[116:119], a[8:11], a[52:55], v[116:119]
    v_mul_f32 v29, v29, v27
    v_mfma_f32_16x16x32_bf16 v[120:123], a[8:11], a[56:59], v[120:123]
    ds_read_b64_tr_b16 a[70:71], v14 offset:0
    v_mul_f32 v31, v31, v27
    v_mfma_f32_16x16x32_bf16 v[124:127], a[8:11], a[60:63], v[124:127]
    v_mul_f32 v28, v28, v26
    v_mfma_f32_16x16x32_bf16 v[156:159], a[12:15], a[60:63], v[156:159]
    ds_read_b64_tr_b16 a[72:73], v15 offset:0
    v_mul_f32 v30, v30, v26
    v_mfma_f32_16x16x32_bf16 v[152:155], a[12:15], a[56:59], v[152:155]
    buffer_load_dwordx4 v6, s[44:47], s73 offen offset:1024  lds
    v_mfma_f32_16x16x32_bf16 v[148:151], a[12:15], a[52:55], v[148:151]
    ds_read_b64_tr_b16 a[74:75], v16 offset:0
    v_cvt_pk_bf16_f32 v28, v28, v29
    v_mfma_f32_16x16x32_bf16 v[144:147], a[12:15], a[48:51], v[144:147]
    v_cvt_pk_bf16_f32 v30, v30, v31
    v_mfma_f32_16x16x32_bf16 v[140:143], a[12:15], a[44:47], v[140:143]
    ds_read_b64_tr_b16 a[76:77], v17 offset:0
    v_dot2_f32_bf16 v7, v28, v23, v7
    v_mfma_f32_16x16x32_bf16 v[136:139], a[12:15], a[40:43], v[136:139]
    v_dot2_f32_bf16 v8, v30, v23, v8
    v_mfma_f32_16x16x32_bf16 v[132:135], a[12:15], a[36:39], v[132:135]
    ds_read_b64_tr_b16 a[78:79], v18 offset:0
    v_accvgpr_read_b32 v26, a216
    v_mfma_f32_16x16x32_bf16 v[128:131], a[12:15], a[32:35], v[128:131]
    v_accvgpr_read_b32 v28, a200
    v_mfma_f32_16x16x32_bf16 v[160:163], a[16:19], a[32:35], v[160:163]
    ds_read_b64_tr_b16 a[80:81], v19 offset:0
    s_add_u32 m0, s77, 32768
    v_mfma_f32_16x16x32_bf16 v[164:167], a[16:19], a[36:39], v[164:167]
    buffer_load_dwordx4 v5, s[40:43], s72 offen  lds
    v_mfma_f32_16x16x32_bf16 v[168:171], a[16:19], a[40:43], v[168:171]
    ds_read_b64_tr_b16 a[82:83], v19 offset:1024
    v_accvgpr_read_b32 v30, a208
    v_mfma_f32_16x16x32_bf16 v[172:175], a[16:19], a[44:47], v[172:175]
    v_and_b32 v27, 0xffff0000, v26
    v_mfma_f32_16x16x32_bf16 v[176:179], a[16:19], a[48:51], v[176:179]
    ds_read_b64_tr_b16 a[84:85], v20 offset:0
    v_and_b32 v29, 0xffff0000, v28
    v_mfma_f32_16x16x32_bf16 v[180:183], a[16:19], a[52:55], v[180:183]
    v_and_b32 v31, 0xffff0000, v30
    v_mfma_f32_16x16x32_bf16 v[184:187], a[16:19], a[56:59], v[184:187]
    ds_read_b64_tr_b16 a[86:87], v20 offset:1024
    v_lshlrev_b32 v26, 16, v26
    v_mfma_f32_16x16x32_bf16 v[188:191], a[16:19], a[60:63], v[188:191]
    buffer_load_dwordx4 v5, s[52:55], s72 offen offset:1024  lds
    v_mfma_f32_16x16x32_bf16 v[220:223], a[20:23], a[60:63], v[220:223]
    ds_read_b64_tr_b16 a[88:89], v21 offset:0
    v_lshlrev_b32 v28, 16, v28
    v_mfma_f32_16x16x32_bf16 v[216:219], a[20:23], a[56:59], v[216:219]
    v_lshlrev_b32 v30, 16, v30
    v_mfma_f32_16x16x32_bf16 v[212:215], a[20:23], a[52:55], v[212:215]
    ds_read_b64_tr_b16 a[90:91], v21 offset:1024
    v_mul_f32 v29, v29, v27
    v_mfma_f32_16x16x32_bf16 v[208:211], a[20:23], a[48:51], v[208:211]
    v_mul_f32 v31, v31, v27
    v_mfma_f32_16x16x32_bf16 v[204:207], a[20:23], a[44:47], v[204:207]
    ds_read_b64_tr_b16 a[92:93], v22 offset:0
    v_mul_f32 v28, v28, v26
    v_mfma_f32_16x16x32_bf16 v[200:203], a[20:23], a[40:43], v[200:203]
    v_mul_f32 v30, v30, v26
    v_mfma_f32_16x16x32_bf16 v[196:199], a[20:23], a[36:39], v[196:199]
    ds_read_b64_tr_b16 a[94:95], v22 offset:1024
    s_add_u32 m0, m0, 40960
    v_mfma_f32_16x16x32_bf16 v[192:195], a[20:23], a[32:35], v[192:195]
    buffer_load_dwordx4 v6, s[44:47], s74 offen  lds
    v_mfma_f32_16x16x32_bf16 v[224:227], a[24:27], a[32:35], v[224:227]
    v_cvt_pk_bf16_f32 v28, v28, v29
    v_mfma_f32_16x16x32_bf16 v[228:231], a[24:27], a[36:39], v[228:231]
    v_cvt_pk_bf16_f32 v30, v30, v31
    v_mfma_f32_16x16x32_bf16 v[232:235], a[24:27], a[40:43], v[232:235]
    v_dot2_f32_bf16 v7, v28, v23, v7
    v_mfma_f32_16x16x32_bf16 v[236:239], a[24:27], a[44:47], v[236:239]
    v_dot2_f32_bf16 v8, v30, v23, v8
    v_mfma_f32_16x16x32_bf16 v[240:243], a[24:27], a[48:51], v[240:243]
    v_accvgpr_read_b32 v26, a217
    v_mfma_f32_16x16x32_bf16 v[244:247], a[24:27], a[52:55], v[244:247]
    v_accvgpr_read_b32 v28, a201
    v_mfma_f32_16x16x32_bf16 v[248:251], a[24:27], a[56:59], v[248:251]
    v_accvgpr_read_b32 v30, a209
    v_mfma_f32_16x16x32_bf16 v[252:255], a[24:27], a[60:63], v[252:255]
    buffer_load_dwordx4 v6, s[44:47], s75 offen offset:1024  lds
    v_mfma_f32_16x16x32_bf16 a[176:179], a[28:31], a[60:63], a[176:179]
    v_and_b32 v27, 0xffff0000, v26
    v_mfma_f32_16x16x32_bf16 a[172:175], a[28:31], a[56:59], a[172:175]
    v_add_u32 v5, 0x380000, v5
    v_mfma_f32_16x16x32_bf16 a[168:171], a[28:31], a[52:55], a[168:171]
    s_mul_i32 s61, s15, 8
    v_add_u32 v6, s61, v6
    v_mfma_f32_16x16x32_bf16 a[164:167], a[28:31], a[48:51], a[164:167]
    v_mfma_f32_16x16x32_bf16 a[160:163], a[28:31], a[44:47], a[160:163]
    s_waitcnt vmcnt(8) lgkmcnt(0)
    s_barrier
    v_mfma_f32_16x16x32_bf16 a[156:159], a[28:31], a[40:43], a[156:159]
    v_mfma_f32_16x16x32_bf16 a[152:155], a[28:31], a[36:39], a[152:155]
    v_mfma_f32_16x16x32_bf16 a[148:151], a[28:31], a[32:35], a[148:151]
    v_mfma_f32_16x16x32_bf16 v[32:35], a[64:67], a[96:99], v[32:35]
    ds_read_b128 a[32:35], v9 offset:32768
    s_add_u32 m0, s76, 0
    v_mfma_f32_16x16x32_bf16 v[36:39], a[64:67], a[100:103], v[36:39]
    buffer_load_dwordx4 v3, s[36:39], 0 offen offset:0  lds
    v_mfma_f32_16x16x32_bf16 v[40:43], a[64:67], a[104:107], v[40:43]
    ds_read_b128 a[36:39], v9 offset:34816
    v_and_b32 v29, 0xffff0000, v28
    v_mfma_f32_16x16x32_bf16 v[44:47], a[64:67], a[108:111], v[44:47]
    v_and_b32 v31, 0xffff0000, v30
    v_mfma_f32_16x16x32_bf16 v[48:51], a[64:67], a[112:115], v[48:51]
    ds_read_b128 a[40:43], v9 offset:36864
    v_lshlrev_b32 v26, 16, v26
    v_mfma_f32_16x16x32_bf16 v[52:55], a[64:67], a[116:119], v[52:55]
    v_lshlrev_b32 v28, 16, v28
    v_mfma_f32_16x16x32_bf16 v[56:59], a[64:67], a[120:123], v[56:59]
    ds_read_b128 a[44:47], v9 offset:38912
    v_lshlrev_b32 v30, 16, v30
    v_mfma_f32_16x16x32_bf16 v[60:63], a[64:67], a[124:127], v[60:63]
    v_mul_f32 v29, v29, v27
    v_mfma_f32_16x16x32_bf16 v[92:95], a[68:71], a[124:127], v[92:95]
    ds_read_b128 a[48:51], v9 offset:40960
    v_mul_f32 v31, v31, v27
    v_mfma_f32_16x16x32_bf16 v[88:91], a[68:71], a[120:123], v[88:91]
    buffer_load_dwordx4 v4, s[36:39], s65 offen offset:1024  lds
    v_mfma_f32_16x16x32_bf16 v[84:87], a[68:71], a[116:119], v[84:87]
    ds_read_b128 a[52:55], v9 offset:43008
    v_mul_f32 v28, v28, v26
    v_mfma_f32_16x16x32_bf16 v[80:83], a[68:71], a[112:115], v[80:83]
    v_mul_f32 v30, v30, v26
    v_mfma_f32_16x16x32_bf16 v[76:79], a[68:71], a[108:111], v[76:79]
    ds_read_b128 a[56:59], v9 offset:45056
    v_cvt_pk_bf16_f32 v28, v28, v29
    v_mfma_f32_16x16x32_bf16 v[72:75], a[68:71], a[104:107], v[72:75]
    v_cvt_pk_bf16_f32 v30, v30, v31
    v_mfma_f32_16x16x32_bf16 v[68:71], a[68:71], a[100:103], v[68:71]
    ds_read_b128 a[60:63], v9 offset:47104
    v_dot2_f32_bf16 v7, v28, v23, v7
    v_mfma_f32_16x16x32_bf16 v[64:67], a[68:71], a[96:99], v[64:67]
    v_dot2_f32_bf16 v8, v30, v23, v8
    v_mfma_f32_16x16x32_bf16 v[96:99], a[72:75], a[96:99], v[96:99]
    ds_read_b64_tr_b16 a[0:1], v11 offset:8192
    v_accvgpr_read_b32 v26, a218
    v_mfma_f32_16x16x32_bf16 v[100:103], a[72:75], a[100:103], v[100:103]
    buffer_load_dwordx4 v3, s[36:39], s66 offen offset:2048  lds
    v_mfma_f32_16x16x32_bf16 v[104:107], a[72:75], a[104:107], v[104:107]
    ds_read_b64_tr_b16 a[2:3], v12 offset:8192
    v_accvgpr_read_b32 v28, a202
    v_mfma_f32_16x16x32_bf16 v[108:111], a[72:75], a[108:111], v[108:111]
    v_accvgpr_read_b32 v30, a210
    v_mfma_f32_16x16x32_bf16 v[112:115], a[72:75], a[112:115], v[112:115]
    ds_read_b64_tr_b16 a[4:5], v13 offset:8192
    v_and_b32 v27, 0xffff0000, v26
    v_mfma_f32_16x16x32_bf16 v[116:119], a[72:75], a[116:119], v[116:119]
    v_and_b32 v29, 0xffff0000, v28
    v_mfma_f32_16x16x32_bf16 v[120:123], a[72:75], a[120:123], v[120:123]
    ds_read_b64_tr_b16 a[6:7], v14 offset:8192
    v_and_b32 v31, 0xffff0000, v30
    v_mfma_f32_16x16x32_bf16 v[124:127], a[72:75], a[124:127], v[124:127]
    v_lshlrev_b32 v26, 16, v26
    v_mfma_f32_16x16x32_bf16 v[156:159], a[76:79], a[124:127], v[156:159]
    ds_read_b64_tr_b16 a[8:9], v15 offset:8192
    v_lshlrev_b32 v28, 16, v28
    v_mfma_f32_16x16x32_bf16 v[152:155], a[76:79], a[120:123], v[152:155]
    buffer_load_dwordx4 v4, s[36:39], s67 offen offset:3072  lds
    v_mfma_f32_16x16x32_bf16 v[148:151], a[76:79], a[116:119], v[148:151]
    ds_read_b64_tr_b16 a[10:11], v16 offset:8192
    v_lshlrev_b32 v30, 16, v30
    v_mfma_f32_16x16x32_bf16 v[144:147], a[76:79], a[112:115], v[144:147]
    v_mul_f32 v29, v29, v27
    v_mfma_f32_16x16x32_bf16 v[140:143], a[76:79], a[108:111], v[140:143]
    ds_read_b64_tr_b16 a[12:13], v17 offset:8192
    v_mul_f32 v31, v31, v27
    v_mfma_f32_16x16x32_bf16 v[136:139], a[76:79], a[104:107], v[136:139]
    v_mul_f32 v28, v28, v26
    v_mfma_f32_16x16x32_bf16 v[132:135], a[76:79], a[100:103], v[132:135]
    ds_read_b64_tr_b16 a[14:15], v18 offset:8192
    v_mul_f32 v30, v30, v26
    v_mfma_f32_16x16x32_bf16 v[128:131], a[76:79], a[96:99], v[128:131]
    v_cvt_pk_bf16_f32 v28, v28, v29
    v_mfma_f32_16x16x32_bf16 v[160:163], a[80:83], a[96:99], v[160:163]
    ds_read_b64_tr_b16 a[16:17], v19 offset:8192
    s_add_u32 m0, m0, 4096
    v_mfma_f32_16x16x32_bf16 v[164:167], a[80:83], a[100:103], v[164:167]
    buffer_load_dwordx4 v3, s[36:39], s68 offen offset:0  lds
    v_mfma_f32_16x16x32_bf16 v[168:171], a[80:83], a[104:107], v[168:171]
    ds_read_b64_tr_b16 a[18:19], v19 offset:9216
    v_cvt_pk_bf16_f32 v30, v30, v31
    v_mfma_f32_16x16x32_bf16 v[172:175], a[80:83], a[108:111], v[172:175]
    v_dot2_f32_bf16 v7, v28, v23, v7
    v_mfma_f32_16x16x32_bf16 v[176:179], a[80:83], a[112:115], v[176:179]
    ds_read_b64_tr_b16 a[20:21], v20 offset:8192
    v_dot2_f32_bf16 v8, v30, v23, v8
    v_mfma_f32_16x16x32_bf16 v[180:183], a[80:83], a[116:119], v[180:183]
    v_accvgpr_read_b32 v26, a219
    v_mfma_f32_16x16x32_bf16 v[184:187], a[80:83], a[120:123], v[184:187]
    ds_read_b64_tr_b16 a[22:23], v20 offset:9216
    v_accvgpr_read_b32 v28, a203
    v_mfma_f32_16x16x32_bf16 v[188:191], a[80:83], a[124:127], v[188:191]
    v_accvgpr_read_b32 v30, a211
    v_mfma_f32_16x16x32_bf16 v[220:223], a[84:87], a[124:127], v[220:223]
    ds_read_b64_tr_b16 a[24:25], v21 offset:8192
    v_and_b32 v27, 0xffff0000, v26
    v_mfma_f32_16x16x32_bf16 v[216:219], a[84:87], a[120:123], v[216:219]
    buffer_load_dwordx4 v4, s[36:39], s69 offen offset:1024  lds
    v_mfma_f32_16x16x32_bf16 v[212:215], a[84:87], a[116:119], v[212:215]
    ds_read_b64_tr_b16 a[26:27], v21 offset:9216
    v_and_b32 v29, 0xffff0000, v28
    v_mfma_f32_16x16x32_bf16 v[208:211], a[84:87], a[112:115], v[208:211]
    v_and_b32 v31, 0xffff0000, v30
    v_mfma_f32_16x16x32_bf16 v[204:207], a[84:87], a[108:111], v[204:207]
    ds_read_b64_tr_b16 a[28:29], v22 offset:8192
    v_lshlrev_b32 v26, 16, v26
    v_mfma_f32_16x16x32_bf16 v[200:203], a[84:87], a[104:107], v[200:203]
    v_lshlrev_b32 v28, 16, v28
    v_mfma_f32_16x16x32_bf16 v[196:199], a[84:87], a[100:103], v[196:199]
    ds_read_b64_tr_b16 a[30:31], v22 offset:9216
    v_lshlrev_b32 v30, 16, v30
    v_mfma_f32_16x16x32_bf16 v[192:195], a[84:87], a[96:99], v[192:195]
    buffer_load_dwordx4 v3, s[36:39], s70 offen offset:2048  lds
    v_mfma_f32_16x16x32_bf16 v[224:227], a[88:91], a[96:99], v[224:227]
    v_mul_f32 v29, v29, v27
    v_mfma_f32_16x16x32_bf16 v[228:231], a[88:91], a[100:103], v[228:231]
    v_mul_f32 v31, v31, v27
    v_mfma_f32_16x16x32_bf16 v[232:235], a[88:91], a[104:107], v[232:235]
    v_mul_f32 v28, v28, v26
    v_mfma_f32_16x16x32_bf16 v[236:239], a[88:91], a[108:111], v[236:239]
    v_mul_f32 v30, v30, v26
    v_mfma_f32_16x16x32_bf16 v[240:243], a[88:91], a[112:115], v[240:243]
    v_cvt_pk_bf16_f32 v28, v28, v29
    v_mfma_f32_16x16x32_bf16 v[244:247], a[88:91], a[116:119], v[244:247]
    v_cvt_pk_bf16_f32 v30, v30, v31
    v_mfma_f32_16x16x32_bf16 v[248:251], a[88:91], a[120:123], v[248:251]
    v_dot2_f32_bf16 v7, v28, v23, v7
    v_mfma_f32_16x16x32_bf16 v[252:255], a[88:91], a[124:127], v[252:255]
    buffer_load_dwordx4 v4, s[36:39], s71 offen offset:3072  lds
    v_mfma_f32_16x16x32_bf16 a[176:179], a[92:95], a[124:127], a[176:179]
    v_dot2_f32_bf16 v8, v30, v23, v8
    v_mfma_f32_16x16x32_bf16 a[172:175], a[92:95], a[120:123], a[172:175]
    v_add_u32 v3, 0x400, v3
    v_mfma_f32_16x16x32_bf16 a[168:171], a[92:95], a[116:119], a[168:171]
    v_mfma_f32_16x16x32_bf16 a[164:167], a[92:95], a[112:115], a[164:167]
    v_add_u32 v4, 0x400, v4
    v_mfma_f32_16x16x32_bf16 a[160:163], a[92:95], a[108:111], a[160:163]
    s_waitcnt lgkmcnt(0)
    s_barrier
    v_mfma_f32_16x16x32_bf16 a[156:159], a[92:95], a[104:107], a[156:159]
    v_mfma_f32_16x16x32_bf16 a[152:155], a[92:95], a[100:103], a[152:155]
    v_mfma_f32_16x16x32_bf16 a[148:151], a[92:95], a[96:99], a[148:151]
    v_mfma_f32_16x16x32_bf16 v[32:35], a[0:3], a[32:35], v[32:35]
    ds_read_b128 a[96:99], v10 offset:32768
    s_add_u32 m0, s77, 0
    v_mfma_f32_16x16x32_bf16 v[36:39], a[0:3], a[36:39], v[36:39]
    buffer_load_dwordx4 v5, s[40:43], 0 offen  lds
    v_mfma_f32_16x16x32_bf16 v[40:43], a[0:3], a[40:43], v[40:43]
    ds_read_b128 a[100:103], v10 offset:34816
    v_mfma_f32_16x16x32_bf16 v[44:47], a[0:3], a[44:47], v[44:47]
    v_add_f32_dpp v7, v7, v7 row_ror:8 row_mask:0xf bank_mask:0xf
    v_mfma_f32_16x16x32_bf16 v[48:51], a[0:3], a[48:51], v[48:51]
    ds_read_b128 a[104:107], v10 offset:36864
    v_add_f32_dpp v8, v8, v8 row_ror:8 row_mask:0xf bank_mask:0xf
    v_mfma_f32_16x16x32_bf16 v[52:55], a[0:3], a[52:55], v[52:55]
    v_add_f32_dpp v7, v7, v7 row_ror:4 row_mask:0xf bank_mask:0xf
    v_mfma_f32_16x16x32_bf16 v[56:59], a[0:3], a[56:59], v[56:59]
    ds_read_b128 a[108:111], v10 offset:38912
    v_add_f32_dpp v8, v8, v8 row_ror:4 row_mask:0xf bank_mask:0xf
    v_mfma_f32_16x16x32_bf16 v[60:63], a[0:3], a[60:63], v[60:63]
    v_add_f32_dpp v7, v7, v7 row_ror:2 row_mask:0xf bank_mask:0xf
    v_mfma_f32_16x16x32_bf16 v[92:95], a[4:7], a[60:63], v[92:95]
    ds_read_b128 a[112:115], v10 offset:40960
    v_add_f32_dpp v8, v8, v8 row_ror:2 row_mask:0xf bank_mask:0xf
    v_mfma_f32_16x16x32_bf16 v[88:91], a[4:7], a[56:59], v[88:91]
    buffer_load_dwordx4 v5, s[52:55], 0 offen offset:1024  lds
    v_mfma_f32_16x16x32_bf16 v[84:87], a[4:7], a[52:55], v[84:87]
    ds_read_b128 a[116:119], v10 offset:43008
    v_add_f32_dpp v7, v7, v7 row_ror:1 row_mask:0xf bank_mask:0xf
    v_mfma_f32_16x16x32_bf16 v[80:83], a[4:7], a[48:51], v[80:83]
    v_add_f32_dpp v8, v8, v8 row_ror:1 row_mask:0xf bank_mask:0xf
    v_mfma_f32_16x16x32_bf16 v[76:79], a[4:7], a[44:47], v[76:79]
    ds_read_b128 a[120:123], v10 offset:45056
    v_mov_b32 v28, v7
    v_mfma_f32_16x16x32_bf16 v[72:75], a[4:7], a[40:43], v[72:75]
    v_mov_b32 v29, v8
    v_mfma_f32_16x16x32_bf16 v[68:71], a[4:7], a[36:39], v[68:71]
    ds_read_b128 a[124:127], v10 offset:47104
    v_permlane16_swap_b32 v7, v28
    v_mfma_f32_16x16x32_bf16 v[64:67], a[4:7], a[32:35], v[64:67]
    v_permlane16_swap_b32 v8, v29
    v_mfma_f32_16x16x32_bf16 v[96:99], a[8:11], a[32:35], v[96:99]
    ds_read_b64_tr_b16 a[64:65], v11 offset:16384
    s_add_u32 m0, m0, 40960
    v_mfma_f32_16x16x32_bf16 v[100:103], a[8:11], a[36:39], v[100:103]
    buffer_load_dwordx4 v6, s[44:47], 0 offen  lds
    v_mfma_f32_16x16x32_bf16 v[104:107], a[8:11], a[40:43], v[104:107]
    ds_read_b64_tr_b16 a[66:67], v12 offset:16384
    v_add_f32 v7, v7, v28
    v_mfma_f32_16x16x32_bf16 v[108:111], a[8:11], a[44:47], v[108:111]
    v_add_f32 v8, v8, v29
    v_mfma_f32_16x16x32_bf16 v[112:115], a[8:11], a[48:51], v[112:115]
    ds_read_b64_tr_b16 a[68:69], v13 offset:16384
    v_mov_b32 v28, v7
    v_mfma_f32_16x16x32_bf16 v[116:119], a[8:11], a[52:55], v[116:119]
    v_mov_b32 v29, v8
    v_mfma_f32_16x16x32_bf16 v[120:123], a[8:11], a[56:59], v[120:123]
    ds_read_b64_tr_b16 a[70:71], v14 offset:16384
    v_permlane32_swap_b32 v7, v28
    v_mfma_f32_16x16x32_bf16 v[124:127], a[8:11], a[60:63], v[124:127]
    v_permlane32_swap_b32 v8, v29
    v_mfma_f32_16x16x32_bf16 v[156:159], a[12:15], a[60:63], v[156:159]
    ds_read_b64_tr_b16 a[72:73], v15 offset:16384
    v_add_f32 v7, v7, v28
    v_mfma_f32_16x16x32_bf16 v[152:155], a[12:15], a[56:59], v[152:155]
    buffer_load_dwordx4 v6, s[44:47], s73 offen offset:1024  lds
    v_mfma_f32_16x16x32_bf16 v[148:151], a[12:15], a[52:55], v[148:151]
    ds_read_b64_tr_b16 a[74:75], v16 offset:16384
    v_add_f32 v8, v8, v29
    v_mfma_f32_16x16x32_bf16 v[144:147], a[12:15], a[48:51], v[144:147]
    v_cvt_pk_bf16_f32 v7, v7, v7
    v_mfma_f32_16x16x32_bf16 v[140:143], a[12:15], a[44:47], v[140:143]
    ds_read_b64_tr_b16 a[76:77], v17 offset:16384
    v_cvt_pk_bf16_f32 v8, v8, v8
    v_mfma_f32_16x16x32_bf16 v[136:139], a[12:15], a[40:43], v[136:139]
    v_and_b32 v7, 0xffff0000, v7
    v_mfma_f32_16x16x32_bf16 v[132:135], a[12:15], a[36:39], v[132:135]
    ds_read_b64_tr_b16 a[78:79], v18 offset:16384
    v_and_b32 v8, 0xffff0000, v8
    v_mfma_f32_16x16x32_bf16 v[128:131], a[12:15], a[32:35], v[128:131]
    v_mul_f32 v7, 0xbfb8aa3b, v7
    v_mfma_f32_16x16x32_bf16 v[160:163], a[16:19], a[32:35], v[160:163]
    ds_read_b64_tr_b16 a[80:81], v19 offset:16384
    s_add_u32 m0, s77, 8192
    v_mfma_f32_16x16x32_bf16 v[164:167], a[16:19], a[36:39], v[164:167]
    buffer_load_dwordx4 v5, s[40:43], s72 offen  lds
    v_mfma_f32_16x16x32_bf16 v[168:171], a[16:19], a[40:43], v[168:171]
    ds_read_b64_tr_b16 a[82:83], v19 offset:17408
    v_mul_f32 v8, 0xbfb8aa3b, v8
    v_mfma_f32_16x16x32_bf16 v[172:175], a[16:19], a[44:47], v[172:175]
    v_exp_f32 v7, v7
    v_mfma_f32_16x16x32_bf16 v[176:179], a[16:19], a[48:51], v[176:179]
    ds_read_b64_tr_b16 a[84:85], v20 offset:16384
    v_mfma_f32_16x16x32_bf16 v[180:183], a[16:19], a[52:55], v[180:183]
    v_exp_f32 v8, v8
    v_mfma_f32_16x16x32_bf16 v[184:187], a[16:19], a[56:59], v[184:187]
    ds_read_b64_tr_b16 a[86:87], v20 offset:17408
    v_mfma_f32_16x16x32_bf16 v[188:191], a[16:19], a[60:63], v[188:191]
    buffer_load_dwordx4 v5, s[52:55], s72 offen offset:1024  lds
    v_mfma_f32_16x16x32_bf16 v[220:223], a[20:23], a[60:63], v[220:223]
    ds_read_b64_tr_b16 a[88:89], v21 offset:16384
    v_add_f32 v7, 1.0, v7
    v_mfma_f32_16x16x32_bf16 v[216:219], a[20:23], a[56:59], v[216:219]
    v_add_f32 v8, 1.0, v8
    v_mfma_f32_16x16x32_bf16 v[212:215], a[20:23], a[52:55], v[212:215]
    ds_read_b64_tr_b16 a[90:91], v21 offset:17408
    v_rcp_f32 v7, v7
    v_mfma_f32_16x16x32_bf16 v[208:211], a[20:23], a[48:51], v[208:211]
    v_mfma_f32_16x16x32_bf16 v[204:207], a[20:23], a[44:47], v[204:207]
    ds_read_b64_tr_b16 a[92:93], v22 offset:16384
    v_rcp_f32 v8, v8
    v_mfma_f32_16x16x32_bf16 v[200:203], a[20:23], a[40:43], v[200:203]
    v_mfma_f32_16x16x32_bf16 v[196:199], a[20:23], a[36:39], v[196:199]
    ds_read_b64_tr_b16 a[94:95], v22 offset:17408
    s_add_u32 m0, m0, 40960
    v_mfma_f32_16x16x32_bf16 v[192:195], a[20:23], a[32:35], v[192:195]
    buffer_load_dwordx4 v6, s[44:47], s74 offen  lds
    v_mfma_f32_16x16x32_bf16 v[224:227], a[24:27], a[32:35], v[224:227]
    v_cvt_pk_bf16_f32 v7, v7, v7
    v_mfma_f32_16x16x32_bf16 v[228:231], a[24:27], a[36:39], v[228:231]
    v_cvt_pk_bf16_f32 v8, v8, v8
    v_mfma_f32_16x16x32_bf16 v[232:235], a[24:27], a[40:43], v[232:235]
    v_and_b32 v26, 0xffff0000, v7
    v_mfma_f32_16x16x32_bf16 v[236:239], a[24:27], a[44:47], v[236:239]
    v_and_b32 v27, 0xffff0000, v8
    v_mfma_f32_16x16x32_bf16 v[240:243], a[24:27], a[48:51], v[240:243]
    v_mfma_f32_16x16x32_bf16 v[244:247], a[24:27], a[52:55], v[244:247]
    v_mfma_f32_16x16x32_bf16 v[248:251], a[24:27], a[56:59], v[248:251]
    v_mfma_f32_16x16x32_bf16 v[252:255], a[24:27], a[60:63], v[252:255]
    buffer_load_dwordx4 v6, s[44:47], s75 offen offset:1024  lds
    v_mfma_f32_16x16x32_bf16 a[176:179], a[28:31], a[60:63], a[176:179]
    v_mfma_f32_16x16x32_bf16 a[172:175], a[28:31], a[56:59], a[172:175]
    v_mfma_f32_16x16x32_bf16 a[168:171], a[28:31], a[52:55], a[168:171]
    v_mfma_f32_16x16x32_bf16 a[164:167], a[28:31], a[48:51], a[164:167]
    v_mfma_f32_16x16x32_bf16 a[160:163], a[28:31], a[44:47], a[160:163]
    s_waitcnt vmcnt(8) lgkmcnt(0)
    s_barrier
    v_mfma_f32_16x16x32_bf16 a[156:159], a[28:31], a[40:43], a[156:159]
    v_mfma_f32_16x16x32_bf16 a[152:155], a[28:31], a[36:39], a[152:155]
    v_mfma_f32_16x16x32_bf16 a[148:151], a[28:31], a[32:35], a[148:151]
    v_mfma_f32_16x16x32_bf16 v[32:35], a[64:67], a[96:99], v[32:35]
    ds_read_b128 a[32:35], v9 offset:0
    s_add_u32 m0, s76, 32768
    v_mfma_f32_16x16x32_bf16 v[36:39], a[64:67], a[100:103], v[36:39]
    buffer_load_dwordx4 v3, s[36:39], 0 offen offset:0  lds
    v_mfma_f32_16x16x32_bf16 v[40:43], a[64:67], a[104:107], v[40:43]
    ds_read_b128 a[36:39], v9 offset:2048
    v_mfma_f32_16x16x32_bf16 v[44:47], a[64:67], a[108:111], v[44:47]
    v_mfma_f32_16x16x32_bf16 v[48:51], a[64:67], a[112:115], v[48:51]
    ds_read_b128 a[40:43], v9 offset:4096
    v_mfma_f32_16x16x32_bf16 v[52:55], a[64:67], a[116:119], v[52:55]
    v_mfma_f32_16x16x32_bf16 v[56:59], a[64:67], a[120:123], v[56:59]
    ds_read_b128 a[44:47], v9 offset:6144
    v_mfma_f32_16x16x32_bf16 v[60:63], a[64:67], a[124:127], v[60:63]
    v_mfma_f32_16x16x32_bf16 v[92:95], a[68:71], a[124:127], v[92:95]
    ds_read_b128 a[48:51], v9 offset:8192
    v_mfma_f32_16x16x32_bf16 v[88:91], a[68:71], a[120:123], v[88:91]
    buffer_load_dwordx4 v4, s[36:39], s65 offen offset:1024  lds
    v_mfma_f32_16x16x32_bf16 v[84:87], a[68:71], a[116:119], v[84:87]
    ds_read_b128 a[52:55], v9 offset:10240
    v_mfma_f32_16x16x32_bf16 v[80:83], a[68:71], a[112:115], v[80:83]
    v_mfma_f32_16x16x32_bf16 v[76:79], a[68:71], a[108:111], v[76:79]
    ds_read_b128 a[56:59], v9 offset:12288
    v_mfma_f32_16x16x32_bf16 v[72:75], a[68:71], a[104:107], v[72:75]
    v_mfma_f32_16x16x32_bf16 v[68:71], a[68:71], a[100:103], v[68:71]
    ds_read_b128 a[60:63], v9 offset:14336
    v_mfma_f32_16x16x32_bf16 v[64:67], a[68:71], a[96:99], v[64:67]
    v_mfma_f32_16x16x32_bf16 v[96:99], a[72:75], a[96:99], v[96:99]
    ds_read_b64_tr_b16 a[0:1], v11 offset:24576
    v_mfma_f32_16x16x32_bf16 v[100:103], a[72:75], a[100:103], v[100:103]
    buffer_load_dwordx4 v3, s[36:39], s66 offen offset:2048  lds
    v_mfma_f32_16x16x32_bf16 v[104:107], a[72:75], a[104:107], v[104:107]
    ds_read_b64_tr_b16 a[2:3], v12 offset:24576
    v_mfma_f32_16x16x32_bf16 v[108:111], a[72:75], a[108:111], v[108:111]
    v_mfma_f32_16x16x32_bf16 v[112:115], a[72:75], a[112:115], v[112:115]
    ds_read_b64_tr_b16 a[4:5], v13 offset:24576
    v_mfma_f32_16x16x32_bf16 v[116:119], a[72:75], a[116:119], v[116:119]
    v_mfma_f32_16x16x32_bf16 v[120:123], a[72:75], a[120:123], v[120:123]
    ds_read_b64_tr_b16 a[6:7], v14 offset:24576
    v_mfma_f32_16x16x32_bf16 v[124:127], a[72:75], a[124:127], v[124:127]
    v_mfma_f32_16x16x32_bf16 v[156:159], a[76:79], a[124:127], v[156:159]
    ds_read_b64_tr_b16 a[8:9], v15 offset:24576
    v_mfma_f32_16x16x32_bf16 v[152:155], a[76:79], a[120:123], v[152:155]
    buffer_load_dwordx4 v4, s[36:39], s67 offen offset:3072  lds
    v_mfma_f32_16x16x32_bf16 v[148:151], a[76:79], a[116:119], v[148:151]
    ds_read_b64_tr_b16 a[10:11], v16 offset:24576
    v_mfma_f32_16x16x32_bf16 v[144:147], a[76:79], a[112:115], v[144:147]
    v_mfma_f32_16x16x32_bf16 v[140:143], a[76:79], a[108:111], v[140:143]
    ds_read_b64_tr_b16 a[12:13], v17 offset:24576
    v_mfma_f32_16x16x32_bf16 v[136:139], a[76:79], a[104:107], v[136:139]
    v_mfma_f32_16x16x32_bf16 v[132:135], a[76:79], a[100:103], v[132:135]
    ds_read_b64_tr_b16 a[14:15], v18 offset:24576
    v_mfma_f32_16x16x32_bf16 v[128:131], a[76:79], a[96:99], v[128:131]
    v_mfma_f32_16x16x32_bf16 v[160:163], a[80:83], a[96:99], v[160:163]
    ds_read_b64_tr_b16 a[16:17], v19 offset:24576
    s_add_u32 m0, m0, 4096
    v_mfma_f32_16x16x32_bf16 v[164:167], a[80:83], a[100:103], v[164:167]
    buffer_load_dwordx4 v3, s[36:39], s68 offen offset:0  lds
    v_mfma_f32_16x16x32_bf16 v[168:171], a[80:83], a[104:107], v[168:171]
    ds_read_b64_tr_b16 a[18:19], v19 offset:25600
    v_mfma_f32_16x16x32_bf16 v[172:175], a[80:83], a[108:111], v[172:175]
    v_mfma_f32_16x16x32_bf16 v[176:179], a[80:83], a[112:115], v[176:179]
    ds_read_b64_tr_b16 a[20:21], v20 offset:24576
    v_mfma_f32_16x16x32_bf16 v[180:183], a[80:83], a[116:119], v[180:183]
    v_mfma_f32_16x16x32_bf16 v[184:187], a[80:83], a[120:123], v[184:187]
    ds_read_b64_tr_b16 a[22:23], v20 offset:25600
    v_mfma_f32_16x16x32_bf16 v[188:191], a[80:83], a[124:127], v[188:191]
    v_mfma_f32_16x16x32_bf16 v[220:223], a[84:87], a[124:127], v[220:223]
    ds_read_b64_tr_b16 a[24:25], v21 offset:24576
    v_mfma_f32_16x16x32_bf16 v[216:219], a[84:87], a[120:123], v[216:219]
    buffer_load_dwordx4 v4, s[36:39], s69 offen offset:1024  lds
    v_mfma_f32_16x16x32_bf16 v[212:215], a[84:87], a[116:119], v[212:215]
    ds_read_b64_tr_b16 a[26:27], v21 offset:25600
    v_mfma_f32_16x16x32_bf16 v[208:211], a[84:87], a[112:115], v[208:211]
    v_mfma_f32_16x16x32_bf16 v[204:207], a[84:87], a[108:111], v[204:207]
    ds_read_b64_tr_b16 a[28:29], v22 offset:24576
    v_mfma_f32_16x16x32_bf16 v[200:203], a[84:87], a[104:107], v[200:203]
    v_mfma_f32_16x16x32_bf16 v[196:199], a[84:87], a[100:103], v[196:199]
    ds_read_b64_tr_b16 a[30:31], v22 offset:25600
    v_mfma_f32_16x16x32_bf16 v[192:195], a[84:87], a[96:99], v[192:195]
    buffer_load_dwordx4 v3, s[36:39], s70 offen offset:2048  lds
    v_mfma_f32_16x16x32_bf16 v[224:227], a[88:91], a[96:99], v[224:227]
    v_mfma_f32_16x16x32_bf16 v[228:231], a[88:91], a[100:103], v[228:231]
    v_mfma_f32_16x16x32_bf16 v[232:235], a[88:91], a[104:107], v[232:235]
    v_mfma_f32_16x16x32_bf16 v[236:239], a[88:91], a[108:111], v[236:239]
    v_mfma_f32_16x16x32_bf16 v[240:243], a[88:91], a[112:115], v[240:243]
    v_mfma_f32_16x16x32_bf16 v[244:247], a[88:91], a[116:119], v[244:247]
    v_mfma_f32_16x16x32_bf16 v[248:251], a[88:91], a[120:123], v[248:251]
    v_mfma_f32_16x16x32_bf16 v[252:255], a[88:91], a[124:127], v[252:255]
    buffer_load_dwordx4 v4, s[36:39], s71 offen offset:3072  lds
    v_mfma_f32_16x16x32_bf16 a[176:179], a[92:95], a[124:127], a[176:179]
    v_mfma_f32_16x16x32_bf16 a[172:175], a[92:95], a[120:123], a[172:175]
    v_mfma_f32_16x16x32_bf16 a[168:171], a[92:95], a[116:119], a[168:171]
    v_mfma_f32_16x16x32_bf16 a[164:167], a[92:95], a[112:115], a[164:167]
    v_mfma_f32_16x16x32_bf16 a[160:163], a[92:95], a[108:111], a[160:163]
    s_waitcnt lgkmcnt(0)
    s_barrier
    v_mfma_f32_16x16x32_bf16 a[156:159], a[92:95], a[104:107], a[156:159]
    v_mfma_f32_16x16x32_bf16 a[152:155], a[92:95], a[100:103], a[152:155]
    v_mfma_f32_16x16x32_bf16 a[148:151], a[92:95], a[96:99], a[148:151]
    v_mfma_f32_16x16x32_bf16 v[32:35], a[0:3], a[32:35], v[32:35]
    ds_read_b128 a[96:99], v10 offset:0
    v_mfma_f32_16x16x32_bf16 v[36:39], a[0:3], a[36:39], v[36:39]
    v_mfma_f32_16x16x32_bf16 v[40:43], a[0:3], a[40:43], v[40:43]
    ds_read_b128 a[100:103], v10 offset:2048
    v_mfma_f32_16x16x32_bf16 v[44:47], a[0:3], a[44:47], v[44:47]
    v_mfma_f32_16x16x32_bf16 v[48:51], a[0:3], a[48:51], v[48:51]
    ds_read_b128 a[104:107], v10 offset:4096
    global_load_dword a253, v0, s[100:101]
    v_add_u32 v0, 0x2000, v0
    v_mfma_f32_16x16x32_bf16 v[52:55], a[0:3], a[52:55], v[52:55]
    s_bfe_u32 s11, s2, 0x30003
    s_mul_i32 s11, s11, 4352
    s_add_u32 s11, s11, 23396352
    v_mfma_f32_16x16x32_bf16 v[56:59], a[0:3], a[56:59], v[56:59]
    ds_read_b128 a[108:111], v10 offset:6144
    v_mfma_f32_16x16x32_bf16 v[60:63], a[0:3], a[60:63], v[60:63]
    v_mfma_f32_16x16x32_bf16 v[92:95], a[4:7], a[60:63], v[92:95]
    ds_read_b128 a[112:115], v10 offset:8192
    v_mfma_f32_16x16x32_bf16 v[88:91], a[4:7], a[56:59], v[88:91]
    v_mfma_f32_16x16x32_bf16 v[84:87], a[4:7], a[52:55], v[84:87]
    ds_read_b128 a[116:119], v10 offset:10240
    v_mfma_f32_16x16x32_bf16 v[80:83], a[4:7], a[48:51], v[80:83]
    s_mov_b32 s44, s28
    s_mov_b32 s45, s29
    s_mov_b32 s46, 23330816
    v_mfma_f32_16x16x32_bf16 v[76:79], a[4:7], a[44:47], v[76:79]
    ds_read_b128 a[120:123], v10 offset:12288
    v_mfma_f32_16x16x32_bf16 v[72:75], a[4:7], a[40:43], v[72:75]
    s_lshl_b32 s69, s56, 13
    s_add_u32 s68, s69, 23068672
    v_mfma_f32_16x16x32_bf16 v[68:71], a[4:7], a[36:39], v[68:71]
    ds_read_b128 a[124:127], v10 offset:14336
    v_mfma_f32_16x16x32_bf16 v[64:67], a[4:7], a[32:35], v[64:67]
    v_mfma_f32_16x16x32_bf16 v[96:99], a[8:11], a[32:35], v[96:99]
    ds_read_b64_tr_b16 a[64:65], v11 offset:32768
    v_mfma_f32_16x16x32_bf16 v[100:103], a[8:11], a[36:39], v[100:103]
    v_mfma_f32_16x16x32_bf16 v[104:107], a[8:11], a[40:43], v[104:107]
    ds_read_b64_tr_b16 a[66:67], v12 offset:32768
    v_mfma_f32_16x16x32_bf16 v[108:111], a[8:11], a[44:47], v[108:111]
    v_mfma_f32_16x16x32_bf16 v[112:115], a[8:11], a[48:51], v[112:115]
    ds_read_b64_tr_b16 a[68:69], v13 offset:32768
    v_mfma_f32_16x16x32_bf16 v[116:119], a[8:11], a[52:55], v[116:119]
    v_mfma_f32_16x16x32_bf16 v[120:123], a[8:11], a[56:59], v[120:123]
    ds_read_b64_tr_b16 a[70:71], v14 offset:32768
    v_mfma_f32_16x16x32_bf16 v[124:127], a[8:11], a[60:63], v[124:127]
    v_mfma_f32_16x16x32_bf16 v[156:159], a[12:15], a[60:63], v[156:159]
    ds_read_b64_tr_b16 a[72:73], v15 offset:32768
    v_mfma_f32_16x16x32_bf16 v[152:155], a[12:15], a[56:59], v[152:155]
    v_mfma_f32_16x16x32_bf16 v[148:151], a[12:15], a[52:55], v[148:151]
    ds_read_b64_tr_b16 a[74:75], v16 offset:32768
    v_mfma_f32_16x16x32_bf16 v[144:147], a[12:15], a[48:51], v[144:147]
    v_mfma_f32_16x16x32_bf16 v[140:143], a[12:15], a[44:47], v[140:143]
    ds_read_b64_tr_b16 a[76:77], v17 offset:32768
    v_mfma_f32_16x16x32_bf16 v[136:139], a[12:15], a[40:43], v[136:139]
    v_mfma_f32_16x16x32_bf16 v[132:135], a[12:15], a[36:39], v[132:135]
    ds_read_b64_tr_b16 a[78:79], v18 offset:32768
    v_mfma_f32_16x16x32_bf16 v[128:131], a[12:15], a[32:35], v[128:131]
    v_mfma_f32_16x16x32_bf16 v[160:163], a[16:19], a[32:35], v[160:163]
    ds_read_b64_tr_b16 a[80:81], v19 offset:32768
    v_mfma_f32_16x16x32_bf16 v[164:167], a[16:19], a[36:39], v[164:167]
    v_mfma_f32_16x16x32_bf16 v[168:171], a[16:19], a[40:43], v[168:171]
    ds_read_b64_tr_b16 a[82:83], v19 offset:33792
    v_mfma_f32_16x16x32_bf16 v[172:175], a[16:19], a[44:47], v[172:175]
    v_mfma_f32_16x16x32_bf16 v[176:179], a[16:19], a[48:51], v[176:179]
    ds_read_b64_tr_b16 a[84:85], v20 offset:32768
    v_mfma_f32_16x16x32_bf16 v[180:183], a[16:19], a[52:55], v[180:183]
    v_mfma_f32_16x16x32_bf16 v[184:187], a[16:19], a[56:59], v[184:187]
    ds_read_b64_tr_b16 a[86:87], v20 offset:33792
    v_mfma_f32_16x16x32_bf16 v[188:191], a[16:19], a[60:63], v[188:191]
    v_mfma_f32_16x16x32_bf16 v[220:223], a[20:23], a[60:63], v[220:223]
    ds_read_b64_tr_b16 a[88:89], v21 offset:32768
    v_mfma_f32_16x16x32_bf16 v[216:219], a[20:23], a[56:59], v[216:219]
    s_mov_b64 exec, 1
    buffer_store_dwordx2 v[26:27], v25, s[32:35], s59 offen sc1
    s_mov_b64 exec, -1
    s_nop 2
    v_mfma_f32_16x16x32_bf16 v[212:215], a[20:23], a[52:55], v[212:215]
    ds_read_b64_tr_b16 a[90:91], v21 offset:33792
    v_mfma_f32_16x16x32_bf16 v[208:211], a[20:23], a[48:51], v[208:211]
    v_mfma_f32_16x16x32_bf16 v[204:207], a[20:23], a[44:47], v[204:207]
    ds_read_b64_tr_b16 a[92:93], v22 offset:32768
    v_mfma_f32_16x16x32_bf16 v[200:203], a[20:23], a[40:43], v[200:203]
    buffer_load_dwordx4 v[28:31], v2, s[32:35], s11 offen sc1
    v_mfma_f32_16x16x32_bf16 v[196:199], a[20:23], a[36:39], v[196:199]
    ds_read_b64_tr_b16 a[94:95], v22 offset:33792
    v_mfma_f32_16x16x32_bf16 v[192:195], a[20:23], a[32:35], v[192:195]
    v_mfma_f32_16x16x32_bf16 v[224:227], a[24:27], a[32:35], v[224:227]
    v_mfma_f32_16x16x32_bf16 v[228:231], a[24:27], a[36:39], v[228:231]
    v_mfma_f32_16x16x32_bf16 v[232:235], a[24:27], a[40:43], v[232:235]
    v_mfma_f32_16x16x32_bf16 v[236:239], a[24:27], a[44:47], v[236:239]
    v_mfma_f32_16x16x32_bf16 v[240:243], a[24:27], a[48:51], v[240:243]
    v_mfma_f32_16x16x32_bf16 v[244:247], a[24:27], a[52:55], v[244:247]
    v_mfma_f32_16x16x32_bf16 v[248:251], a[24:27], a[56:59], v[248:251]
    v_mfma_f32_16x16x32_bf16 v[252:255], a[24:27], a[60:63], v[252:255]
    v_mfma_f32_16x16x32_bf16 a[176:179], a[28:31], a[60:63], a[176:179]
    v_mfma_f32_16x16x32_bf16 a[172:175], a[28:31], a[56:59], a[172:175]
    v_mfma_f32_16x16x32_bf16 a[168:171], a[28:31], a[52:55], a[168:171]
    v_mfma_f32_16x16x32_bf16 a[164:167], a[28:31], a[48:51], a[164:167]
    v_mfma_f32_16x16x32_bf16 a[160:163], a[28:31], a[44:47], a[160:163]
    s_waitcnt vmcnt(3) lgkmcnt(0)
    s_barrier
    v_mfma_f32_16x16x32_bf16 a[156:159], a[28:31], a[40:43], a[156:159]
    v_mfma_f32_16x16x32_bf16 a[152:155], a[28:31], a[36:39], a[152:155]
    v_mfma_f32_16x16x32_bf16 a[148:151], a[28:31], a[32:35], a[148:151]
    v_mfma_f32_16x16x32_bf16 v[32:35], a[64:67], a[96:99], v[32:35]
    ds_read_b128 a[32:35], v9 offset:32768
    v_mfma_f32_16x16x32_bf16 v[36:39], a[64:67], a[100:103], v[36:39]
    v_mfma_f32_16x16x32_bf16 v[40:43], a[64:67], a[104:107], v[40:43]
    ds_read_b128 a[36:39], v9 offset:34816
    v_mfma_f32_16x16x32_bf16 v[44:47], a[64:67], a[108:111], v[44:47]
    v_mfma_f32_16x16x32_bf16 v[48:51], a[64:67], a[112:115], v[48:51]
    ds_read_b128 a[40:43], v9 offset:36864
    v_mfma_f32_16x16x32_bf16 v[52:55], a[64:67], a[116:119], v[52:55]
    v_mfma_f32_16x16x32_bf16 v[56:59], a[64:67], a[120:123], v[56:59]
    ds_read_b128 a[44:47], v9 offset:38912
    v_mfma_f32_16x16x32_bf16 v[60:63], a[64:67], a[124:127], v[60:63]
    v_mfma_f32_16x16x32_bf16 v[92:95], a[68:71], a[124:127], v[92:95]
    ds_read_b128 a[48:51], v9 offset:40960
    v_mfma_f32_16x16x32_bf16 v[88:91], a[68:71], a[120:123], v[88:91]
    v_mfma_f32_16x16x32_bf16 v[84:87], a[68:71], a[116:119], v[84:87]
    ds_read_b128 a[52:55], v9 offset:43008
    v_mfma_f32_16x16x32_bf16 v[80:83], a[68:71], a[112:115], v[80:83]
    v_mfma_f32_16x16x32_bf16 v[76:79], a[68:71], a[108:111], v[76:79]
    ds_read_b128 a[56:59], v9 offset:45056
    v_mfma_f32_16x16x32_bf16 v[72:75], a[68:71], a[104:107], v[72:75]
    v_mfma_f32_16x16x32_bf16 v[68:71], a[68:71], a[100:103], v[68:71]
    ds_read_b128 a[60:63], v9 offset:47104
    v_mfma_f32_16x16x32_bf16 v[64:67], a[68:71], a[96:99], v[64:67]
    v_mfma_f32_16x16x32_bf16 v[96:99], a[72:75], a[96:99], v[96:99]
    ds_read_b64_tr_b16 a[0:1], v11 offset:0
    v_mfma_f32_16x16x32_bf16 v[100:103], a[72:75], a[100:103], v[100:103]
    v_mfma_f32_16x16x32_bf16 v[104:107], a[72:75], a[104:107], v[104:107]
    ds_read_b64_tr_b16 a[2:3], v12 offset:0
    v_mfma_f32_16x16x32_bf16 v[108:111], a[72:75], a[108:111], v[108:111]
    v_mfma_f32_16x16x32_bf16 v[112:115], a[72:75], a[112:115], v[112:115]
    ds_read_b64_tr_b16 a[4:5], v13 offset:0
    v_mfma_f32_16x16x32_bf16 v[116:119], a[72:75], a[116:119], v[116:119]
    v_mfma_f32_16x16x32_bf16 v[120:123], a[72:75], a[120:123], v[120:123]
    ds_read_b64_tr_b16 a[6:7], v14 offset:0
    v_mfma_f32_16x16x32_bf16 v[124:127], a[72:75], a[124:127], v[124:127]
    v_mfma_f32_16x16x32_bf16 v[156:159], a[76:79], a[124:127], v[156:159]
    ds_read_b64_tr_b16 a[8:9], v15 offset:0
    v_mfma_f32_16x16x32_bf16 v[152:155], a[76:79], a[120:123], v[152:155]
    v_mfma_f32_16x16x32_bf16 v[148:151], a[76:79], a[116:119], v[148:151]
    ds_read_b64_tr_b16 a[10:11], v16 offset:0
    v_mfma_f32_16x16x32_bf16 v[144:147], a[76:79], a[112:115], v[144:147]
    v_mfma_f32_16x16x32_bf16 v[140:143], a[76:79], a[108:111], v[140:143]
    ds_read_b64_tr_b16 a[12:13], v17 offset:0
    v_mfma_f32_16x16x32_bf16 v[136:139], a[76:79], a[104:107], v[136:139]
    v_mfma_f32_16x16x32_bf16 v[132:135], a[76:79], a[100:103], v[132:135]
    ds_read_b64_tr_b16 a[14:15], v18 offset:0
    v_mfma_f32_16x16x32_bf16 v[128:131], a[76:79], a[96:99], v[128:131]
    v_mfma_f32_16x16x32_bf16 v[160:163], a[80:83], a[96:99], v[160:163]
    ds_read_b64_tr_b16 a[16:17], v19 offset:0
    v_mfma_f32_16x16x32_bf16 v[164:167], a[80:83], a[100:103], v[164:167]
    v_mfma_f32_16x16x32_bf16 v[168:171], a[80:83], a[104:107], v[168:171]
    ds_read_b64_tr_b16 a[18:19], v19 offset:1024
    v_mfma_f32_16x16x32_bf16 v[172:175], a[80:83], a[108:111], v[172:175]
    v_mfma_f32_16x16x32_bf16 v[176:179], a[80:83], a[112:115], v[176:179]
    ds_read_b64_tr_b16 a[20:21], v20 offset:0
    v_mfma_f32_16x16x32_bf16 v[180:183], a[80:83], a[116:119], v[180:183]
    v_mfma_f32_16x16x32_bf16 v[184:187], a[80:83], a[120:123], v[184:187]
    ds_read_b64_tr_b16 a[22:23], v20 offset:1024
    v_mfma_f32_16x16x32_bf16 v[188:191], a[80:83], a[124:127], v[188:191]
    v_mfma_f32_16x16x32_bf16 v[220:223], a[84:87], a[124:127], v[220:223]
    ds_read_b64_tr_b16 a[24:25], v21 offset:0
    v_mfma_f32_16x16x32_bf16 v[216:219], a[84:87], a[120:123], v[216:219]
    v_mfma_f32_16x16x32_bf16 v[212:215], a[84:87], a[116:119], v[212:215]
    ds_read_b64_tr_b16 a[26:27], v21 offset:1024
    v_mfma_f32_16x16x32_bf16 v[208:211], a[84:87], a[112:115], v[208:211]
    v_mfma_f32_16x16x32_bf16 v[204:207], a[84:87], a[108:111], v[204:207]
    ds_read_b64_tr_b16 a[28:29], v22 offset:0
    v_mfma_f32_16x16x32_bf16 v[200:203], a[84:87], a[104:107], v[200:203]
    v_mfma_f32_16x16x32_bf16 v[196:199], a[84:87], a[100:103], v[196:199]
    ds_read_b64_tr_b16 a[30:31], v22 offset:1024
    v_mfma_f32_16x16x32_bf16 v[192:195], a[84:87], a[96:99], v[192:195]
    v_mfma_f32_16x16x32_bf16 v[224:227], a[88:91], a[96:99], v[224:227]
    v_mfma_f32_16x16x32_bf16 v[228:231], a[88:91], a[100:103], v[228:231]
    v_mfma_f32_16x16x32_bf16 v[232:235], a[88:91], a[104:107], v[232:235]
    v_mfma_f32_16x16x32_bf16 v[236:239], a[88:91], a[108:111], v[236:239]
    s_waitcnt vmcnt(0)
    v_xor_b32 v28, v28, v24
    v_xor_b32 v29, v29, v24
    v_xor_b32 v30, v30, v24
    v_xor_b32 v31, v31, v24
    v_or3_b32 v28, v28, v29, v30
    v_or_b32 v28, v28, v31
    v_cmp_eq_u32 vcc, 0, v28
    s_nop 0
    s_cmp_eq_u64 vcc, -1
    s_cbranch_scc0 P1_SLOWE
P1_EOK:
    v_mfma_f32_16x16x32_bf16 v[240:243], a[88:91], a[112:115], v[240:243]
    v_mfma_f32_16x16x32_bf16 v[244:247], a[88:91], a[116:119], v[244:247]
    v_mfma_f32_16x16x32_bf16 v[248:251], a[88:91], a[120:123], v[248:251]
    v_mfma_f32_16x16x32_bf16 v[252:255], a[88:91], a[124:127], v[252:255]
    v_mfma_f32_16x16x32_bf16 a[176:179], a[92:95], a[124:127], a[176:179]
    v_mfma_f32_16x16x32_bf16 a[172:175], a[92:95], a[120:123], a[172:175]
    v_mfma_f32_16x16x32_bf16 a[168:171], a[92:95], a[116:119], a[168:171]
    v_mfma_f32_16x16x32_bf16 a[164:167], a[92:95], a[112:115], a[164:167]
    v_mfma_f32_16x16x32_bf16 a[160:163], a[92:95], a[108:111], a[160:163]
    s_waitcnt lgkmcnt(0)
    s_barrier
    v_mfma_f32_16x16x32_bf16 a[156:159], a[92:95], a[104:107], a[156:159]
    v_mfma_f32_16x16x32_bf16 a[152:155], a[92:95], a[100:103], a[152:155]
    v_mfma_f32_16x16x32_bf16 a[148:151], a[92:95], a[96:99], a[148:151]
    s_cmp_eq_u32 s9, 1
    s_cbranch_scc1 P1_EPIB
    v_mfma_f32_16x16x32_bf16 v[32:35], a[0:3], a[32:35], v[32:35]
    ds_read_b128 a[96:99], v10 offset:32768
    v_mfma_f32_16x16x32_bf16 v[36:39], a[0:3], a[36:39], v[36:39]
    v_mfma_f32_16x16x32_bf16 v[40:43], a[0:3], a[40:43], v[40:43]
    ds_read_b128 a[100:103], v10 offset:34816
    v_mfma_f32_16x16x32_bf16 v[44:47], a[0:3], a[44:47], v[44:47]
    v_mfma_f32_16x16x32_bf16 v[48:51], a[0:3], a[48:51], v[48:51]
    ds_read_b128 a[104:107], v10 offset:36864
    s_add_u32 m0, s69, 0
    v_mfma_f32_16x16x32_bf16 v[52:55], a[0:3], a[52:55], v[52:55]
    buffer_load_dwordx4 v2, s[44:47], s68 offen offset:0 sc1 lds
    v_mfma_f32_16x16x32_bf16 v[56:59], a[0:3], a[56:59], v[56:59]
    ds_read_b128 a[108:111], v10 offset:38912
    v_mfma_f32_16x16x32_bf16 v[60:63], a[0:3], a[60:63], v[60:63]
    v_mfma_f32_16x16x32_bf16 v[92:95], a[4:7], a[60:63], v[92:95]
    ds_read_b128 a[112:115], v10 offset:40960
    v_mfma_f32_16x16x32_bf16 v[88:91], a[4:7], a[56:59], v[88:91]
    v_mfma_f32_16x16x32_bf16 v[84:87], a[4:7], a[52:55], v[84:87]
    ds_read_b128 a[116:119], v10 offset:43008
    v_mfma_f32_16x16x32_bf16 v[80:83], a[4:7], a[48:51], v[80:83]
    buffer_load_dwordx4 v2, s[44:47], s68 offen offset:1024 sc1 lds
    v_mfma_f32_16x16x32_bf16 v[76:79], a[4:7], a[44:47], v[76:79]
    ds_read_b128 a[120:123], v10 offset:45056
    v_mfma_f32_16x16x32_bf16 v[72:75], a[4:7], a[40:43], v[72:75]
    v_mfma_f32_16x16x32_bf16 v[68:71], a[4:7], a[36:39], v[68:71]
    ds_read_b128 a[124:127], v10 offset:47104
    v_mfma_f32_16x16x32_bf16 v[64:67], a[4:7], a[32:35], v[64:67]
    v_mfma_f32_16x16x32_bf16 v[96:99], a[8:11], a[32:35], v[96:99]
    ds_read_b64_tr_b16 a[64:65], v11 offset:8192
    v_mfma_f32_16x16x32_bf16 v[100:103], a[8:11], a[36:39], v[100:103]
    buffer_load_dwordx4 v2, s[44:47], s68 offen offset:2048 sc1 lds
    v_mfma_f32_16x16x32_bf16 v[104:107], a[8:11], a[40:43], v[104:107]
    ds_read_b64_tr_b16 a[66:67], v12 offset:8192
    v_mfma_f32_16x16x32_bf16 v[108:111], a[8:11], a[44:47], v[108:111]
    v_mfma_f32_16x16x32_bf16 v[112:115], a[8:11], a[48:51], v[112:115]
    ds_read_b64_tr_b16 a[68:69], v13 offset:8192
    v_mfma_f32_16x16x32_bf16 v[116:119], a[8:11], a[52:55], v[116:119]
    v_mfma_f32_16x16x32_bf16 v[120:123], a[8:11], a[56:59], v[120:123]
    ds_read_b64_tr_b16 a[70:71], v14 offset:8192
    v_mfma_f32_16x16x32_bf16 v[124:127], a[8:11], a[60:63], v[124:127]
    buffer_load_dwordx4 v2, s[44:47], s68 offen offset:3072 sc1 lds
    v_mfma_f32_16x16x32_bf16 v[156:159], a[12:15], a[60:63], v[156:159]
    ds_read_b64_tr_b16 a[72:73], v15 offset:8192
    v_mfma_f32_16x16x32_bf16 v[152:155], a[12:15], a[56:59], v[152:155]
    v_mfma_f32_16x16x32_bf16 v[148:151], a[12:15], a[52:55], v[148:151]
    ds_read_b64_tr_b16 a[74:75], v16 offset:8192
    v_mfma_f32_16x16x32_bf16 v[144:147], a[12:15], a[48:51], v[144:147]
    v_mfma_f32_16x16x32_bf16 v[140:143], a[12:15], a[44:47], v[140:143]
    ds_read_b64_tr_b16 a[76:77], v17 offset:8192
    s_add_u32 m0, m0, 4096
    s_add_u32 s68, s68, 4096
    v_mfma_f32_16x16x32_bf16 v[136:139], a[12:15], a[40:43], v[136:139]
    buffer_load_dwordx4 v2, s[44:47], s68 offen offset:0 sc1 lds
    v_mfma_f32_16x16x32_bf16 v[132:135], a[12:15], a[36:39], v[132:135]
    ds_read_b64_tr_b16 a[78:79], v18 offset:8192
    v_mfma_f32_16x16x32_bf16 v[128:131], a[12:15], a[32:35], v[128:131]
    v_mfma_f32_16x16x32_bf16 v[160:163], a[16:19], a[32:35], v[160:163]
    ds_read_b64_tr_b16 a[80:81], v19 offset:8192
    v_mfma_f32_16x16x32_bf16 v[164:167], a[16:19], a[36:39], v[164:167]
    v_mfma_f32_16x16x32_bf16 v[168:171], a[16:19], a[40:43], v[168:171]
    ds_read_b64_tr_b16 a[82:83], v19 offset:9216
    v_mfma_f32_16x16x32_bf16 v[172:175], a[16:19], a[44:47], v[172:175]
    buffer_load_dwordx4 v2, s[44:47], s68 offen offset:1024 sc1 lds
    v_mfma_f32_16x16x32_bf16 v[176:179], a[16:19], a[48:51], v[176:179]
    ds_read_b64_tr_b16 a[84:85], v20 offset:8192
    v_mfma_f32_16x16x32_bf16 v[180:183], a[16:19], a[52:55], v[180:183]
    v_mfma_f32_16x16x32_bf16 v[184:187], a[16:19], a[56:59], v[184:187]
    ds_read_b64_tr_b16 a[86:87], v20 offset:9216
    v_mfma_f32_16x16x32_bf16 v[188:191], a[16:19], a[60:63], v[188:191]
    v_mfma_f32_16x16x32_bf16 v[220:223], a[20:23], a[60:63], v[220:223]
    ds_read_b64_tr_b16 a[88:89], v21 offset:8192
    v_mfma_f32_16x16x32_bf16 v[216:219], a[20:23], a[56:59], v[216:219]
    buffer_load_dwordx4 v2, s[44:47], s68 offen offset:2048 sc1 lds
    v_mfma_f32_16x16x32_bf16 v[212:215], a[20:23], a[52:55], v[212:215]
    ds_read_b64_tr_b16 a[90:91], v21 offset:9216
    v_mfma_f32_16x16x32_bf16 v[208:211], a[20:23], a[48:51], v[208:211]
    v_mfma_f32_16x16x32_bf16 v[204:207], a[20:23], a[44:47], v[204:207]
    ds_read_b64_tr_b16 a[92:93], v22 offset:8192
    v_mfma_f32_16x16x32_bf16 v[200:203], a[20:23], a[40:43], v[200:203]
    v_mfma_f32_16x16x32_bf16 v[196:199], a[20:23], a[36:39], v[196:199]
    ds_read_b64_tr_b16 a[94:95], v22 offset:9216
    buffer_load_dwordx4 v2, s[44:47], s68 offen offset:3072 sc1 lds
    v_mfma_f32_16x16x32_bf16 v[192:195], a[20:23], a[32:35], v[192:195]
    s_add_u32 s68, s68, 28672
    v_mfma_f32_16x16x32_bf16 v[224:227], a[24:27], a[32:35], v[224:227]
    v_mfma_f32_16x16x32_bf16 v[228:231], a[24:27], a[36:39], v[228:231]
    v_mfma_f32_16x16x32_bf16 v[232:235], a[24:27], a[40:43], v[232:235]
    v_mfma_f32_16x16x32_bf16 v[236:239], a[24:27], a[44:47], v[236:239]
    v_mfma_f32_16x16x32_bf16 v[240:243], a[24:27], a[48:51], v[240:243]
    v_mfma_f32_16x16x32_bf16 v[244:247], a[24:27], a[52:55], v[244:247]
    v_mfma_f32_16x16x32_bf16 v[248:251], a[24:27], a[56:59], v[248:251]
    v_mfma_f32_16x16x32_bf16 v[252:255], a[24:27], a[60:63], v[252:255]
    v_mfma_f32_16x16x32_bf16 a[176:179], a[28:31], a[60:63], a[176:179]
    v_mfma_f32_16x16x32_bf16 a[172:175], a[28:31], a[56:59], a[172:175]
    v_mfma_f32_16x16x32_bf16 a[168:171], a[28:31], a[52:55], a[168:171]
    v_mfma_f32_16x16x32_bf16 a[164:167], a[28:31], a[48:51], a[164:167]
    v_mfma_f32_16x16x32_bf16 a[160:163], a[28:31], a[44:47], a[160:163]
    s_waitcnt lgkmcnt(0)
    s_barrier
    v_mfma_f32_16x16x32_bf16 a[156:159], a[28:31], a[40:43], a[156:159]
    v_mfma_f32_16x16x32_bf16 a[152:155], a[28:31], a[36:39], a[152:155]
    v_mfma_f32_16x16x32_bf16 a[148:151], a[28:31], a[32:35], a[148:151]
    v_mfma_f32_16x16x32_bf16 v[32:35], a[64:67], a[96:99], v[32:35]
    s_lshr_b32 s58, s56, 1
    s_and_b32 s59, s56, 1
    s_lshl_b32 s0, s63, 4
    s_lshl_b32 s60, s58, 3
    s_add_u32 s0, s0, s60
    v_mfma_f32_16x16x32_bf16 v[64:67], a[68:71], a[96:99], v[64:67]
    s_lshl_b32 s0, s0, 11
    s_add_u32 s0, s0, 33554432
    s_lshr_b32 s60, s64, 2
    s_mul_i32 s1, s60, 14
    s_and_b32 s61, s64, 3
    v_mfma_f32_16x16x32_bf16 v[96:99], a[72:75], a[96:99], v[96:99]
    s_lshl_b32 s61, s61, 2
    s_add_u32 s1, s1, s61
    s_add_u32 s1, s1, s59
    s_add_u32 s1, s1, s59
    s_mul_i32 s1, s1, 266240
    v_mfma_f32_16x16x32_bf16 v[128:131], a[76:79], a[96:99], v[128:131]
    s_add_u32 s0, s0, s1
    s_add_u32 s3, s0, 266240
    v_mfma_f32_16x16x32_bf16 v[160:163], a[80:83], a[96:99], v[160:163]
    v_mfma_f32_16x16x32_bf16 v[192:195], a[84:87], a[96:99], v[192:195]
    v_mfma_f32_16x16x32_bf16 v[224:227], a[88:91], a[96:99], v[224:227]
    v_mfma_f32_16x16x32_bf16 a[148:151], a[92:95], a[96:99], a[148:151]
    v_mfma_f32_16x16x32_bf16 v[36:39], a[64:67], a[100:103], v[36:39]
    v_mfma_f32_16x16x32_bf16 v[68:71], a[68:71], a[100:103], v[68:71]
    v_mfma_f32_16x16x32_bf16 v[100:103], a[72:75], a[100:103], v[100:103]
    v_mfma_f32_16x16x32_bf16 v[132:135], a[76:79], a[100:103], v[132:135]
    v_mfma_f32_16x16x32_bf16 v[164:167], a[80:83], a[100:103], v[164:167]
    v_max_f32 v32, 0, v32
    v_max_f32 v33, 0, v33
    v_max_f32 v34, 0, v34
    v_max_f32 v35, 0, v35
    v_max_f32 v64, 0, v64
    v_mfma_f32_16x16x32_bf16 v[196:199], a[84:87], a[100:103], v[196:199]
    v_max_f32 v65, 0, v65
    v_max_f32 v66, 0, v66
    v_max_f32 v67, 0, v67
    v_mul_f32 v32, v32, v160
    v_mul_f32 v33, v33, v161
    v_mfma_f32_16x16x32_bf16 v[228:231], a[88:91], a[100:103], v[228:231]
    v_mul_f32 v34, v34, v162
    v_mul_f32 v35, v35, v163
    v_mul_f32 v64, v64, v192
    v_mul_f32 v65, v65, v193
    v_mul_f32 v66, v66, v194
    v_mfma_f32_16x16x32_bf16 a[152:155], a[92:95], a[100:103], a[152:155]
    v_mul_f32 v67, v67, v195
    v_cvt_pk_bf16_f32 v160, v32, v33
    v_cvt_pk_bf16_f32 v161, v34, v35
    v_cvt_pk_bf16_f32 v162, v64, v65
    v_cvt_pk_bf16_f32 v163, v66, v67
    v_mfma_f32_16x16x32_bf16 v[40:43], a[64:67], a[104:107], v[40:43]
    v_accvgpr_read_b32 v20, a148
    v_accvgpr_read_b32 v21, a149
    v_accvgpr_read_b32 v22, a150
    v_accvgpr_read_b32 v23, a151
    v_max_f32 v96, 0, v96
    v_mfma_f32_16x16x32_bf16 v[72:75], a[68:71], a[104:107], v[72:75]
    v_max_f32 v97, 0, v97
    v_max_f32 v98, 0, v98
    v_max_f32 v99, 0, v99
    v_max_f32 v128, 0, v128
    v_max_f32 v129, 0, v129
    v_mfma_f32_16x16x32_bf16 v[104:107], a[72:75], a[104:107], v[104:107]
    v_max_f32 v130, 0, v130
    v_max_f32 v131, 0, v131
    v_mul_f32 v96, v96, v224
    v_mul_f32 v97, v97, v225
    v_mul_f32 v98, v98, v226
    v_mfma_f32_16x16x32_bf16 v[136:139], a[76:79], a[104:107], v[136:139]
    v_mul_f32 v99, v99, v227
    v_mul_f32 v128, v128, v20
    v_mul_f32 v129, v129, v21
    v_mul_f32 v130, v130, v22
    v_mul_f32 v131, v131, v23
    v_mfma_f32_16x16x32_bf16 v[168:171], a[80:83], a[104:107], v[168:171]
    v_cvt_pk_bf16_f32 v192, v96, v97
    v_cvt_pk_bf16_f32 v193, v98, v99
    v_cvt_pk_bf16_f32 v194, v128, v129
    v_cvt_pk_bf16_f32 v195, v130, v131
    s_add_u32 m0, s69, 32768
    v_mfma_f32_16x16x32_bf16 v[200:203], a[84:87], a[104:107], v[200:203]
    s_nop 0
    buffer_load_dwordx4 v2, s[44:47], s68 offen offset:0 sc1 lds
    v_max_f32 v36, 0, v36
    v_max_f32 v37, 0, v37
    v_max_f32 v38, 0, v38
    v_mfma_f32_16x16x32_bf16 v[232:235], a[88:91], a[104:107], v[232:235]
    v_max_f32 v39, 0, v39
    v_max_f32 v68, 0, v68
    v_max_f32 v69, 0, v69
    v_max_f32 v70, 0, v70
    v_max_f32 v71, 0, v71
    v_mfma_f32_16x16x32_bf16 a[156:159], a[92:95], a[104:107], a[156:159]
    v_mul_f32 v36, v36, v164
    v_mul_f32 v37, v37, v165
    v_mul_f32 v38, v38, v166
    v_mul_f32 v39, v39, v167
    v_mul_f32 v68, v68, v196
    v_mfma_f32_16x16x32_bf16 v[44:47], a[64:67], a[108:111], v[44:47]
    v_mul_f32 v69, v69, v197
    v_mul_f32 v70, v70, v198
    v_mul_f32 v71, v71, v199
    v_cvt_pk_bf16_f32 v164, v36, v37
    v_cvt_pk_bf16_f32 v165, v38, v39
    v_mfma_f32_16x16x32_bf16 v[76:79], a[68:71], a[108:111], v[76:79]
    v_cvt_pk_bf16_f32 v166, v68, v69
    v_cvt_pk_bf16_f32 v167, v70, v71
    v_accvgpr_read_b32 v28, a152
    v_accvgpr_read_b32 v29, a153
    v_accvgpr_read_b32 v30, a154
    v_mfma_f32_16x16x32_bf16 v[108:111], a[72:75], a[108:111], v[108:111]
    v_accvgpr_read_b32 v31, a155
    v_max_f32 v100, 0, v100
    v_max_f32 v101, 0, v101
    v_max_f32 v102, 0, v102
    v_max_f32 v103, 0, v103
    v_mfma_f32_16x16x32_bf16 v[140:143], a[76:79], a[108:111], v[140:143]
    v_max_f32 v132, 0, v132
    v_max_f32 v133, 0, v133
    v_max_f32 v134, 0, v134
    v_max_f32 v135, 0, v135
    v_mul_f32 v100, v100, v228
    v_mfma_f32_16x16x32_bf16 v[172:175], a[80:83], a[108:111], v[172:175]
    v_mul_f32 v101, v101, v229
    v_mul_f32 v102, v102, v230
    v_mul_f32 v103, v103, v231
    v_mul_f32 v132, v132, v28
    v_mul_f32 v133, v133, v29
    v_mfma_f32_16x16x32_bf16 v[204:207], a[84:87], a[108:111], v[204:207]
    v_mul_f32 v134, v134, v30
    v_mul_f32 v135, v135, v31
    v_cvt_pk_bf16_f32 v196, v100, v101
    v_cvt_pk_bf16_f32 v197, v102, v103
    v_cvt_pk_bf16_f32 v198, v132, v133
    v_mfma_f32_16x16x32_bf16 v[236:239], a[88:91], a[108:111], v[236:239]
    v_cvt_pk_bf16_f32 v199, v134, v135
    v_mfma_f32_16x16x32_bf16 a[160:163], a[92:95], a[108:111], a[160:163]
    buffer_load_dwordx4 v2, s[44:47], s68 offen offset:1024 sc1 lds
    v_max_f32 v40, 0, v40
    v_max_f32 v41, 0, v41
    v_max_f32 v42, 0, v42
    v_max_f32 v43, 0, v43
    v_mfma_f32_16x16x32_bf16 v[48:51], a[64:67], a[112:115], v[48:51]
    v_max_f32 v72, 0, v72
    v_max_f32 v73, 0, v73
    v_max_f32 v74, 0, v74
    v_max_f32 v75, 0, v75
    v_mul_f32 v40, v40, v168
    v_mfma_f32_16x16x32_bf16 v[80:83], a[68:71], a[112:115], v[80:83]
    v_mul_f32 v41, v41, v169
    v_mul_f32 v42, v42, v170
    v_mul_f32 v43, v43, v171
    v_mul_f32 v72, v72, v200
    v_mul_f32 v73, v73, v201
    v_mfma_f32_16x16x32_bf16 v[112:115], a[72:75], a[112:115], v[112:115]
    v_mul_f32 v74, v74, v202
    v_mul_f32 v75, v75, v203
    v_cvt_pk_bf16_f32 v168, v40, v41
    v_cvt_pk_bf16_f32 v169, v42, v43
    v_cvt_pk_bf16_f32 v170, v72, v73
    v_mfma_f32_16x16x32_bf16 v[144:147], a[76:79], a[112:115], v[144:147]
    v_cvt_pk_bf16_f32 v171, v74, v75
    v_accvgpr_read_b32 v20, a156
    v_accvgpr_read_b32 v21, a157
    v_accvgpr_read_b32 v22, a158
    v_accvgpr_read_b32 v23, a159
    v_mfma_f32_16x16x32_bf16 v[176:179], a[80:83], a[112:115], v[176:179]
    v_max_f32 v104, 0, v104
    v_max_f32 v105, 0, v105
    v_max_f32 v106, 0, v106
    v_max_f32 v107, 0, v107
    v_max_f32 v136, 0, v136
    v_mfma_f32_16x16x32_bf16 v[208:211], a[84:87], a[112:115], v[208:211]
    v_max_f32 v137, 0, v137
    v_max_f32 v138, 0, v138
    v_max_f32 v139, 0, v139
    v_mul_f32 v104, v104, v232
    v_mul_f32 v105, v105, v233
    v_mfma_f32_16x16x32_bf16 v[240:243], a[88:91], a[112:115], v[240:243]
    v_mul_f32 v106, v106, v234
    v_mul_f32 v107, v107, v235
    v_mul_f32 v136, v136, v20
    v_mul_f32 v137, v137, v21
    v_mul_f32 v138, v138, v22
    v_mfma_f32_16x16x32_bf16 a[164:167], a[92:95], a[112:115], a[164:167]
    v_mul_f32 v139, v139, v23
    v_cvt_pk_bf16_f32 v200, v104, v105
    v_cvt_pk_bf16_f32 v201, v106, v107
    v_cvt_pk_bf16_f32 v202, v136, v137
    v_cvt_pk_bf16_f32 v203, v138, v139
    v_mfma_f32_16x16x32_bf16 v[52:55], a[64:67], a[116:119], v[52:55]
    buffer_load_dwordx4 v2, s[44:47], s68 offen offset:2048 sc1 lds
    v_max_f32 v44, 0, v44
    v_max_f32 v45, 0, v45
    v_max_f32 v46, 0, v46
    v_max_f32 v47, 0, v47
    v_mfma_f32_16x16x32_bf16 v[84:87], a[68:71], a[116:119], v[84:87]
    v_max_f32 v76, 0, v76
    v_max_f32 v77, 0, v77
    v_max_f32 v78, 0, v78
    v_max_f32 v79, 0, v79
    v_mul_f32 v44, v44, v172
    v_mfma_f32_16x16x32_bf16 v[116:119], a[72:75], a[116:119], v[116:119]
    v_mul_f32 v45, v45, v173
    v_mul_f32 v46, v46, v174
    v_mul_f32 v47, v47, v175
    v_mul_f32 v76, v76, v204
    v_mul_f32 v77, v77, v205
    v_mfma_f32_16x16x32_bf16 v[148:151], a[76:79], a[116:119], v[148:151]
    v_mul_f32 v78, v78, v206
    v_mul_f32 v79, v79, v207
    v_cvt_pk_bf16_f32 v172, v44, v45
    v_cvt_pk_bf16_f32 v173, v46, v47
    v_cvt_pk_bf16_f32 v174, v76, v77
    v_mfma_f32_16x16x32_bf16 v[180:183], a[80:83], a[116:119], v[180:183]
    v_cvt_pk_bf16_f32 v175, v78, v79
    v_accvgpr_read_b32 v28, a160
    v_accvgpr_read_b32 v29, a161
    v_accvgpr_read_b32 v30, a162
    v_accvgpr_read_b32 v31, a163
    v_mfma_f32_16x16x32_bf16 v[212:215], a[84:87], a[116:119], v[212:215]
    v_max_f32 v108, 0, v108
    v_max_f32 v109, 0, v109
    v_max_f32 v110, 0, v110
    v_max_f32 v111, 0, v111
    v_max_f32 v140, 0, v140
    v_mfma_f32_16x16x32_bf16 v[244:247], a[88:91], a[116:119], v[244:247]
    v_max_f32 v141, 0, v141
    v_max_f32 v142, 0, v142
    v_max_f32 v143, 0, v143
    v_mul_f32 v108, v108, v236
    v_mul_f32 v109, v109, v237
    v_mfma_f32_16x16x32_bf16 a[168:171], a[92:95], a[116:119], a[168:171]
    v_mul_f32 v110, v110, v238
    v_mul_f32 v111, v111, v239
    v_mul_f32 v140, v140, v28
    v_mul_f32 v141, v141, v29
    v_mul_f32 v142, v142, v30
    v_mfma_f32_16x16x32_bf16 v[56:59], a[64:67], a[120:123], v[56:59]
    v_mul_f32 v143, v143, v31
    v_cvt_pk_bf16_f32 v204, v108, v109
    v_cvt_pk_bf16_f32 v205, v110, v111
    v_cvt_pk_bf16_f32 v206, v140, v141
    v_cvt_pk_bf16_f32 v207, v142, v143
    v_mfma_f32_16x16x32_bf16 v[88:91], a[68:71], a[120:123], v[88:91]
    buffer_load_dwordx4 v2, s[44:47], s68 offen offset:3072 sc1 lds
    v_max_f32 v48, 0, v48
    v_max_f32 v49, 0, v49
    v_max_f32 v50, 0, v50
    v_max_f32 v51, 0, v51
    v_mfma_f32_16x16x32_bf16 v[120:123], a[72:75], a[120:123], v[120:123]
    v_max_f32 v80, 0, v80
    v_max_f32 v81, 0, v81
    v_max_f32 v82, 0, v82
    v_max_f32 v83, 0, v83
    v_mul_f32 v48, v48, v176
    v_mfma_f32_16x16x32_bf16 v[152:155], a[76:79], a[120:123], v[152:155]
    v_mul_f32 v49, v49, v177
    v_mul_f32 v50, v50, v178
    v_mul_f32 v51, v51, v179
    v_mul_f32 v80, v80, v208
    v_mul_f32 v81, v81, v209
    v_mfma_f32_16x16x32_bf16 v[184:187], a[80:83], a[120:123], v[184:187]
    v_mul_f32 v82, v82, v210
    v_mul_f32 v83, v83, v211
    v_cvt_pk_bf16_f32 v176, v48, v49
    v_cvt_pk_bf16_f32 v177, v50, v51
    v_cvt_pk_bf16_f32 v178, v80, v81
    v_mfma_f32_16x16x32_bf16 v[216:219], a[84:87], a[120:123], v[216:219]
    v_cvt_pk_bf16_f32 v179, v82, v83
    v_accvgpr_read_b32 v20, a164
    v_accvgpr_read_b32 v21, a165
    v_accvgpr_read_b32 v22, a166
    v_accvgpr_read_b32 v23, a167
    v_mfma_f32_16x16x32_bf16 v[248:251], a[88:91], a[120:123], v[248:251]
    v_max_f32 v112, 0, v112
    v_max_f32 v113, 0, v113
    v_max_f32 v114, 0, v114
    v_max_f32 v115, 0, v115
    v_max_f32 v144, 0, v144
    v_mfma_f32_16x16x32_bf16 a[172:175], a[92:95], a[120:123], a[172:175]
    v_max_f32 v145, 0, v145
    v_max_f32 v146, 0, v146
    v_max_f32 v147, 0, v147
    v_mul_f32 v112, v112, v240
    v_mul_f32 v113, v113, v241
    v_mfma_f32_16x16x32_bf16 v[60:63], a[64:67], a[124:127], v[60:63]
    v_mul_f32 v114, v114, v242
    v_mul_f32 v115, v115, v243
    v_mul_f32 v144, v144, v20
    v_mul_f32 v145, v145, v21
    v_mul_f32 v146, v146, v22
    v_mfma_f32_16x16x32_bf16 v[92:95], a[68:71], a[124:127], v[92:95]
    v_mul_f32 v147, v147, v23
    v_cvt_pk_bf16_f32 v208, v112, v113
    v_cvt_pk_bf16_f32 v209, v114, v115
    v_cvt_pk_bf16_f32 v210, v144, v145
    v_cvt_pk_bf16_f32 v211, v146, v147
    v_mfma_f32_16x16x32_bf16 v[124:127], a[72:75], a[124:127], v[124:127]
    s_add_u32 m0, m0, 4096
    s_add_u32 s68, s68, 4096
    s_nop 0
    buffer_load_dwordx4 v2, s[44:47], s68 offen offset:0 sc1 lds
    v_max_f32 v52, 0, v52
    v_mfma_f32_16x16x32_bf16 v[156:159], a[76:79], a[124:127], v[156:159]
    v_max_f32 v53, 0, v53
    v_max_f32 v54, 0, v54
    v_max_f32 v55, 0, v55
    v_max_f32 v84, 0, v84
    v_max_f32 v85, 0, v85
    v_mfma_f32_16x16x32_bf16 v[188:191], a[80:83], a[124:127], v[188:191]
    v_max_f32 v86, 0, v86
    v_max_f32 v87, 0, v87
    v_mul_f32 v52, v52, v180
    v_mul_f32 v53, v53, v181
    v_mul_f32 v54, v54, v182
    v_mfma_f32_16x16x32_bf16 v[220:223], a[84:87], a[124:127], v[220:223]
    v_mul_f32 v55, v55, v183
    v_mul_f32 v84, v84, v212
    v_mul_f32 v85, v85, v213
    v_mul_f32 v86, v86, v214
    v_mul_f32 v87, v87, v215
    v_mfma_f32_16x16x32_bf16 v[252:255], a[88:91], a[124:127], v[252:255]
    v_cvt_pk_bf16_f32 v180, v52, v53
    v_cvt_pk_bf16_f32 v181, v54, v55
    v_cvt_pk_bf16_f32 v182, v84, v85
    v_cvt_pk_bf16_f32 v183, v86, v87
    v_accvgpr_read_b32 v28, a168
    v_mfma_f32_16x16x32_bf16 a[176:179], a[92:95], a[124:127], a[176:179]
    v_accvgpr_read_b32 v29, a169
    v_accvgpr_read_b32 v30, a170
    v_accvgpr_read_b32 v31, a171
    v_max_f32 v116, 0, v116
    v_max_f32 v117, 0, v117
    s_nop 7
    v_max_f32 v118, 0, v118
    v_max_f32 v119, 0, v119
    v_max_f32 v148, 0, v148
    v_max_f32 v149, 0, v149
    v_max_f32 v150, 0, v150
    v_max_f32 v151, 0, v151
    v_mul_f32 v116, v116, v244
    v_mul_f32 v117, v117, v245
    v_mul_f32 v118, v118, v246
    v_mul_f32 v119, v119, v247
    v_mul_f32 v148, v148, v28
    v_mul_f32 v149, v149, v29
    v_mul_f32 v150, v150, v30
    v_mul_f32 v151, v151, v31
    v_cvt_pk_bf16_f32 v212, v116, v117
    v_cvt_pk_bf16_f32 v213, v118, v119
    v_cvt_pk_bf16_f32 v214, v148, v149
    v_cvt_pk_bf16_f32 v215, v150, v151
    buffer_load_dwordx4 v2, s[44:47], s68 offen offset:1024 sc1 lds
    v_max_f32 v56, 0, v56
    v_max_f32 v57, 0, v57
    v_max_f32 v58, 0, v58
    v_max_f32 v59, 0, v59
    v_max_f32 v88, 0, v88
    v_max_f32 v89, 0, v89
    v_max_f32 v90, 0, v90
    v_max_f32 v91, 0, v91
    v_mul_f32 v56, v56, v184
    v_mul_f32 v57, v57, v185
    v_mul_f32 v58, v58, v186
    v_mul_f32 v59, v59, v187
    v_mul_f32 v88, v88, v216
    v_mul_f32 v89, v89, v217
    v_mul_f32 v90, v90, v218
    v_mul_f32 v91, v91, v219
    v_cvt_pk_bf16_f32 v184, v56, v57
    v_cvt_pk_bf16_f32 v185, v58, v59
    v_cvt_pk_bf16_f32 v186, v88, v89
    v_cvt_pk_bf16_f32 v187, v90, v91
    v_accvgpr_read_b32 v20, a172
    v_accvgpr_read_b32 v21, a173
    v_accvgpr_read_b32 v22, a174
    v_accvgpr_read_b32 v23, a175
    v_max_f32 v120, 0, v120
    v_max_f32 v121, 0, v121
    v_max_f32 v122, 0, v122
    v_max_f32 v123, 0, v123
    v_max_f32 v152, 0, v152
    v_max_f32 v153, 0, v153
    v_max_f32 v154, 0, v154
    v_max_f32 v155, 0, v155
    v_mul_f32 v120, v120, v248
    v_mul_f32 v121, v121, v249
    v_mul_f32 v122, v122, v250
    v_mul_f32 v123, v123, v251
    v_mul_f32 v152, v152, v20
    v_mul_f32 v153, v153, v21
    v_mul_f32 v154, v154, v22
    v_mul_f32 v155, v155, v23
    v_cvt_pk_bf16_f32 v216, v120, v121
    v_cvt_pk_bf16_f32 v217, v122, v123
    v_cvt_pk_bf16_f32 v218, v152, v153
    v_cvt_pk_bf16_f32 v219, v154, v155
    buffer_load_dwordx4 v2, s[44:47], s68 offen offset:2048 sc1 lds
    v_max_f32 v60, 0, v60
    v_max_f32 v61, 0, v61
    v_max_f32 v62, 0, v62
    v_max_f32 v63, 0, v63
    v_max_f32 v92, 0, v92
    v_max_f32 v93, 0, v93
    v_max_f32 v94, 0, v94
    v_max_f32 v95, 0, v95
    v_mul_f32 v60, v60, v188
    v_mul_f32 v61, v61, v189
    v_mul_f32 v62, v62, v190
    v_mul_f32 v63, v63, v191
    v_mul_f32 v92, v92, v220
    v_mul_f32 v93, v93, v221
    v_mul_f32 v94, v94, v222
    v_mul_f32 v95, v95, v223
    v_cvt_pk_bf16_f32 v188, v60, v61
    v_cvt_pk_bf16_f32 v189, v62, v63
    v_cvt_pk_bf16_f32 v190, v92, v93
    v_cvt_pk_bf16_f32 v191, v94, v95
    v_accvgpr_read_b32 v28, a176
    v_accvgpr_read_b32 v29, a177
    v_accvgpr_read_b32 v30, a178
    v_accvgpr_read_b32 v31, a179
    v_max_f32 v124, 0, v124
    v_max_f32 v125, 0, v125
    v_max_f32 v126, 0, v126
    v_max_f32 v127, 0, v127
    v_max_f32 v156, 0, v156
    v_max_f32 v157, 0, v157
    v_max_f32 v158, 0, v158
    v_max_f32 v159, 0, v159
    v_mul_f32 v124, v124, v252
    v_mul_f32 v125, v125, v253
    v_mul_f32 v126, v126, v254
    v_mul_f32 v127, v127, v255
    v_mul_f32 v156, v156, v28
    v_mul_f32 v157, v157, v29
    v_mul_f32 v158, v158, v30
    v_mul_f32 v159, v159, v31
    v_cvt_pk_bf16_f32 v220, v124, v125
    v_cvt_pk_bf16_f32 v221, v126, v127
    v_cvt_pk_bf16_f32 v222, v156, v157
    v_cvt_pk_bf16_f32 v223, v158, v159
    buffer_load_dwordx4 v2, s[44:47], s68 offen offset:3072 sc1 lds
    s_add_u32 s68, s68, 28672
    s_branch P1_EPID
P1_EPIB:
    v_mfma_f32_16x16x32_bf16 v[160:163], a[16:19], a[32:35], v[160:163]
    ds_read_b128 a[96:99], v10 offset:32768
    s_lshr_b32 s58, s56, 1
    s_and_b32 s59, s56, 1
    v_mfma_f32_16x16x32_bf16 v[164:167], a[16:19], a[36:39], v[164:167]
    ds_read_b128 a[100:103], v10 offset:34816
    s_lshl_b32 s0, s63, 4
    s_lshl_b32 s60, s58, 3
    v_mfma_f32_16x16x32_bf16 v[168:171], a[16:19], a[40:43], v[168:171]
    ds_read_b128 a[104:107], v10 offset:36864
    s_add_u32 s0, s0, s60
    s_lshl_b32 s0, s0, 11
    v_mfma_f32_16x16x32_bf16 v[172:175], a[16:19], a[44:47], v[172:175]
    ds_read_b128 a[108:111], v10 offset:38912
    s_add_u32 s0, s0, 33554432
    s_lshr_b32 s60, s64, 2
    v_mfma_f32_16x16x32_bf16 v[176:179], a[16:19], a[48:51], v[176:179]
    ds_read_b128 a[112:115], v10 offset:40960
    s_mul_i32 s1, s60, 14
    s_and_b32 s61, s64, 3
    v_mfma_f32_16x16x32_bf16 v[180:183], a[16:19], a[52:55], v[180:183]
    ds_read_b128 a[116:119], v10 offset:43008
    s_lshl_b32 s61, s61, 2
    s_add_u32 s1, s1, s61
    v_mfma_f32_16x16x32_bf16 v[184:187], a[16:19], a[56:59], v[184:187]
    ds_read_b128 a[120:123], v10 offset:45056
    s_add_u32 s1, s1, s59
    s_mul_i32 s1, s1, 266240
    v_mfma_f32_16x16x32_bf16 v[188:191], a[16:19], a[60:63], v[188:191]
    ds_read_b128 a[124:127], v10 offset:47104
    s_add_u32 s0, s0, s1
    s_mov_b32 s3, 1073741824
    v_mfma_f32_16x16x32_bf16 v[192:195], a[20:23], a[32:35], v[192:195]
    ds_read_b64_tr_b16 a[80:81], v19 offset:8192
    s_lshl_b32 s14, s63, 3
    s_add_u32 s14, s14, s60
    v_mfma_f32_16x16x32_bf16 v[196:199], a[20:23], a[36:39], v[196:199]
    ds_read_b64_tr_b16 a[82:83], v19 offset:9216
    s_lshl_b32 s14, s14, 2
    s_lshl_b32 s59, s59, 1
    v_mfma_f32_16x16x32_bf16 v[200:203], a[20:23], a[40:43], v[200:203]
    ds_read_b64_tr_b16 a[84:85], v20 offset:8192
    s_add_u32 s60, s14, s59
    s_lshl_b32 s60, s60, 1
    v_mfma_f32_16x16x32_bf16 v[204:207], a[20:23], a[44:47], v[204:207]
    ds_read_b64_tr_b16 a[86:87], v20 offset:9216
    s_add_u32 s60, s60, s58
    s_lshl_b32 s60, s60, 14
    v_mfma_f32_16x16x32_bf16 v[208:211], a[20:23], a[48:51], v[208:211]
    ds_read_b64_tr_b16 a[88:89], v21 offset:8192
    s_add_u32 s58, s60, 72351744
    s_add_u32 s59, s58, 32768
    v_mfma_f32_16x16x32_bf16 v[212:215], a[20:23], a[52:55], v[212:215]
    ds_read_b64_tr_b16 a[90:91], v21 offset:9216
    v_cmp_lt_u32 vcc, 23, v1
    v_add_u32 v26, 128, v2
    v_mfma_f32_16x16x32_bf16 v[216:219], a[20:23], a[56:59], v[216:219]
    ds_read_b64_tr_b16 a[92:93], v22 offset:8192
    s_nop 0
    v_cndmask_b32 v26, v2, v26, vcc
    v_mfma_f32_16x16x32_bf16 v[220:223], a[20:23], a[60:63], v[220:223]
    ds_read_b64_tr_b16 a[94:95], v22 offset:9216
    s_add_u32 s14, s14, s56
    s_lshl_b32 s14, s14, 8
    v_mfma_f32_16x16x32_bf16 v[224:227], a[24:27], a[32:35], v[224:227]
    ds_read_b64_tr_b16 a[64:65], v11 offset:8192
    s_add_u32 s14, s14, 23461888
    s_mov_b32 s66, 0x3e8293ee
    v_mfma_f32_16x16x32_bf16 v[228:231], a[24:27], a[36:39], v[228:231]
    ds_read_b64_tr_b16 a[66:67], v12 offset:8192
    s_mov_b32 s67, 0x3e8293ee
    v_mfma_f32_16x16x32_bf16 v[232:235], a[24:27], a[40:43], v[232:235]
    ds_read_b64_tr_b16 a[68:69], v13 offset:8192
    v_mfma_f32_16x16x32_bf16 v[236:239], a[24:27], a[44:47], v[236:239]
    ds_read_b64_tr_b16 a[70:71], v14 offset:8192
    v_mfma_f32_16x16x32_bf16 v[240:243], a[24:27], a[48:51], v[240:243]
    ds_read_b64_tr_b16 a[72:73], v15 offset:8192
    v_mfma_f32_16x16x32_bf16 v[244:247], a[24:27], a[52:55], v[244:247]
    ds_read_b64_tr_b16 a[74:75], v16 offset:8192
    v_mfma_f32_16x16x32_bf16 v[248:251], a[24:27], a[56:59], v[248:251]
    ds_read_b64_tr_b16 a[76:77], v17 offset:8192
    v_mfma_f32_16x16x32_bf16 v[252:255], a[24:27], a[60:63], v[252:255]
    ds_read_b64_tr_b16 a[78:79], v18 offset:8192
    s_add_u32 m0, s69, 0
    v_mfma_f32_16x16x32_bf16 a[148:151], a[28:31], a[32:35], a[148:151]
    buffer_load_dwordx4 v2, s[44:47], s68 offen offset:0 sc1 lds
    v_mfma_f32_16x16x32_bf16 a[152:155], a[28:31], a[36:39], a[152:155]
    buffer_load_dwordx4 v2, s[44:47], s68 offen offset:1024 sc1 lds
    v_mfma_f32_16x16x32_bf16 a[156:159], a[28:31], a[40:43], a[156:159]
    buffer_load_dwordx4 v2, s[44:47], s68 offen offset:2048 sc1 lds
    v_mfma_f32_16x16x32_bf16 a[160:163], a[28:31], a[44:47], a[160:163]
    buffer_load_dwordx4 v2, s[44:47], s68 offen offset:3072 sc1 lds
    s_add_u32 m0, m0, 4096
    s_add_u32 s68, s68, 4096
    v_mfma_f32_16x16x32_bf16 a[164:167], a[28:31], a[48:51], a[164:167]
    buffer_load_dwordx4 v2, s[44:47], s68 offen offset:0 sc1 lds
    v_mfma_f32_16x16x32_bf16 a[168:171], a[28:31], a[52:55], a[168:171]
    buffer_load_dwordx4 v2, s[44:47], s68 offen offset:1024 sc1 lds
    v_mfma_f32_16x16x32_bf16 a[172:175], a[28:31], a[56:59], a[172:175]
    buffer_load_dwordx4 v2, s[44:47], s68 offen offset:2048 sc1 lds
    v_mfma_f32_16x16x32_bf16 a[176:179], a[28:31], a[60:63], a[176:179]
    buffer_load_dwordx4 v2, s[44:47], s68 offen offset:3072 sc1 lds
    s_add_u32 s68, s68, 28672
    s_waitcnt lgkmcnt(0)
    s_barrier
    v_mfma_f32_16x16x32_bf16 v[160:163], a[80:83], a[96:99], v[160:163]
    v_mfma_f32_16x16x32_bf16 v[192:195], a[84:87], a[96:99], v[192:195]
    v_mfma_f32_16x16x32_bf16 v[224:227], a[88:91], a[96:99], v[224:227]
    v_mfma_f32_16x16x32_bf16 a[148:151], a[92:95], a[96:99], a[148:151]
    v_mfma_f32_16x16x32_bf16 v[164:167], a[80:83], a[100:103], v[164:167]
    v_mfma_f32_16x16x32_bf16 v[196:199], a[84:87], a[100:103], v[196:199]
    v_mfma_f32_16x16x32_bf16 v[228:231], a[88:91], a[100:103], v[228:231]
    v_mfma_f32_16x16x32_bf16 a[152:155], a[92:95], a[100:103], a[152:155]
    v_mfma_f32_16x16x32_bf16 v[168:171], a[80:83], a[104:107], v[168:171]
    v_mul_f32 v160, s66, v160
    v_mul_f32 v161, s66, v161
    v_mul_f32 v162, s66, v162
    v_mfma_f32_16x16x32_bf16 v[200:203], a[84:87], a[104:107], v[200:203]
    v_mul_f32 v163, s66, v163
    v_mul_f32 v192, s66, v192
    v_mul_f32 v193, s66, v193
    v_mfma_f32_16x16x32_bf16 v[232:235], a[88:91], a[104:107], v[232:235]
    v_mul_f32 v194, s66, v194
    v_mul_f32 v195, s66, v195
    v_cvt_pk_bf16_f32 v160, v160, v161
    v_mfma_f32_16x16x32_bf16 a[156:159], a[92:95], a[104:107], a[156:159]
    v_cvt_pk_bf16_f32 v161, v162, v163
    v_cvt_pk_bf16_f32 v162, v192, v193
    v_cvt_pk_bf16_f32 v163, v194, v195
    v_mfma_f32_16x16x32_bf16 v[172:175], a[80:83], a[108:111], v[172:175]
    buffer_store_dwordx4 v[160:163], v26, s[32:35], s58 offen offset:0 sc1
    v_accvgpr_read_b32 v20, a148
    v_accvgpr_read_b32 v21, a149
    v_mfma_f32_16x16x32_bf16 v[204:207], a[84:87], a[108:111], v[204:207]
    v_accvgpr_read_b32 v22, a150
    v_accvgpr_read_b32 v23, a151
    v_mul_f32 v224, s66, v224
    v_mfma_f32_16x16x32_bf16 v[236:239], a[88:91], a[108:111], v[236:239]
    v_mul_f32 v225, s66, v225
    v_mul_f32 v226, s66, v226
    v_mul_f32 v227, s66, v227
    v_mfma_f32_16x16x32_bf16 a[160:163], a[92:95], a[108:111], a[160:163]
    v_mul_f32 v20, s66, v20
    v_mul_f32 v21, s66, v21
    v_mul_f32 v22, s66, v22
    v_mfma_f32_16x16x32_bf16 v[176:179], a[80:83], a[112:115], v[176:179]
    v_mul_f32 v23, s66, v23
    v_cvt_pk_bf16_f32 v224, v224, v225
    v_cvt_pk_bf16_f32 v225, v226, v227
    v_mfma_f32_16x16x32_bf16 v[208:211], a[84:87], a[112:115], v[208:211]
    v_cvt_pk_bf16_f32 v226, v20, v21
    v_cvt_pk_bf16_f32 v227, v22, v23
    v_mfma_f32_16x16x32_bf16 v[240:243], a[88:91], a[112:115], v[240:243]
    buffer_store_dwordx4 v[224:227], v26, s[32:35], s59 offen offset:0 sc1
    v_mul_f32 v164, s66, v164
    v_mul_f32 v165, s66, v165
    v_mfma_f32_16x16x32_bf16 a[164:167], a[92:95], a[112:115], a[164:167]
    v_mul_f32 v166, s66, v166
    v_mul_f32 v167, s66, v167
    v_mul_f32 v196, s66, v196
    v_mfma_f32_16x16x32_bf16 v[180:183], a[80:83], a[116:119], v[180:183]
    v_mul_f32 v197, s66, v197
    v_mul_f32 v198, s66, v198
    v_mul_f32 v199, s66, v199
    v_mfma_f32_16x16x32_bf16 v[212:215], a[84:87], a[116:119], v[212:215]
    v_cvt_pk_bf16_f32 v164, v164, v165
    v_cvt_pk_bf16_f32 v165, v166, v167
    v_cvt_pk_bf16_f32 v166, v196, v197
    v_mfma_f32_16x16x32_bf16 v[244:247], a[88:91], a[116:119], v[244:247]
    v_cvt_pk_bf16_f32 v167, v198, v199
    v_mfma_f32_16x16x32_bf16 a[168:171], a[92:95], a[116:119], a[168:171]
    buffer_store_dwordx4 v[164:167], v26, s[32:35], s58 offen offset:2048 sc1
    s_add_u32 s58, s58, 4096
    v_accvgpr_read_b32 v28, a152
    v_mfma_f32_16x16x32_bf16 v[184:187], a[80:83], a[120:123], v[184:187]
    v_accvgpr_read_b32 v29, a153
    v_accvgpr_read_b32 v30, a154
    v_accvgpr_read_b32 v31, a155
    v_mfma_f32_16x16x32_bf16 v[216:219], a[84:87], a[120:123], v[216:219]
    v_mul_f32 v228, s66, v228
    v_mul_f32 v229, s66, v229
    v_mul_f32 v230, s66, v230
    v_mfma_f32_16x16x32_bf16 v[248:251], a[88:91], a[120:123], v[248:251]
    v_mul_f32 v231, s66, v231
    v_mul_f32 v28, s66, v28
    v_mul_f32 v29, s66, v29
    v_mfma_f32_16x16x32_bf16 a[172:175], a[92:95], a[120:123], a[172:175]
    v_mul_f32 v30, s66, v30
    v_mul_f32 v31, s66, v31
    v_cvt_pk_bf16_f32 v228, v228, v229
    v_mfma_f32_16x16x32_bf16 v[188:191], a[80:83], a[124:127], v[188:191]
    v_cvt_pk_bf16_f32 v229, v230, v231
    v_cvt_pk_bf16_f32 v230, v28, v29
    v_cvt_pk_bf16_f32 v231, v30, v31
    v_mfma_f32_16x16x32_bf16 v[220:223], a[84:87], a[124:127], v[220:223]
    buffer_store_dwordx4 v[228:231], v26, s[32:35], s59 offen offset:2048 sc1
    s_add_u32 s59, s59, 4096
    v_mul_f32 v168, s66, v168
    v_mfma_f32_16x16x32_bf16 v[252:255], a[88:91], a[124:127], v[252:255]
    v_mul_f32 v169, s66, v169
    v_mul_f32 v170, s66, v170
    v_mul_f32 v171, s66, v171
    v_mfma_f32_16x16x32_bf16 a[176:179], a[92:95], a[124:127], a[176:179]
    v_mul_f32 v200, s66, v200
    v_mul_f32 v201, s66, v201
    v_mul_f32 v202, s66, v202
    v_mfma_f32_16x16x32_bf16 v[32:35], a[0:3], a[32:35], v[32:35]
    v_mul_f32 v203, s66, v203
    v_cvt_pk_bf16_f32 v168, v168, v169
    v_cvt_pk_bf16_f32 v169, v170, v171
    v_mfma_f32_16x16x32_bf16 v[36:39], a[0:3], a[36:39], v[36:39]
    v_cvt_pk_bf16_f32 v170, v200, v201
    v_cvt_pk_bf16_f32 v171, v202, v203
    v_mfma_f32_16x16x32_bf16 v[40:43], a[0:3], a[40:43], v[40:43]
    buffer_store_dwordx4 v[168:171], v26, s[32:35], s58 offen offset:0 sc1
    v_accvgpr_read_b32 v20, a156
    v_accvgpr_read_b32 v21, a157
    v_mfma_f32_16x16x32_bf16 v[44:47], a[0:3], a[44:47], v[44:47]
    v_accvgpr_read_b32 v22, a158
    v_accvgpr_read_b32 v23, a159
    v_mul_f32 v232, s66, v232
    v_mfma_f32_16x16x32_bf16 v[48:51], a[0:3], a[48:51], v[48:51]
    v_mul_f32 v233, s66, v233
    v_mul_f32 v234, s66, v234
    v_mul_f32 v235, s66, v235
    v_mfma_f32_16x16x32_bf16 v[52:55], a[0:3], a[52:55], v[52:55]
    v_mul_f32 v20, s66, v20
    v_mul_f32 v21, s66, v21
    v_mul_f32 v22, s66, v22
    v_mfma_f32_16x16x32_bf16 v[56:59], a[0:3], a[56:59], v[56:59]
    v_mul_f32 v23, s66, v23
    v_cvt_pk_bf16_f32 v232, v232, v233
    v_cvt_pk_bf16_f32 v233, v234, v235
    v_mfma_f32_16x16x32_bf16 v[60:63], a[0:3], a[60:63], v[60:63]
    v_cvt_pk_bf16_f32 v234, v20, v21
    v_cvt_pk_bf16_f32 v235, v22, v23
    v_mfma_f32_16x16x32_bf16 v[64:67], a[4:7], a[32:35], v[64:67]
    buffer_store_dwordx4 v[232:235], v26, s[32:35], s59 offen offset:0 sc1
    v_mul_f32 v172, s66, v172
    v_mul_f32 v173, s66, v173
    v_mfma_f32_16x16x32_bf16 v[68:71], a[4:7], a[36:39], v[68:71]
    v_mul_f32 v174, s66, v174
    v_mul_f32 v175, s66, v175
    v_mul_f32 v204, s66, v204
    v_mfma_f32_16x16x32_bf16 v[72:75], a[4:7], a[40:43], v[72:75]
    v_mul_f32 v205, s66, v205
    v_mul_f32 v206, s66, v206
    v_mul_f32 v207, s66, v207
    v_mfma_f32_16x16x32_bf16 v[76:79], a[4:7], a[44:47], v[76:79]
    v_cvt_pk_bf16_f32 v172, v172, v173
    v_cvt_pk_bf16_f32 v173, v174, v175
    v_cvt_pk_bf16_f32 v174, v204, v205
    v_mfma_f32_16x16x32_bf16 v[80:83], a[4:7], a[48:51], v[80:83]
    v_cvt_pk_bf16_f32 v175, v206, v207
    v_mfma_f32_16x16x32_bf16 v[84:87], a[4:7], a[52:55], v[84:87]
    buffer_store_dwordx4 v[172:175], v26, s[32:35], s58 offen offset:2048 sc1
    s_add_u32 s58, s58, 4096
    v_accvgpr_read_b32 v28, a160
    v_mfma_f32_16x16x32_bf16 v[88:91], a[4:7], a[56:59], v[88:91]
    v_accvgpr_read_b32 v29, a161
    v_accvgpr_read_b32 v30, a162
    v_accvgpr_read_b32 v31, a163
    v_mfma_f32_16x16x32_bf16 v[92:95], a[4:7], a[60:63], v[92:95]
    v_mul_f32 v236, s66, v236
    v_mul_f32 v237, s66, v237
    v_mul_f32 v238, s66, v238
    v_mfma_f32_16x16x32_bf16 v[96:99], a[8:11], a[32:35], v[96:99]
    v_mul_f32 v239, s66, v239
    v_mul_f32 v28, s66, v28
    v_mul_f32 v29, s66, v29
    v_mfma_f32_16x16x32_bf16 v[100:103], a[8:11], a[36:39], v[100:103]
    v_mul_f32 v30, s66, v30
    v_mul_f32 v31, s66, v31
    v_cvt_pk_bf16_f32 v236, v236, v237
    v_mfma_f32_16x16x32_bf16 v[104:107], a[8:11], a[40:43], v[104:107]
    v_cvt_pk_bf16_f32 v237, v238, v239
    v_cvt_pk_bf16_f32 v238, v28, v29
    v_cvt_pk_bf16_f32 v239, v30, v31
    v_mfma_f32_16x16x32_bf16 v[108:111], a[8:11], a[44:47], v[108:111]
    buffer_store_dwordx4 v[236:239], v26, s[32:35], s59 offen offset:2048 sc1
    s_add_u32 s59, s59, 4096
    v_mul_f32 v176, s66, v176
    v_mfma_f32_16x16x32_bf16 v[112:115], a[8:11], a[48:51], v[112:115]
    v_mul_f32 v177, s66, v177
    v_mul_f32 v178, s66, v178
    v_mul_f32 v179, s66, v179
    v_mfma_f32_16x16x32_bf16 v[116:119], a[8:11], a[52:55], v[116:119]
    v_mul_f32 v208, s66, v208
    v_mul_f32 v209, s66, v209
    v_mul_f32 v210, s66, v210
    v_mfma_f32_16x16x32_bf16 v[120:123], a[8:11], a[56:59], v[120:123]
    v_mul_f32 v211, s66, v211
    v_cvt_pk_bf16_f32 v176, v176, v177
    v_cvt_pk_bf16_f32 v177, v178, v179
    v_mfma_f32_16x16x32_bf16 v[124:127], a[8:11], a[60:63], v[124:127]
    v_cvt_pk_bf16_f32 v178, v208, v209
    v_cvt_pk_bf16_f32 v179, v210, v211
    v_mfma_f32_16x16x32_bf16 v[128:131], a[12:15], a[32:35], v[128:131]
    buffer_store_dwordx4 v[176:179], v26, s[32:35], s58 offen offset:0 sc1
    v_accvgpr_read_b32 v20, a164
    v_accvgpr_read_b32 v21, a165
    v_mfma_f32_16x16x32_bf16 v[132:135], a[12:15], a[36:39], v[132:135]
    v_accvgpr_read_b32 v22, a166
    v_accvgpr_read_b32 v23, a167
    v_mul_f32 v240, s66, v240
    v_mfma_f32_16x16x32_bf16 v[136:139], a[12:15], a[40:43], v[136:139]
    v_mul_f32 v241, s66, v241
    v_mul_f32 v242, s66, v242
    v_mul_f32 v243, s66, v243
    v_mfma_f32_16x16x32_bf16 v[140:143], a[12:15], a[44:47], v[140:143]
    v_mul_f32 v20, s66, v20
    v_mul_f32 v21, s66, v21
    v_mul_f32 v22, s66, v22
    v_mfma_f32_16x16x32_bf16 v[144:147], a[12:15], a[48:51], v[144:147]
    v_mul_f32 v23, s66, v23
    v_cvt_pk_bf16_f32 v240, v240, v241
    v_cvt_pk_bf16_f32 v241, v242, v243
    v_mfma_f32_16x16x32_bf16 v[148:151], a[12:15], a[52:55], v[148:151]
    v_cvt_pk_bf16_f32 v242, v20, v21
    v_cvt_pk_bf16_f32 v243, v22, v23
    v_mfma_f32_16x16x32_bf16 v[152:155], a[12:15], a[56:59], v[152:155]
    buffer_store_dwordx4 v[240:243], v26, s[32:35], s59 offen offset:0 sc1
    v_mul_f32 v180, s66, v180
    v_mul_f32 v181, s66, v181
    v_mfma_f32_16x16x32_bf16 v[156:159], a[12:15], a[60:63], v[156:159]
    v_mul_f32 v182, s66, v182
    v_mul_f32 v183, s66, v183
    v_mul_f32 v212, s66, v212
    v_mfma_f32_16x16x32_bf16 v[32:35], a[64:67], a[96:99], v[32:35]
    v_mul_f32 v213, s66, v213
    v_mul_f32 v214, s66, v214
    v_mul_f32 v215, s66, v215
    v_mfma_f32_16x16x32_bf16 v[64:67], a[68:71], a[96:99], v[64:67]
    v_cvt_pk_bf16_f32 v180, v180, v181
    v_cvt_pk_bf16_f32 v181, v182, v183
    v_cvt_pk_bf16_f32 v182, v212, v213
    v_mfma_f32_16x16x32_bf16 v[96:99], a[72:75], a[96:99], v[96:99]
    v_cvt_pk_bf16_f32 v183, v214, v215
    v_mfma_f32_16x16x32_bf16 v[128:131], a[76:79], a[96:99], v[128:131]
    buffer_store_dwordx4 v[180:183], v26, s[32:35], s58 offen offset:2048 sc1
    s_add_u32 s58, s58, 4096
    v_accvgpr_read_b32 v28, a168
    v_mfma_f32_16x16x32_bf16 v[36:39], a[64:67], a[100:103], v[36:39]
    v_accvgpr_read_b32 v29, a169
    v_accvgpr_read_b32 v30, a170
    v_accvgpr_read_b32 v31, a171
    v_mfma_f32_16x16x32_bf16 v[68:71], a[68:71], a[100:103], v[68:71]
    v_mul_f32 v244, s66, v244
    v_mul_f32 v245, s66, v245
    v_mul_f32 v246, s66, v246
    v_mfma_f32_16x16x32_bf16 v[100:103], a[72:75], a[100:103], v[100:103]
    v_mul_f32 v247, s66, v247
    v_mul_f32 v28, s66, v28
    v_mul_f32 v29, s66, v29
    v_mfma_f32_16x16x32_bf16 v[132:135], a[76:79], a[100:103], v[132:135]
    v_mul_f32 v30, s66, v30
    v_mul_f32 v31, s66, v31
    v_cvt_pk_bf16_f32 v244, v244, v245
    v_mfma_f32_16x16x32_bf16 v[40:43], a[64:67], a[104:107], v[40:43]
    v_cvt_pk_bf16_f32 v245, v246, v247
    v_cvt_pk_bf16_f32 v246, v28, v29
    v_cvt_pk_bf16_f32 v247, v30, v31
    v_mfma_f32_16x16x32_bf16 v[72:75], a[68:71], a[104:107], v[72:75]
    buffer_store_dwordx4 v[244:247], v26, s[32:35], s59 offen offset:2048 sc1
    s_add_u32 s59, s59, 4096
    v_mul_f32 v184, s66, v184
    v_mfma_f32_16x16x32_bf16 v[104:107], a[72:75], a[104:107], v[104:107]
    v_mul_f32 v185, s66, v185
    v_mul_f32 v186, s66, v186
    v_mul_f32 v187, s66, v187
    v_mfma_f32_16x16x32_bf16 v[136:139], a[76:79], a[104:107], v[136:139]
    v_mul_f32 v216, s66, v216
    v_mul_f32 v217, s66, v217
    v_mul_f32 v218, s66, v218
    v_mfma_f32_16x16x32_bf16 v[44:47], a[64:67], a[108:111], v[44:47]
    v_mul_f32 v219, s66, v219
    v_cvt_pk_bf16_f32 v184, v184, v185
    v_cvt_pk_bf16_f32 v185, v186, v187
    v_mfma_f32_16x16x32_bf16 v[76:79], a[68:71], a[108:111], v[76:79]
    v_cvt_pk_bf16_f32 v186, v216, v217
    v_cvt_pk_bf16_f32 v187, v218, v219
    v_mfma_f32_16x16x32_bf16 v[108:111], a[72:75], a[108:111], v[108:111]
    buffer_store_dwordx4 v[184:187], v26, s[32:35], s58 offen offset:0 sc1
    v_accvgpr_read_b32 v20, a172
    v_accvgpr_read_b32 v21, a173
    v_mfma_f32_16x16x32_bf16 v[140:143], a[76:79], a[108:111], v[140:143]
    v_accvgpr_read_b32 v22, a174
    v_accvgpr_read_b32 v23, a175
    v_mul_f32 v248, s66, v248
    v_mfma_f32_16x16x32_bf16 v[48:51], a[64:67], a[112:115], v[48:51]
    v_mul_f32 v249, s66, v249
    v_mul_f32 v250, s66, v250
    v_mul_f32 v251, s66, v251
    v_mfma_f32_16x16x32_bf16 v[80:83], a[68:71], a[112:115], v[80:83]
    v_mul_f32 v20, s66, v20
    v_mul_f32 v21, s66, v21
    v_mul_f32 v22, s66, v22
    v_mfma_f32_16x16x32_bf16 v[112:115], a[72:75], a[112:115], v[112:115]
    v_mul_f32 v23, s66, v23
    v_cvt_pk_bf16_f32 v248, v248, v249
    v_cvt_pk_bf16_f32 v249, v250, v251
    v_mfma_f32_16x16x32_bf16 v[144:147], a[76:79], a[112:115], v[144:147]
    v_cvt_pk_bf16_f32 v250, v20, v21
    v_cvt_pk_bf16_f32 v251, v22, v23
    v_mfma_f32_16x16x32_bf16 v[52:55], a[64:67], a[116:119], v[52:55]
    buffer_store_dwordx4 v[248:251], v26, s[32:35], s59 offen offset:0 sc1
    v_mul_f32 v188, s66, v188
    v_mul_f32 v189, s66, v189
    v_mfma_f32_16x16x32_bf16 v[84:87], a[68:71], a[116:119], v[84:87]
    v_mul_f32 v190, s66, v190
    v_mul_f32 v191, s66, v191
    v_mul_f32 v220, s66, v220
    v_mfma_f32_16x16x32_bf16 v[116:119], a[72:75], a[116:119], v[116:119]
    v_mul_f32 v221, s66, v221
    v_mul_f32 v222, s66, v222
    v_mul_f32 v223, s66, v223
    v_mfma_f32_16x16x32_bf16 v[148:151], a[76:79], a[116:119], v[148:151]
    v_cvt_pk_bf16_f32 v188, v188, v189
    v_cvt_pk_bf16_f32 v189, v190, v191
    v_cvt_pk_bf16_f32 v190, v220, v221
    v_mfma_f32_16x16x32_bf16 v[56:59], a[64:67], a[120:123], v[56:59]
    v_cvt_pk_bf16_f32 v191, v222, v223
    v_mfma_f32_16x16x32_bf16 v[88:91], a[68:71], a[120:123], v[88:91]
    buffer_store_dwordx4 v[188:191], v26, s[32:35], s58 offen offset:2048 sc1
    s_add_u32 s58, s58, 4096
    v_accvgpr_read_b32 v28, a176
    v_mfma_f32_16x16x32_bf16 v[120:123], a[72:75], a[120:123], v[120:123]
    v_accvgpr_read_b32 v29, a177
    v_accvgpr_read_b32 v30, a178
    v_accvgpr_read_b32 v31, a179
    v_mfma_f32_16x16x32_bf16 v[152:155], a[76:79], a[120:123], v[152:155]
    v_mul_f32 v252, s66, v252
    v_mul_f32 v253, s66, v253
    v_mul_f32 v254, s66, v254
    v_mfma_f32_16x16x32_bf16 v[60:63], a[64:67], a[124:127], v[60:63]
    v_mul_f32 v255, s66, v255
    v_mul_f32 v28, s66, v28
    v_mul_f32 v29, s66, v29
    v_mfma_f32_16x16x32_bf16 v[92:95], a[68:71], a[124:127], v[92:95]
    v_mul_f32 v30, s66, v30
    v_mul_f32 v31, s66, v31
    v_cvt_pk_bf16_f32 v252, v252, v253
    v_mfma_f32_16x16x32_bf16 v[124:127], a[72:75], a[124:127], v[124:127]
    v_cvt_pk_bf16_f32 v253, v254, v255
    v_cvt_pk_bf16_f32 v254, v28, v29
    v_cvt_pk_bf16_f32 v255, v30, v31
    v_mfma_f32_16x16x32_bf16 v[156:159], a[76:79], a[124:127], v[156:159]
    buffer_store_dwordx4 v[252:255], v26, s[32:35], s59 offen offset:2048 sc1
    s_add_u32 s59, s59, 4096
    s_add_u32 m0, s69, 32768
    s_nop 0
    buffer_load_dwordx4 v2, s[44:47], s68 offen offset:0 sc1 lds
    buffer_load_dwordx4 v2, s[44:47], s68 offen offset:1024 sc1 lds
    buffer_load_dwordx4 v2, s[44:47], s68 offen offset:2048 sc1 lds
    buffer_load_dwordx4 v2, s[44:47], s68 offen offset:3072 sc1 lds
    s_add_u32 m0, m0, 4096
    s_add_u32 s68, s68, 4096
    s_nop 0
    buffer_load_dwordx4 v2, s[44:47], s68 offen offset:0 sc1 lds
    buffer_load_dwordx4 v2, s[44:47], s68 offen offset:1024 sc1 lds
    buffer_load_dwordx4 v2, s[44:47], s68 offen offset:2048 sc1 lds
    buffer_load_dwordx4 v2, s[44:47], s68 offen offset:3072 sc1 lds
    s_add_u32 s68, s68, 28672
    v_max_f32 v32, 0, v32
    v_max_f32 v33, 0, v33
    v_max_f32 v34, 0, v34
    v_max_f32 v35, 0, v35
    v_max_f32 v64, 0, v64
    v_max_f32 v65, 0, v65
    v_max_f32 v66, 0, v66
    v_max_f32 v67, 0, v67
    v_pk_mul_f32 v[32:33], v[32:33], v[96:97]
    v_pk_mul_f32 v[34:35], v[34:35], v[98:99]
    v_pk_mul_f32 v[64:65], v[64:65], v[128:129]
    v_pk_mul_f32 v[66:67], v[66:67], v[130:131]
    v_cvt_pk_bf16_f32 v160, v32, v33
    v_cvt_pk_bf16_f32 v161, v34, v35
    v_cvt_pk_bf16_f32 v162, v64, v65
    v_cvt_pk_bf16_f32 v163, v66, v67
    v_max_f32 v36, 0, v36
    v_max_f32 v37, 0, v37
    v_max_f32 v38, 0, v38
    v_max_f32 v39, 0, v39
    v_max_f32 v68, 0, v68
    v_max_f32 v69, 0, v69
    v_max_f32 v70, 0, v70
    v_max_f32 v71, 0, v71
    v_pk_mul_f32 v[36:37], v[36:37], v[100:101]
    v_pk_mul_f32 v[38:39], v[38:39], v[102:103]
    v_pk_mul_f32 v[68:69], v[68:69], v[132:133]
    v_pk_mul_f32 v[70:71], v[70:71], v[134:135]
    v_cvt_pk_bf16_f32 v164, v36, v37
    v_cvt_pk_bf16_f32 v165, v38, v39
    v_cvt_pk_bf16_f32 v166, v68, v69
    v_cvt_pk_bf16_f32 v167, v70, v71
    v_max_f32 v40, 0, v40
    v_max_f32 v41, 0, v41
    v_max_f32 v42, 0, v42
    v_max_f32 v43, 0, v43
    v_max_f32 v72, 0, v72
    v_max_f32 v73, 0, v73
    v_max_f32 v74, 0, v74
    v_max_f32 v75, 0, v75
    v_pk_mul_f32 v[40:41], v[40:41], v[104:105]
    v_pk_mul_f32 v[42:43], v[42:43], v[106:107]
    v_pk_mul_f32 v[72:73], v[72:73], v[136:137]
    v_pk_mul_f32 v[74:75], v[74:75], v[138:139]
    v_cvt_pk_bf16_f32 v168, v40, v41
    v_cvt_pk_bf16_f32 v169, v42, v43
    v_cvt_pk_bf16_f32 v170, v72, v73
    v_cvt_pk_bf16_f32 v171, v74, v75
    v_max_f32 v44, 0, v44
    v_max_f32 v45, 0, v45
    v_max_f32 v46, 0, v46
    v_max_f32 v47, 0, v47
    v_max_f32 v76, 0, v76
    v_max_f32 v77, 0, v77
    v_max_f32 v78, 0, v78
    v_max_f32 v79, 0, v79
    v_pk_mul_f32 v[44:45], v[44:45], v[108:109]
    v_pk_mul_f32 v[46:47], v[46:47], v[110:111]
    v_pk_mul_f32 v[76:77], v[76:77], v[140:141]
    v_pk_mul_f32 v[78:79], v[78:79], v[142:143]
    v_cvt_pk_bf16_f32 v172, v44, v45
    v_cvt_pk_bf16_f32 v173, v46, v47
    v_cvt_pk_bf16_f32 v174, v76, v77
    v_cvt_pk_bf16_f32 v175, v78, v79
    v_max_f32 v48, 0, v48
    v_max_f32 v49, 0, v49
    v_max_f32 v50, 0, v50
    v_max_f32 v51, 0, v51
    v_max_f32 v80, 0, v80
    v_max_f32 v81, 0, v81
    v_max_f32 v82, 0, v82
    v_max_f32 v83, 0, v83
    v_pk_mul_f32 v[48:49], v[48:49], v[112:113]
    v_pk_mul_f32 v[50:51], v[50:51], v[114:115]
    v_pk_mul_f32 v[80:81], v[80:81], v[144:145]
    v_pk_mul_f32 v[82:83], v[82:83], v[146:147]
    v_cvt_pk_bf16_f32 v176, v48, v49
    v_cvt_pk_bf16_f32 v177, v50, v51
    v_cvt_pk_bf16_f32 v178, v80, v81
    v_cvt_pk_bf16_f32 v179, v82, v83
    v_max_f32 v52, 0, v52
    v_max_f32 v53, 0, v53
    v_max_f32 v54, 0, v54
    v_max_f32 v55, 0, v55
    v_max_f32 v84, 0, v84
    v_max_f32 v85, 0, v85
    v_max_f32 v86, 0, v86
    v_max_f32 v87, 0, v87
    v_pk_mul_f32 v[52:53], v[52:53], v[116:117]
    v_pk_mul_f32 v[54:55], v[54:55], v[118:119]
    v_pk_mul_f32 v[84:85], v[84:85], v[148:149]
    v_pk_mul_f32 v[86:87], v[86:87], v[150:151]
    v_cvt_pk_bf16_f32 v180, v52, v53
    v_cvt_pk_bf16_f32 v181, v54, v55
    v_cvt_pk_bf16_f32 v182, v84, v85
    v_cvt_pk_bf16_f32 v183, v86, v87
    v_max_f32 v56, 0, v56
    v_max_f32 v57, 0, v57
    v_max_f32 v58, 0, v58
    v_max_f32 v59, 0, v59
    v_max_f32 v88, 0, v88
    v_max_f32 v89, 0, v89
    v_max_f32 v90, 0, v90
    v_max_f32 v91, 0, v91
    v_pk_mul_f32 v[56:57], v[56:57], v[120:121]
    v_pk_mul_f32 v[58:59], v[58:59], v[122:123]
    v_pk_mul_f32 v[88:89], v[88:89], v[152:153]
    v_pk_mul_f32 v[90:91], v[90:91], v[154:155]
    v_cvt_pk_bf16_f32 v184, v56, v57
    v_cvt_pk_bf16_f32 v185, v58, v59
    v_cvt_pk_bf16_f32 v186, v88, v89
    v_cvt_pk_bf16_f32 v187, v90, v91
    v_max_f32 v60, 0, v60
    v_max_f32 v61, 0, v61
    v_max_f32 v62, 0, v62
    v_max_f32 v63, 0, v63
    v_max_f32 v92, 0, v92
    v_max_f32 v93, 0, v93
    v_max_f32 v94, 0, v94
    v_max_f32 v95, 0, v95
    v_pk_mul_f32 v[60:61], v[60:61], v[124:125]
    v_pk_mul_f32 v[62:63], v[62:63], v[126:127]
    v_pk_mul_f32 v[92:93], v[92:93], v[156:157]
    v_pk_mul_f32 v[94:95], v[94:95], v[158:159]
    v_cvt_pk_bf16_f32 v188, v60, v61
    v_cvt_pk_bf16_f32 v189, v62, v63
    v_cvt_pk_bf16_f32 v190, v92, v93
    v_cvt_pk_bf16_f32 v191, v94, v95
    s_waitcnt vmcnt(8)
    s_mov_b64 exec, 1
    buffer_store_dword v24, v25, s[32:35], s14 offen sc1
    s_mov_b64 exec, -1
P1_EPID:
    v_mov_b32 v6, s57
    v_mov_b32 v5, 0
    v_bfe_u32 v8, v1, 4, 1
    v_and_b32 v9, 15, v1
    v_lshrrev_b32 v10, 5, v1
    v_lshl_add_u32 v9, v10, 4, v9
    v_lshlrev_b32 v9, 4, v9
    v_lshl_add_u32 v7, v8, 11, v9
    v_mov_b32 v68, 0
    v_mov_b32 v69, 0
    v_mov_b32 v70, 0
    v_mov_b32 v71, 0
    v_mov_b32 v72, 0
    v_mov_b32 v73, 0
    v_mov_b32 v74, 0
    v_mov_b32 v75, 0
    v_mov_b32 v76, 0
    v_mov_b32 v77, 0
    v_mov_b32 v78, 0
    v_mov_b32 v79, 0
    v_mov_b32 v80, 0
    v_mov_b32 v81, 0
    v_mov_b32 v82, 0
    v_mov_b32 v83, 0
    v_mov_b32 v100, 0
    v_mov_b32 v101, 0
    v_mov_b32 v102, 0
    v_mov_b32 v103, 0
    v_mov_b32 v84, 0
    v_mov_b32 v85, 0
    v_mov_b32 v86, 0
    v_mov_b32 v87, 0
    v_mov_b32 v88, 0
    v_mov_b32 v89, 0
    v_mov_b32 v90, 0
    v_mov_b32 v91, 0
    v_mov_b32 v92, 0
    v_mov_b32 v93, 0
    v_mov_b32 v94, 0
    v_mov_b32 v95, 0
    v_mov_b32 v96, 0
    v_mov_b32 v97, 0
    v_mov_b32 v98, 0
    v_mov_b32 v99, 0
    v_mov_b32 v104, 0
    v_mov_b32 v105, 0
    v_mov_b32 v106, 0
    v_mov_b32 v107, 0
    v_mov_b32 v60, 0
    v_mov_b32 v61, 0
    v_mov_b32 v62, 0
    v_mov_b32 v63, 0
    v_mov_b32 v64, 0
    v_mov_b32 v65, 0
    v_mov_b32 v66, 0
    v_mov_b32 v67, 0
    v_accvgpr_write_b32 a168, 0
    v_accvgpr_write_b32 a169, 0
    v_accvgpr_write_b32 a170, 0
    v_accvgpr_write_b32 a171, 0
    v_accvgpr_write_b32 a172, 0
    v_accvgpr_write_b32 a173, 0
    v_accvgpr_write_b32 a174, 0
    v_accvgpr_write_b32 a175, 0
    v_bfe_u32 v12, v1, 2, 1
    v_cmp_eq_u32 vcc, 0, v12
    v_mov_b32 v13, 0x3f803f80
    v_mov_b32 v3, v2
    v_cndmask_b32 v12, 0, v13, vcc
    v_xor_b32 v13, v13, v12
    v_add_u32 v4, 32768, v2
    v_and_b32 v18, 1, v1
    v_mul_u32_u24 v18, 0xaaaa, v18
    v_add_u32 v18, 0x4444, v18
    v_cmp_lt_u32 vcc, 23, v1
    v_add_u32 v17, 128, v2
    s_nop 0
    v_cndmask_b32 v17, v2, v17, vcc
    v_accvgpr_write_b32 a176, v12
    v_accvgpr_write_b32 a177, v12
    v_accvgpr_write_b32 a178, v13
    v_accvgpr_write_b32 a179, v13
    s_mov_b32 s65, 0
    s_mov_b32 s66, 32768
    s_mov_b32 s67, 65536
    s_add_u32 s79, s69, 65536
    s_lshl_b32 s70, s63, 2
    s_add_u32 s70, s70, s56
    s_lshl_b32 s70, s70, 6
    s_add_u32 s70, s70, s64
    s_lshl_b32 s70, s70, 2
    s_add_u32 s70, s70, 23527424
    s_lshl_b32 s59, s63, 3
    s_lshr_b32 s60, s64, 2
    s_add_u32 s59, s59, s60
    s_lshl_b32 s59, s59, 2
    s_and_b32 s60, s56, 2
    s_add_u32 s59, s59, s60
    s_bfe_u32 s60, s64, 0x10001
    s_add_u32 s59, s59, s60
    s_lshl_b32 s59, s59, 8
    s_add_u32 s59, s59, 23461888
    s_lshl_b32 s14, s63, 5
    s_add_u32 s14, s14, s64
    s_lshl_b32 s14, s14, 2
    s_add_u32 s14, s14, s56
    s_lshl_b32 s14, s14, 13
    s_add_u32 s14, s14, 72351744
    s_add_u32 s61, s14, 4096
    v_and_b32 v10, 40, v1
    v_cmp_eq_u32 vcc, 40, v10
    v_add_u32 v11, 128, v7
    s_nop 0
    v_cndmask_b32 v10, v7, v11, vcc
    s_mov_b32 s58, 1048576
P2_POLL_L:
    buffer_load_dword v16, v5, s[32:35], s59 offen sc1
    s_waitcnt vmcnt(0)
    v_cmp_eq_u32 vcc, s57, v16
    s_nop 0
    s_cmp_eq_u64 vcc, -1
    s_cbranch_scc1 P2_POLL_OK
    s_sleep 1
    s_sub_u32 s58, s58, 1
    s_cmp_lg_u32 s58, 0
    s_cbranch_scc1 P2_POLL_L
    s_endpgm
P2_POLL_OK:
    buffer_load_dwordx4 a[128:131], v10, s[32:35], s14 offen offset:0 sc1
    buffer_load_dwordx4 a[132:135], v11, s[32:35], s14 offen offset:512 sc1
    buffer_load_dwordx4 a[136:139], v10, s[32:35], s61 offen offset:0 sc1
    buffer_load_dwordx4 a[140:143], v11, s[32:35], s61 offen offset:512 sc1
    s_barrier
    ds_read_b128 a[144:147], v3
    ds_read_b128 a[148:151], v3 offset:1024
    ds_read_b128 a[160:163], v3 offset:2048
    ds_read_b128 a[164:167], v3 offset:3072
    s_waitcnt vmcnt(0) lgkmcnt(0)
    v_mfma_f32_32x32x16_bf16 v[20:35], a[144:147], a[128:131], 0
    v_mfma_f32_32x32x16_bf16 v[20:35], a[148:151], a[132:135], v[20:35]
    s_nop 7
    s_nop 3
    s_mov_b32 s62, 0
    v_mfma_f32_32x32x16_bf16 v[84:99], a[168:171], v[60:63], v[84:99]
    s_waitcnt lgkmcnt(0)
    buffer_store_dwordx4 v[160:163], v17, s[32:35], s0 offen offset:0 sc1
    v_exp_f32 v20, v20
    v_exp_f32 v21, v21
    v_exp_f32 v22, v22
    v_exp_f32 v23, v23
    v_mfma_f32_32x32x16_bf16 v[36:51], a[144:147], a[136:139], 0
    ds_read_b128 a[152:155], v3 offset:4096
    v_cvt_pk_bf16_f32 v52, v20, v21
    v_exp_f32 v24, v24
    v_exp_f32 v25, v25
    v_cvt_pk_bf16_f32 v53, v22, v23
    v_exp_f32 v26, v26
    v_mfma_f32_32x32x16_bf16 v[36:51], a[148:151], a[140:143], v[36:51]
    ds_read_b128 a[156:159], v3 offset:5120
    v_exp_f32 v27, v27
    v_cvt_pk_bf16_f32 v54, v24, v25
    v_exp_f32 v28, v28
    v_exp_f32 v29, v29
    v_cvt_pk_bf16_f32 v55, v26, v27
    v_smfmac_f32_16x16x64_bf16 v[104:107], a[176:179], v[60:67], v18
    s_mov_b32 m0, s79
    v_exp_f32 v30, v30
    v_exp_f32 v31, v31
    v_cvt_pk_bf16_f32 v56, v28, v29
    v_exp_f32 v32, v32
    v_mfma_f32_32x32x16_bf16 v[84:99], a[172:175], v[64:67], v[84:99]
    buffer_load_dwordx4 v2, s[44:47], s68 offen offset:0 sc1 lds
    v_exp_f32 v33, v33
    v_cvt_pk_bf16_f32 v57, v30, v31
    v_exp_f32 v34, v34
    v_exp_f32 v35, v35
    v_cvt_pk_bf16_f32 v58, v32, v33
    v_cvt_pk_bf16_f32 v59, v34, v35
    v_mfma_f32_32x32x16_bf16 v[68:83], a[160:163], v[52:55], v[68:83]
    s_waitcnt lgkmcnt(0)
    v_exp_f32 v36, v36
    v_exp_f32 v37, v37
    v_exp_f32 v38, v38
    v_exp_f32 v39, v39
    v_mfma_f32_32x32x16_bf16 v[20:35], a[152:155], a[128:131], 0
    ds_read_b128 a[168:171], v3 offset:6144
    v_cvt_pk_bf16_f32 v60, v36, v37
    v_exp_f32 v40, v40
    v_exp_f32 v41, v41
    v_cvt_pk_bf16_f32 v61, v38, v39
    v_exp_f32 v42, v42
    v_mfma_f32_32x32x16_bf16 v[20:35], a[156:159], a[132:135], v[20:35]
    ds_read_b128 a[172:175], v3 offset:7168
    v_exp_f32 v43, v43
    v_cvt_pk_bf16_f32 v62, v40, v41
    v_exp_f32 v44, v44
    v_exp_f32 v45, v45
    v_cvt_pk_bf16_f32 v63, v42, v43
    v_smfmac_f32_16x16x64_bf16 v[100:103], a[176:179], v[52:59], v18
    s_mov_b32 m0, s79
    v_exp_f32 v46, v46
    v_exp_f32 v47, v47
    v_cvt_pk_bf16_f32 v64, v44, v45
    v_exp_f32 v48, v48
    v_mfma_f32_32x32x16_bf16 v[68:83], a[164:167], v[56:59], v[68:83]
    buffer_load_dwordx4 v2, s[44:47], s68 offen offset:1024 sc1 lds
    v_exp_f32 v49, v49
    v_cvt_pk_bf16_f32 v65, v46, v47
    v_exp_f32 v50, v50
    v_exp_f32 v51, v51
    v_cvt_pk_bf16_f32 v66, v48, v49
    v_cvt_pk_bf16_f32 v67, v50, v51
    v_mfma_f32_32x32x16_bf16 v[84:99], a[160:163], v[60:63], v[84:99]
    s_waitcnt lgkmcnt(0)
    buffer_store_dwordx4 v[164:167], v17, s[32:35], s0 offen offset:2048 sc1
    s_add_u32 s0, s0, 4096
    v_exp_f32 v20, v20
    v_exp_f32 v21, v21
    v_exp_f32 v22, v22
    v_exp_f32 v23, v23
    v_mfma_f32_32x32x16_bf16 v[36:51], a[152:155], a[136:139], 0
    ds_read_b128 a[144:147], v3 offset:8192
    v_cvt_pk_bf16_f32 v52, v20, v21
    v_exp_f32 v24, v24
    v_exp_f32 v25, v25
    v_cvt_pk_bf16_f32 v53, v22, v23
    v_exp_f32 v26, v26
    v_mfma_f32_32x32x16_bf16 v[36:51], a[156:159], a[140:143], v[36:51]
    ds_read_b128 a[148:151], v3 offset:9216
    v_exp_f32 v27, v27
    v_cvt_pk_bf16_f32 v54, v24, v25
    v_exp_f32 v28, v28
    v_exp_f32 v29, v29
    v_cvt_pk_bf16_f32 v55, v26, v27
    v_smfmac_f32_16x16x64_bf16 v[104:107], a[176:179], v[60:67], v18
    s_mov_b32 m0, s79
    v_exp_f32 v30, v30
    v_exp_f32 v31, v31
    v_cvt_pk_bf16_f32 v56, v28, v29
    v_exp_f32 v32, v32
    v_mfma_f32_32x32x16_bf16 v[84:99], a[164:167], v[64:67], v[84:99]
    buffer_load_dwordx4 v2, s[44:47], s68 offen offset:2048 sc1 lds
    v_exp_f32 v33, v33
    v_cvt_pk_bf16_f32 v57, v30, v31
    v_exp_f32 v34, v34
    v_exp_f32 v35, v35
    v_cvt_pk_bf16_f32 v58, v32, v33
    v_cvt_pk_bf16_f32 v59, v34, v35
    v_mfma_f32_32x32x16_bf16 v[68:83], a[168:171], v[52:55], v[68:83]
    s_waitcnt lgkmcnt(0)
    v_exp_f32 v36, v36
    v_exp_f32 v37, v37
    v_exp_f32 v38, v38
    v_exp_f32 v39, v39
    v_mfma_f32_32x32x16_bf16 v[20:35], a[144:147], a[128:131], 0
    ds_read_b128 a[160:163], v3 offset:10240
    v_cvt_pk_bf16_f32 v60, v36, v37
    v_exp_f32 v40, v40
    v_exp_f32 v41, v41
    v_cvt_pk_bf16_f32 v61, v38, v39
    v_exp_f32 v42, v42
    v_mfma_f32_32x32x16_bf16 v[20:35], a[148:151], a[132:135], v[20:35]
    ds_read_b128 a[164:167], v3 offset:11264
    v_exp_f32 v43, v43
    v_cvt_pk_bf16_f32 v62, v40, v41
    v_exp_f32 v44, v44
    v_exp_f32 v45, v45
    v_cvt_pk_bf16_f32 v63, v42, v43
    v_smfmac_f32_16x16x64_bf16 v[100:103], a[176:179], v[52:59], v18
    s_mov_b32 m0, s79
    v_exp_f32 v46, v46
    v_exp_f32 v47, v47
    v_cvt_pk_bf16_f32 v64, v44, v45
    v_exp_f32 v48, v48
    v_mfma_f32_32x32x16_bf16 v[68:83], a[172:175], v[56:59], v[68:83]
    buffer_load_dwordx4 v2, s[44:47], s68 offen offset:3072 sc1 lds
    v_exp_f32 v49, v49
    v_cvt_pk_bf16_f32 v65, v46, v47
    v_exp_f32 v50, v50
    v_exp_f32 v51, v51
    v_cvt_pk_bf16_f32 v66, v48, v49
    v_cvt_pk_bf16_f32 v67, v50, v51
    v_mfma_f32_32x32x16_bf16 v[84:99], a[168:171], v[60:63], v[84:99]
    s_waitcnt lgkmcnt(0)
    buffer_store_dwordx4 v[168:171], v17, s[32:35], s0 offen offset:0 sc1
    v_exp_f32 v20, v20
    v_exp_f32 v21, v21
    v_exp_f32 v22, v22
    v_exp_f32 v23, v23
    v_mfma_f32_32x32x16_bf16 v[36:51], a[144:147], a[136:139], 0
    s_add_u32 s68, s68, 4096
    ds_read_b128 a[152:155], v3 offset:12288
    v_cvt_pk_bf16_f32 v52, v20, v21
    v_exp_f32 v24, v24
    v_exp_f32 v25, v25
    v_cvt_pk_bf16_f32 v53, v22, v23
    v_exp_f32 v26, v26
    v_mfma_f32_32x32x16_bf16 v[36:51], a[148:151], a[140:143], v[36:51]
    s_add_u32 s79, s79, 4096
    ds_read_b128 a[156:159], v3 offset:13312
    v_exp_f32 v27, v27
    v_cvt_pk_bf16_f32 v54, v24, v25
    v_exp_f32 v28, v28
    v_exp_f32 v29, v29
    v_cvt_pk_bf16_f32 v55, v26, v27
    v_smfmac_f32_16x16x64_bf16 v[104:107], a[176:179], v[60:67], v18
    s_mov_b32 m0, s79
    v_exp_f32 v30, v30
    v_exp_f32 v31, v31
    v_cvt_pk_bf16_f32 v56, v28, v29
    v_exp_f32 v32, v32
    v_mfma_f32_32x32x16_bf16 v[84:99], a[172:175], v[64:67], v[84:99]
    buffer_load_dwordx4 v2, s[44:47], s68 offen offset:0 sc1 lds
    v_exp_f32 v33, v33
    v_cvt_pk_bf16_f32 v57, v30, v31
    v_exp_f32 v34, v34
    v_exp_f32 v35, v35
    v_cvt_pk_bf16_f32 v58, v32, v33
    v_cvt_pk_bf16_f32 v59, v34, v35
    v_mfma_f32_32x32x16_bf16 v[68:83], a[160:163], v[52:55], v[68:83]
    s_waitcnt lgkmcnt(0)
    v_exp_f32 v36, v36
    v_exp_f32 v37, v37
    v_exp_f32 v38, v38
    v_exp_f32 v39, v39
    v_mfma_f32_32x32x16_bf16 v[20:35], a[152:155], a[128:131], 0
    ds_read_b128 a[168:171], v3 offset:14336
    v_cvt_pk_bf16_f32 v60, v36, v37
    v_exp_f32 v40, v40
    v_exp_f32 v41, v41
    v_cvt_pk_bf16_f32 v61, v38, v39
    v_exp_f32 v42, v42
    v_mfma_f32_32x32x16_bf16 v[20:35], a[156:159], a[132:135], v[20:35]
    ds_read_b128 a[172:175], v3 offset:15360
    v_exp_f32 v43, v43
    v_cvt_pk_bf16_f32 v62, v40, v41
    v_exp_f32 v44, v44
    v_exp_f32 v45, v45
    v_cvt_pk_bf16_f32 v63, v42, v43
    v_smfmac_f32_16x16x64_bf16 v[100:103], a[176:179], v[52:59], v18
    s_mov_b32 m0, s79
    v_exp_f32 v46, v46
    v_exp_f32 v47, v47
    v_cvt_pk_bf16_f32 v64, v44, v45
    v_exp_f32 v48, v48
    v_mfma_f32_32x32x16_bf16 v[68:83], a[164:167], v[56:59], v[68:83]
    buffer_load_dwordx4 v2, s[44:47], s68 offen offset:1024 sc1 lds
    v_exp_f32 v49, v49
    v_cvt_pk_bf16_f32 v65, v46, v47
    v_exp_f32 v50, v50
    v_exp_f32 v51, v51
    v_cvt_pk_bf16_f32 v66, v48, v49
    v_cvt_pk_bf16_f32 v67, v50, v51
    v_mfma_f32_32x32x16_bf16 v[84:99], a[160:163], v[60:63], v[84:99]
    s_waitcnt lgkmcnt(0)
    buffer_store_dwordx4 v[172:175], v17, s[32:35], s0 offen offset:2048 sc1
    s_add_u32 s0, s0, 4096
    v_exp_f32 v20, v20
    v_exp_f32 v21, v21
    v_exp_f32 v22, v22
    v_exp_f32 v23, v23
    v_mfma_f32_32x32x16_bf16 v[36:51], a[152:155], a[136:139], 0
    ds_read_b128 a[144:147], v3 offset:16384
    v_cvt_pk_bf16_f32 v52, v20, v21
    v_exp_f32 v24, v24
    v_exp_f32 v25, v25
    v_cvt_pk_bf16_f32 v53, v22, v23
    v_exp_f32 v26, v26
    v_mfma_f32_32x32x16_bf16 v[36:51], a[156:159], a[140:143], v[36:51]
    ds_read_b128 a[148:151], v3 offset:17408
    v_exp_f32 v27, v27
    v_cvt_pk_bf16_f32 v54, v24, v25
    v_exp_f32 v28, v28
    v_exp_f32 v29, v29
    v_cvt_pk_bf16_f32 v55, v26, v27
    v_smfmac_f32_16x16x64_bf16 v[104:107], a[176:179], v[60:67], v18
    s_mov_b32 m0, s79
    v_exp_f32 v30, v30
    v_exp_f32 v31, v31
    v_cvt_pk_bf16_f32 v56, v28, v29
    v_exp_f32 v32, v32
    v_mfma_f32_32x32x16_bf16 v[84:99], a[164:167], v[64:67], v[84:99]
    buffer_load_dwordx4 v2, s[44:47], s68 offen offset:2048 sc1 lds
    v_exp_f32 v33, v33
    v_cvt_pk_bf16_f32 v57, v30, v31
    v_exp_f32 v34, v34
    v_exp_f32 v35, v35
    v_cvt_pk_bf16_f32 v58, v32, v33
    v_cvt_pk_bf16_f32 v59, v34, v35
    v_mfma_f32_32x32x16_bf16 v[68:83], a[168:171], v[52:55], v[68:83]
    s_waitcnt lgkmcnt(0)
    v_exp_f32 v36, v36
    v_exp_f32 v37, v37
    v_exp_f32 v38, v38
    v_exp_f32 v39, v39
    v_mfma_f32_32x32x16_bf16 v[20:35], a[144:147], a[128:131], 0
    ds_read_b128 a[160:163], v3 offset:18432
    v_cvt_pk_bf16_f32 v60, v36, v37
    v_exp_f32 v40, v40
    v_exp_f32 v41, v41
    v_cvt_pk_bf16_f32 v61, v38, v39
    v_exp_f32 v42, v42
    v_mfma_f32_32x32x16_bf16 v[20:35], a[148:151], a[132:135], v[20:35]
    ds_read_b128 a[164:167], v3 offset:19456
    v_exp_f32 v43, v43
    v_cvt_pk_bf16_f32 v62, v40, v41
    v_exp_f32 v44, v44
    v_exp_f32 v45, v45
    v_cvt_pk_bf16_f32 v63, v42, v43
    v_smfmac_f32_16x16x64_bf16 v[100:103], a[176:179], v[52:59], v18
    s_mov_b32 m0, s79
    v_exp_f32 v46, v46
    v_exp_f32 v47, v47
    v_cvt_pk_bf16_f32 v64, v44, v45
    v_exp_f32 v48, v48
    v_mfma_f32_32x32x16_bf16 v[68:83], a[172:175], v[56:59], v[68:83]
    buffer_load_dwordx4 v2, s[44:47], s68 offen offset:3072 sc1 lds
    v_exp_f32 v49, v49
    v_cvt_pk_bf16_f32 v65, v46, v47
    v_exp_f32 v50, v50
    v_exp_f32 v51, v51
    v_cvt_pk_bf16_f32 v66, v48, v49
    v_cvt_pk_bf16_f32 v67, v50, v51
    v_mfma_f32_32x32x16_bf16 v[84:99], a[168:171], v[60:63], v[84:99]
    s_waitcnt lgkmcnt(0)
    buffer_store_dwordx4 v[176:179], v17, s[32:35], s0 offen offset:0 sc1
    v_exp_f32 v20, v20
    v_exp_f32 v21, v21
    v_exp_f32 v22, v22
    v_exp_f32 v23, v23
    v_mfma_f32_32x32x16_bf16 v[36:51], a[144:147], a[136:139], 0
    s_add_u32 s68, s68, 28672
    ds_read_b128 a[152:155], v3 offset:20480
    v_cvt_pk_bf16_f32 v52, v20, v21
    v_exp_f32 v24, v24
    v_exp_f32 v25, v25
    v_cvt_pk_bf16_f32 v53, v22, v23
    v_exp_f32 v26, v26
    v_mfma_f32_32x32x16_bf16 v[36:51], a[148:151], a[140:143], v[36:51]
    ds_read_b128 a[156:159], v3 offset:21504
    v_exp_f32 v27, v27
    v_cvt_pk_bf16_f32 v54, v24, v25
    v_exp_f32 v28, v28
    v_exp_f32 v29, v29
    v_cvt_pk_bf16_f32 v55, v26, v27
    v_smfmac_f32_16x16x64_bf16 v[104:107], a[176:179], v[60:67], v18
    v_exp_f32 v30, v30
    v_exp_f32 v31, v31
    v_cvt_pk_bf16_f32 v56, v28, v29
    v_exp_f32 v32, v32
    v_mfma_f32_32x32x16_bf16 v[84:99], a[172:175], v[64:67], v[84:99]
    v_exp_f32 v33, v33
    v_cvt_pk_bf16_f32 v57, v30, v31
    v_exp_f32 v34, v34
    v_exp_f32 v35, v35
    v_cvt_pk_bf16_f32 v58, v32, v33
    v_cvt_pk_bf16_f32 v59, v34, v35
    v_mfma_f32_32x32x16_bf16 v[68:83], a[160:163], v[52:55], v[68:83]
    s_waitcnt lgkmcnt(0)
    v_exp_f32 v36, v36
    v_exp_f32 v37, v37
    v_exp_f32 v38, v38
    v_exp_f32 v39, v39
    v_mfma_f32_32x32x16_bf16 v[20:35], a[152:155], a[128:131], 0
    ds_read_b128 a[168:171], v3 offset:22528
    v_cvt_pk_bf16_f32 v60, v36, v37
    v_exp_f32 v40, v40
    v_exp_f32 v41, v41
    v_cvt_pk_bf16_f32 v61, v38, v39
    v_exp_f32 v42, v42
    v_mfma_f32_32x32x16_bf16 v[20:35], a[156:159], a[132:135], v[20:35]
    ds_read_b128 a[172:175], v3 offset:23552
    v_exp_f32 v43, v43
    v_cvt_pk_bf16_f32 v62, v40, v41
    v_exp_f32 v44, v44
    v_exp_f32 v45, v45
    v_cvt_pk_bf16_f32 v63, v42, v43
    v_smfmac_f32_16x16x64_bf16 v[100:103], a[176:179], v[52:59], v18
    v_exp_f32 v46, v46
    v_exp_f32 v47, v47
    v_cvt_pk_bf16_f32 v64, v44, v45
    v_exp_f32 v48, v48
    v_mfma_f32_32x32x16_bf16 v[68:83], a[164:167], v[56:59], v[68:83]
    global_load_dword a253, v0, s[100:101]
    v_add_u32 v0, 0x2000, v0
    v_exp_f32 v49, v49
    v_cvt_pk_bf16_f32 v65, v46, v47
    v_exp_f32 v50, v50
    v_exp_f32 v51, v51
    v_cvt_pk_bf16_f32 v66, v48, v49
    v_cvt_pk_bf16_f32 v67, v50, v51
    v_mfma_f32_32x32x16_bf16 v[84:99], a[160:163], v[60:63], v[84:99]
    s_waitcnt lgkmcnt(0)
    buffer_store_dwordx4 v[180:183], v17, s[32:35], s0 offen offset:2048 sc1
    s_add_u32 s0, s0, 4096
    v_exp_f32 v20, v20
    v_exp_f32 v21, v21
    v_exp_f32 v22, v22
    v_exp_f32 v23, v23
    v_mfma_f32_32x32x16_bf16 v[36:51], a[152:155], a[136:139], 0
    ds_read_b128 a[144:147], v3 offset:24576
    v_cvt_pk_bf16_f32 v52, v20, v21
    v_exp_f32 v24, v24
    v_exp_f32 v25, v25
    v_cvt_pk_bf16_f32 v53, v22, v23
    v_exp_f32 v26, v26
    v_mfma_f32_32x32x16_bf16 v[36:51], a[156:159], a[140:143], v[36:51]
    ds_read_b128 a[148:151], v3 offset:25600
    v_exp_f32 v27, v27
    v_cvt_pk_bf16_f32 v54, v24, v25
    v_exp_f32 v28, v28
    v_exp_f32 v29, v29
    v_cvt_pk_bf16_f32 v55, v26, v27
    v_smfmac_f32_16x16x64_bf16 v[104:107], a[176:179], v[60:67], v18
    v_exp_f32 v30, v30
    v_exp_f32 v31, v31
    v_cvt_pk_bf16_f32 v56, v28, v29
    v_exp_f32 v32, v32
    v_mfma_f32_32x32x16_bf16 v[84:99], a[164:167], v[64:67], v[84:99]
    v_exp_f32 v33, v33
    v_cvt_pk_bf16_f32 v57, v30, v31
    v_exp_f32 v34, v34
    v_exp_f32 v35, v35
    v_cvt_pk_bf16_f32 v58, v32, v33
    v_cvt_pk_bf16_f32 v59, v34, v35
    v_mfma_f32_32x32x16_bf16 v[68:83], a[168:171], v[52:55], v[68:83]
    s_waitcnt lgkmcnt(0)
    v_exp_f32 v36, v36
    v_exp_f32 v37, v37
    v_exp_f32 v38, v38
    v_exp_f32 v39, v39
    v_mfma_f32_32x32x16_bf16 v[20:35], a[144:147], a[128:131], 0
    ds_read_b128 a[160:163], v3 offset:26624
    v_cvt_pk_bf16_f32 v60, v36, v37
    v_exp_f32 v40, v40
    v_exp_f32 v41, v41
    v_cvt_pk_bf16_f32 v61, v38, v39
    v_exp_f32 v42, v42
    v_mfma_f32_32x32x16_bf16 v[20:35], a[148:151], a[132:135], v[20:35]
    ds_read_b128 a[164:167], v3 offset:27648
    v_exp_f32 v43, v43
    v_cvt_pk_bf16_f32 v62, v40, v41
    v_exp_f32 v44, v44
    v_exp_f32 v45, v45
    v_cvt_pk_bf16_f32 v63, v42, v43
    v_smfmac_f32_16x16x64_bf16 v[100:103], a[176:179], v[52:59], v18
    v_exp_f32 v46, v46
    v_exp_f32 v47, v47
    v_cvt_pk_bf16_f32 v64, v44, v45
    v_exp_f32 v48, v48
    v_mfma_f32_32x32x16_bf16 v[68:83], a[172:175], v[56:59], v[68:83]
    v_exp_f32 v49, v49
    v_cvt_pk_bf16_f32 v65, v46, v47
    v_exp_f32 v50, v50
    v_exp_f32 v51, v51
    v_cvt_pk_bf16_f32 v66, v48, v49
    v_cvt_pk_bf16_f32 v67, v50, v51
    v_mfma_f32_32x32x16_bf16 v[84:99], a[168:171], v[60:63], v[84:99]
    s_waitcnt lgkmcnt(0)
    buffer_store_dwordx4 v[184:187], v17, s[32:35], s0 offen offset:0 sc1
    v_exp_f32 v20, v20
    v_exp_f32 v21, v21
    v_exp_f32 v22, v22
    v_exp_f32 v23, v23
    v_mfma_f32_32x32x16_bf16 v[36:51], a[144:147], a[136:139], 0
    ds_read_b128 a[152:155], v3 offset:28672
    v_cvt_pk_bf16_f32 v52, v20, v21
    v_exp_f32 v24, v24
    v_exp_f32 v25, v25
    v_cvt_pk_bf16_f32 v53, v22, v23
    v_exp_f32 v26, v26
    v_mfma_f32_32x32x16_bf16 v[36:51], a[148:151], a[140:143], v[36:51]
    ds_read_b128 a[156:159], v3 offset:29696
    v_exp_f32 v27, v27
    v_cvt_pk_bf16_f32 v54, v24, v25
    v_exp_f32 v28, v28
    v_exp_f32 v29, v29
    v_cvt_pk_bf16_f32 v55, v26, v27
    v_smfmac_f32_16x16x64_bf16 v[104:107], a[176:179], v[60:67], v18
    v_exp_f32 v30, v30
    v_exp_f32 v31, v31
    v_cvt_pk_bf16_f32 v56, v28, v29
    v_exp_f32 v32, v32
    v_mfma_f32_32x32x16_bf16 v[84:99], a[172:175], v[64:67], v[84:99]
    v_exp_f32 v33, v33
    v_cvt_pk_bf16_f32 v57, v30, v31
    v_exp_f32 v34, v34
    v_exp_f32 v35, v35
    v_cvt_pk_bf16_f32 v58, v32, v33
    v_cvt_pk_bf16_f32 v59, v34, v35
    v_mfma_f32_32x32x16_bf16 v[68:83], a[160:163], v[52:55], v[68:83]
    s_waitcnt lgkmcnt(0)
    v_exp_f32 v36, v36
    v_exp_f32 v37, v37
    v_exp_f32 v38, v38
    v_exp_f32 v39, v39
    v_mfma_f32_32x32x16_bf16 v[20:35], a[152:155], a[128:131], 0
    ds_read_b128 a[168:171], v3 offset:30720
    v_cvt_pk_bf16_f32 v60, v36, v37
    v_exp_f32 v40, v40
    v_exp_f32 v41, v41
    v_cvt_pk_bf16_f32 v61, v38, v39
    v_exp_f32 v42, v42
    v_mfma_f32_32x32x16_bf16 v[20:35], a[156:159], a[132:135], v[20:35]
    ds_read_b128 a[172:175], v3 offset:31744
    v_exp_f32 v43, v43
    v_cvt_pk_bf16_f32 v62, v40, v41
    v_exp_f32 v44, v44
    v_exp_f32 v45, v45
    v_cvt_pk_bf16_f32 v63, v42, v43
    v_smfmac_f32_16x16x64_bf16 v[100:103], a[176:179], v[52:59], v18
    v_exp_f32 v46, v46
    v_exp_f32 v47, v47
    v_cvt_pk_bf16_f32 v64, v44, v45
    v_exp_f32 v48, v48
    v_mfma_f32_32x32x16_bf16 v[68:83], a[164:167], v[56:59], v[68:83]
    v_exp_f32 v49, v49
    v_cvt_pk_bf16_f32 v65, v46, v47
    v_exp_f32 v50, v50
    v_exp_f32 v51, v51
    v_cvt_pk_bf16_f32 v66, v48, v49
    v_cvt_pk_bf16_f32 v67, v50, v51
    v_mfma_f32_32x32x16_bf16 v[84:99], a[160:163], v[60:63], v[84:99]
    s_waitcnt vmcnt(21) lgkmcnt(0)
    s_barrier
    buffer_store_dwordx4 v[188:191], v17, s[32:35], s0 offen offset:2048 sc1
    s_add_u32 s0, s0, 4096
    v_exp_f32 v20, v20
    v_exp_f32 v21, v21
    v_exp_f32 v22, v22
    v_exp_f32 v23, v23
    v_mfma_f32_32x32x16_bf16 v[36:51], a[152:155], a[136:139], 0
    ds_read_b128 a[144:147], v4 offset:0
    v_cvt_pk_bf16_f32 v52, v20, v21
    v_exp_f32 v24, v24
    v_exp_f32 v25, v25
    v_cvt_pk_bf16_f32 v53, v22, v23
    v_exp_f32 v26, v26
    v_mfma_f32_32x32x16_bf16 v[36:51], a[156:159], a[140:143], v[36:51]
    ds_read_b128 a[148:151], v4 offset:1024
    v_exp_f32 v27, v27
    v_cvt_pk_bf16_f32 v54, v24, v25
    v_exp_f32 v28, v28
    v_exp_f32 v29, v29
    v_cvt_pk_bf16_f32 v55, v26, v27
    v_smfmac_f32_16x16x64_bf16 v[104:107], a[176:179], v[60:67], v18
    s_mov_b32 s58, s65
    v_exp_f32 v30, v30
    v_exp_f32 v31, v31
    v_cvt_pk_bf16_f32 v56, v28, v29
    v_exp_f32 v32, v32
    v_mfma_f32_32x32x16_bf16 v[84:99], a[164:167], v[64:67], v[84:99]
    s_mov_b32 s65, s66
    v_exp_f32 v33, v33
    v_cvt_pk_bf16_f32 v57, v30, v31
    v_exp_f32 v34, v34
    v_exp_f32 v35, v35
    v_cvt_pk_bf16_f32 v58, v32, v33
    v_cvt_pk_bf16_f32 v59, v34, v35
    v_mfma_f32_32x32x16_bf16 v[68:83], a[168:171], v[52:55], v[68:83]
    s_waitcnt lgkmcnt(0)
    v_exp_f32 v36, v36
    v_exp_f32 v37, v37
    v_exp_f32 v38, v38
    v_exp_f32 v39, v39
    v_mfma_f32_32x32x16_bf16 v[20:35], a[144:147], a[128:131], 0
    s_mov_b32 s66, s67
    ds_read_b128 a[160:163], v4 offset:2048
    v_cvt_pk_bf16_f32 v60, v36, v37
    v_exp_f32 v40, v40
    v_exp_f32 v41, v41
    v_cvt_pk_bf16_f32 v61, v38, v39
    v_exp_f32 v42, v42
    v_mfma_f32_32x32x16_bf16 v[20:35], a[148:151], a[132:135], v[20:35]
    s_mov_b32 s67, s58
    ds_read_b128 a[164:167], v4 offset:3072
    v_exp_f32 v43, v43
    v_cvt_pk_bf16_f32 v62, v40, v41
    v_exp_f32 v44, v44
    v_exp_f32 v45, v45
    v_cvt_pk_bf16_f32 v63, v42, v43
    v_smfmac_f32_16x16x64_bf16 v[100:103], a[176:179], v[52:59], v18
    s_add_u32 s79, s58, s69
    v_exp_f32 v46, v46
    v_exp_f32 v47, v47
    v_cvt_pk_bf16_f32 v64, v44, v45
    v_exp_f32 v48, v48
    v_mfma_f32_32x32x16_bf16 v[68:83], a[172:175], v[56:59], v[68:83]
    s_add_u32 s62, s62, 1
    v_exp_f32 v49, v49
    v_cvt_pk_bf16_f32 v65, v46, v47
    v_exp_f32 v50, v50
    v_exp_f32 v51, v51
    v_cvt_pk_bf16_f32 v66, v48, v49
    v_cvt_pk_bf16_f32 v67, v50, v51
    v_add_u32 v3, s65, v2
    v_add_u32 v4, s66, v2
    v_mfma_f32_32x32x16_bf16 v[84:99], a[168:171], v[60:63], v[84:99]
    s_waitcnt lgkmcnt(0)
    buffer_store_dwordx4 v[192:195], v17, s[32:35], s3 offen offset:0 sc1
    v_exp_f32 v20, v20
    v_exp_f32 v21, v21
    v_exp_f32 v22, v22
    v_exp_f32 v23, v23
    v_mfma_f32_32x32x16_bf16 v[36:51], a[144:147], a[136:139], 0
    ds_read_b128 a[152:155], v3 offset:4096
    v_cvt_pk_bf16_f32 v52, v20, v21
    v_exp_f32 v24, v24
    v_exp_f32 v25, v25
    v_cvt_pk_bf16_f32 v53, v22, v23
    v_exp_f32 v26, v26
    v_mfma_f32_32x32x16_bf16 v[36:51], a[148:151], a[140:143], v[36:51]
    ds_read_b128 a[156:159], v3 offset:5120
    v_exp_f32 v27, v27
    v_cvt_pk_bf16_f32 v54, v24, v25
    v_exp_f32 v28, v28
    v_exp_f32 v29, v29
    v_cvt_pk_bf16_f32 v55, v26, v27
    v_smfmac_f32_16x16x64_bf16 v[104:107], a[176:179], v[60:67], v18
    s_mov_b32 m0, s79
    v_exp_f32 v30, v30
    v_exp_f32 v31, v31
    v_cvt_pk_bf16_f32 v56, v28, v29
    v_exp_f32 v32, v32
    v_mfma_f32_32x32x16_bf16 v[84:99], a[172:175], v[64:67], v[84:99]
    buffer_load_dwordx4 v2, s[44:47], s68 offen offset:0 sc1 lds
    v_exp_f32 v33, v33
    v_cvt_pk_bf16_f32 v57, v30, v31
    v_exp_f32 v34, v34
    v_exp_f32 v35, v35
    v_cvt_pk_bf16_f32 v58, v32, v33
    v_cvt_pk_bf16_f32 v59, v34, v35
    v_mfma_f32_32x32x16_bf16 v[68:83], a[160:163], v[52:55], v[68:83]
    s_waitcnt lgkmcnt(0)
    v_exp_f32 v36, v36
    v_exp_f32 v37, v37
    v_exp_f32 v38, v38
    v_exp_f32 v39, v39
    v_mfma_f32_32x32x16_bf16 v[20:35], a[152:155], a[128:131], 0
    ds_read_b128 a[168:171], v3 offset:6144
    v_cvt_pk_bf16_f32 v60, v36, v37
    v_exp_f32 v40, v40
    v_exp_f32 v41, v41
    v_cvt_pk_bf16_f32 v61, v38, v39
    v_exp_f32 v42, v42
    v_mfma_f32_32x32x16_bf16 v[20:35], a[156:159], a[132:135], v[20:35]
    ds_read_b128 a[172:175], v3 offset:7168
    v_exp_f32 v43, v43
    v_cvt_pk_bf16_f32 v62, v40, v41
    v_exp_f32 v44, v44
    v_exp_f32 v45, v45
    v_cvt_pk_bf16_f32 v63, v42, v43
    v_smfmac_f32_16x16x64_bf16 v[100:103], a[176:179], v[52:59], v18
    s_mov_b32 m0, s79
    v_exp_f32 v46, v46
    v_exp_f32 v47, v47
    v_cvt_pk_bf16_f32 v64, v44, v45
    v_exp_f32 v48, v48
    v_mfma_f32_32x32x16_bf16 v[68:83], a[164:167], v[56:59], v[68:83]
    buffer_load_dwordx4 v2, s[44:47], s68 offen offset:1024 sc1 lds
    v_exp_f32 v49, v49
    v_cvt_pk_bf16_f32 v65, v46, v47
    v_exp_f32 v50, v50
    v_exp_f32 v51, v51
    v_cvt_pk_bf16_f32 v66, v48, v49
    v_cvt_pk_bf16_f32 v67, v50, v51
    v_mfma_f32_32x32x16_bf16 v[84:99], a[160:163], v[60:63], v[84:99]
    s_waitcnt lgkmcnt(0)
    buffer_store_dwordx4 v[196:199], v17, s[32:35], s3 offen offset:2048 sc1
    s_add_u32 s3, s3, 4096
    v_exp_f32 v20, v20
    v_exp_f32 v21, v21
    v_exp_f32 v22, v22
    v_exp_f32 v23, v23
    v_mfma_f32_32x32x16_bf16 v[36:51], a[152:155], a[136:139], 0
    ds_read_b128 a[144:147], v3 offset:8192
    v_cvt_pk_bf16_f32 v52, v20, v21
    v_exp_f32 v24, v24
    v_exp_f32 v25, v25
    v_cvt_pk_bf16_f32 v53, v22, v23
    v_exp_f32 v26, v26
    v_mfma_f32_32x32x16_bf16 v[36:51], a[156:159], a[140:143], v[36:51]
    ds_read_b128 a[148:151], v3 offset:9216
    v_exp_f32 v27, v27
    v_cvt_pk_bf16_f32 v54, v24, v25
    v_exp_f32 v28, v28
    v_exp_f32 v29, v29
    v_cvt_pk_bf16_f32 v55, v26, v27
    v_smfmac_f32_16x16x64_bf16 v[104:107], a[176:179], v[60:67], v18
    s_mov_b32 m0, s79
    v_exp_f32 v30, v30
    v_exp_f32 v31, v31
    v_cvt_pk_bf16_f32 v56, v28, v29
    v_exp_f32 v32, v32
    v_mfma_f32_32x32x16_bf16 v[84:99], a[164:167], v[64:67], v[84:99]
    buffer_load_dwordx4 v2, s[44:47], s68 offen offset:2048 sc1 lds
    v_exp_f32 v33, v33
    v_cvt_pk_bf16_f32 v57, v30, v31
    v_exp_f32 v34, v34
    v_exp_f32 v35, v35
    v_cvt_pk_bf16_f32 v58, v32, v33
    v_cvt_pk_bf16_f32 v59, v34, v35
    v_mfma_f32_32x32x16_bf16 v[68:83], a[168:171], v[52:55], v[68:83]
    s_waitcnt lgkmcnt(0)
    v_exp_f32 v36, v36
    v_exp_f32 v37, v37
    v_exp_f32 v38, v38
    v_exp_f32 v39, v39
    v_mfma_f32_32x32x16_bf16 v[20:35], a[144:147], a[128:131], 0
    ds_read_b128 a[160:163], v3 offset:10240
    v_cvt_pk_bf16_f32 v60, v36, v37
    v_exp_f32 v40, v40
    v_exp_f32 v41, v41
    v_cvt_pk_bf16_f32 v61, v38, v39
    v_exp_f32 v42, v42
    v_mfma_f32_32x32x16_bf16 v[20:35], a[148:151], a[132:135], v[20:35]
    ds_read_b128 a[164:167], v3 offset:11264
    v_exp_f32 v43, v43
    v_cvt_pk_bf16_f32 v62, v40, v41
    v_exp_f32 v44, v44
    v_exp_f32 v45, v45
    v_cvt_pk_bf16_f32 v63, v42, v43
    v_smfmac_f32_16x16x64_bf16 v[100:103], a[176:179], v[52:59], v18
    s_mov_b32 m0, s79
    v_exp_f32 v46, v46
    v_exp_f32 v47, v47
    v_cvt_pk_bf16_f32 v64, v44, v45
    v_exp_f32 v48, v48
    v_mfma_f32_32x32x16_bf16 v[68:83], a[172:175], v[56:59], v[68:83]
    buffer_load_dwordx4 v2, s[44:47], s68 offen offset:3072 sc1 lds
    v_exp_f32 v49, v49
    v_cvt_pk_bf16_f32 v65, v46, v47
    v_exp_f32 v50, v50
    v_exp_f32 v51, v51
    v_cvt_pk_bf16_f32 v66, v48, v49
    v_cvt_pk_bf16_f32 v67, v50, v51
    v_mfma_f32_32x32x16_bf16 v[84:99], a[168:171], v[60:63], v[84:99]
    s_waitcnt lgkmcnt(0)
    buffer_store_dwordx4 v[200:203], v17, s[32:35], s3 offen offset:0 sc1
    v_exp_f32 v20, v20
    v_exp_f32 v21, v21
    v_exp_f32 v22, v22
    v_exp_f32 v23, v23
    v_mfma_f32_32x32x16_bf16 v[36:51], a[144:147], a[136:139], 0
    s_add_u32 s68, s68, 4096
    ds_read_b128 a[152:155], v3 offset:12288
    v_cvt_pk_bf16_f32 v52, v20, v21
    v_exp_f32 v24, v24
    v_exp_f32 v25, v25
    v_cvt_pk_bf16_f32 v53, v22, v23
    v_exp_f32 v26, v26
    v_mfma_f32_32x32x16_bf16 v[36:51], a[148:151], a[140:143], v[36:51]
    s_add_u32 s79, s79, 4096
    ds_read_b128 a[156:159], v3 offset:13312
    v_exp_f32 v27, v27
    v_cvt_pk_bf16_f32 v54, v24, v25
    v_exp_f32 v28, v28
    v_exp_f32 v29, v29
    v_cvt_pk_bf16_f32 v55, v26, v27
    v_smfmac_f32_16x16x64_bf16 v[104:107], a[176:179], v[60:67], v18
    s_mov_b32 m0, s79
    v_exp_f32 v30, v30
    v_exp_f32 v31, v31
    v_cvt_pk_bf16_f32 v56, v28, v29
    v_exp_f32 v32, v32
    v_mfma_f32_32x32x16_bf16 v[84:99], a[172:175], v[64:67], v[84:99]
    buffer_load_dwordx4 v2, s[44:47], s68 offen offset:0 sc1 lds
    v_exp_f32 v33, v33
    v_cvt_pk_bf16_f32 v57, v30, v31
    v_exp_f32 v34, v34
    v_exp_f32 v35, v35
    v_cvt_pk_bf16_f32 v58, v32, v33
    v_cvt_pk_bf16_f32 v59, v34, v35
    v_mfma_f32_32x32x16_bf16 v[68:83], a[160:163], v[52:55], v[68:83]
    s_waitcnt lgkmcnt(0)
    v_exp_f32 v36, v36
    v_exp_f32 v37, v37
    v_exp_f32 v38, v38
    v_exp_f32 v39, v39
    v_mfma_f32_32x32x16_bf16 v[20:35], a[152:155], a[128:131], 0
    ds_read_b128 a[168:171], v3 offset:14336
    v_cvt_pk_bf16_f32 v60, v36, v37
    v_exp_f32 v40, v40
    v_exp_f32 v41, v41
    v_cvt_pk_bf16_f32 v61, v38, v39
    v_exp_f32 v42, v42
    v_mfma_f32_32x32x16_bf16 v[20:35], a[156:159], a[132:135], v[20:35]
    ds_read_b128 a[172:175], v3 offset:15360
    v_exp_f32 v43, v43
    v_cvt_pk_bf16_f32 v62, v40, v41
    v_exp_f32 v44, v44
    v_exp_f32 v45, v45
    v_cvt_pk_bf16_f32 v63, v42, v43
    v_smfmac_f32_16x16x64_bf16 v[100:103], a[176:179], v[52:59], v18
    s_mov_b32 m0, s79
    v_exp_f32 v46, v46
    v_exp_f32 v47, v47
    v_cvt_pk_bf16_f32 v64, v44, v45
    v_exp_f32 v48, v48
    v_mfma_f32_32x32x16_bf16 v[68:83], a[164:167], v[56:59], v[68:83]
    buffer_load_dwordx4 v2, s[44:47], s68 offen offset:1024 sc1 lds
    v_exp_f32 v49, v49
    v_cvt_pk_bf16_f32 v65, v46, v47
    v_exp_f32 v50, v50
    v_exp_f32 v51, v51
    v_cvt_pk_bf16_f32 v66, v48, v49
    v_cvt_pk_bf16_f32 v67, v50, v51
    v_mfma_f32_32x32x16_bf16 v[84:99], a[160:163], v[60:63], v[84:99]
    s_waitcnt lgkmcnt(0)
    buffer_store_dwordx4 v[204:207], v17, s[32:35], s3 offen offset:2048 sc1
    s_add_u32 s3, s3, 4096
    v_exp_f32 v20, v20
    v_exp_f32 v21, v21
    v_exp_f32 v22, v22
    v_exp_f32 v23, v23
    v_mfma_f32_32x32x16_bf16 v[36:51], a[152:155], a[136:139], 0
    ds_read_b128 a[144:147], v3 offset:16384
    v_cvt_pk_bf16_f32 v52, v20, v21
    v_exp_f32 v24, v24
    v_exp_f32 v25, v25
    v_cvt_pk_bf16_f32 v53, v22, v23
    v_exp_f32 v26, v26
    v_mfma_f32_32x32x16_bf16 v[36:51], a[156:159], a[140:143], v[36:51]
    ds_read_b128 a[148:151], v3 offset:17408
    v_exp_f32 v27, v27
    v_cvt_pk_bf16_f32 v54, v24, v25
    v_exp_f32 v28, v28
    v_exp_f32 v29, v29
    v_cvt_pk_bf16_f32 v55, v26, v27
    v_smfmac_f32_16x16x64_bf16 v[104:107], a[176:179], v[60:67], v18
    s_mov_b32 m0, s79
    v_exp_f32 v30, v30
    v_exp_f32 v31, v31
    v_cvt_pk_bf16_f32 v56, v28, v29
    v_exp_f32 v32, v32
    v_mfma_f32_32x32x16_bf16 v[84:99], a[164:167], v[64:67], v[84:99]
    buffer_load_dwordx4 v2, s[44:47], s68 offen offset:2048 sc1 lds
    v_exp_f32 v33, v33
    v_cvt_pk_bf16_f32 v57, v30, v31
    v_exp_f32 v34, v34
    v_exp_f32 v35, v35
    v_cvt_pk_bf16_f32 v58, v32, v33
    v_cvt_pk_bf16_f32 v59, v34, v35
    v_mfma_f32_32x32x16_bf16 v[68:83], a[168:171], v[52:55], v[68:83]
    s_waitcnt lgkmcnt(0)
    v_exp_f32 v36, v36
    v_exp_f32 v37, v37
    v_exp_f32 v38, v38
    v_exp_f32 v39, v39
    v_mfma_f32_32x32x16_bf16 v[20:35], a[144:147], a[128:131], 0
    ds_read_b128 a[160:163], v3 offset:18432
    v_cvt_pk_bf16_f32 v60, v36, v37
    v_exp_f32 v40, v40
    v_exp_f32 v41, v41
    v_cvt_pk_bf16_f32 v61, v38, v39
    v_exp_f32 v42, v42
    v_mfma_f32_32x32x16_bf16 v[20:35], a[148:151], a[132:135], v[20:35]
    ds_read_b128 a[164:167], v3 offset:19456
    v_exp_f32 v43, v43
    v_cvt_pk_bf16_f32 v62, v40, v41
    v_exp_f32 v44, v44
    v_exp_f32 v45, v45
    v_cvt_pk_bf16_f32 v63, v42, v43
    v_smfmac_f32_16x16x64_bf16 v[100:103], a[176:179], v[52:59], v18
    s_mov_b32 m0, s79
    v_exp_f32 v46, v46
    v_exp_f32 v47, v47
    v_cvt_pk_bf16_f32 v64, v44, v45
    v_exp_f32 v48, v48
    v_mfma_f32_32x32x16_bf16 v[68:83], a[172:175], v[56:59], v[68:83]
    buffer_load_dwordx4 v2, s[44:47], s68 offen offset:3072 sc1 lds
    v_exp_f32 v49, v49
    v_cvt_pk_bf16_f32 v65, v46, v47
    v_exp_f32 v50, v50
    v_exp_f32 v51, v51
    v_cvt_pk_bf16_f32 v66, v48, v49
    v_cvt_pk_bf16_f32 v67, v50, v51
    v_mfma_f32_32x32x16_bf16 v[84:99], a[168:171], v[60:63], v[84:99]
    s_waitcnt lgkmcnt(0)
    buffer_store_dwordx4 v[208:211], v17, s[32:35], s3 offen offset:0 sc1
    v_exp_f32 v20, v20
    v_exp_f32 v21, v21
    v_exp_f32 v22, v22
    v_exp_f32 v23, v23
    v_mfma_f32_32x32x16_bf16 v[36:51], a[144:147], a[136:139], 0
    s_add_u32 s68, s68, 28672
    ds_read_b128 a[152:155], v3 offset:20480
    v_cvt_pk_bf16_f32 v52, v20, v21
    v_exp_f32 v24, v24
    v_exp_f32 v25, v25
    v_cvt_pk_bf16_f32 v53, v22, v23
    v_exp_f32 v26, v26
    v_mfma_f32_32x32x16_bf16 v[36:51], a[148:151], a[140:143], v[36:51]
    ds_read_b128 a[156:159], v3 offset:21504
    v_exp_f32 v27, v27
    v_cvt_pk_bf16_f32 v54, v24, v25
    v_exp_f32 v28, v28
    v_exp_f32 v29, v29
    v_cvt_pk_bf16_f32 v55, v26, v27
    v_smfmac_f32_16x16x64_bf16 v[104:107], a[176:179], v[60:67], v18
    v_exp_f32 v30, v30
    v_exp_f32 v31, v31
    v_cvt_pk_bf16_f32 v56, v28, v29
    v_exp_f32 v32, v32
    v_mfma_f32_32x32x16_bf16 v[84:99], a[172:175], v[64:67], v[84:99]
    v_exp_f32 v33, v33
    v_cvt_pk_bf16_f32 v57, v30, v31
    v_exp_f32 v34, v34
    v_exp_f32 v35, v35
    v_cvt_pk_bf16_f32 v58, v32, v33
    v_cvt_pk_bf16_f32 v59, v34, v35
    v_mfma_f32_32x32x16_bf16 v[68:83], a[160:163], v[52:55], v[68:83]
    s_waitcnt lgkmcnt(0)
    v_exp_f32 v36, v36
    v_exp_f32 v37, v37
    v_exp_f32 v38, v38
    v_exp_f32 v39, v39
    v_mfma_f32_32x32x16_bf16 v[20:35], a[152:155], a[128:131], 0
    ds_read_b128 a[168:171], v3 offset:22528
    v_cvt_pk_bf16_f32 v60, v36, v37
    v_exp_f32 v40, v40
    v_exp_f32 v41, v41
    v_cvt_pk_bf16_f32 v61, v38, v39
    v_exp_f32 v42, v42
    v_mfma_f32_32x32x16_bf16 v[20:35], a[156:159], a[132:135], v[20:35]
    ds_read_b128 a[172:175], v3 offset:23552
    v_exp_f32 v43, v43
    v_cvt_pk_bf16_f32 v62, v40, v41
    v_exp_f32 v44, v44
    v_exp_f32 v45, v45
    v_cvt_pk_bf16_f32 v63, v42, v43
    v_smfmac_f32_16x16x64_bf16 v[100:103], a[176:179], v[52:59], v18
    v_exp_f32 v46, v46
    v_exp_f32 v47, v47
    v_cvt_pk_bf16_f32 v64, v44, v45
    v_exp_f32 v48, v48
    v_mfma_f32_32x32x16_bf16 v[68:83], a[164:167], v[56:59], v[68:83]
    v_exp_f32 v49, v49
    v_cvt_pk_bf16_f32 v65, v46, v47
    v_exp_f32 v50, v50
    v_exp_f32 v51, v51
    v_cvt_pk_bf16_f32 v66, v48, v49
    v_cvt_pk_bf16_f32 v67, v50, v51
    v_mfma_f32_32x32x16_bf16 v[84:99], a[160:163], v[60:63], v[84:99]
    s_waitcnt lgkmcnt(0)
    buffer_store_dwordx4 v[212:215], v17, s[32:35], s3 offen offset:2048 sc1
    s_add_u32 s3, s3, 4096
    v_exp_f32 v20, v20
    v_exp_f32 v21, v21
    v_exp_f32 v22, v22
    v_exp_f32 v23, v23
    v_mfma_f32_32x32x16_bf16 v[36:51], a[152:155], a[136:139], 0
    ds_read_b128 a[144:147], v3 offset:24576
    v_cvt_pk_bf16_f32 v52, v20, v21
    v_exp_f32 v24, v24
    v_exp_f32 v25, v25
    v_cvt_pk_bf16_f32 v53, v22, v23
    v_exp_f32 v26, v26
    v_mfma_f32_32x32x16_bf16 v[36:51], a[156:159], a[140:143], v[36:51]
    ds_read_b128 a[148:151], v3 offset:25600
    v_exp_f32 v27, v27
    v_cvt_pk_bf16_f32 v54, v24, v25
    v_exp_f32 v28, v28
    v_exp_f32 v29, v29
    v_cvt_pk_bf16_f32 v55, v26, v27
    v_smfmac_f32_16x16x64_bf16 v[104:107], a[176:179], v[60:67], v18
    v_exp_f32 v30, v30
    v_exp_f32 v31, v31
    v_cvt_pk_bf16_f32 v56, v28, v29
    v_exp_f32 v32, v32
    v_mfma_f32_32x32x16_bf16 v[84:99], a[164:167], v[64:67], v[84:99]
    v_exp_f32 v33, v33
    v_cvt_pk_bf16_f32 v57, v30, v31
    v_exp_f32 v34, v34
    v_exp_f32 v35, v35
    v_cvt_pk_bf16_f32 v58, v32, v33
    v_cvt_pk_bf16_f32 v59, v34, v35
    v_mfma_f32_32x32x16_bf16 v[68:83], a[168:171], v[52:55], v[68:83]
    s_waitcnt lgkmcnt(0)
    v_exp_f32 v36, v36
    v_exp_f32 v37, v37
    v_exp_f32 v38, v38
    v_exp_f32 v39, v39
    v_mfma_f32_32x32x16_bf16 v[20:35], a[144:147], a[128:131], 0
    ds_read_b128 a[160:163], v3 offset:26624
    v_cvt_pk_bf16_f32 v60, v36, v37
    v_exp_f32 v40, v40
    v_exp_f32 v41, v41
    v_cvt_pk_bf16_f32 v61, v38, v39
    v_exp_f32 v42, v42
    v_mfma_f32_32x32x16_bf16 v[20:35], a[148:151], a[132:135], v[20:35]
    ds_read_b128 a[164:167], v3 offset:27648
    v_exp_f32 v43, v43
    v_cvt_pk_bf16_f32 v62, v40, v41
    v_exp_f32 v44, v44
    v_exp_f32 v45, v45
    v_cvt_pk_bf16_f32 v63, v42, v43
    v_smfmac_f32_16x16x64_bf16 v[100:103], a[176:179], v[52:59], v18
    v_exp_f32 v46, v46
    v_exp_f32 v47, v47
    v_cvt_pk_bf16_f32 v64, v44, v45
    v_exp_f32 v48, v48
    v_mfma_f32_32x32x16_bf16 v[68:83], a[172:175], v[56:59], v[68:83]
    v_exp_f32 v49, v49
    v_cvt_pk_bf16_f32 v65, v46, v47
    v_exp_f32 v50, v50
    v_exp_f32 v51, v51
    v_cvt_pk_bf16_f32 v66, v48, v49
    v_cvt_pk_bf16_f32 v67, v50, v51
    v_mfma_f32_32x32x16_bf16 v[84:99], a[168:171], v[60:63], v[84:99]
    s_waitcnt lgkmcnt(0)
    buffer_store_dwordx4 v[216:219], v17, s[32:35], s3 offen offset:0 sc1
    v_exp_f32 v20, v20
    v_exp_f32 v21, v21
    v_exp_f32 v22, v22
    v_exp_f32 v23, v23
    v_mfma_f32_32x32x16_bf16 v[36:51], a[144:147], a[136:139], 0
    ds_read_b128 a[152:155], v3 offset:28672
    v_cvt_pk_bf16_f32 v52, v20, v21
    v_exp_f32 v24, v24
    v_exp_f32 v25, v25
    v_cvt_pk_bf16_f32 v53, v22, v23
    v_exp_f32 v26, v26
    v_mfma_f32_32x32x16_bf16 v[36:51], a[148:151], a[140:143], v[36:51]
    ds_read_b128 a[156:159], v3 offset:29696
    v_exp_f32 v27, v27
    v_cvt_pk_bf16_f32 v54, v24, v25
    v_exp_f32 v28, v28
    v_exp_f32 v29, v29
    v_cvt_pk_bf16_f32 v55, v26, v27
    v_smfmac_f32_16x16x64_bf16 v[104:107], a[176:179], v[60:67], v18
    v_exp_f32 v30, v30
    v_exp_f32 v31, v31
    v_cvt_pk_bf16_f32 v56, v28, v29
    v_exp_f32 v32, v32
    v_mfma_f32_32x32x16_bf16 v[84:99], a[172:175], v[64:67], v[84:99]
    v_exp_f32 v33, v33
    v_cvt_pk_bf16_f32 v57, v30, v31
    v_exp_f32 v34, v34
    v_exp_f32 v35, v35
    v_cvt_pk_bf16_f32 v58, v32, v33
    v_cvt_pk_bf16_f32 v59, v34, v35
    v_mfma_f32_32x32x16_bf16 v[68:83], a[160:163], v[52:55], v[68:83]
    s_waitcnt lgkmcnt(0)
    v_exp_f32 v36, v36
    v_exp_f32 v37, v37
    v_exp_f32 v38, v38
    v_exp_f32 v39, v39
    v_mfma_f32_32x32x16_bf16 v[20:35], a[152:155], a[128:131], 0
    ds_read_b128 a[168:171], v3 offset:30720
    v_cvt_pk_bf16_f32 v60, v36, v37
    v_exp_f32 v40, v40
    v_exp_f32 v41, v41
    v_cvt_pk_bf16_f32 v61, v38, v39
    v_exp_f32 v42, v42
    v_mfma_f32_32x32x16_bf16 v[20:35], a[156:159], a[132:135], v[20:35]
    ds_read_b128 a[172:175], v3 offset:31744
    v_exp_f32 v43, v43
    v_cvt_pk_bf16_f32 v62, v40, v41
    v_exp_f32 v44, v44
    v_exp_f32 v45, v45
    v_cvt_pk_bf16_f32 v63, v42, v43
    v_smfmac_f32_16x16x64_bf16 v[100:103], a[176:179], v[52:59], v18
    v_exp_f32 v46, v46
    v_exp_f32 v47, v47
    v_cvt_pk_bf16_f32 v64, v44, v45
    v_exp_f32 v48, v48
    v_mfma_f32_32x32x16_bf16 v[68:83], a[164:167], v[56:59], v[68:83]
    v_exp_f32 v49, v49
    v_cvt_pk_bf16_f32 v65, v46, v47
    v_exp_f32 v50, v50
    v_exp_f32 v51, v51
    v_cvt_pk_bf16_f32 v66, v48, v49
    v_cvt_pk_bf16_f32 v67, v50, v51
    v_mfma_f32_32x32x16_bf16 v[84:99], a[160:163], v[60:63], v[84:99]
    s_waitcnt vmcnt(20) lgkmcnt(0)
    s_barrier
    buffer_store_dwordx4 v[220:223], v17, s[32:35], s3 offen offset:2048 sc1
    s_add_u32 s3, s3, 4096
    v_exp_f32 v20, v20
    v_exp_f32 v21, v21
    v_exp_f32 v22, v22
    v_exp_f32 v23, v23
    v_mfma_f32_32x32x16_bf16 v[36:51], a[152:155], a[136:139], 0
    ds_read_b128 a[144:147], v4 offset:0
    v_cvt_pk_bf16_f32 v52, v20, v21
    v_exp_f32 v24, v24
    v_exp_f32 v25, v25
    v_cvt_pk_bf16_f32 v53, v22, v23
    v_exp_f32 v26, v26
    v_mfma_f32_32x32x16_bf16 v[36:51], a[156:159], a[140:143], v[36:51]
    ds_read_b128 a[148:151], v4 offset:1024
    v_exp_f32 v27, v27
    v_cvt_pk_bf16_f32 v54, v24, v25
    v_exp_f32 v28, v28
    v_exp_f32 v29, v29
    v_cvt_pk_bf16_f32 v55, v26, v27
    v_smfmac_f32_16x16x64_bf16 v[104:107], a[176:179], v[60:67], v18
    s_mov_b32 s58, s65
    v_exp_f32 v30, v30
    v_exp_f32 v31, v31
    v_cvt_pk_bf16_f32 v56, v28, v29
    v_exp_f32 v32, v32
    v_mfma_f32_32x32x16_bf16 v[84:99], a[164:167], v[64:67], v[84:99]
    s_mov_b32 s65, s66
    v_exp_f32 v33, v33
    v_cvt_pk_bf16_f32 v57, v30, v31
    v_exp_f32 v34, v34
    v_exp_f32 v35, v35
    v_cvt_pk_bf16_f32 v58, v32, v33
    v_cvt_pk_bf16_f32 v59, v34, v35
    v_mfma_f32_32x32x16_bf16 v[68:83], a[168:171], v[52:55], v[68:83]
    s_waitcnt lgkmcnt(0)
    v_exp_f32 v36, v36
    v_exp_f32 v37, v37
    v_exp_f32 v38, v38
    v_exp_f32 v39, v39
    v_mfma_f32_32x32x16_bf16 v[20:35], a[144:147], a[128:131], 0
    s_mov_b32 s66, s67
    ds_read_b128 a[160:163], v4 offset:2048
    v_cvt_pk_bf16_f32 v60, v36, v37
    v_exp_f32 v40, v40
    v_exp_f32 v41, v41
    v_cvt_pk_bf16_f32 v61, v38, v39
    v_exp_f32 v42, v42
    v_mfma_f32_32x32x16_bf16 v[20:35], a[148:151], a[132:135], v[20:35]
    s_mov_b32 s67, s58
    ds_read_b128 a[164:167], v4 offset:3072
    v_exp_f32 v43, v43
    v_cvt_pk_bf16_f32 v62, v40, v41
    v_exp_f32 v44, v44
    v_exp_f32 v45, v45
    v_cvt_pk_bf16_f32 v63, v42, v43
    v_smfmac_f32_16x16x64_bf16 v[100:103], a[176:179], v[52:59], v18
    s_add_u32 s79, s58, s69
    v_exp_f32 v46, v46
    v_exp_f32 v47, v47
    v_cvt_pk_bf16_f32 v64, v44, v45
    v_exp_f32 v48, v48
    v_mfma_f32_32x32x16_bf16 v[68:83], a[172:175], v[56:59], v[68:83]
    s_add_u32 s62, s62, 1
    v_exp_f32 v49, v49
    v_cvt_pk_bf16_f32 v65, v46, v47
    v_exp_f32 v50, v50
    v_exp_f32 v51, v51
    v_cvt_pk_bf16_f32 v66, v48, v49
    v_cvt_pk_bf16_f32 v67, v50, v51
    v_add_u32 v3, s65, v2
    v_add_u32 v4, s66, v2
    v_mfma_f32_32x32x16_bf16 v[84:99], a[168:171], v[60:63], v[84:99]
    s_waitcnt lgkmcnt(0)
    s_and_b32 s58, s64, 1
    s_lshl_b32 s71, s63, 1
    s_add_u32 s71, s71, s58
    s_lshr_b32 s58, s64, 3
    s_lshl_b32 s58, s58, 2
    s_bfe_u32 s59, s64, 0x20001
    s_add_u32 s72, s58, s59
    s_lshl_b32 s58, s72, 7
    s_add_u32 s40, s20, s58
    s_addc_u32 s41, s21, 0
    s_sub_u32 s42, 7340032, s58
    s_add_u32 s30, s12, s58
    s_addc_u32 s31, s13, 0
    s_sub_u32 s15, 2097152, s58
    s_mov_b32 s10, 11
    v_exp_f32 v20, v20
    v_exp_f32 v21, v21
    v_exp_f32 v22, v22
    v_exp_f32 v23, v23
    v_mfma_f32_32x32x16_bf16 v[36:51], a[144:147], a[136:139], 0
    ds_read_b128 a[152:155], v3 offset:4096
    s_mov_b32 s38, 16384
    s_mov_b32 s48, s24
    s_mov_b32 s49, s25
    s_mov_b32 s50, 0x400000
    s_mul_i32 s73, s56, 266240
    s_lshl_b32 s58, s71, 14
    s_add_u32 s73, s73, s58
    s_add_u32 s73, s73, 33554432
    s_add_u32 s36, s28, s73
    s_addc_u32 s37, s29, 0
    s_mov_b32 s73, 4096
    s_mov_b32 s74, 8192
    s_mov_b32 s16, 12288
    s_lshl_b32 s78, s56, 14
    s_add_u32 s78, s78, 98304
    s_mov_b32 s75, 15360
    s_mov_b32 s76, 30720
    s_mov_b32 s77, 46080
    s_and_b32 s58, s72, 7
    s_cmp_lg_u32 s58, 3
    s_cbranch_scc1 P3_NOCW
    s_lshr_b32 s58, s72, 3
    s_mul_i32 s58, s58, 1179648
    s_add_u32 s58, s58, 28311552
    s_add_u32 s40, s28, s58
    s_addc_u32 s41, s29, 0
    s_mov_b32 s42, 917504
    s_add_u32 s30, s40, 917504
    s_addc_u32 s31, s41, 0
    s_mov_b32 s15, 262144
    s_mov_b32 s10, 8
    s_mov_b32 s75, 1024
    s_mov_b32 s76, 2048
    s_mov_b32 s77, 3072
P3_NOCW:
    s_lshl_b32 s18, 128, s10
    s_mul_i32 s19, s18, 28
    v_cvt_pk_bf16_f32 v52, v20, v21
    v_exp_f32 v24, v24
    v_exp_f32 v25, v25
    v_cvt_pk_bf16_f32 v53, v22, v23
    v_exp_f32 v26, v26
    v_mfma_f32_32x32x16_bf16 v[36:51], a[148:151], a[140:143], v[36:51]
    ds_read_b128 a[156:159], v3 offset:5120
    v_exp_f32 v27, v27
    v_cvt_pk_bf16_f32 v54, v24, v25
    v_exp_f32 v28, v28
    v_exp_f32 v29, v29
    v_cvt_pk_bf16_f32 v55, v26, v27
    v_smfmac_f32_16x16x64_bf16 v[104:107], a[176:179], v[60:67], v18
    s_mov_b32 m0, s79
    v_lshrrev_b32 v8, 3, v1
    v_lshrrev_b32 v9, 4, v1
    v_lshlrev_b32 v10, 1, v9
    v_and_b32 v11, 7, v1
    v_xor_b32 v10, v10, v11
    v_lshlrev_b32 v10, 4, v10
    s_lshl_b32 s58, s56, 5
    v_add_u32 v8, s58, v8
    v_lshl_add_u32 v244, v8, s10, v10
    s_lshl_b32 s58, s18, 2
    v_add_u32 v19, s58, v244
    v_lshrrev_b32 v8, 2, v1
    v_bfe_u32 v9, v1, 3, 2
    v_and_b32 v10, 3, v1
    v_lshlrev_b32 v10, 3, v10
    v_lshl_add_u32 v10, v8, 7, v10
    v_add_u32 v10, s78, v10
    v_xor_b32 v11, 0, v9
    v_lshl_add_u32 v245, v11, 5, v10
    v_xor_b32 v11, 1, v9
    v_lshl_add_u32 v246, v11, 5, v10
    v_xor_b32 v11, 2, v9
    v_lshl_add_u32 v247, v11, 5, v10
    v_xor_b32 v11, 3, v9
    v_lshl_add_u32 v248, v11, 5, v10
    s_lshr_b32 s58, s71, 1
    s_lshl_b32 s58, s58, 10
    s_lshl_b32 s59, s63, 10
    v_mov_b32 v12, s58
    v_mov_b32 v13, s59
    v_cmp_gt_u32 vcc, 32, v1
    v_and_b32 v14, 31, v1
    v_lshlrev_b32 v14, 2, v14
    v_cndmask_b32 v12, v12, v13, vcc
    v_bfe_u32 v13, v1, 3, 2
    v_lshl_add_u32 v12, v13, 8, v12
    v_and_b32 v13, 7, v1
    v_lshl_add_u32 v12, v13, 4, v12
    v_lshrrev_b32 v13, 5, v1
    v_lshl_add_u32 v13, v13, 8, v14
    v_and_b32 v15, 15, v1
    v_lshlrev_b32 v15, 2, v15
    s_add_u32 s17, s56, 80
    s_mul_i32 s17, s17, 266240
    s_lshl_b32 s58, s71, 14
    s_add_u32 s17, s17, s58
    s_add_u32 s17, s17, 33554432
    s_lshl_b32 s59, s2, 2
    s_add_u32 s59, s59, s56
    s_lshl_b32 s59, s59, 10
    v_lshrrev_b32 v249, 3, v1
    v_lshlrev_b32 v249, 7, v249
    v_add_u32 v249, s59, v249
    s_mov_b32 s52, s20
    s_mov_b32 s53, s21
    s_mov_b32 s54, 7340032
    s_mov_b32 s8, 0x100000
    v_exp_f32 v30, v30
    v_exp_f32 v31, v31
    v_cvt_pk_bf16_f32 v56, v28, v29
    v_exp_f32 v32, v32
    v_mfma_f32_32x32x16_bf16 v[84:99], a[172:175], v[64:67], v[84:99]
    buffer_load_dwordx4 v2, s[44:47], s68 offen offset:0 sc1 lds
    v_exp_f32 v33, v33
    v_cvt_pk_bf16_f32 v57, v30, v31
    v_exp_f32 v34, v34
    v_exp_f32 v35, v35
    v_cvt_pk_bf16_f32 v58, v32, v33
    v_cvt_pk_bf16_f32 v59, v34, v35
    v_mfma_f32_32x32x16_bf16 v[68:83], a[160:163], v[52:55], v[68:83]
    s_waitcnt lgkmcnt(0)
    s_add_u32 m0, s78, 0
    v_exp_f32 v36, v36
    v_exp_f32 v37, v37
    v_exp_f32 v38, v38
    v_exp_f32 v39, v39
    v_mfma_f32_32x32x16_bf16 v[20:35], a[152:155], a[128:131], 0
    ds_read_b128 a[168:171], v3 offset:6144
    buffer_load_dwordx4 v244, s[40:43], 0 offen offset:0 sc1 lds
    v_cvt_pk_bf16_f32 v60, v36, v37
    v_exp_f32 v40, v40
    v_exp_f32 v41, v41
    v_cvt_pk_bf16_f32 v61, v38, v39
    v_exp_f32 v42, v42
    v_mfma_f32_32x32x16_bf16 v[20:35], a[156:159], a[132:135], v[20:35]
    ds_read_b128 a[172:175], v3 offset:7168
    buffer_load_dwordx4 v244, s[40:43], s75 offen offset:1024 sc1 lds
    v_exp_f32 v43, v43
    v_cvt_pk_bf16_f32 v62, v40, v41
    v_exp_f32 v44, v44
    v_exp_f32 v45, v45
    v_cvt_pk_bf16_f32 v63, v42, v43
    v_smfmac_f32_16x16x64_bf16 v[100:103], a[176:179], v[52:59], v18
    s_mov_b32 m0, s79
    v_exp_f32 v46, v46
    v_exp_f32 v47, v47
    v_cvt_pk_bf16_f32 v64, v44, v45
    v_exp_f32 v48, v48
    v_mfma_f32_32x32x16_bf16 v[68:83], a[164:167], v[56:59], v[68:83]
    buffer_load_dwordx4 v2, s[44:47], s68 offen offset:1024 sc1 lds
    v_exp_f32 v49, v49
    v_cvt_pk_bf16_f32 v65, v46, v47
    v_exp_f32 v50, v50
    v_exp_f32 v51, v51
    v_cvt_pk_bf16_f32 v66, v48, v49
    v_cvt_pk_bf16_f32 v67, v50, v51
    v_mfma_f32_32x32x16_bf16 v[84:99], a[160:163], v[60:63], v[84:99]
    s_waitcnt lgkmcnt(0)
    buffer_load_dword a252, v249, s[52:55], s8 offen
    s_add_u32 s8, s8, 0x100000
    s_add_u32 m0, s78, 0
    v_exp_f32 v20, v20
    v_exp_f32 v21, v21
    v_exp_f32 v22, v22
    v_exp_f32 v23, v23
    v_mfma_f32_32x32x16_bf16 v[36:51], a[152:155], a[136:139], 0
    ds_read_b128 a[144:147], v3 offset:8192
    buffer_load_dwordx4 v244, s[40:43], s76 offen offset:2048 sc1 lds
    v_cvt_pk_bf16_f32 v52, v20, v21
    v_exp_f32 v24, v24
    v_exp_f32 v25, v25
    v_cvt_pk_bf16_f32 v53, v22, v23
    v_exp_f32 v26, v26
    v_mfma_f32_32x32x16_bf16 v[36:51], a[156:159], a[140:143], v[36:51]
    ds_read_b128 a[148:151], v3 offset:9216
    buffer_load_dwordx4 v244, s[40:43], s77 offen offset:3072 sc1 lds
    v_add_u32 v244, s18, v244
    v_exp_f32 v27, v27
    v_cvt_pk_bf16_f32 v54, v24, v25
    v_exp_f32 v28, v28
    v_exp_f32 v29, v29
    v_cvt_pk_bf16_f32 v55, v26, v27
    v_smfmac_f32_16x16x64_bf16 v[104:107], a[176:179], v[60:67], v18
    s_mov_b32 m0, s79
    v_exp_f32 v30, v30
    v_exp_f32 v31, v31
    v_cvt_pk_bf16_f32 v56, v28, v29
    v_exp_f32 v32, v32
    v_mfma_f32_32x32x16_bf16 v[84:99], a[164:167], v[64:67], v[84:99]
    buffer_load_dwordx4 v2, s[44:47], s68 offen offset:2048 sc1 lds
    v_exp_f32 v33, v33
    v_cvt_pk_bf16_f32 v57, v30, v31
    v_exp_f32 v34, v34
    v_exp_f32 v35, v35
    v_cvt_pk_bf16_f32 v58, v32, v33
    v_cvt_pk_bf16_f32 v59, v34, v35
    v_mfma_f32_32x32x16_bf16 v[68:83], a[168:171], v[52:55], v[68:83]
    s_waitcnt lgkmcnt(0)
    s_add_u32 m0, s78, 4096
    v_exp_f32 v36, v36
    v_exp_f32 v37, v37
    v_exp_f32 v38, v38
    v_exp_f32 v39, v39
    v_mfma_f32_32x32x16_bf16 v[20:35], a[144:147], a[128:131], 0
    ds_read_b128 a[160:163], v3 offset:10240
    buffer_load_dwordx4 v244, s[40:43], 0 offen offset:0 sc1 lds
    v_cvt_pk_bf16_f32 v60, v36, v37
    v_exp_f32 v40, v40
    v_exp_f32 v41, v41
    v_cvt_pk_bf16_f32 v61, v38, v39
    v_exp_f32 v42, v42
    v_mfma_f32_32x32x16_bf16 v[20:35], a[148:151], a[132:135], v[20:35]
    ds_read_b128 a[164:167], v3 offset:11264
    buffer_load_dwordx4 v244, s[40:43], s75 offen offset:1024 sc1 lds
    v_exp_f32 v43, v43
    v_cvt_pk_bf16_f32 v62, v40, v41
    v_exp_f32 v44, v44
    v_exp_f32 v45, v45
    v_cvt_pk_bf16_f32 v63, v42, v43
    v_smfmac_f32_16x16x64_bf16 v[100:103], a[176:179], v[52:59], v18
    s_mov_b32 m0, s79
    v_exp_f32 v46, v46
    v_exp_f32 v47, v47
    v_cvt_pk_bf16_f32 v64, v44, v45
    v_exp_f32 v48, v48
    v_mfma_f32_32x32x16_bf16 v[68:83], a[172:175], v[56:59], v[68:83]
    buffer_load_dwordx4 v2, s[44:47], s68 offen offset:3072 sc1 lds
    v_exp_f32 v49, v49
    v_cvt_pk_bf16_f32 v65, v46, v47
    v_exp_f32 v50, v50
    v_exp_f32 v51, v51
    v_cvt_pk_bf16_f32 v66, v48, v49
    v_cvt_pk_bf16_f32 v67, v50, v51
    v_mfma_f32_32x32x16_bf16 v[84:99], a[168:171], v[60:63], v[84:99]
    s_waitcnt lgkmcnt(0)
    s_add_u32 m0, s78, 4096
    v_exp_f32 v20, v20
    v_exp_f32 v21, v21
    v_exp_f32 v22, v22
    v_exp_f32 v23, v23
    v_mfma_f32_32x32x16_bf16 v[36:51], a[144:147], a[136:139], 0
    s_add_u32 s68, s68, 4096
    ds_read_b128 a[152:155], v3 offset:12288
    buffer_load_dwordx4 v244, s[40:43], s76 offen offset:2048 sc1 lds
    v_cvt_pk_bf16_f32 v52, v20, v21
    v_exp_f32 v24, v24
    v_exp_f32 v25, v25
    v_cvt_pk_bf16_f32 v53, v22, v23
    v_exp_f32 v26, v26
    v_mfma_f32_32x32x16_bf16 v[36:51], a[148:151], a[140:143], v[36:51]
    s_add_u32 s79, s79, 4096
    ds_read_b128 a[156:159], v3 offset:13312
    buffer_load_dwordx4 v244, s[40:43], s77 offen offset:3072 sc1 lds
    v_add_u32 v244, s18, v244
    v_exp_f32 v27, v27
    v_cvt_pk_bf16_f32 v54, v24, v25
    v_exp_f32 v28, v28
    v_exp_f32 v29, v29
    v_cvt_pk_bf16_f32 v55, v26, v27
    v_smfmac_f32_16x16x64_bf16 v[104:107], a[176:179], v[60:67], v18
    s_mov_b32 m0, s79
    v_exp_f32 v30, v30
    v_exp_f32 v31, v31
    v_cvt_pk_bf16_f32 v56, v28, v29
    v_exp_f32 v32, v32
    v_mfma_f32_32x32x16_bf16 v[84:99], a[172:175], v[64:67], v[84:99]
    buffer_load_dwordx4 v2, s[44:47], s68 offen offset:0 sc1 lds
    v_exp_f32 v33, v33
    v_cvt_pk_bf16_f32 v57, v30, v31
    v_exp_f32 v34, v34
    v_exp_f32 v35, v35
    v_cvt_pk_bf16_f32 v58, v32, v33
    v_cvt_pk_bf16_f32 v59, v34, v35
    v_mfma_f32_32x32x16_bf16 v[68:83], a[160:163], v[52:55], v[68:83]
    s_waitcnt lgkmcnt(0)
    s_add_u32 m0, s78, 8192
    v_exp_f32 v36, v36
    v_exp_f32 v37, v37
    v_exp_f32 v38, v38
    v_exp_f32 v39, v39
    v_mfma_f32_32x32x16_bf16 v[20:35], a[152:155], a[128:131], 0
    ds_read_b128 a[168:171], v3 offset:14336
    buffer_load_dwordx4 v244, s[40:43], 0 offen offset:0 sc1 lds
    v_cvt_pk_bf16_f32 v60, v36, v37
    v_exp_f32 v40, v40
    v_exp_f32 v41, v41
    v_cvt_pk_bf16_f32 v61, v38, v39
    v_exp_f32 v42, v42
    v_mfma_f32_32x32x16_bf16 v[20:35], a[156:159], a[132:135], v[20:35]
    ds_read_b128 a[172:175], v3 offset:15360
    buffer_load_dwordx4 v244, s[40:43], s75 offen offset:1024 sc1 lds
    v_exp_f32 v43, v43
    v_cvt_pk_bf16_f32 v62, v40, v41
    v_exp_f32 v44, v44
    v_exp_f32 v45, v45
    v_cvt_pk_bf16_f32 v63, v42, v43
    v_smfmac_f32_16x16x64_bf16 v[100:103], a[176:179], v[52:59], v18
    s_mov_b32 m0, s79
    v_exp_f32 v46, v46
    v_exp_f32 v47, v47
    v_cvt_pk_bf16_f32 v64, v44, v45
    v_exp_f32 v48, v48
    v_mfma_f32_32x32x16_bf16 v[68:83], a[164:167], v[56:59], v[68:83]
    buffer_load_dwordx4 v2, s[44:47], s68 offen offset:1024 sc1 lds
    v_exp_f32 v49, v49
    v_cvt_pk_bf16_f32 v65, v46, v47
    v_exp_f32 v50, v50
    v_exp_f32 v51, v51
    v_cvt_pk_bf16_f32 v66, v48, v49
    v_cvt_pk_bf16_f32 v67, v50, v51
    v_mfma_f32_32x32x16_bf16 v[84:99], a[160:163], v[60:63], v[84:99]
    s_waitcnt lgkmcnt(0)
    buffer_load_dword a252, v249, s[52:55], s8 offen
    s_add_u32 s8, s8, 0x100000
    s_add_u32 m0, s78, 8192
    v_exp_f32 v20, v20
    v_exp_f32 v21, v21
    v_exp_f32 v22, v22
    v_exp_f32 v23, v23
    v_mfma_f32_32x32x16_bf16 v[36:51], a[152:155], a[136:139], 0
    ds_read_b128 a[144:147], v3 offset:16384
    buffer_load_dwordx4 v244, s[40:43], s76 offen offset:2048 sc1 lds
    v_cvt_pk_bf16_f32 v52, v20, v21
    v_exp_f32 v24, v24
    v_exp_f32 v25, v25
    v_cvt_pk_bf16_f32 v53, v22, v23
    v_exp_f32 v26, v26
    v_mfma_f32_32x32x16_bf16 v[36:51], a[156:159], a[140:143], v[36:51]
    ds_read_b128 a[148:151], v3 offset:17408
    buffer_load_dwordx4 v244, s[40:43], s77 offen offset:3072 sc1 lds
    v_add_u32 v244, s18, v244
    v_exp_f32 v27, v27
    v_cvt_pk_bf16_f32 v54, v24, v25
    v_exp_f32 v28, v28
    v_exp_f32 v29, v29
    v_cvt_pk_bf16_f32 v55, v26, v27
    v_smfmac_f32_16x16x64_bf16 v[104:107], a[176:179], v[60:67], v18
    s_mov_b32 m0, s79
    v_exp_f32 v30, v30
    v_exp_f32 v31, v31
    v_cvt_pk_bf16_f32 v56, v28, v29
    v_exp_f32 v32, v32
    v_mfma_f32_32x32x16_bf16 v[84:99], a[164:167], v[64:67], v[84:99]
    buffer_load_dwordx4 v2, s[44:47], s68 offen offset:2048 sc1 lds
    v_exp_f32 v33, v33
    v_cvt_pk_bf16_f32 v57, v30, v31
    v_exp_f32 v34, v34
    v_exp_f32 v35, v35
    v_cvt_pk_bf16_f32 v58, v32, v33
    v_cvt_pk_bf16_f32 v59, v34, v35
    v_mfma_f32_32x32x16_bf16 v[68:83], a[168:171], v[52:55], v[68:83]
    s_waitcnt lgkmcnt(0)
    s_add_u32 m0, s78, 12288
    v_exp_f32 v36, v36
    v_exp_f32 v37, v37
    v_exp_f32 v38, v38
    v_exp_f32 v39, v39
    v_mfma_f32_32x32x16_bf16 v[20:35], a[144:147], a[128:131], 0
    ds_read_b128 a[160:163], v3 offset:18432
    buffer_load_dwordx4 v244, s[40:43], 0 offen offset:0 sc1 lds
    v_cvt_pk_bf16_f32 v60, v36, v37
    v_exp_f32 v40, v40
    v_exp_f32 v41, v41
    v_cvt_pk_bf16_f32 v61, v38, v39
    v_exp_f32 v42, v42
    v_mfma_f32_32x32x16_bf16 v[20:35], a[148:151], a[132:135], v[20:35]
    ds_read_b128 a[164:167], v3 offset:19456
    buffer_load_dwordx4 v244, s[40:43], s75 offen offset:1024 sc1 lds
    v_exp_f32 v43, v43
    v_cvt_pk_bf16_f32 v62, v40, v41
    v_exp_f32 v44, v44
    v_exp_f32 v45, v45
    v_cvt_pk_bf16_f32 v63, v42, v43
    v_smfmac_f32_16x16x64_bf16 v[100:103], a[176:179], v[52:59], v18
    s_mov_b32 m0, s79
    v_exp_f32 v46, v46
    v_exp_f32 v47, v47
    v_cvt_pk_bf16_f32 v64, v44, v45
    v_exp_f32 v48, v48
    v_mfma_f32_32x32x16_bf16 v[68:83], a[172:175], v[56:59], v[68:83]
    buffer_load_dwordx4 v2, s[44:47], s68 offen offset:3072 sc1 lds
    v_exp_f32 v49, v49
    v_cvt_pk_bf16_f32 v65, v46, v47
    v_exp_f32 v50, v50
    v_exp_f32 v51, v51
    v_cvt_pk_bf16_f32 v66, v48, v49
    v_cvt_pk_bf16_f32 v67, v50, v51
    v_mfma_f32_32x32x16_bf16 v[84:99], a[168:171], v[60:63], v[84:99]
    s_waitcnt lgkmcnt(0)
    s_add_u32 m0, s78, 12288
    v_exp_f32 v20, v20
    v_exp_f32 v21, v21
    v_exp_f32 v22, v22
    v_exp_f32 v23, v23
    v_mfma_f32_32x32x16_bf16 v[36:51], a[144:147], a[136:139], 0
    s_add_u32 s68, s68, 28672
    ds_read_b128 a[152:155], v3 offset:20480
    buffer_load_dwordx4 v244, s[40:43], s76 offen offset:2048 sc1 lds
    v_cvt_pk_bf16_f32 v52, v20, v21
    v_exp_f32 v24, v24
    v_exp_f32 v25, v25
    v_cvt_pk_bf16_f32 v53, v22, v23
    v_exp_f32 v26, v26
    v_mfma_f32_32x32x16_bf16 v[36:51], a[148:151], a[140:143], v[36:51]
    ds_read_b128 a[156:159], v3 offset:21504
    buffer_load_dwordx4 v244, s[40:43], s77 offen offset:3072 sc1 lds
    v_add_u32 v244, s18, v244
    v_exp_f32 v27, v27
    v_cvt_pk_bf16_f32 v54, v24, v25
    v_exp_f32 v28, v28
    v_exp_f32 v29, v29
    v_cvt_pk_bf16_f32 v55, v26, v27
    v_smfmac_f32_16x16x64_bf16 v[104:107], a[176:179], v[60:67], v18
    v_exp_f32 v30, v30
    v_exp_f32 v31, v31
    v_cvt_pk_bf16_f32 v56, v28, v29
    v_exp_f32 v32, v32
    v_mfma_f32_32x32x16_bf16 v[84:99], a[172:175], v[64:67], v[84:99]
    v_exp_f32 v33, v33
    v_cvt_pk_bf16_f32 v57, v30, v31
    v_exp_f32 v34, v34
    v_exp_f32 v35, v35
    v_cvt_pk_bf16_f32 v58, v32, v33
    v_cvt_pk_bf16_f32 v59, v34, v35
    v_mfma_f32_32x32x16_bf16 v[68:83], a[160:163], v[52:55], v[68:83]
    s_waitcnt lgkmcnt(0)
    v_exp_f32 v36, v36
    v_exp_f32 v37, v37
    v_exp_f32 v38, v38
    v_exp_f32 v39, v39
    v_mfma_f32_32x32x16_bf16 v[20:35], a[152:155], a[128:131], 0
    ds_read_b128 a[168:171], v3 offset:22528
    v_cvt_pk_bf16_f32 v60, v36, v37
    v_exp_f32 v40, v40
    v_exp_f32 v41, v41
    v_cvt_pk_bf16_f32 v61, v38, v39
    v_exp_f32 v42, v42
    v_mfma_f32_32x32x16_bf16 v[20:35], a[156:159], a[132:135], v[20:35]
    ds_read_b128 a[172:175], v3 offset:23552
    v_exp_f32 v43, v43
    v_cvt_pk_bf16_f32 v62, v40, v41
    v_exp_f32 v44, v44
    v_exp_f32 v45, v45
    v_cvt_pk_bf16_f32 v63, v42, v43
    v_smfmac_f32_16x16x64_bf16 v[100:103], a[176:179], v[52:59], v18
    v_exp_f32 v46, v46
    v_exp_f32 v47, v47
    v_cvt_pk_bf16_f32 v64, v44, v45
    v_exp_f32 v48, v48
    v_mfma_f32_32x32x16_bf16 v[68:83], a[164:167], v[56:59], v[68:83]
    v_exp_f32 v49, v49
    v_cvt_pk_bf16_f32 v65, v46, v47
    v_exp_f32 v50, v50
    v_exp_f32 v51, v51
    v_cvt_pk_bf16_f32 v66, v48, v49
    v_cvt_pk_bf16_f32 v67, v50, v51
    v_mfma_f32_32x32x16_bf16 v[84:99], a[160:163], v[60:63], v[84:99]
    s_waitcnt lgkmcnt(0)
    v_exp_f32 v20, v20
    v_exp_f32 v21, v21
    v_exp_f32 v22, v22
    v_exp_f32 v23, v23
    v_mfma_f32_32x32x16_bf16 v[36:51], a[152:155], a[136:139], 0
    ds_read_b128 a[144:147], v3 offset:24576
    v_cvt_pk_bf16_f32 v52, v20, v21
    v_exp_f32 v24, v24
    v_exp_f32 v25, v25
    v_cvt_pk_bf16_f32 v53, v22, v23
    v_exp_f32 v26, v26
    v_mfma_f32_32x32x16_bf16 v[36:51], a[156:159], a[140:143], v[36:51]
    ds_read_b128 a[148:151], v3 offset:25600
    v_exp_f32 v27, v27
    v_cvt_pk_bf16_f32 v54, v24, v25
    v_exp_f32 v28, v28
    v_exp_f32 v29, v29
    v_cvt_pk_bf16_f32 v55, v26, v27
    v_smfmac_f32_16x16x64_bf16 v[104:107], a[176:179], v[60:67], v18
    v_exp_f32 v30, v30
    v_exp_f32 v31, v31
    v_cvt_pk_bf16_f32 v56, v28, v29
    v_exp_f32 v32, v32
    v_mfma_f32_32x32x16_bf16 v[84:99], a[164:167], v[64:67], v[84:99]
    global_load_dword a253, v0, s[100:101]
    v_add_u32 v0, 0x2000, v0
    v_exp_f32 v33, v33
    v_cvt_pk_bf16_f32 v57, v30, v31
    v_exp_f32 v34, v34
    v_exp_f32 v35, v35
    v_cvt_pk_bf16_f32 v58, v32, v33
    v_cvt_pk_bf16_f32 v59, v34, v35
    v_mfma_f32_32x32x16_bf16 v[68:83], a[168:171], v[52:55], v[68:83]
    s_waitcnt lgkmcnt(0)
    v_exp_f32 v36, v36
    v_exp_f32 v37, v37
    v_exp_f32 v38, v38
    v_exp_f32 v39, v39
    v_mfma_f32_32x32x16_bf16 v[20:35], a[144:147], a[128:131], 0
    ds_read_b128 a[160:163], v3 offset:26624
    v_cvt_pk_bf16_f32 v60, v36, v37
    v_exp_f32 v40, v40
    v_exp_f32 v41, v41
    v_cvt_pk_bf16_f32 v61, v38, v39
    v_exp_f32 v42, v42
    v_mfma_f32_32x32x16_bf16 v[20:35], a[148:151], a[132:135], v[20:35]
    ds_read_b128 a[164:167], v3 offset:27648
    v_exp_f32 v43, v43
    v_cvt_pk_bf16_f32 v62, v40, v41
    v_exp_f32 v44, v44
    v_exp_f32 v45, v45
    v_cvt_pk_bf16_f32 v63, v42, v43
    v_smfmac_f32_16x16x64_bf16 v[100:103], a[176:179], v[52:59], v18
    v_exp_f32 v46, v46
    v_exp_f32 v47, v47
    v_cvt_pk_bf16_f32 v64, v44, v45
    v_exp_f32 v48, v48
    v_mfma_f32_32x32x16_bf16 v[68:83], a[172:175], v[56:59], v[68:83]
    v_exp_f32 v49, v49
    v_cvt_pk_bf16_f32 v65, v46, v47
    v_exp_f32 v50, v50
    v_exp_f32 v51, v51
    v_cvt_pk_bf16_f32 v66, v48, v49
    v_cvt_pk_bf16_f32 v67, v50, v51
    v_mfma_f32_32x32x16_bf16 v[84:99], a[168:171], v[60:63], v[84:99]
    s_waitcnt lgkmcnt(0)
    v_exp_f32 v20, v20
    v_exp_f32 v21, v21
    v_exp_f32 v22, v22
    v_exp_f32 v23, v23
    v_mfma_f32_32x32x16_bf16 v[36:51], a[144:147], a[136:139], 0
    ds_read_b128 a[152:155], v3 offset:28672
    v_cvt_pk_bf16_f32 v52, v20, v21
    v_exp_f32 v24, v24
    v_exp_f32 v25, v25
    v_cvt_pk_bf16_f32 v53, v22, v23
    v_exp_f32 v26, v26
    v_mfma_f32_32x32x16_bf16 v[36:51], a[148:151], a[140:143], v[36:51]
    ds_read_b128 a[156:159], v3 offset:29696
    s_waitcnt vmcnt(27)
    s_mov_b64 exec, 1
    buffer_store_dword v6, v5, s[32:35], s70 offen sc1
    s_mov_b64 exec, -1
    s_nop 2
    v_exp_f32 v27, v27
    v_cvt_pk_bf16_f32 v54, v24, v25
    v_exp_f32 v28, v28
    v_exp_f32 v29, v29
    v_cvt_pk_bf16_f32 v55, v26, v27
    v_smfmac_f32_16x16x64_bf16 v[104:107], a[176:179], v[60:67], v18
    buffer_load_dword a252, v249, s[52:55], s8 offen
    s_add_u32 s8, s8, 0x100000
    v_exp_f32 v30, v30
    v_exp_f32 v31, v31
    v_cvt_pk_bf16_f32 v56, v28, v29
    v_exp_f32 v32, v32
    v_mfma_f32_32x32x16_bf16 v[84:99], a[172:175], v[64:67], v[84:99]
    v_exp_f32 v33, v33
    v_cvt_pk_bf16_f32 v57, v30, v31
    v_exp_f32 v34, v34
    v_exp_f32 v35, v35
    v_cvt_pk_bf16_f32 v58, v32, v33
    v_cvt_pk_bf16_f32 v59, v34, v35
    v_mfma_f32_32x32x16_bf16 v[68:83], a[160:163], v[52:55], v[68:83]
    s_waitcnt lgkmcnt(0)
    v_exp_f32 v36, v36
    v_exp_f32 v37, v37
    v_exp_f32 v38, v38
    v_exp_f32 v39, v39
    v_mfma_f32_32x32x16_bf16 v[20:35], a[152:155], a[128:131], 0
    ds_read_b128 a[168:171], v3 offset:30720
    v_cvt_pk_bf16_f32 v60, v36, v37
    v_exp_f32 v40, v40
    v_exp_f32 v41, v41
    v_cvt_pk_bf16_f32 v61, v38, v39
    v_exp_f32 v42, v42
    v_mfma_f32_32x32x16_bf16 v[20:35], a[156:159], a[132:135], v[20:35]
    ds_read_b128 a[172:175], v3 offset:31744
    v_exp_f32 v43, v43
    v_cvt_pk_bf16_f32 v62, v40, v41
    v_exp_f32 v44, v44
    v_exp_f32 v45, v45
    v_cvt_pk_bf16_f32 v63, v42, v43
    v_smfmac_f32_16x16x64_bf16 v[100:103], a[176:179], v[52:59], v18
    v_exp_f32 v46, v46
    v_exp_f32 v47, v47
    v_cvt_pk_bf16_f32 v64, v44, v45
    v_exp_f32 v48, v48
    v_mfma_f32_32x32x16_bf16 v[68:83], a[164:167], v[56:59], v[68:83]
    v_exp_f32 v49, v49
    v_cvt_pk_bf16_f32 v65, v46, v47
    v_exp_f32 v50, v50
    v_exp_f32 v51, v51
    v_cvt_pk_bf16_f32 v66, v48, v49
    v_cvt_pk_bf16_f32 v67, v50, v51
    v_mfma_f32_32x32x16_bf16 v[84:99], a[160:163], v[60:63], v[84:99]
    s_waitcnt vmcnt(33) lgkmcnt(0)
    s_barrier
    v_exp_f32 v20, v20
    v_exp_f32 v21, v21
    v_exp_f32 v22, v22
    v_exp_f32 v23, v23
    v_mfma_f32_32x32x16_bf16 v[36:51], a[152:155], a[136:139], 0
    ds_read_b128 a[144:147], v4 offset:0
    v_cvt_pk_bf16_f32 v52, v20, v21
    v_exp_f32 v24, v24
    v_exp_f32 v25, v25
    v_cvt_pk_bf16_f32 v53, v22, v23
    v_exp_f32 v26, v26
    v_mfma_f32_32x32x16_bf16 v[36:51], a[156:159], a[140:143], v[36:51]
    ds_read_b128 a[148:151], v4 offset:1024
    v_exp_f32 v27, v27
    v_cvt_pk_bf16_f32 v54, v24, v25
    v_exp_f32 v28, v28
    v_exp_f32 v29, v29
    v_cvt_pk_bf16_f32 v55, v26, v27
    v_smfmac_f32_16x16x64_bf16 v[104:107], a[176:179], v[60:67], v18
    s_mov_b32 s58, s65
    v_exp_f32 v30, v30
    v_exp_f32 v31, v31
    v_cvt_pk_bf16_f32 v56, v28, v29
    v_exp_f32 v32, v32
    v_mfma_f32_32x32x16_bf16 v[84:99], a[164:167], v[64:67], v[84:99]
    s_mov_b32 s65, s66
    v_exp_f32 v33, v33
    v_cvt_pk_bf16_f32 v57, v30, v31
    v_exp_f32 v34, v34
    v_exp_f32 v35, v35
    v_cvt_pk_bf16_f32 v58, v32, v33
    v_cvt_pk_bf16_f32 v59, v34, v35
    v_mfma_f32_32x32x16_bf16 v[68:83], a[168:171], v[52:55], v[68:83]
    s_waitcnt lgkmcnt(0)
    v_exp_f32 v36, v36
    v_exp_f32 v37, v37
    v_exp_f32 v38, v38
    v_exp_f32 v39, v39
    v_mfma_f32_32x32x16_bf16 v[20:35], a[144:147], a[128:131], 0
    s_mov_b32 s66, s67
    ds_read_b128 a[160:163], v4 offset:2048
    v_cvt_pk_bf16_f32 v60, v36, v37
    v_exp_f32 v40, v40
    v_exp_f32 v41, v41
    v_cvt_pk_bf16_f32 v61, v38, v39
    v_exp_f32 v42, v42
    v_mfma_f32_32x32x16_bf16 v[20:35], a[148:151], a[132:135], v[20:35]
    s_mov_b32 s67, s58
    ds_read_b128 a[164:167], v4 offset:3072
    v_exp_f32 v43, v43
    v_cvt_pk_bf16_f32 v62, v40, v41
    v_exp_f32 v44, v44
    v_exp_f32 v45, v45
    v_cvt_pk_bf16_f32 v63, v42, v43
    v_smfmac_f32_16x16x64_bf16 v[100:103], a[176:179], v[52:59], v18
    s_add_u32 s79, s58, s69
    v_exp_f32 v46, v46
    v_exp_f32 v47, v47
    v_cvt_pk_bf16_f32 v64, v44, v45
    v_exp_f32 v48, v48
    v_mfma_f32_32x32x16_bf16 v[68:83], a[172:175], v[56:59], v[68:83]
    s_add_u32 s62, s62, 1
    v_exp_f32 v49, v49
    v_cvt_pk_bf16_f32 v65, v46, v47
    v_exp_f32 v50, v50
    v_exp_f32 v51, v51
    v_cvt_pk_bf16_f32 v66, v48, v49
    v_cvt_pk_bf16_f32 v67, v50, v51
    v_add_u32 v3, s65, v2
    v_add_u32 v4, s66, v2
    v_mfma_f32_32x32x16_bf16 v[84:99], a[168:171], v[60:63], v[84:99]
    s_waitcnt lgkmcnt(0)
    v_exp_f32 v20, v20
    v_exp_f32 v21, v21
    v_exp_f32 v22, v22
    v_exp_f32 v23, v23
    v_mfma_f32_32x32x16_bf16 v[36:51], a[144:147], a[136:139], 0
    ds_read_b128 a[152:155], v3 offset:4096
    v_cvt_pk_bf16_f32 v52, v20, v21
    v_exp_f32 v24, v24
    v_exp_f32 v25, v25
    v_cvt_pk_bf16_f32 v53, v22, v23
    v_exp_f32 v26, v26
    v_mfma_f32_32x32x16_bf16 v[36:51], a[148:151], a[140:143], v[36:51]
    ds_read_b128 a[156:159], v3 offset:5120
    v_exp_f32 v27, v27
    v_cvt_pk_bf16_f32 v54, v24, v25
    v_exp_f32 v28, v28
    v_exp_f32 v29, v29
    v_cvt_pk_bf16_f32 v55, v26, v27
    v_smfmac_f32_16x16x64_bf16 v[104:107], a[176:179], v[60:67], v18
    s_mov_b32 m0, s79
    v_exp_f32 v30, v30
    v_exp_f32 v31, v31
    v_cvt_pk_bf16_f32 v56, v28, v29
    v_exp_f32 v32, v32
    v_mfma_f32_32x32x16_bf16 v[84:99], a[172:175], v[64:67], v[84:99]
    buffer_load_dwordx4 v2, s[44:47], s68 offen offset:0 sc1 lds
    v_exp_f32 v33, v33
    v_cvt_pk_bf16_f32 v57, v30, v31
    v_exp_f32 v34, v34
    v_exp_f32 v35, v35
    v_cvt_pk_bf16_f32 v58, v32, v33
    v_cvt_pk_bf16_f32 v59, v34, v35
    v_mfma_f32_32x32x16_bf16 v[68:83], a[160:163], v[52:55], v[68:83]
    s_waitcnt lgkmcnt(0)
    v_exp_f32 v36, v36
    v_exp_f32 v37, v37
    v_exp_f32 v38, v38
    v_exp_f32 v39, v39
    v_mfma_f32_32x32x16_bf16 v[20:35], a[152:155], a[128:131], 0
    ds_read_b128 a[168:171], v3 offset:6144
    v_cvt_pk_bf16_f32 v60, v36, v37
    v_exp_f32 v40, v40
    v_exp_f32 v41, v41
    v_cvt_pk_bf16_f32 v61, v38, v39
    v_exp_f32 v42, v42
    v_mfma_f32_32x32x16_bf16 v[20:35], a[156:159], a[132:135], v[20:35]
    ds_read_b128 a[172:175], v3 offset:7168
    v_exp_f32 v43, v43
    v_cvt_pk_bf16_f32 v62, v40, v41
    v_exp_f32 v44, v44
    v_exp_f32 v45, v45
    v_cvt_pk_bf16_f32 v63, v42, v43
    v_smfmac_f32_16x16x64_bf16 v[100:103], a[176:179], v[52:59], v18
    s_mov_b32 m0, s79
    v_exp_f32 v46, v46
    v_exp_f32 v47, v47
    v_cvt_pk_bf16_f32 v64, v44, v45
    v_exp_f32 v48, v48
    v_mfma_f32_32x32x16_bf16 v[68:83], a[164:167], v[56:59], v[68:83]
    buffer_load_dwordx4 v2, s[44:47], s68 offen offset:1024 sc1 lds
    v_exp_f32 v49, v49
    v_cvt_pk_bf16_f32 v65, v46, v47
    v_exp_f32 v50, v50
    v_exp_f32 v51, v51
    v_cvt_pk_bf16_f32 v66, v48, v49
    v_cvt_pk_bf16_f32 v67, v50, v51
    v_mfma_f32_32x32x16_bf16 v[84:99], a[160:163], v[60:63], v[84:99]
    s_waitcnt lgkmcnt(0)
    v_exp_f32 v20, v20
    v_exp_f32 v21, v21
    v_exp_f32 v22, v22
    v_exp_f32 v23, v23
    v_mfma_f32_32x32x16_bf16 v[36:51], a[152:155], a[136:139], 0
    ds_read_b128 a[144:147], v3 offset:8192
    v_cvt_pk_bf16_f32 v52, v20, v21
    v_exp_f32 v24, v24
    v_exp_f32 v25, v25
    v_cvt_pk_bf16_f32 v53, v22, v23
    v_exp_f32 v26, v26
    v_mfma_f32_32x32x16_bf16 v[36:51], a[156:159], a[140:143], v[36:51]
    ds_read_b128 a[148:151], v3 offset:9216
    v_exp_f32 v27, v27
    v_cvt_pk_bf16_f32 v54, v24, v25
    v_exp_f32 v28, v28
    v_exp_f32 v29, v29
    v_cvt_pk_bf16_f32 v55, v26, v27
    v_smfmac_f32_16x16x64_bf16 v[104:107], a[176:179], v[60:67], v18
    s_mov_b32 m0, s79
    s_mov_b32 s59, 23527424
    buffer_load_dwordx4 v[252:255], v12, s[32:35], s59 offen sc1
    v_exp_f32 v30, v30
    v_exp_f32 v31, v31
    v_cvt_pk_bf16_f32 v56, v28, v29
    v_exp_f32 v32, v32
    v_mfma_f32_32x32x16_bf16 v[84:99], a[164:167], v[64:67], v[84:99]
    buffer_load_dwordx4 v2, s[44:47], s68 offen offset:2048 sc1 lds
    v_exp_f32 v33, v33
    v_cvt_pk_bf16_f32 v57, v30, v31
    v_exp_f32 v34, v34
    v_exp_f32 v35, v35
    v_cvt_pk_bf16_f32 v58, v32, v33
    v_cvt_pk_bf16_f32 v59, v34, v35
    v_mfma_f32_32x32x16_bf16 v[68:83], a[168:171], v[52:55], v[68:83]
    s_waitcnt lgkmcnt(0)
    v_exp_f32 v36, v36
    v_exp_f32 v37, v37
    v_exp_f32 v38, v38
    v_exp_f32 v39, v39
    v_mfma_f32_32x32x16_bf16 v[20:35], a[144:147], a[128:131], 0
    ds_read_b128 a[160:163], v3 offset:10240
    v_cvt_pk_bf16_f32 v60, v36, v37
    v_exp_f32 v40, v40
    v_exp_f32 v41, v41
    v_cvt_pk_bf16_f32 v61, v38, v39
    v_exp_f32 v42, v42
    v_mfma_f32_32x32x16_bf16 v[20:35], a[148:151], a[132:135], v[20:35]
    ds_read_b128 a[164:167], v3 offset:11264
    v_exp_f32 v43, v43
    v_cvt_pk_bf16_f32 v62, v40, v41
    v_exp_f32 v44, v44
    v_exp_f32 v45, v45
    v_cvt_pk_bf16_f32 v63, v42, v43
    v_smfmac_f32_16x16x64_bf16 v[100:103], a[176:179], v[52:59], v18
    s_mov_b32 m0, s79
    v_exp_f32 v46, v46
    v_exp_f32 v47, v47
    v_cvt_pk_bf16_f32 v64, v44, v45
    v_exp_f32 v48, v48
    v_mfma_f32_32x32x16_bf16 v[68:83], a[172:175], v[56:59], v[68:83]
    buffer_load_dwordx4 v2, s[44:47], s68 offen offset:3072 sc1 lds
    v_exp_f32 v49, v49
    v_cvt_pk_bf16_f32 v65, v46, v47
    v_exp_f32 v50, v50
    v_exp_f32 v51, v51
    v_cvt_pk_bf16_f32 v66, v48, v49
    v_cvt_pk_bf16_f32 v67, v50, v51
    v_mfma_f32_32x32x16_bf16 v[84:99], a[168:171], v[60:63], v[84:99]
    s_waitcnt lgkmcnt(0)
    v_exp_f32 v20, v20
    v_exp_f32 v21, v21
    v_exp_f32 v22, v22
    v_exp_f32 v23, v23
    v_mfma_f32_32x32x16_bf16 v[36:51], a[144:147], a[136:139], 0
    s_add_u32 s68, s68, 4096
    ds_read_b128 a[152:155], v3 offset:12288
    v_cvt_pk_bf16_f32 v52, v20, v21
    v_exp_f32 v24, v24
    v_exp_f32 v25, v25
    v_cvt_pk_bf16_f32 v53, v22, v23
    v_exp_f32 v26, v26
    v_mfma_f32_32x32x16_bf16 v[36:51], a[148:151], a[140:143], v[36:51]
    s_add_u32 s79, s79, 4096
    ds_read_b128 a[156:159], v3 offset:13312
    v_exp_f32 v27, v27
    v_cvt_pk_bf16_f32 v54, v24, v25
    v_exp_f32 v28, v28
    v_exp_f32 v29, v29
    v_cvt_pk_bf16_f32 v55, v26, v27
    v_smfmac_f32_16x16x64_bf16 v[104:107], a[176:179], v[60:67], v18
    s_mov_b32 m0, s79
    v_exp_f32 v30, v30
    v_exp_f32 v31, v31
    v_cvt_pk_bf16_f32 v56, v28, v29
    v_exp_f32 v32, v32
    v_mfma_f32_32x32x16_bf16 v[84:99], a[172:175], v[64:67], v[84:99]
    buffer_load_dwordx4 v2, s[44:47], s68 offen offset:0 sc1 lds
    v_exp_f32 v33, v33
    v_cvt_pk_bf16_f32 v57, v30, v31
    v_exp_f32 v34, v34
    v_exp_f32 v35, v35
    v_cvt_pk_bf16_f32 v58, v32, v33
    v_cvt_pk_bf16_f32 v59, v34, v35
    v_mfma_f32_32x32x16_bf16 v[68:83], a[160:163], v[52:55], v[68:83]
    s_waitcnt lgkmcnt(0)
    v_exp_f32 v36, v36
    v_exp_f32 v37, v37
    v_exp_f32 v38, v38
    v_exp_f32 v39, v39
    v_mfma_f32_32x32x16_bf16 v[20:35], a[152:155], a[128:131], 0
    ds_read_b128 a[168:171], v3 offset:14336
    v_cvt_pk_bf16_f32 v60, v36, v37
    v_exp_f32 v40, v40
    v_exp_f32 v41, v41
    v_cvt_pk_bf16_f32 v61, v38, v39
    v_exp_f32 v42, v42
    v_mfma_f32_32x32x16_bf16 v[20:35], a[156:159], a[132:135], v[20:35]
    ds_read_b128 a[172:175], v3 offset:15360
    s_waitcnt vmcnt(3)
    v_xor_b32 v252, v252, v6
    v_xor_b32 v253, v253, v6
    v_xor_b32 v254, v254, v6
    v_xor_b32 v255, v255, v6
    v_or3_b32 v252, v252, v253, v254
    v_or_b32 v252, v252, v255
    v_cmp_eq_u32 vcc, 0, v252
    s_nop 0
    s_cmp_eq_u64 vcc, -1
    s_cbranch_scc0 P3_SLOWH
P3_HOK:
    v_exp_f32 v43, v43
    v_cvt_pk_bf16_f32 v62, v40, v41
    v_exp_f32 v44, v44
    v_exp_f32 v45, v45
    v_cvt_pk_bf16_f32 v63, v42, v43
    v_smfmac_f32_16x16x64_bf16 v[100:103], a[176:179], v[52:59], v18
    s_mov_b32 m0, s79
    s_lshl_b32 s60, s63, 10
    s_lshl_b32 s61, s56, 8
    s_add_u32 s60, s60, s61
    s_add_u32 s60, s60, 23330816
    s_lshl_b32 s61, s71, 9
    s_add_u32 s61, s61, 23330816
    v_exp_f32 v46, v46
    v_exp_f32 v47, v47
    v_cvt_pk_bf16_f32 v64, v44, v45
    v_exp_f32 v48, v48
    v_mfma_f32_32x32x16_bf16 v[68:83], a[164:167], v[56:59], v[68:83]
    buffer_load_dwordx4 v2, s[44:47], s68 offen offset:1024 sc1 lds
    v_exp_f32 v49, v49
    v_cvt_pk_bf16_f32 v65, v46, v47
    v_exp_f32 v50, v50
    v_exp_f32 v51, v51
    v_cvt_pk_bf16_f32 v66, v48, v49
    v_cvt_pk_bf16_f32 v67, v50, v51
    v_mfma_f32_32x32x16_bf16 v[84:99], a[160:163], v[60:63], v[84:99]
    s_waitcnt lgkmcnt(0)
    buffer_load_dwordx4 a[0:3], v17, s[36:39], 0 offen offset:0 sc1
    v_exp_f32 v20, v20
    v_exp_f32 v21, v21
    v_exp_f32 v22, v22
    v_exp_f32 v23, v23
    v_mfma_f32_32x32x16_bf16 v[36:51], a[152:155], a[136:139], 0
    ds_read_b128 a[144:147], v3 offset:16384
    v_cvt_pk_bf16_f32 v52, v20, v21
    v_exp_f32 v24, v24
    v_exp_f32 v25, v25
    v_cvt_pk_bf16_f32 v53, v22, v23
    v_exp_f32 v26, v26
    v_mfma_f32_32x32x16_bf16 v[36:51], a[156:159], a[140:143], v[36:51]
    ds_read_b128 a[148:151], v3 offset:17408
    buffer_load_dwordx4 a[12:15], v17, s[36:39], s73 offen offset:2048 sc1
    v_exp_f32 v27, v27
    v_cvt_pk_bf16_f32 v54, v24, v25
    v_exp_f32 v28, v28
    v_exp_f32 v29, v29
    v_cvt_pk_bf16_f32 v55, v26, v27
    v_smfmac_f32_16x16x64_bf16 v[104:107], a[176:179], v[60:67], v18
    s_mov_b32 m0, s79
    buffer_load_dwordx4 a[4:7], v17, s[36:39], 0 offen offset:2048 sc1
    v_exp_f32 v30, v30
    v_exp_f32 v31, v31
    v_cvt_pk_bf16_f32 v56, v28, v29
    v_exp_f32 v32, v32
    v_mfma_f32_32x32x16_bf16 v[84:99], a[164:167], v[64:67], v[84:99]
    buffer_load_dwordx4 v2, s[44:47], s68 offen offset:2048 sc1 lds
    buffer_load_dwordx4 a[8:11], v17, s[36:39], s73 offen offset:0 sc1
    v_exp_f32 v33, v33
    v_cvt_pk_bf16_f32 v57, v30, v31
    v_exp_f32 v34, v34
    v_exp_f32 v35, v35
    v_cvt_pk_bf16_f32 v58, v32, v33
    v_cvt_pk_bf16_f32 v59, v34, v35
    v_mfma_f32_32x32x16_bf16 v[68:83], a[168:171], v[52:55], v[68:83]
    s_waitcnt lgkmcnt(0)
    buffer_load_dwordx4 a[16:19], v17, s[36:39], s74 offen offset:0 sc1
    v_exp_f32 v36, v36
    v_exp_f32 v37, v37
    v_exp_f32 v38, v38
    v_exp_f32 v39, v39
    v_mfma_f32_32x32x16_bf16 v[20:35], a[144:147], a[128:131], 0
    ds_read_b128 a[160:163], v3 offset:18432
    v_cvt_pk_bf16_f32 v60, v36, v37
    v_exp_f32 v40, v40
    v_exp_f32 v41, v41
    v_cvt_pk_bf16_f32 v61, v38, v39
    v_exp_f32 v42, v42
    v_mfma_f32_32x32x16_bf16 v[20:35], a[148:151], a[132:135], v[20:35]
    ds_read_b128 a[164:167], v3 offset:19456
    v_exp_f32 v43, v43
    v_cvt_pk_bf16_f32 v62, v40, v41
    v_exp_f32 v44, v44
    v_exp_f32 v45, v45
    v_cvt_pk_bf16_f32 v63, v42, v43
    v_smfmac_f32_16x16x64_bf16 v[100:103], a[176:179], v[52:59], v18
    s_mov_b32 m0, s79
    buffer_load_dwordx4 a[20:23], v17, s[36:39], s74 offen offset:2048 sc1
    v_exp_f32 v46, v46
    v_exp_f32 v47, v47
    v_cvt_pk_bf16_f32 v64, v44, v45
    v_exp_f32 v48, v48
    v_mfma_f32_32x32x16_bf16 v[68:83], a[172:175], v[56:59], v[68:83]
    buffer_load_dwordx4 v2, s[44:47], s68 offen offset:3072 sc1 lds
    buffer_load_dwordx4 a[24:27], v17, s[36:39], s16 offen offset:0 sc1
    v_exp_f32 v49, v49
    v_cvt_pk_bf16_f32 v65, v46, v47
    v_exp_f32 v50, v50
    v_exp_f32 v51, v51
    v_cvt_pk_bf16_f32 v66, v48, v49
    v_cvt_pk_bf16_f32 v67, v50, v51
    v_mfma_f32_32x32x16_bf16 v[84:99], a[168:171], v[60:63], v[84:99]
    s_waitcnt lgkmcnt(0)
    buffer_load_dwordx4 a[28:31], v17, s[36:39], s16 offen offset:2048 sc1
    s_add_u32 s36, s36, 1064960
    s_addc_u32 s37, s37, 0
    v_exp_f32 v20, v20
    v_exp_f32 v21, v21
    v_exp_f32 v22, v22
    v_exp_f32 v23, v23
    v_mfma_f32_32x32x16_bf16 v[36:51], a[144:147], a[136:139], 0
    s_add_u32 s68, s68, 28672
    ds_read_b128 a[152:155], v3 offset:20480
    v_cvt_pk_bf16_f32 v52, v20, v21
    v_exp_f32 v24, v24
    v_exp_f32 v25, v25
    v_cvt_pk_bf16_f32 v53, v22, v23
    v_exp_f32 v26, v26
    v_mfma_f32_32x32x16_bf16 v[36:51], a[148:151], a[140:143], v[36:51]
    ds_read_b128 a[156:159], v3 offset:21504
    v_exp_f32 v27, v27
    v_cvt_pk_bf16_f32 v54, v24, v25
    v_exp_f32 v28, v28
    v_exp_f32 v29, v29
    v_cvt_pk_bf16_f32 v55, v26, v27
    v_smfmac_f32_16x16x64_bf16 v[104:107], a[176:179], v[60:67], v18
    buffer_load_dword a252, v249, s[52:55], s8 offen
    s_add_u32 s8, s8, 0x100000
    buffer_load_dwordx4 a[32:35], v17, s[36:39], 0 offen offset:0 sc1
    v_exp_f32 v30, v30
    v_exp_f32 v31, v31
    v_cvt_pk_bf16_f32 v56, v28, v29
    v_exp_f32 v32, v32
    v_mfma_f32_32x32x16_bf16 v[84:99], a[172:175], v[64:67], v[84:99]
    buffer_load_dwordx4 a[36:39], v17, s[36:39], 0 offen offset:2048 sc1
    v_exp_f32 v33, v33
    v_cvt_pk_bf16_f32 v57, v30, v31
    v_exp_f32 v34, v34
    v_exp_f32 v35, v35
    v_cvt_pk_bf16_f32 v58, v32, v33
    v_cvt_pk_bf16_f32 v59, v34, v35
    v_mfma_f32_32x32x16_bf16 v[68:83], a[160:163], v[52:55], v[68:83]
    s_waitcnt lgkmcnt(0)
    buffer_load_dwordx4 a[40:43], v17, s[36:39], s73 offen offset:0 sc1
    v_exp_f32 v36, v36
    v_exp_f32 v37, v37
    v_exp_f32 v38, v38
    v_exp_f32 v39, v39
    v_mfma_f32_32x32x16_bf16 v[20:35], a[152:155], a[128:131], 0
    ds_read_b128 a[168:171], v3 offset:22528
    v_cvt_pk_bf16_f32 v60, v36, v37
    v_exp_f32 v40, v40
    v_exp_f32 v41, v41
    v_cvt_pk_bf16_f32 v61, v38, v39
    v_exp_f32 v42, v42
    v_mfma_f32_32x32x16_bf16 v[20:35], a[156:159], a[132:135], v[20:35]
    ds_read_b128 a[172:175], v3 offset:23552
    v_exp_f32 v43, v43
    v_cvt_pk_bf16_f32 v62, v40, v41
    v_exp_f32 v44, v44
    v_exp_f32 v45, v45
    v_cvt_pk_bf16_f32 v63, v42, v43
    v_smfmac_f32_16x16x64_bf16 v[100:103], a[176:179], v[52:59], v18
    buffer_load_dwordx4 a[44:47], v17, s[36:39], s73 offen offset:2048 sc1
    v_exp_f32 v46, v46
    v_exp_f32 v47, v47
    v_cvt_pk_bf16_f32 v64, v44, v45
    v_exp_f32 v48, v48
    v_mfma_f32_32x32x16_bf16 v[68:83], a[164:167], v[56:59], v[68:83]
    buffer_load_dwordx4 a[48:51], v17, s[36:39], s74 offen offset:0 sc1
    v_exp_f32 v49, v49
    v_cvt_pk_bf16_f32 v65, v46, v47
    v_exp_f32 v50, v50
    v_exp_f32 v51, v51
    v_cvt_pk_bf16_f32 v66, v48, v49
    v_cvt_pk_bf16_f32 v67, v50, v51
    v_mfma_f32_32x32x16_bf16 v[84:99], a[160:163], v[60:63], v[84:99]
    s_waitcnt lgkmcnt(0)
    buffer_load_dwordx4 a[52:55], v17, s[36:39], s74 offen offset:2048 sc1
    v_exp_f32 v20, v20
    v_exp_f32 v21, v21
    v_exp_f32 v22, v22
    v_exp_f32 v23, v23
    v_mfma_f32_32x32x16_bf16 v[36:51], a[152:155], a[136:139], 0
    ds_read_b128 a[144:147], v3 offset:24576
    v_cvt_pk_bf16_f32 v52, v20, v21
    v_exp_f32 v24, v24
    v_exp_f32 v25, v25
    v_cvt_pk_bf16_f32 v53, v22, v23
    v_exp_f32 v26, v26
    v_mfma_f32_32x32x16_bf16 v[36:51], a[156:159], a[140:143], v[36:51]
    ds_read_b128 a[148:151], v3 offset:25600
    v_exp_f32 v27, v27
    v_cvt_pk_bf16_f32 v54, v24, v25
    v_exp_f32 v28, v28
    v_exp_f32 v29, v29
    v_cvt_pk_bf16_f32 v55, v26, v27
    v_smfmac_f32_16x16x64_bf16 v[104:107], a[176:179], v[60:67], v18
    buffer_load_dwordx4 a[56:59], v17, s[36:39], s16 offen offset:0 sc1
    v_exp_f32 v30, v30
    v_exp_f32 v31, v31
    v_cvt_pk_bf16_f32 v56, v28, v29
    v_exp_f32 v32, v32
    v_mfma_f32_32x32x16_bf16 v[84:99], a[164:167], v[64:67], v[84:99]
    buffer_load_dwordx4 a[60:63], v17, s[36:39], s16 offen offset:2048 sc1
    s_add_u32 s36, s36, 1064960
    s_addc_u32 s37, s37, 0
    v_exp_f32 v33, v33
    v_cvt_pk_bf16_f32 v57, v30, v31
    v_exp_f32 v34, v34
    v_exp_f32 v35, v35
    v_cvt_pk_bf16_f32 v58, v32, v33
    v_cvt_pk_bf16_f32 v59, v34, v35
    v_mfma_f32_32x32x16_bf16 v[68:83], a[168:171], v[52:55], v[68:83]
    s_waitcnt lgkmcnt(0)
    buffer_load_dwordx4 a[64:67], v17, s[36:39], 0 offen offset:0 sc1
    v_exp_f32 v36, v36
    v_exp_f32 v37, v37
    v_exp_f32 v38, v38
    v_exp_f32 v39, v39
    v_mfma_f32_32x32x16_bf16 v[20:35], a[144:147], a[128:131], 0
    ds_read_b128 a[160:163], v3 offset:26624
    v_cvt_pk_bf16_f32 v60, v36, v37
    v_exp_f32 v40, v40
    v_exp_f32 v41, v41
    v_cvt_pk_bf16_f32 v61, v38, v39
    v_exp_f32 v42, v42
    v_mfma_f32_32x32x16_bf16 v[20:35], a[148:151], a[132:135], v[20:35]
    ds_read_b128 a[164:167], v3 offset:27648
    buffer_load_dwordx4 a[76:79], v17, s[36:39], s73 offen offset:2048 sc1
    v_exp_f32 v43, v43
    v_cvt_pk_bf16_f32 v62, v40, v41
    v_exp_f32 v44, v44
    v_exp_f32 v45, v45
    v_cvt_pk_bf16_f32 v63, v42, v43
    v_smfmac_f32_16x16x64_bf16 v[100:103], a[176:179], v[52:59], v18
    buffer_load_dwordx4 a[68:71], v17, s[36:39], 0 offen offset:2048 sc1
    v_exp_f32 v46, v46
    v_exp_f32 v47, v47
    v_cvt_pk_bf16_f32 v64, v44, v45
    v_exp_f32 v48, v48
    v_mfma_f32_32x32x16_bf16 v[68:83], a[172:175], v[56:59], v[68:83]
    buffer_load_dwordx4 a[72:75], v17, s[36:39], s73 offen offset:0 sc1
    v_exp_f32 v49, v49
    v_cvt_pk_bf16_f32 v65, v46, v47
    v_exp_f32 v50, v50
    v_exp_f32 v51, v51
    v_cvt_pk_bf16_f32 v66, v48, v49
    v_cvt_pk_bf16_f32 v67, v50, v51
    v_mfma_f32_32x32x16_bf16 v[84:99], a[168:171], v[60:63], v[84:99]
    s_waitcnt lgkmcnt(0)
    buffer_load_dwordx4 a[80:83], v17, s[36:39], s74 offen offset:0 sc1
    v_exp_f32 v20, v20
    v_exp_f32 v21, v21
    v_exp_f32 v22, v22
    v_exp_f32 v23, v23
    v_mfma_f32_32x32x16_bf16 v[36:51], a[144:147], a[136:139], 0
    ds_read_b128 a[152:155], v3 offset:28672
    v_cvt_pk_bf16_f32 v52, v20, v21
    v_exp_f32 v24, v24
    v_exp_f32 v25, v25
    v_cvt_pk_bf16_f32 v53, v22, v23
    v_exp_f32 v26, v26
    v_mfma_f32_32x32x16_bf16 v[36:51], a[148:151], a[140:143], v[36:51]
    ds_read_b128 a[156:159], v3 offset:29696
    v_exp_f32 v27, v27
    v_cvt_pk_bf16_f32 v54, v24, v25
    v_exp_f32 v28, v28
    v_exp_f32 v29, v29
    v_cvt_pk_bf16_f32 v55, v26, v27
    v_smfmac_f32_16x16x64_bf16 v[104:107], a[176:179], v[60:67], v18
    buffer_load_dwordx4 a[84:87], v17, s[36:39], s74 offen offset:2048 sc1
    v_exp_f32 v30, v30
    v_exp_f32 v31, v31
    v_cvt_pk_bf16_f32 v56, v28, v29
    v_exp_f32 v32, v32
    v_mfma_f32_32x32x16_bf16 v[84:99], a[172:175], v[64:67], v[84:99]
    buffer_load_dwordx4 a[88:91], v17, s[36:39], s16 offen offset:0 sc1
    v_exp_f32 v33, v33
    v_cvt_pk_bf16_f32 v57, v30, v31
    v_exp_f32 v34, v34
    v_exp_f32 v35, v35
    v_cvt_pk_bf16_f32 v58, v32, v33
    v_cvt_pk_bf16_f32 v59, v34, v35
    v_mfma_f32_32x32x16_bf16 v[68:83], a[160:163], v[52:55], v[68:83]
    s_waitcnt lgkmcnt(0)
    buffer_load_dwordx4 a[92:95], v17, s[36:39], s16 offen offset:2048 sc1
    s_add_u32 s36, s36, 1064960
    s_addc_u32 s37, s37, 0
    v_exp_f32 v36, v36
    v_exp_f32 v37, v37
    v_exp_f32 v38, v38
    v_exp_f32 v39, v39
    v_mfma_f32_32x32x16_bf16 v[20:35], a[152:155], a[128:131], 0
    ds_read_b128 a[168:171], v3 offset:30720
    v_cvt_pk_bf16_f32 v60, v36, v37
    v_exp_f32 v40, v40
    v_exp_f32 v41, v41
    v_cvt_pk_bf16_f32 v61, v38, v39
    v_exp_f32 v42, v42
    v_mfma_f32_32x32x16_bf16 v[20:35], a[156:159], a[132:135], v[20:35]
    ds_read_b128 a[172:175], v3 offset:31744
    v_exp_f32 v43, v43
    v_cvt_pk_bf16_f32 v62, v40, v41
    v_exp_f32 v44, v44
    v_exp_f32 v45, v45
    v_cvt_pk_bf16_f32 v63, v42, v43
    v_smfmac_f32_16x16x64_bf16 v[100:103], a[176:179], v[52:59], v18
    buffer_load_dwordx4 a[96:99], v17, s[36:39], 0 offen offset:0 sc1
    v_exp_f32 v46, v46
    v_exp_f32 v47, v47
    v_cvt_pk_bf16_f32 v64, v44, v45
    v_exp_f32 v48, v48
    v_mfma_f32_32x32x16_bf16 v[68:83], a[164:167], v[56:59], v[68:83]
    buffer_load_dwordx4 a[100:103], v17, s[36:39], 0 offen offset:2048 sc1
    v_exp_f32 v49, v49
    v_cvt_pk_bf16_f32 v65, v46, v47
    v_exp_f32 v50, v50
    v_exp_f32 v51, v51
    v_cvt_pk_bf16_f32 v66, v48, v49
    v_cvt_pk_bf16_f32 v67, v50, v51
    v_mfma_f32_32x32x16_bf16 v[84:99], a[160:163], v[60:63], v[84:99]
    s_waitcnt vmcnt(41) lgkmcnt(0)
    s_barrier
    buffer_load_dwordx4 a[104:107], v17, s[36:39], s73 offen offset:0 sc1
    v_exp_f32 v20, v20
    v_exp_f32 v21, v21
    v_exp_f32 v22, v22
    v_exp_f32 v23, v23
    v_mfma_f32_32x32x16_bf16 v[36:51], a[152:155], a[136:139], 0
    ds_read_b128 a[144:147], v4 offset:0
    v_cvt_pk_bf16_f32 v52, v20, v21
    v_exp_f32 v24, v24
    v_exp_f32 v25, v25
    v_cvt_pk_bf16_f32 v53, v22, v23
    v_exp_f32 v26, v26
    v_mfma_f32_32x32x16_bf16 v[36:51], a[156:159], a[140:143], v[36:51]
    ds_read_b128 a[148:151], v4 offset:1024
    v_exp_f32 v27, v27
    v_cvt_pk_bf16_f32 v54, v24, v25
    v_exp_f32 v28, v28
    v_exp_f32 v29, v29
    v_cvt_pk_bf16_f32 v55, v26, v27
    v_smfmac_f32_16x16x64_bf16 v[104:107], a[176:179], v[60:67], v18
    s_mov_b32 s58, s65
    buffer_load_dwordx4 a[108:111], v17, s[36:39], s73 offen offset:2048 sc1
    v_exp_f32 v30, v30
    v_exp_f32 v31, v31
    v_cvt_pk_bf16_f32 v56, v28, v29
    v_exp_f32 v32, v32
    v_mfma_f32_32x32x16_bf16 v[84:99], a[164:167], v[64:67], v[84:99]
    s_mov_b32 s65, s66
    buffer_load_dwordx4 a[112:115], v17, s[36:39], s74 offen offset:0 sc1
    v_exp_f32 v33, v33
    v_cvt_pk_bf16_f32 v57, v30, v31
    v_exp_f32 v34, v34
    v_exp_f32 v35, v35
    v_cvt_pk_bf16_f32 v58, v32, v33
    v_cvt_pk_bf16_f32 v59, v34, v35
    v_mfma_f32_32x32x16_bf16 v[68:83], a[168:171], v[52:55], v[68:83]
    s_waitcnt lgkmcnt(0)
    buffer_load_dwordx4 a[116:119], v17, s[36:39], s74 offen offset:2048 sc1
    v_exp_f32 v36, v36
    v_exp_f32 v37, v37
    v_exp_f32 v38, v38
    v_exp_f32 v39, v39
    v_mfma_f32_32x32x16_bf16 v[20:35], a[144:147], a[128:131], 0
    s_mov_b32 s66, s67
    ds_read_b128 a[160:163], v4 offset:2048
    v_cvt_pk_bf16_f32 v60, v36, v37
    v_exp_f32 v40, v40
    v_exp_f32 v41, v41
    v_cvt_pk_bf16_f32 v61, v38, v39
    v_exp_f32 v42, v42
    v_mfma_f32_32x32x16_bf16 v[20:35], a[148:151], a[132:135], v[20:35]
    s_mov_b32 s67, s58
    ds_read_b128 a[164:167], v4 offset:3072
    v_exp_f32 v43, v43
    v_cvt_pk_bf16_f32 v62, v40, v41
    v_exp_f32 v44, v44
    v_exp_f32 v45, v45
    v_cvt_pk_bf16_f32 v63, v42, v43
    v_smfmac_f32_16x16x64_bf16 v[100:103], a[176:179], v[52:59], v18
    s_add_u32 s79, s58, s69
    buffer_load_dwordx4 a[120:123], v17, s[36:39], s16 offen offset:0 sc1
    s_waitcnt vmcnt(63)
    ds_read_b64_tr_b16 a[220:221], v245 offset:0
    ds_read_b64_tr_b16 a[222:223], v245 offset:2048
    ds_read_b64_tr_b16 a[224:225], v246 offset:0
    ds_read_b64_tr_b16 a[226:227], v246 offset:2048
    ds_read_b64_tr_b16 a[228:229], v247 offset:0
    ds_read_b64_tr_b16 a[230:231], v247 offset:2048
    ds_read_b64_tr_b16 a[232:233], v248 offset:0
    ds_read_b64_tr_b16 a[234:235], v248 offset:2048
    v_exp_f32 v46, v46
    v_exp_f32 v47, v47
    v_cvt_pk_bf16_f32 v64, v44, v45
    v_exp_f32 v48, v48
    v_mfma_f32_32x32x16_bf16 v[68:83], a[172:175], v[56:59], v[68:83]
    s_add_u32 s62, s62, 1
    buffer_load_dwordx4 a[124:127], v17, s[36:39], s16 offen offset:2048 sc1
    s_add_u32 s36, s36, 1064960
    s_addc_u32 s37, s37, 0
    v_exp_f32 v49, v49
    v_cvt_pk_bf16_f32 v65, v46, v47
    v_exp_f32 v50, v50
    v_exp_f32 v51, v51
    v_cvt_pk_bf16_f32 v66, v48, v49
    v_cvt_pk_bf16_f32 v67, v50, v51
    v_add_u32 v3, s65, v2
    v_add_u32 v4, s66, v2
    v_mfma_f32_32x32x16_bf16 v[84:99], a[168:171], v[60:63], v[84:99]
    s_waitcnt vmcnt(25) lgkmcnt(0)
    v_exp_f32 v20, v20
    v_exp_f32 v21, v21
    v_exp_f32 v22, v22
    v_mfma_f32_16x16x32_bf16 v[116:119], a[220:223], a[0:3], 0
    ds_read_b128 a[152:155], v3 offset:4096
    v_exp_f32 v23, v23
    v_mfma_f32_32x32x16_bf16 v[36:51], a[144:147], a[136:139], 0
    s_add_u32 m0, s78, 0
    v_exp_f32 v24, v24
    v_exp_f32 v25, v25
    v_exp_f32 v26, v26
    v_mfma_f32_16x16x32_bf16 v[148:151], a[224:227], a[0:3], 0
    buffer_load_dwordx4 v244, s[40:43], 0 offen offset:0 sc1 lds
    v_cvt_pk_bf16_f32 v52, v20, v21
    v_cvt_pk_bf16_f32 v53, v22, v23
    v_mfma_f32_16x16x32_bf16 v[180:183], a[228:231], a[0:3], 0
    ds_read_b128 a[156:159], v3 offset:5120
    v_exp_f32 v27, v27
    v_mfma_f32_32x32x16_bf16 v[36:51], a[148:151], a[140:143], v[36:51]
    ds_read_b64_tr_b16 a[236:237], v245 offset:4096
    v_exp_f32 v28, v28
    v_exp_f32 v29, v29
    v_exp_f32 v30, v30
    v_mfma_f32_16x16x32_bf16 v[212:215], a[232:235], a[0:3], 0
    v_cvt_pk_bf16_f32 v54, v24, v25
    v_cvt_pk_bf16_f32 v55, v26, v27
    v_smfmac_f32_16x16x64_bf16 v[104:107], a[176:179], v[60:67], v18
    buffer_load_dwordx4 a[0:3], v17, s[36:39], 0 offen offset:0 sc1
    v_cvt_pk_bf16_f32 v56, v28, v29
    v_mfma_f32_16x16x32_bf16 v[120:123], a[220:223], a[4:7], 0
    s_mov_b32 m0, s79
    v_exp_f32 v31, v31
    v_mfma_f32_32x32x16_bf16 v[84:99], a[172:175], v[64:67], v[84:99]
    buffer_load_dwordx4 v2, s[44:47], s68 offen offset:0 sc1 lds
    v_exp_f32 v32, v32
    v_exp_f32 v33, v33
    v_exp_f32 v34, v34
    v_mfma_f32_16x16x32_bf16 v[152:155], a[224:227], a[4:7], 0
    ds_read_b64_tr_b16 a[238:239], v245 offset:6144
    v_exp_f32 v35, v35
    v_mfma_f32_16x16x32_bf16 v[184:187], a[228:231], a[4:7], 0
    v_cvt_pk_bf16_f32 v57, v30, v31
    v_cvt_pk_bf16_f32 v58, v32, v33
    v_mfma_f32_16x16x32_bf16 v[216:219], a[232:235], a[4:7], 0
    buffer_load_dwordx4 a[4:7], v17, s[36:39], 0 offen offset:2048 sc1
    v_cvt_pk_bf16_f32 v59, v34, v35
    v_mfma_f32_32x32x16_bf16 v[68:83], a[160:163], v[52:55], v[68:83]
    s_waitcnt lgkmcnt(2)
    v_exp_f32 v36, v36
    v_exp_f32 v37, v37
    v_exp_f32 v38, v38
    v_mfma_f32_16x16x32_bf16 v[124:127], a[220:223], a[8:11], 0
    ds_read_b128 a[168:171], v3 offset:6144
    v_exp_f32 v39, v39
    v_mfma_f32_32x32x16_bf16 v[20:35], a[152:155], a[128:131], 0
    s_add_u32 m0, s78, 0
    v_exp_f32 v40, v40
    v_exp_f32 v41, v41
    v_exp_f32 v42, v42
    v_mfma_f32_16x16x32_bf16 v[156:159], a[224:227], a[8:11], 0
    buffer_load_dwordx4 v244, s[40:43], s75 offen offset:1024 sc1 lds
    v_cvt_pk_bf16_f32 v60, v36, v37
    v_cvt_pk_bf16_f32 v61, v38, v39
    v_mfma_f32_16x16x32_bf16 v[188:191], a[228:231], a[8:11], 0
    ds_read_b128 a[172:175], v3 offset:7168
    v_exp_f32 v43, v43
    v_mfma_f32_32x32x16_bf16 v[20:35], a[156:159], a[132:135], v[20:35]
    ds_read_b64_tr_b16 a[240:241], v246 offset:4096
    v_exp_f32 v44, v44
    v_exp_f32 v45, v45
    v_exp_f32 v46, v46
    v_mfma_f32_16x16x32_bf16 v[220:223], a[232:235], a[8:11], 0
    v_cvt_pk_bf16_f32 v62, v40, v41
    v_cvt_pk_bf16_f32 v63, v42, v43
    v_smfmac_f32_16x16x64_bf16 v[100:103], a[176:179], v[52:59], v18
    buffer_load_dwordx4 a[8:11], v17, s[36:39], s73 offen offset:0 sc1
    v_cvt_pk_bf16_f32 v64, v44, v45
    v_mfma_f32_16x16x32_bf16 v[128:131], a[220:223], a[12:15], 0
    s_mov_b32 m0, s79
    v_exp_f32 v47, v47
    v_mfma_f32_32x32x16_bf16 v[68:83], a[164:167], v[56:59], v[68:83]
    buffer_load_dwordx4 v2, s[44:47], s68 offen offset:1024 sc1 lds
    v_exp_f32 v48, v48
    v_exp_f32 v49, v49
    v_exp_f32 v50, v50
    v_mfma_f32_16x16x32_bf16 v[160:163], a[224:227], a[12:15], 0
    ds_read_b64_tr_b16 a[242:243], v246 offset:6144
    v_exp_f32 v51, v51
    v_mfma_f32_16x16x32_bf16 v[192:195], a[228:231], a[12:15], 0
    v_cvt_pk_bf16_f32 v65, v46, v47
    v_cvt_pk_bf16_f32 v66, v48, v49
    v_mfma_f32_16x16x32_bf16 v[224:227], a[232:235], a[12:15], 0
    buffer_load_dwordx4 a[12:15], v17, s[36:39], s73 offen offset:2048 sc1
    v_cvt_pk_bf16_f32 v67, v50, v51
    v_mfma_f32_32x32x16_bf16 v[84:99], a[160:163], v[60:63], v[84:99]
    s_waitcnt lgkmcnt(2)
    v_exp_f32 v20, v20
    v_exp_f32 v21, v21
    v_exp_f32 v22, v22
    v_mfma_f32_16x16x32_bf16 v[132:135], a[220:223], a[16:19], 0
    ds_read_b128 a[144:147], v3 offset:8192
    v_exp_f32 v23, v23
    v_mfma_f32_32x32x16_bf16 v[36:51], a[152:155], a[136:139], 0
    s_add_u32 m0, s78, 0
    v_exp_f32 v24, v24
    v_exp_f32 v25, v25
    v_exp_f32 v26, v26
    v_mfma_f32_16x16x32_bf16 v[164:167], a[224:227], a[16:19], 0
    buffer_load_dwordx4 v244, s[40:43], s76 offen offset:2048 sc1 lds
    v_cvt_pk_bf16_f32 v52, v20, v21
    v_cvt_pk_bf16_f32 v53, v22, v23
    v_mfma_f32_16x16x32_bf16 v[196:199], a[228:231], a[16:19], 0
    ds_read_b128 a[148:151], v3 offset:9216
    v_exp_f32 v27, v27
    v_mfma_f32_32x32x16_bf16 v[36:51], a[156:159], a[140:143], v[36:51]
    ds_read_b64_tr_b16 a[244:245], v247 offset:4096
    v_exp_f32 v28, v28
    v_exp_f32 v29, v29
    v_exp_f32 v30, v30
    v_mfma_f32_16x16x32_bf16 v[228:231], a[232:235], a[16:19], 0
    v_cvt_pk_bf16_f32 v54, v24, v25
    v_cvt_pk_bf16_f32 v55, v26, v27
    v_smfmac_f32_16x16x64_bf16 v[104:107], a[176:179], v[60:67], v18
    buffer_load_dwordx4 a[16:19], v17, s[36:39], s74 offen offset:0 sc1
    v_cvt_pk_bf16_f32 v56, v28, v29
    v_mfma_f32_16x16x32_bf16 v[136:139], a[220:223], a[20:23], 0
    s_mov_b32 m0, s79
    v_exp_f32 v31, v31
    v_mfma_f32_32x32x16_bf16 v[84:99], a[164:167], v[64:67], v[84:99]
    buffer_load_dwordx4 v2, s[44:47], s68 offen offset:2048 sc1 lds
    v_exp_f32 v32, v32
    v_exp_f32 v33, v33
    v_exp_f32 v34, v34
    v_mfma_f32_16x16x32_bf16 v[168:171], a[224:227], a[20:23], 0
    ds_read_b64_tr_b16 a[246:247], v247 offset:6144
    v_exp_f32 v35, v35
    v_mfma_f32_16x16x32_bf16 v[200:203], a[228:231], a[20:23], 0
    v_cvt_pk_bf16_f32 v57, v30, v31
    v_cvt_pk_bf16_f32 v58, v32, v33
    v_mfma_f32_16x16x32_bf16 v[232:235], a[232:235], a[20:23], 0
    buffer_load_dwordx4 a[20:23], v17, s[36:39], s74 offen offset:2048 sc1
    v_cvt_pk_bf16_f32 v59, v34, v35
    v_mfma_f32_32x32x16_bf16 v[68:83], a[168:171], v[52:55], v[68:83]
    s_waitcnt lgkmcnt(2)
    v_exp_f32 v36, v36
    v_exp_f32 v37, v37
    v_exp_f32 v38, v38
    v_mfma_f32_16x16x32_bf16 v[140:143], a[220:223], a[24:27], 0
    ds_read_b128 a[160:163], v3 offset:10240
    v_exp_f32 v39, v39
    v_mfma_f32_32x32x16_bf16 v[20:35], a[144:147], a[128:131], 0
    s_add_u32 m0, s78, 0
    v_exp_f32 v40, v40
    v_exp_f32 v41, v41
    v_exp_f32 v42, v42
    v_mfma_f32_16x16x32_bf16 v[172:175], a[224:227], a[24:27], 0
    buffer_load_dwordx4 v244, s[40:43], s77 offen offset:3072 sc1 lds
    v_cvt_pk_bf16_f32 v60, v36, v37
    v_cvt_pk_bf16_f32 v61, v38, v39
    v_mfma_f32_16x16x32_bf16 v[204:207], a[228:231], a[24:27], 0
    ds_read_b128 a[164:167], v3 offset:11264
    v_exp_f32 v43, v43
    v_mfma_f32_32x32x16_bf16 v[20:35], a[148:151], a[132:135], v[20:35]
    ds_read_b64_tr_b16 a[248:249], v248 offset:4096
    v_exp_f32 v44, v44
    v_exp_f32 v45, v45
    v_exp_f32 v46, v46
    v_mfma_f32_16x16x32_bf16 v[236:239], a[232:235], a[24:27], 0
    ds_read_b64_tr_b16 a[250:251], v248 offset:6144
    v_cvt_pk_bf16_f32 v62, v40, v41
    v_cvt_pk_bf16_f32 v63, v42, v43
    v_smfmac_f32_16x16x64_bf16 v[100:103], a[176:179], v[52:59], v18
    buffer_load_dwordx4 a[24:27], v17, s[36:39], s16 offen offset:0 sc1
    v_cvt_pk_bf16_f32 v64, v44, v45
    v_mfma_f32_16x16x32_bf16 v[144:147], a[220:223], a[28:31], 0
    s_mov_b32 m0, s79
    v_exp_f32 v47, v47
    v_mfma_f32_32x32x16_bf16 v[68:83], a[172:175], v[56:59], v[68:83]
    buffer_load_dwordx4 v2, s[44:47], s68 offen offset:3072 sc1 lds
    v_exp_f32 v48, v48
    v_exp_f32 v49, v49
    v_exp_f32 v50, v50
    v_mfma_f32_16x16x32_bf16 v[176:179], a[224:227], a[28:31], 0
    v_exp_f32 v51, v51
    v_mfma_f32_16x16x32_bf16 v[208:211], a[228:231], a[28:31], 0
    v_add_u32 v244, s18, v244
    v_cvt_pk_bf16_f32 v65, v46, v47
    v_cvt_pk_bf16_f32 v66, v48, v49
    v_mfma_f32_16x16x32_bf16 v[240:243], a[232:235], a[28:31], 0
    buffer_load_dwordx4 a[28:31], v17, s[36:39], s16 offen offset:2048 sc1
    v_cvt_pk_bf16_f32 v67, v50, v51
    v_mfma_f32_32x32x16_bf16 v[84:99], a[168:171], v[60:63], v[84:99]
    s_waitcnt vmcnt(32) lgkmcnt(0)
    v_exp_f32 v20, v20
    v_exp_f32 v21, v21
    v_exp_f32 v22, v22
    v_mfma_f32_16x16x32_bf16 v[116:119], a[236:239], a[32:35], v[116:119]
    s_add_u32 s68, s68, 4096
    ds_read_b128 a[152:155], v3 offset:12288
    v_exp_f32 v23, v23
    v_mfma_f32_32x32x16_bf16 v[36:51], a[144:147], a[136:139], 0
    s_add_u32 m0, s78, 4096
    v_exp_f32 v24, v24
    v_exp_f32 v25, v25
    v_exp_f32 v26, v26
    v_mfma_f32_16x16x32_bf16 v[148:151], a[240:243], a[32:35], v[148:151]
    buffer_load_dwordx4 v244, s[40:43], 0 offen offset:0 sc1 lds
    v_cvt_pk_bf16_f32 v52, v20, v21
    v_cvt_pk_bf16_f32 v53, v22, v23
    v_mfma_f32_16x16x32_bf16 v[180:183], a[244:247], a[32:35], v[180:183]
    s_add_u32 s79, s79, 4096
    ds_read_b128 a[156:159], v3 offset:13312
    v_exp_f32 v27, v27
    v_mfma_f32_32x32x16_bf16 v[36:51], a[148:151], a[140:143], v[36:51]
    ds_read_b64_tr_b16 a[220:221], v245 offset:8192
    v_exp_f32 v28, v28
    v_exp_f32 v29, v29
    v_exp_f32 v30, v30
    v_mfma_f32_16x16x32_bf16 v[212:215], a[248:251], a[32:35], v[212:215]
    s_add_u32 s36, s36, 1064960
    s_addc_u32 s37, s37, 0
    v_cvt_pk_bf16_f32 v54, v24, v25
    v_cvt_pk_bf16_f32 v55, v26, v27
    v_smfmac_f32_16x16x64_bf16 v[104:107], a[176:179], v[60:67], v18
    buffer_load_dwordx4 a[32:35], v17, s[36:39], 0 offen offset:0 sc1
    v_cvt_pk_bf16_f32 v56, v28, v29
    v_mfma_f32_16x16x32_bf16 v[120:123], a[236:239], a[36:39], v[120:123]
    s_mov_b32 m0, s79
    v_exp_f32 v31, v31
    v_mfma_f32_32x32x16_bf16 v[84:99], a[172:175], v[64:67], v[84:99]
    buffer_load_dwordx4 v2, s[44:47], s68 offen offset:0 sc1 lds
    v_exp_f32 v32, v32
    v_exp_f32 v33, v33
    v_exp_f32 v34, v34
    v_mfma_f32_16x16x32_bf16 v[152:155], a[240:243], a[36:39], v[152:155]
    ds_read_b64_tr_b16 a[222:223], v245 offset:10240
    v_exp_f32 v35, v35
    v_mfma_f32_16x16x32_bf16 v[184:187], a[244:247], a[36:39], v[184:187]
    v_cvt_pk_bf16_f32 v57, v30, v31
    v_cvt_pk_bf16_f32 v58, v32, v33
    v_mfma_f32_16x16x32_bf16 v[216:219], a[248:251], a[36:39], v[216:219]
    buffer_load_dwordx4 a[36:39], v17, s[36:39], 0 offen offset:2048 sc1
    v_cvt_pk_bf16_f32 v59, v34, v35
    v_mfma_f32_32x32x16_bf16 v[68:83], a[160:163], v[52:55], v[68:83]
    s_waitcnt lgkmcnt(2)
    v_exp_f32 v36, v36
    v_exp_f32 v37, v37
    v_exp_f32 v38, v38
    v_mfma_f32_16x16x32_bf16 v[124:127], a[236:239], a[40:43], v[124:127]
    ds_read_b128 a[168:171], v3 offset:14336
    v_exp_f32 v39, v39
    v_mfma_f32_32x32x16_bf16 v[20:35], a[152:155], a[128:131], 0
    s_add_u32 m0, s78, 4096
    v_exp_f32 v40, v40
    v_exp_f32 v41, v41
    v_exp_f32 v42, v42
    v_mfma_f32_16x16x32_bf16 v[156:159], a[240:243], a[40:43], v[156:159]
    buffer_load_dwordx4 v244, s[40:43], s75 offen offset:1024 sc1 lds
    v_cvt_pk_bf16_f32 v60, v36, v37
    v_cvt_pk_bf16_f32 v61, v38, v39
    v_mfma_f32_16x16x32_bf16 v[188:191], a[244:247], a[40:43], v[188:191]
    ds_read_b128 a[172:175], v3 offset:15360
    v_exp_f32 v43, v43
    v_mfma_f32_32x32x16_bf16 v[20:35], a[156:159], a[132:135], v[20:35]
    ds_read_b64_tr_b16 a[224:225], v246 offset:8192
    v_exp_f32 v44, v44
    v_exp_f32 v45, v45
    v_exp_f32 v46, v46
    v_mfma_f32_16x16x32_bf16 v[220:223], a[248:251], a[40:43], v[220:223]
    v_cvt_pk_bf16_f32 v62, v40, v41
    v_cvt_pk_bf16_f32 v63, v42, v43
    v_smfmac_f32_16x16x64_bf16 v[100:103], a[176:179], v[52:59], v18
    buffer_load_dwordx4 a[40:43], v17, s[36:39], s73 offen offset:0 sc1
    v_cvt_pk_bf16_f32 v64, v44, v45
    v_mfma_f32_16x16x32_bf16 v[128:131], a[236:239], a[44:47], v[128:131]
    s_mov_b32 m0, s79
    v_exp_f32 v47, v47
    v_mfma_f32_32x32x16_bf16 v[68:83], a[164:167], v[56:59], v[68:83]
    buffer_load_dwordx4 v2, s[44:47], s68 offen offset:1024 sc1 lds
    v_exp_f32 v48, v48
    v_exp_f32 v49, v49
    v_exp_f32 v50, v50
    v_mfma_f32_16x16x32_bf16 v[160:163], a[240:243], a[44:47], v[160:163]
    ds_read_b64_tr_b16 a[226:227], v246 offset:10240
    v_exp_f32 v51, v51
    v_mfma_f32_16x16x32_bf16 v[192:195], a[244:247], a[44:47], v[192:195]
    v_cvt_pk_bf16_f32 v65, v46, v47
    v_cvt_pk_bf16_f32 v66, v48, v49
    v_mfma_f32_16x16x32_bf16 v[224:227], a[248:251], a[44:47], v[224:227]
    buffer_load_dwordx4 a[44:47], v17, s[36:39], s73 offen offset:2048 sc1
    v_cvt_pk_bf16_f32 v67, v50, v51
    v_mfma_f32_32x32x16_bf16 v[84:99], a[160:163], v[60:63], v[84:99]
    s_waitcnt lgkmcnt(2)
    v_exp_f32 v20, v20
    v_exp_f32 v21, v21
    v_exp_f32 v22, v22
    v_mfma_f32_16x16x32_bf16 v[132:135], a[236:239], a[48:51], v[132:135]
    ds_read_b128 a[144:147], v3 offset:16384
    v_exp_f32 v23, v23
    v_mfma_f32_32x32x16_bf16 v[36:51], a[152:155], a[136:139], 0
    s_add_u32 m0, s78, 4096
    v_exp_f32 v24, v24
    v_exp_f32 v25, v25
    v_exp_f32 v26, v26
    v_mfma_f32_16x16x32_bf16 v[164:167], a[240:243], a[48:51], v[164:167]
    buffer_load_dwordx4 v244, s[40:43], s76 offen offset:2048 sc1 lds
    v_cvt_pk_bf16_f32 v52, v20, v21
    v_cvt_pk_bf16_f32 v53, v22, v23
    v_mfma_f32_16x16x32_bf16 v[196:199], a[244:247], a[48:51], v[196:199]
    ds_read_b128 a[148:151], v3 offset:17408
    v_exp_f32 v27, v27
    v_mfma_f32_32x32x16_bf16 v[36:51], a[156:159], a[140:143], v[36:51]
    ds_read_b64_tr_b16 a[228:229], v247 offset:8192
    v_exp_f32 v28, v28
    v_exp_f32 v29, v29
    v_exp_f32 v30, v30
    v_mfma_f32_16x16x32_bf16 v[228:231], a[248:251], a[48:51], v[228:231]
    v_cvt_pk_bf16_f32 v54, v24, v25
    v_cvt_pk_bf16_f32 v55, v26, v27
    v_smfmac_f32_16x16x64_bf16 v[104:107], a[176:179], v[60:67], v18
    buffer_load_dwordx4 a[48:51], v17, s[36:39], s74 offen offset:0 sc1
    v_cvt_pk_bf16_f32 v56, v28, v29
    v_mfma_f32_16x16x32_bf16 v[136:139], a[236:239], a[52:55], v[136:139]
    s_mov_b32 m0, s79
    v_exp_f32 v31, v31
    v_mfma_f32_32x32x16_bf16 v[84:99], a[164:167], v[64:67], v[84:99]
    buffer_load_dwordx4 v2, s[44:47], s68 offen offset:2048 sc1 lds
    v_exp_f32 v32, v32
    v_exp_f32 v33, v33
    v_exp_f32 v34, v34
    v_mfma_f32_16x16x32_bf16 v[168:171], a[240:243], a[52:55], v[168:171]
    ds_read_b64_tr_b16 a[230:231], v247 offset:10240
    v_exp_f32 v35, v35
    v_mfma_f32_16x16x32_bf16 v[200:203], a[244:247], a[52:55], v[200:203]
    v_cvt_pk_bf16_f32 v57, v30, v31
    v_cvt_pk_bf16_f32 v58, v32, v33
    v_mfma_f32_16x16x32_bf16 v[232:235], a[248:251], a[52:55], v[232:235]
    buffer_load_dwordx4 a[52:55], v17, s[36:39], s74 offen offset:2048 sc1
    v_cvt_pk_bf16_f32 v59, v34, v35
    v_mfma_f32_32x32x16_bf16 v[68:83], a[168:171], v[52:55], v[68:83]
    s_waitcnt lgkmcnt(2)
    v_exp_f32 v36, v36
    v_exp_f32 v37, v37
    v_exp_f32 v38, v38
    v_mfma_f32_16x16x32_bf16 v[140:143], a[236:239], a[56:59], v[140:143]
    ds_read_b128 a[160:163], v3 offset:18432
    v_exp_f32 v39, v39
    v_mfma_f32_32x32x16_bf16 v[20:35], a[144:147], a[128:131], 0
    s_add_u32 m0, s78, 4096
    v_exp_f32 v40, v40
    v_exp_f32 v41, v41
    v_exp_f32 v42, v42
    v_mfma_f32_16x16x32_bf16 v[172:175], a[240:243], a[56:59], v[172:175]
    buffer_load_dwordx4 v244, s[40:43], s77 offen offset:3072 sc1 lds
    v_cvt_pk_bf16_f32 v60, v36, v37
    v_cvt_pk_bf16_f32 v61, v38, v39
    v_mfma_f32_16x16x32_bf16 v[204:207], a[244:247], a[56:59], v[204:207]
    ds_read_b128 a[164:167], v3 offset:19456
    v_exp_f32 v43, v43
    v_mfma_f32_32x32x16_bf16 v[20:35], a[148:151], a[132:135], v[20:35]
    ds_read_b64_tr_b16 a[232:233], v248 offset:8192
    v_exp_f32 v44, v44
    v_exp_f32 v45, v45
    v_exp_f32 v46, v46
    v_mfma_f32_16x16x32_bf16 v[236:239], a[248:251], a[56:59], v[236:239]
    ds_read_b64_tr_b16 a[234:235], v248 offset:10240
    v_cvt_pk_bf16_f32 v62, v40, v41
    v_cvt_pk_bf16_f32 v63, v42, v43
    v_smfmac_f32_16x16x64_bf16 v[100:103], a[176:179], v[52:59], v18
    buffer_load_dwordx4 a[56:59], v17, s[36:39], s16 offen offset:0 sc1
    v_cvt_pk_bf16_f32 v64, v44, v45
    v_mfma_f32_16x16x32_bf16 v[144:147], a[236:239], a[60:63], v[144:147]
    s_mov_b32 m0, s79
    v_exp_f32 v47, v47
    v_mfma_f32_32x32x16_bf16 v[68:83], a[172:175], v[56:59], v[68:83]
    buffer_load_dwordx4 v2, s[44:47], s68 offen offset:3072 sc1 lds
    v_exp_f32 v48, v48
    v_exp_f32 v49, v49
    v_exp_f32 v50, v50
    v_mfma_f32_16x16x32_bf16 v[176:179], a[240:243], a[60:63], v[176:179]
    v_exp_f32 v51, v51
    v_mfma_f32_16x16x32_bf16 v[208:211], a[244:247], a[60:63], v[208:211]
    v_add_u32 v244, s18, v244
    v_cvt_pk_bf16_f32 v65, v46, v47
    v_cvt_pk_bf16_f32 v66, v48, v49
    v_mfma_f32_16x16x32_bf16 v[240:243], a[248:251], a[60:63], v[240:243]
    buffer_load_dwordx4 a[60:63], v17, s[36:39], s16 offen offset:2048 sc1
    v_cvt_pk_bf16_f32 v67, v50, v51
    v_mfma_f32_32x32x16_bf16 v[84:99], a[168:171], v[60:63], v[84:99]
    s_waitcnt vmcnt(40) lgkmcnt(0)
    v_exp_f32 v20, v20
    v_exp_f32 v21, v21
    v_exp_f32 v22, v22
    v_mfma_f32_16x16x32_bf16 v[116:119], a[220:223], a[64:67], v[116:119]
    s_add_u32 s68, s68, 28672
    ds_read_b128 a[152:155], v3 offset:20480
    v_exp_f32 v23, v23
    v_mfma_f32_32x32x16_bf16 v[36:51], a[144:147], a[136:139], 0
    s_add_u32 m0, s78, 8192
    v_exp_f32 v24, v24
    v_exp_f32 v25, v25
    v_exp_f32 v26, v26
    v_mfma_f32_16x16x32_bf16 v[148:151], a[224:227], a[64:67], v[148:151]
    buffer_load_dwordx4 v244, s[40:43], 0 offen offset:0 sc1 lds
    v_cvt_pk_bf16_f32 v52, v20, v21
    v_cvt_pk_bf16_f32 v53, v22, v23
    v_mfma_f32_16x16x32_bf16 v[180:183], a[228:231], a[64:67], v[180:183]
    ds_read_b128 a[156:159], v3 offset:21504
    v_exp_f32 v27, v27
    v_mfma_f32_32x32x16_bf16 v[36:51], a[148:151], a[140:143], v[36:51]
    ds_read_b64_tr_b16 a[236:237], v245 offset:12288
    v_exp_f32 v28, v28
    v_exp_f32 v29, v29
    v_exp_f32 v30, v30
    v_mfma_f32_16x16x32_bf16 v[212:215], a[232:235], a[64:67], v[212:215]
    s_add_u32 s36, s36, 1064960
    s_addc_u32 s37, s37, 0
    v_cvt_pk_bf16_f32 v54, v24, v25
    v_cvt_pk_bf16_f32 v55, v26, v27
    v_smfmac_f32_16x16x64_bf16 v[104:107], a[176:179], v[60:67], v18
    buffer_load_dwordx4 a[64:67], v17, s[36:39], 0 offen offset:0 sc1
    v_cvt_pk_bf16_f32 v56, v28, v29
    v_mfma_f32_16x16x32_bf16 v[120:123], a[220:223], a[68:71], v[120:123]
    v_exp_f32 v31, v31
    v_mfma_f32_32x32x16_bf16 v[84:99], a[172:175], v[64:67], v[84:99]
    v_exp_f32 v32, v32
    v_exp_f32 v33, v33
    v_exp_f32 v34, v34
    v_mfma_f32_16x16x32_bf16 v[152:155], a[224:227], a[68:71], v[152:155]
    ds_read_b64_tr_b16 a[238:239], v245 offset:14336
    v_exp_f32 v35, v35
    v_mfma_f32_16x16x32_bf16 v[184:187], a[228:231], a[68:71], v[184:187]
    v_cvt_pk_bf16_f32 v57, v30, v31
    v_cvt_pk_bf16_f32 v58, v32, v33
    v_mfma_f32_16x16x32_bf16 v[216:219], a[232:235], a[68:71], v[216:219]
    buffer_load_dwordx4 a[68:71], v17, s[36:39], 0 offen offset:2048 sc1
    v_cvt_pk_bf16_f32 v59, v34, v35
    v_mfma_f32_32x32x16_bf16 v[68:83], a[160:163], v[52:55], v[68:83]
    s_waitcnt lgkmcnt(2)
    v_exp_f32 v36, v36
    v_exp_f32 v37, v37
    v_exp_f32 v38, v38
    v_mfma_f32_16x16x32_bf16 v[124:127], a[220:223], a[72:75], v[124:127]
    ds_read_b128 a[168:171], v3 offset:22528
    v_exp_f32 v39, v39
    v_mfma_f32_32x32x16_bf16 v[20:35], a[152:155], a[128:131], 0
    s_add_u32 m0, s78, 8192
    v_exp_f32 v40, v40
    v_exp_f32 v41, v41
    v_exp_f32 v42, v42
    v_mfma_f32_16x16x32_bf16 v[156:159], a[224:227], a[72:75], v[156:159]
    buffer_load_dwordx4 v244, s[40:43], s75 offen offset:1024 sc1 lds
    v_cvt_pk_bf16_f32 v60, v36, v37
    v_cvt_pk_bf16_f32 v61, v38, v39
    v_mfma_f32_16x16x32_bf16 v[188:191], a[228:231], a[72:75], v[188:191]
    ds_read_b128 a[172:175], v3 offset:23552
    v_exp_f32 v43, v43
    v_mfma_f32_32x32x16_bf16 v[20:35], a[156:159], a[132:135], v[20:35]
    ds_read_b64_tr_b16 a[240:241], v246 offset:12288
    v_exp_f32 v44, v44
    v_exp_f32 v45, v45
    v_exp_f32 v46, v46
    v_mfma_f32_16x16x32_bf16 v[220:223], a[232:235], a[72:75], v[220:223]
    s_cmp_eq_u32 s62, 6
    s_cselect_b32 s8, 0, s8
    s_cselect_b32 s52, s12, s52
    s_cselect_b32 s53, s13, s53
    s_cselect_b32 s54, 0x200000, s54
    v_cvt_pk_bf16_f32 v62, v40, v41
    v_cvt_pk_bf16_f32 v63, v42, v43
    v_smfmac_f32_16x16x64_bf16 v[100:103], a[176:179], v[52:59], v18
    buffer_load_dwordx4 a[72:75], v17, s[36:39], s73 offen offset:0 sc1
    v_cvt_pk_bf16_f32 v64, v44, v45
    v_mfma_f32_16x16x32_bf16 v[128:131], a[220:223], a[76:79], v[128:131]
    v_exp_f32 v47, v47
    v_mfma_f32_32x32x16_bf16 v[68:83], a[164:167], v[56:59], v[68:83]
    buffer_load_dword a252, v249, s[52:55], s8 offen
    v_exp_f32 v48, v48
    v_exp_f32 v49, v49
    v_exp_f32 v50, v50
    v_mfma_f32_16x16x32_bf16 v[160:163], a[224:227], a[76:79], v[160:163]
    ds_read_b64_tr_b16 a[242:243], v246 offset:14336
    v_exp_f32 v51, v51
    v_mfma_f32_16x16x32_bf16 v[192:195], a[228:231], a[76:79], v[192:195]
    v_cvt_pk_bf16_f32 v65, v46, v47
    v_cvt_pk_bf16_f32 v66, v48, v49
    v_mfma_f32_16x16x32_bf16 v[224:227], a[232:235], a[76:79], v[224:227]
    buffer_load_dwordx4 a[76:79], v17, s[36:39], s73 offen offset:2048 sc1
    v_cvt_pk_bf16_f32 v67, v50, v51
    v_mfma_f32_32x32x16_bf16 v[84:99], a[160:163], v[60:63], v[84:99]
    s_waitcnt lgkmcnt(2)
    v_exp_f32 v20, v20
    v_exp_f32 v21, v21
    v_exp_f32 v22, v22
    v_mfma_f32_16x16x32_bf16 v[132:135], a[220:223], a[80:83], v[132:135]
    s_add_u32 s8, s8, 0x100000
    ds_read_b128 a[144:147], v3 offset:24576
    v_exp_f32 v23, v23
    v_mfma_f32_32x32x16_bf16 v[36:51], a[152:155], a[136:139], 0
    s_add_u32 m0, s78, 8192
    v_exp_f32 v24, v24
    v_exp_f32 v25, v25
    v_exp_f32 v26, v26
    v_mfma_f32_16x16x32_bf16 v[164:167], a[224:227], a[80:83], v[164:167]
    buffer_load_dwordx4 v244, s[40:43], s76 offen offset:2048 sc1 lds
    v_cvt_pk_bf16_f32 v52, v20, v21
    v_cvt_pk_bf16_f32 v53, v22, v23
    v_mfma_f32_16x16x32_bf16 v[196:199], a[228:231], a[80:83], v[196:199]
    ds_read_b128 a[148:151], v3 offset:25600
    v_exp_f32 v27, v27
    v_mfma_f32_32x32x16_bf16 v[36:51], a[156:159], a[140:143], v[36:51]
    ds_read_b64_tr_b16 a[244:245], v247 offset:12288
    v_exp_f32 v28, v28
    v_exp_f32 v29, v29
    v_exp_f32 v30, v30
    v_mfma_f32_16x16x32_bf16 v[228:231], a[232:235], a[80:83], v[228:231]
    v_cvt_pk_bf16_f32 v54, v24, v25
    v_cvt_pk_bf16_f32 v55, v26, v27
    v_smfmac_f32_16x16x64_bf16 v[104:107], a[176:179], v[60:67], v18
    buffer_load_dwordx4 a[80:83], v17, s[36:39], s74 offen offset:0 sc1
    v_cvt_pk_bf16_f32 v56, v28, v29
    v_mfma_f32_16x16x32_bf16 v[136:139], a[220:223], a[84:87], v[136:139]
    v_exp_f32 v31, v31
    v_mfma_f32_32x32x16_bf16 v[84:99], a[164:167], v[64:67], v[84:99]
    v_exp_f32 v32, v32
    v_exp_f32 v33, v33
    v_exp_f32 v34, v34
    v_mfma_f32_16x16x32_bf16 v[168:171], a[224:227], a[84:87], v[168:171]
    ds_read_b64_tr_b16 a[246:247], v247 offset:14336
    v_exp_f32 v35, v35
    v_mfma_f32_16x16x32_bf16 v[200:203], a[228:231], a[84:87], v[200:203]
    v_cvt_pk_bf16_f32 v57, v30, v31
    v_cvt_pk_bf16_f32 v58, v32, v33
    v_mfma_f32_16x16x32_bf16 v[232:235], a[232:235], a[84:87], v[232:235]
    buffer_load_dwordx4 a[84:87], v17, s[36:39], s74 offen offset:2048 sc1
    v_cvt_pk_bf16_f32 v59, v34, v35
    v_mfma_f32_32x32x16_bf16 v[68:83], a[168:171], v[52:55], v[68:83]
    s_waitcnt lgkmcnt(2)
    v_exp_f32 v36, v36
    v_exp_f32 v37, v37
    v_exp_f32 v38, v38
    v_mfma_f32_16x16x32_bf16 v[140:143], a[220:223], a[88:91], v[140:143]
    ds_read_b128 a[160:163], v3 offset:26624
    v_exp_f32 v39, v39
    v_mfma_f32_32x32x16_bf16 v[20:35], a[144:147], a[128:131], 0
    s_add_u32 m0, s78, 8192
    v_exp_f32 v40, v40
    v_exp_f32 v41, v41
    v_exp_f32 v42, v42
    v_mfma_f32_16x16x32_bf16 v[172:175], a[224:227], a[88:91], v[172:175]
    buffer_load_dwordx4 v244, s[40:43], s77 offen offset:3072 sc1 lds
    v_cvt_pk_bf16_f32 v60, v36, v37
    v_cvt_pk_bf16_f32 v61, v38, v39
    v_mfma_f32_16x16x32_bf16 v[204:207], a[228:231], a[88:91], v[204:207]
    ds_read_b128 a[164:167], v3 offset:27648
    v_exp_f32 v43, v43
    v_mfma_f32_32x32x16_bf16 v[20:35], a[148:151], a[132:135], v[20:35]
    ds_read_b64_tr_b16 a[248:249], v248 offset:12288
    v_exp_f32 v44, v44
    v_exp_f32 v45, v45
    v_exp_f32 v46, v46
    v_mfma_f32_16x16x32_bf16 v[236:239], a[232:235], a[88:91], v[236:239]
    ds_read_b64_tr_b16 a[250:251], v248 offset:14336
    v_cvt_pk_bf16_f32 v62, v40, v41
    v_cvt_pk_bf16_f32 v63, v42, v43
    v_smfmac_f32_16x16x64_bf16 v[100:103], a[176:179], v[52:59], v18
    buffer_load_dwordx4 a[88:91], v17, s[36:39], s16 offen offset:0 sc1
    v_cvt_pk_bf16_f32 v64, v44, v45
    v_mfma_f32_16x16x32_bf16 v[144:147], a[220:223], a[92:95], v[144:147]
    buffer_load_dword v250, v14, s[32:35], s60 offen offset:0 sc1
    v_exp_f32 v47, v47
    v_mfma_f32_32x32x16_bf16 v[68:83], a[172:175], v[56:59], v[68:83]
    v_exp_f32 v48, v48
    v_exp_f32 v49, v49
    v_exp_f32 v50, v50
    v_mfma_f32_16x16x32_bf16 v[176:179], a[224:227], a[92:95], v[176:179]
    v_exp_f32 v51, v51
    v_mfma_f32_16x16x32_bf16 v[208:211], a[228:231], a[92:95], v[208:211]
    v_add_u32 v244, s18, v244
    buffer_load_dword v251, v14, s[32:35], s60 offen offset:128 sc1
    v_cvt_pk_bf16_f32 v65, v46, v47
    v_cvt_pk_bf16_f32 v66, v48, v49
    v_mfma_f32_16x16x32_bf16 v[240:243], a[232:235], a[92:95], v[240:243]
    buffer_load_dwordx4 a[92:95], v17, s[36:39], s16 offen offset:2048 sc1
    v_cvt_pk_bf16_f32 v67, v50, v51
    v_mfma_f32_32x32x16_bf16 v[84:99], a[168:171], v[60:63], v[84:99]
    s_waitcnt vmcnt(34) lgkmcnt(0)
    v_exp_f32 v20, v20
    v_exp_f32 v21, v21
    v_exp_f32 v22, v22
    v_mfma_f32_16x16x32_bf16 v[116:119], a[236:239], a[96:99], v[116:119]
    ds_read_b128 a[152:155], v3 offset:28672
    v_exp_f32 v23, v23
    v_mfma_f32_32x32x16_bf16 v[36:51], a[144:147], a[136:139], 0
    s_add_u32 m0, s78, 12288
    v_exp_f32 v24, v24
    v_exp_f32 v25, v25
    v_exp_f32 v26, v26
    v_mfma_f32_16x16x32_bf16 v[148:151], a[240:243], a[96:99], v[148:151]
    buffer_load_dwordx4 v244, s[40:43], 0 offen offset:0 sc1 lds
    v_cvt_pk_bf16_f32 v52, v20, v21
    v_cvt_pk_bf16_f32 v53, v22, v23
    v_mfma_f32_16x16x32_bf16 v[180:183], a[244:247], a[96:99], v[180:183]
    ds_read_b128 a[156:159], v3 offset:29696
    v_exp_f32 v27, v27
    v_mfma_f32_32x32x16_bf16 v[36:51], a[148:151], a[140:143], v[36:51]
    ds_read_b64_tr_b16 a[220:221], v245 offset:0
    v_exp_f32 v28, v28
    v_exp_f32 v29, v29
    v_exp_f32 v30, v30
    v_mfma_f32_16x16x32_bf16 v[212:215], a[248:251], a[96:99], v[212:215]
    s_add_u32 s36, s36, 1064960
    s_addc_u32 s37, s37, 0
    v_cvt_pk_bf16_f32 v54, v24, v25
    v_cvt_pk_bf16_f32 v55, v26, v27
    v_smfmac_f32_16x16x64_bf16 v[104:107], a[176:179], v[60:67], v18
    buffer_load_dwordx4 a[96:99], v17, s[36:39], 0 offen offset:0 sc1
    v_cvt_pk_bf16_f32 v56, v28, v29
    v_mfma_f32_16x16x32_bf16 v[120:123], a[236:239], a[100:103], v[120:123]
    buffer_load_dword v108, v15, s[32:35], s61 offen offset:0 sc1
    v_exp_f32 v31, v31
    v_mfma_f32_32x32x16_bf16 v[84:99], a[172:175], v[64:67], v[84:99]
    global_load_dword a253, v0, s[100:101]
    v_exp_f32 v32, v32
    v_exp_f32 v33, v33
    v_exp_f32 v34, v34
    v_mfma_f32_16x16x32_bf16 v[152:155], a[240:243], a[100:103], v[152:155]
    ds_read_b64_tr_b16 a[222:223], v245 offset:2048
    v_exp_f32 v35, v35
    v_mfma_f32_16x16x32_bf16 v[184:187], a[244:247], a[100:103], v[184:187]
    buffer_load_dword v109, v15, s[32:35], s61 offen offset:64 sc1
    v_cvt_pk_bf16_f32 v57, v30, v31
    v_cvt_pk_bf16_f32 v58, v32, v33
    v_mfma_f32_16x16x32_bf16 v[216:219], a[248:251], a[100:103], v[216:219]
    buffer_load_dwordx4 a[100:103], v17, s[36:39], 0 offen offset:2048 sc1
    v_cvt_pk_bf16_f32 v59, v34, v35
    v_mfma_f32_32x32x16_bf16 v[68:83], a[160:163], v[52:55], v[68:83]
    s_waitcnt lgkmcnt(2)
    v_exp_f32 v36, v36
    v_exp_f32 v37, v37
    v_exp_f32 v38, v38
    v_mfma_f32_16x16x32_bf16 v[124:127], a[236:239], a[104:107], v[124:127]
    ds_read_b128 a[168:171], v3 offset:30720
    v_exp_f32 v39, v39
    v_mfma_f32_32x32x16_bf16 v[20:35], a[152:155], a[128:131], 0
    s_add_u32 m0, s78, 12288
    v_exp_f32 v40, v40
    v_exp_f32 v41, v41
    v_exp_f32 v42, v42
    v_mfma_f32_16x16x32_bf16 v[156:159], a[240:243], a[104:107], v[156:159]
    buffer_load_dwordx4 v244, s[40:43], s75 offen offset:1024 sc1 lds
    v_cvt_pk_bf16_f32 v60, v36, v37
    v_cvt_pk_bf16_f32 v61, v38, v39
    v_mfma_f32_16x16x32_bf16 v[188:191], a[244:247], a[104:107], v[188:191]
    ds_read_b128 a[172:175], v3 offset:31744
    v_exp_f32 v43, v43
    v_mfma_f32_32x32x16_bf16 v[20:35], a[156:159], a[132:135], v[20:35]
    ds_read_b64_tr_b16 a[224:225], v246 offset:0
    v_exp_f32 v44, v44
    v_exp_f32 v45, v45
    v_exp_f32 v46, v46
    v_mfma_f32_16x16x32_bf16 v[220:223], a[248:251], a[104:107], v[220:223]
    v_cvt_pk_bf16_f32 v62, v40, v41
    v_cvt_pk_bf16_f32 v63, v42, v43
    v_smfmac_f32_16x16x64_bf16 v[100:103], a[176:179], v[52:59], v18
    buffer_load_dwordx4 a[104:107], v17, s[36:39], s73 offen offset:0 sc1
    v_cvt_pk_bf16_f32 v64, v44, v45
    v_mfma_f32_16x16x32_bf16 v[128:131], a[236:239], a[108:111], v[128:131]
    buffer_load_dword v110, v15, s[32:35], s61 offen offset:128 sc1
    v_exp_f32 v47, v47
    v_mfma_f32_32x32x16_bf16 v[68:83], a[164:167], v[56:59], v[68:83]
    v_exp_f32 v48, v48
    v_exp_f32 v49, v49
    v_exp_f32 v50, v50
    v_mfma_f32_16x16x32_bf16 v[160:163], a[240:243], a[108:111], v[160:163]
    ds_read_b64_tr_b16 a[226:227], v246 offset:2048
    v_exp_f32 v51, v51
    v_mfma_f32_16x16x32_bf16 v[192:195], a[244:247], a[108:111], v[192:195]
    buffer_load_dword v111, v15, s[32:35], s61 offen offset:192 sc1
    v_cvt_pk_bf16_f32 v65, v46, v47
    v_cvt_pk_bf16_f32 v66, v48, v49
    v_mfma_f32_16x16x32_bf16 v[224:227], a[248:251], a[108:111], v[224:227]
    buffer_load_dwordx4 a[108:111], v17, s[36:39], s73 offen offset:2048 sc1
    v_cvt_pk_bf16_f32 v67, v50, v51
    v_mfma_f32_32x32x16_bf16 v[84:99], a[160:163], v[60:63], v[84:99]
    s_waitcnt vmcnt(63) lgkmcnt(0)
    s_barrier
    v_exp_f32 v20, v20
    v_exp_f32 v21, v21
    v_exp_f32 v22, v22
    v_mfma_f32_16x16x32_bf16 v[132:135], a[236:239], a[112:115], v[132:135]
    ds_read_b128 a[144:147], v4 offset:0
    v_exp_f32 v23, v23
    v_mfma_f32_32x32x16_bf16 v[36:51], a[152:155], a[136:139], 0
    s_add_u32 m0, s78, 12288
    v_exp_f32 v24, v24
    v_exp_f32 v25, v25
    v_exp_f32 v26, v26
    v_mfma_f32_16x16x32_bf16 v[164:167], a[240:243], a[112:115], v[164:167]
    buffer_load_dwordx4 v244, s[40:43], s76 offen offset:2048 sc1 lds
    v_cvt_pk_bf16_f32 v52, v20, v21
    v_cvt_pk_bf16_f32 v53, v22, v23
    v_mfma_f32_16x16x32_bf16 v[196:199], a[244:247], a[112:115], v[196:199]
    ds_read_b128 a[148:151], v4 offset:1024
    v_exp_f32 v27, v27
    v_mfma_f32_32x32x16_bf16 v[36:51], a[156:159], a[140:143], v[36:51]
    ds_read_b64_tr_b16 a[228:229], v247 offset:0
    v_exp_f32 v28, v28
    v_exp_f32 v29, v29
    v_exp_f32 v30, v30
    v_mfma_f32_16x16x32_bf16 v[228:231], a[248:251], a[112:115], v[228:231]
    v_cvt_pk_bf16_f32 v54, v24, v25
    v_cvt_pk_bf16_f32 v55, v26, v27
    v_smfmac_f32_16x16x64_bf16 v[104:107], a[176:179], v[60:67], v18
    buffer_load_dwordx4 a[112:115], v17, s[36:39], s74 offen offset:0 sc1
    v_cvt_pk_bf16_f32 v56, v28, v29
    v_mfma_f32_16x16x32_bf16 v[136:139], a[236:239], a[116:119], v[136:139]
    buffer_load_dword v112, v15, s[32:35], s61 offen offset:256 sc1
    v_exp_f32 v31, v31
    v_mfma_f32_32x32x16_bf16 v[84:99], a[164:167], v[64:67], v[84:99]
    v_exp_f32 v32, v32
    v_exp_f32 v33, v33
    v_exp_f32 v34, v34
    v_mfma_f32_16x16x32_bf16 v[168:171], a[240:243], a[116:119], v[168:171]
    ds_read_b64_tr_b16 a[230:231], v247 offset:2048
    v_exp_f32 v35, v35
    v_mfma_f32_16x16x32_bf16 v[200:203], a[244:247], a[116:119], v[200:203]
    buffer_load_dword v113, v15, s[32:35], s61 offen offset:320 sc1
    v_cvt_pk_bf16_f32 v57, v30, v31
    v_cvt_pk_bf16_f32 v58, v32, v33
    v_mfma_f32_16x16x32_bf16 v[232:235], a[248:251], a[116:119], v[232:235]
    buffer_load_dwordx4 a[116:119], v17, s[36:39], s74 offen offset:2048 sc1
    v_cvt_pk_bf16_f32 v59, v34, v35
    v_mfma_f32_32x32x16_bf16 v[68:83], a[168:171], v[52:55], v[68:83]
    s_waitcnt lgkmcnt(2)
    v_exp_f32 v36, v36
    v_exp_f32 v37, v37
    v_exp_f32 v38, v38
    v_mfma_f32_16x16x32_bf16 v[140:143], a[236:239], a[120:123], v[140:143]
    ds_read_b128 a[160:163], v4 offset:2048
    v_exp_f32 v39, v39
    v_mfma_f32_32x32x16_bf16 v[20:35], a[144:147], a[128:131], 0
    s_add_u32 m0, s78, 12288
    v_exp_f32 v40, v40
    v_exp_f32 v41, v41
    v_exp_f32 v42, v42
    v_mfma_f32_16x16x32_bf16 v[172:175], a[240:243], a[120:123], v[172:175]
    buffer_load_dwordx4 v244, s[40:43], s77 offen offset:3072 sc1 lds
    v_cvt_pk_bf16_f32 v60, v36, v37
    v_cvt_pk_bf16_f32 v61, v38, v39
    v_mfma_f32_16x16x32_bf16 v[204:207], a[244:247], a[120:123], v[204:207]
    s_mov_b32 s58, s65
    ds_read_b128 a[164:167], v4 offset:3072
    v_exp_f32 v43, v43
    v_mfma_f32_32x32x16_bf16 v[20:35], a[148:151], a[132:135], v[20:35]
    s_mov_b32 s65, s66
    ds_read_b64_tr_b16 a[232:233], v248 offset:0
    v_exp_f32 v44, v44
    v_exp_f32 v45, v45
    v_exp_f32 v46, v46
    v_mfma_f32_16x16x32_bf16 v[236:239], a[248:251], a[120:123], v[236:239]
    s_mov_b32 s66, s67
    ds_read_b64_tr_b16 a[234:235], v248 offset:2048
    v_cvt_pk_bf16_f32 v62, v40, v41
    v_cvt_pk_bf16_f32 v63, v42, v43
    v_smfmac_f32_16x16x64_bf16 v[100:103], a[176:179], v[52:59], v18
    s_mov_b32 s67, s58
    buffer_load_dwordx4 a[120:123], v17, s[36:39], s16 offen offset:0 sc1
    v_cvt_pk_bf16_f32 v64, v44, v45
    v_mfma_f32_16x16x32_bf16 v[144:147], a[236:239], a[124:127], v[144:147]
    s_add_u32 s79, s58, s69
    buffer_load_dword v114, v15, s[32:35], s61 offen offset:384 sc1
    v_exp_f32 v47, v47
    v_mfma_f32_32x32x16_bf16 v[68:83], a[172:175], v[56:59], v[68:83]
    s_add_u32 s62, s62, 1
    v_exp_f32 v48, v48
    v_exp_f32 v49, v49
    v_exp_f32 v50, v50
    v_mfma_f32_16x16x32_bf16 v[176:179], a[240:243], a[124:127], v[176:179]
    v_exp_f32 v51, v51
    v_mfma_f32_16x16x32_bf16 v[208:211], a[244:247], a[124:127], v[208:211]
    v_add_u32 v244, s18, v244
    buffer_load_dword v115, v15, s[32:35], s61 offen offset:448 sc1
    v_cvt_pk_bf16_f32 v65, v46, v47
    v_cvt_pk_bf16_f32 v66, v48, v49
    v_mfma_f32_16x16x32_bf16 v[240:243], a[248:251], a[124:127], v[240:243]
    buffer_load_dwordx4 a[124:127], v17, s[36:39], s16 offen offset:2048 sc1
    v_cvt_pk_bf16_f32 v67, v50, v51
    s_add_u32 s36, s36, 1064960
    s_addc_u32 s37, s37, 0
    v_add_u32 v3, s65, v2
    v_add_u32 v4, s66, v2
.p2align 6
P2_MLOOP:
    v_mfma_f32_32x32x16_bf16 v[84:99], a[168:171], v[60:63], v[84:99]
    s_waitcnt vmcnt(29) lgkmcnt(0)
    v_exp_f32 v20, v20
    v_exp_f32 v21, v21
    v_exp_f32 v22, v22
    v_mfma_f32_16x16x32_bf16 v[116:119], a[220:223], a[0:3], v[116:119]
    ds_read_b128 a[152:155], v3 offset:4096
    v_exp_f32 v23, v23
    v_mfma_f32_32x32x16_bf16 v[36:51], a[144:147], a[136:139], 0
    s_add_u32 m0, s78, 0
    v_exp_f32 v24, v24
    v_exp_f32 v25, v25
    v_exp_f32 v26, v26
    v_mfma_f32_16x16x32_bf16 v[148:151], a[224:227], a[0:3], v[148:151]
    buffer_load_dwordx4 v244, s[40:43], 0 offen offset:0 sc1 lds
    v_cvt_pk_bf16_f32 v52, v20, v21
    v_cvt_pk_bf16_f32 v53, v22, v23
    v_mfma_f32_16x16x32_bf16 v[180:183], a[228:231], a[0:3], v[180:183]
    ds_read_b128 a[156:159], v3 offset:5120
    v_exp_f32 v27, v27
    v_mfma_f32_32x32x16_bf16 v[36:51], a[148:151], a[140:143], v[36:51]
    ds_read_b64_tr_b16 a[236:237], v245 offset:4096
    v_exp_f32 v28, v28
    v_exp_f32 v29, v29
    v_exp_f32 v30, v30
    v_mfma_f32_16x16x32_bf16 v[212:215], a[232:235], a[0:3], v[212:215]
    v_cvt_pk_bf16_f32 v54, v24, v25
    v_cvt_pk_bf16_f32 v55, v26, v27
    v_smfmac_f32_16x16x64_bf16 v[104:107], a[176:179], v[60:67], v18
    buffer_load_dwordx4 a[0:3], v17, s[36:39], 0 offen offset:0 sc1
    v_cvt_pk_bf16_f32 v56, v28, v29
    v_mfma_f32_16x16x32_bf16 v[120:123], a[220:223], a[4:7], v[120:123]
    s_mov_b32 m0, s79
    v_exp_f32 v31, v31
    v_mfma_f32_32x32x16_bf16 v[84:99], a[172:175], v[64:67], v[84:99]
    buffer_load_dwordx4 v2, s[44:47], s68 offen offset:0 sc1 lds
    v_exp_f32 v32, v32
    v_exp_f32 v33, v33
    v_exp_f32 v34, v34
    v_mfma_f32_16x16x32_bf16 v[152:155], a[224:227], a[4:7], v[152:155]
    ds_read_b64_tr_b16 a[238:239], v245 offset:6144
    v_exp_f32 v35, v35
    v_mfma_f32_16x16x32_bf16 v[184:187], a[228:231], a[4:7], v[184:187]
    v_cvt_pk_bf16_f32 v57, v30, v31
    v_cvt_pk_bf16_f32 v58, v32, v33
    v_mfma_f32_16x16x32_bf16 v[216:219], a[232:235], a[4:7], v[216:219]
    buffer_load_dwordx4 a[4:7], v17, s[36:39], 0 offen offset:2048 sc1
    v_cvt_pk_bf16_f32 v59, v34, v35
    v_mfma_f32_32x32x16_bf16 v[68:83], a[160:163], v[52:55], v[68:83]
    s_waitcnt lgkmcnt(2)
    v_exp_f32 v36, v36
    v_exp_f32 v37, v37
    v_exp_f32 v38, v38
    v_mfma_f32_16x16x32_bf16 v[124:127], a[220:223], a[8:11], v[124:127]
    ds_read_b128 a[168:171], v3 offset:6144
    v_exp_f32 v39, v39
    v_mfma_f32_32x32x16_bf16 v[20:35], a[152:155], a[128:131], 0
    s_add_u32 m0, s78, 0
    v_exp_f32 v40, v40
    v_exp_f32 v41, v41
    v_exp_f32 v42, v42
    v_mfma_f32_16x16x32_bf16 v[156:159], a[224:227], a[8:11], v[156:159]
    buffer_load_dwordx4 v244, s[40:43], s75 offen offset:1024 sc1 lds
    v_cvt_pk_bf16_f32 v60, v36, v37
    v_cvt_pk_bf16_f32 v61, v38, v39
    v_mfma_f32_16x16x32_bf16 v[188:191], a[228:231], a[8:11], v[188:191]
    ds_read_b128 a[172:175], v3 offset:7168
    v_exp_f32 v43, v43
    v_mfma_f32_32x32x16_bf16 v[20:35], a[156:159], a[132:135], v[20:35]
    ds_read_b64_tr_b16 a[240:241], v246 offset:4096
    v_exp_f32 v44, v44
    v_exp_f32 v45, v45
    v_exp_f32 v46, v46
    v_mfma_f32_16x16x32_bf16 v[220:223], a[232:235], a[8:11], v[220:223]
    v_cvt_pk_bf16_f32 v62, v40, v41
    v_cvt_pk_bf16_f32 v63, v42, v43
    v_smfmac_f32_16x16x64_bf16 v[100:103], a[176:179], v[52:59], v18
    buffer_load_dwordx4 a[8:11], v17, s[36:39], s73 offen offset:0 sc1
    v_cvt_pk_bf16_f32 v64, v44, v45
    v_mfma_f32_16x16x32_bf16 v[128:131], a[220:223], a[12:15], v[128:131]
    s_mov_b32 m0, s79
    v_exp_f32 v47, v47
    v_mfma_f32_32x32x16_bf16 v[68:83], a[164:167], v[56:59], v[68:83]
    buffer_load_dwordx4 v2, s[44:47], s68 offen offset:1024 sc1 lds
    v_exp_f32 v48, v48
    v_exp_f32 v49, v49
    v_exp_f32 v50, v50
    v_mfma_f32_16x16x32_bf16 v[160:163], a[224:227], a[12:15], v[160:163]
    ds_read_b64_tr_b16 a[242:243], v246 offset:6144
    v_exp_f32 v51, v51
    v_mfma_f32_16x16x32_bf16 v[192:195], a[228:231], a[12:15], v[192:195]
    v_cvt_pk_bf16_f32 v65, v46, v47
    v_cvt_pk_bf16_f32 v66, v48, v49
    v_mfma_f32_16x16x32_bf16 v[224:227], a[232:235], a[12:15], v[224:227]
    buffer_load_dwordx4 a[12:15], v17, s[36:39], s73 offen offset:2048 sc1
    v_cvt_pk_bf16_f32 v67, v50, v51
    v_mfma_f32_32x32x16_bf16 v[84:99], a[160:163], v[60:63], v[84:99]
    s_waitcnt lgkmcnt(2)
    v_exp_f32 v20, v20
    v_exp_f32 v21, v21
    v_exp_f32 v22, v22
    v_mfma_f32_16x16x32_bf16 v[132:135], a[220:223], a[16:19], v[132:135]
    ds_read_b128 a[144:147], v3 offset:8192
    v_exp_f32 v23, v23
    v_mfma_f32_32x32x16_bf16 v[36:51], a[152:155], a[136:139], 0
    s_add_u32 m0, s78, 0
    v_exp_f32 v24, v24
    v_exp_f32 v25, v25
    v_exp_f32 v26, v26
    v_mfma_f32_16x16x32_bf16 v[164:167], a[224:227], a[16:19], v[164:167]
    buffer_load_dwordx4 v244, s[40:43], s76 offen offset:2048 sc1 lds
    v_cvt_pk_bf16_f32 v52, v20, v21
    v_cvt_pk_bf16_f32 v53, v22, v23
    v_mfma_f32_16x16x32_bf16 v[196:199], a[228:231], a[16:19], v[196:199]
    ds_read_b128 a[148:151], v3 offset:9216
    v_exp_f32 v27, v27
    v_mfma_f32_32x32x16_bf16 v[36:51], a[156:159], a[140:143], v[36:51]
    ds_read_b64_tr_b16 a[244:245], v247 offset:4096
    v_exp_f32 v28, v28
    v_exp_f32 v29, v29
    v_exp_f32 v30, v30
    v_mfma_f32_16x16x32_bf16 v[228:231], a[232:235], a[16:19], v[228:231]
    v_cvt_pk_bf16_f32 v54, v24, v25
    v_cvt_pk_bf16_f32 v55, v26, v27
    v_smfmac_f32_16x16x64_bf16 v[104:107], a[176:179], v[60:67], v18
    buffer_load_dwordx4 a[16:19], v17, s[36:39], s74 offen offset:0 sc1
    v_cvt_pk_bf16_f32 v56, v28, v29
    v_mfma_f32_16x16x32_bf16 v[136:139], a[220:223], a[20:23], v[136:139]
    s_mov_b32 m0, s79
    v_exp_f32 v31, v31
    v_mfma_f32_32x32x16_bf16 v[84:99], a[164:167], v[64:67], v[84:99]
    buffer_load_dwordx4 v2, s[44:47], s68 offen offset:2048 sc1 lds
    v_exp_f32 v32, v32
    v_exp_f32 v33, v33
    v_exp_f32 v34, v34
    v_mfma_f32_16x16x32_bf16 v[168:171], a[224:227], a[20:23], v[168:171]
    ds_read_b64_tr_b16 a[246:247], v247 offset:6144
    v_exp_f32 v35, v35
    v_mfma_f32_16x16x32_bf16 v[200:203], a[228:231], a[20:23], v[200:203]
    v_cvt_pk_bf16_f32 v57, v30, v31
    v_cvt_pk_bf16_f32 v58, v32, v33
    v_mfma_f32_16x16x32_bf16 v[232:235], a[232:235], a[20:23], v[232:235]
    buffer_load_dwordx4 a[20:23], v17, s[36:39], s74 offen offset:2048 sc1
    v_cvt_pk_bf16_f32 v59, v34, v35
    v_mfma_f32_32x32x16_bf16 v[68:83], a[168:171], v[52:55], v[68:83]
    s_waitcnt lgkmcnt(2)
    v_exp_f32 v36, v36
    v_exp_f32 v37, v37
    v_exp_f32 v38, v38
    v_mfma_f32_16x16x32_bf16 v[140:143], a[220:223], a[24:27], v[140:143]
    ds_read_b128 a[160:163], v3 offset:10240
    v_exp_f32 v39, v39
    v_mfma_f32_32x32x16_bf16 v[20:35], a[144:147], a[128:131], 0
    s_add_u32 m0, s78, 0
    v_exp_f32 v40, v40
    v_exp_f32 v41, v41
    v_exp_f32 v42, v42
    v_mfma_f32_16x16x32_bf16 v[172:175], a[224:227], a[24:27], v[172:175]
    buffer_load_dwordx4 v244, s[40:43], s77 offen offset:3072 sc1 lds
    v_cvt_pk_bf16_f32 v60, v36, v37
    v_cvt_pk_bf16_f32 v61, v38, v39
    v_mfma_f32_16x16x32_bf16 v[204:207], a[228:231], a[24:27], v[204:207]
    ds_read_b128 a[164:167], v3 offset:11264
    v_exp_f32 v43, v43
    v_mfma_f32_32x32x16_bf16 v[20:35], a[148:151], a[132:135], v[20:35]
    ds_read_b64_tr_b16 a[248:249], v248 offset:4096
    v_exp_f32 v44, v44
    v_exp_f32 v45, v45
    v_exp_f32 v46, v46
    v_mfma_f32_16x16x32_bf16 v[236:239], a[232:235], a[24:27], v[236:239]
    ds_read_b64_tr_b16 a[250:251], v248 offset:6144
    v_cvt_pk_bf16_f32 v62, v40, v41
    v_cvt_pk_bf16_f32 v63, v42, v43
    v_smfmac_f32_16x16x64_bf16 v[100:103], a[176:179], v[52:59], v18
    buffer_load_dwordx4 a[24:27], v17, s[36:39], s16 offen offset:0 sc1
    v_cvt_pk_bf16_f32 v64, v44, v45
    v_mfma_f32_16x16x32_bf16 v[144:147], a[220:223], a[28:31], v[144:147]
    s_mov_b32 m0, s79
    v_exp_f32 v47, v47
    v_mfma_f32_32x32x16_bf16 v[68:83], a[172:175], v[56:59], v[68:83]
    buffer_load_dwordx4 v2, s[44:47], s68 offen offset:3072 sc1 lds
    v_exp_f32 v48, v48
    v_exp_f32 v49, v49
    v_exp_f32 v50, v50
    v_mfma_f32_16x16x32_bf16 v[176:179], a[224:227], a[28:31], v[176:179]
    v_exp_f32 v51, v51
    v_mfma_f32_16x16x32_bf16 v[208:211], a[228:231], a[28:31], v[208:211]
    v_add_u32 v244, s18, v244
    v_cvt_pk_bf16_f32 v65, v46, v47
    v_cvt_pk_bf16_f32 v66, v48, v49
    v_mfma_f32_16x16x32_bf16 v[240:243], a[232:235], a[28:31], v[240:243]
    buffer_load_dwordx4 a[28:31], v17, s[36:39], s16 offen offset:2048 sc1
    v_cvt_pk_bf16_f32 v67, v50, v51
    v_mfma_f32_32x32x16_bf16 v[84:99], a[168:171], v[60:63], v[84:99]
    s_waitcnt vmcnt(31) lgkmcnt(0)
    v_exp_f32 v20, v20
    v_exp_f32 v21, v21
    v_exp_f32 v22, v22
    v_mfma_f32_16x16x32_bf16 v[116:119], a[236:239], a[32:35], v[116:119]
    s_add_u32 s68, s68, 4096
    ds_read_b128 a[152:155], v3 offset:12288
    v_exp_f32 v23, v23
    v_mfma_f32_32x32x16_bf16 v[36:51], a[144:147], a[136:139], 0
    s_add_u32 m0, s78, 4096
    v_exp_f32 v24, v24
    v_exp_f32 v25, v25
    v_exp_f32 v26, v26
    v_mfma_f32_16x16x32_bf16 v[148:151], a[240:243], a[32:35], v[148:151]
    buffer_load_dwordx4 v244, s[40:43], 0 offen offset:0 sc1 lds
    v_cvt_pk_bf16_f32 v52, v20, v21
    v_cvt_pk_bf16_f32 v53, v22, v23
    v_mfma_f32_16x16x32_bf16 v[180:183], a[244:247], a[32:35], v[180:183]
    s_add_u32 s79, s79, 4096
    ds_read_b128 a[156:159], v3 offset:13312
    v_exp_f32 v27, v27
    v_mfma_f32_32x32x16_bf16 v[36:51], a[148:151], a[140:143], v[36:51]
    ds_read_b64_tr_b16 a[220:221], v245 offset:8192
    v_exp_f32 v28, v28
    v_exp_f32 v29, v29
    v_exp_f32 v30, v30
    v_mfma_f32_16x16x32_bf16 v[212:215], a[248:251], a[32:35], v[212:215]
    s_add_u32 s36, s36, 1064960
    s_addc_u32 s37, s37, 0
    v_cvt_pk_bf16_f32 v54, v24, v25
    v_cvt_pk_bf16_f32 v55, v26, v27
    v_smfmac_f32_16x16x64_bf16 v[104:107], a[176:179], v[60:67], v18
    buffer_load_dwordx4 a[32:35], v17, s[36:39], 0 offen offset:0 sc1
    v_cvt_pk_bf16_f32 v56, v28, v29
    v_mfma_f32_16x16x32_bf16 v[120:123], a[236:239], a[36:39], v[120:123]
    s_mov_b32 m0, s79
    v_exp_f32 v31, v31
    v_mfma_f32_32x32x16_bf16 v[84:99], a[172:175], v[64:67], v[84:99]
    buffer_load_dwordx4 v2, s[44:47], s68 offen offset:0 sc1 lds
    v_exp_f32 v32, v32
    v_exp_f32 v33, v33
    v_exp_f32 v34, v34
    v_mfma_f32_16x16x32_bf16 v[152:155], a[240:243], a[36:39], v[152:155]
    ds_read_b64_tr_b16 a[222:223], v245 offset:10240
    v_exp_f32 v35, v35
    v_mfma_f32_16x16x32_bf16 v[184:187], a[244:247], a[36:39], v[184:187]
    v_cvt_pk_bf16_f32 v57, v30, v31
    v_cvt_pk_bf16_f32 v58, v32, v33
    v_mfma_f32_16x16x32_bf16 v[216:219], a[248:251], a[36:39], v[216:219]
    buffer_load_dwordx4 a[36:39], v17, s[36:39], 0 offen offset:2048 sc1
    v_cvt_pk_bf16_f32 v59, v34, v35
    v_mfma_f32_32x32x16_bf16 v[68:83], a[160:163], v[52:55], v[68:83]
    s_waitcnt lgkmcnt(2)
    v_exp_f32 v36, v36
    v_exp_f32 v37, v37
    v_exp_f32 v38, v38
    v_mfma_f32_16x16x32_bf16 v[124:127], a[236:239], a[40:43], v[124:127]
    ds_read_b128 a[168:171], v3 offset:14336
    v_exp_f32 v39, v39
    v_mfma_f32_32x32x16_bf16 v[20:35], a[152:155], a[128:131], 0
    s_add_u32 m0, s78, 4096
    v_exp_f32 v40, v40
    v_exp_f32 v41, v41
    v_exp_f32 v42, v42
    v_mfma_f32_16x16x32_bf16 v[156:159], a[240:243], a[40:43], v[156:159]
    buffer_load_dwordx4 v244, s[40:43], s75 offen offset:1024 sc1 lds
    v_cvt_pk_bf16_f32 v60, v36, v37
    v_cvt_pk_bf16_f32 v61, v38, v39
    v_mfma_f32_16x16x32_bf16 v[188:191], a[244:247], a[40:43], v[188:191]
    ds_read_b128 a[172:175], v3 offset:15360
    v_exp_f32 v43, v43
    v_mfma_f32_32x32x16_bf16 v[20:35], a[156:159], a[132:135], v[20:35]
    ds_read_b64_tr_b16 a[224:225], v246 offset:8192
    v_exp_f32 v44, v44
    v_exp_f32 v45, v45
    v_exp_f32 v46, v46
    v_mfma_f32_16x16x32_bf16 v[220:223], a[248:251], a[40:43], v[220:223]
    v_cvt_pk_bf16_f32 v62, v40, v41
    v_cvt_pk_bf16_f32 v63, v42, v43
    v_smfmac_f32_16x16x64_bf16 v[100:103], a[176:179], v[52:59], v18
    buffer_load_dwordx4 a[40:43], v17, s[36:39], s73 offen offset:0 sc1
    v_cvt_pk_bf16_f32 v64, v44, v45
    v_mfma_f32_16x16x32_bf16 v[128:131], a[236:239], a[44:47], v[128:131]
    s_mov_b32 m0, s79
    v_exp_f32 v47, v47
    v_mfma_f32_32x32x16_bf16 v[68:83], a[164:167], v[56:59], v[68:83]
    buffer_load_dwordx4 v2, s[44:47], s68 offen offset:1024 sc1 lds
    v_exp_f32 v48, v48
    v_exp_f32 v49, v49
    v_exp_f32 v50, v50
    v_mfma_f32_16x16x32_bf16 v[160:163], a[240:243], a[44:47], v[160:163]
    ds_read_b64_tr_b16 a[226:227], v246 offset:10240
    v_exp_f32 v51, v51
    v_mfma_f32_16x16x32_bf16 v[192:195], a[244:247], a[44:47], v[192:195]
    v_cvt_pk_bf16_f32 v65, v46, v47
    v_cvt_pk_bf16_f32 v66, v48, v49
    v_mfma_f32_16x16x32_bf16 v[224:227], a[248:251], a[44:47], v[224:227]
    buffer_load_dwordx4 a[44:47], v17, s[36:39], s73 offen offset:2048 sc1
    v_cvt_pk_bf16_f32 v67, v50, v51
    v_mfma_f32_32x32x16_bf16 v[84:99], a[160:163], v[60:63], v[84:99]
    s_waitcnt lgkmcnt(2)
    v_exp_f32 v20, v20
    v_exp_f32 v21, v21
    v_exp_f32 v22, v22
    v_mfma_f32_16x16x32_bf16 v[132:135], a[236:239], a[48:51], v[132:135]
    ds_read_b128 a[144:147], v3 offset:16384
    v_exp_f32 v23, v23
    v_mfma_f32_32x32x16_bf16 v[36:51], a[152:155], a[136:139], 0
    s_add_u32 m0, s78, 4096
    v_exp_f32 v24, v24
    v_exp_f32 v25, v25
    v_exp_f32 v26, v26
    v_mfma_f32_16x16x32_bf16 v[164:167], a[240:243], a[48:51], v[164:167]
    buffer_load_dwordx4 v244, s[40:43], s76 offen offset:2048 sc1 lds
    v_cvt_pk_bf16_f32 v52, v20, v21
    v_cvt_pk_bf16_f32 v53, v22, v23
    v_mfma_f32_16x16x32_bf16 v[196:199], a[244:247], a[48:51], v[196:199]
    ds_read_b128 a[148:151], v3 offset:17408
    v_exp_f32 v27, v27
    v_mfma_f32_32x32x16_bf16 v[36:51], a[156:159], a[140:143], v[36:51]
    ds_read_b64_tr_b16 a[228:229], v247 offset:8192
    v_exp_f32 v28, v28
    v_exp_f32 v29, v29
    v_exp_f32 v30, v30
    v_mfma_f32_16x16x32_bf16 v[228:231], a[248:251], a[48:51], v[228:231]
    v_cvt_pk_bf16_f32 v54, v24, v25
    v_cvt_pk_bf16_f32 v55, v26, v27
    v_smfmac_f32_16x16x64_bf16 v[104:107], a[176:179], v[60:67], v18
    buffer_load_dwordx4 a[48:51], v17, s[36:39], s74 offen offset:0 sc1
    v_cvt_pk_bf16_f32 v56, v28, v29
    v_mfma_f32_16x16x32_bf16 v[136:139], a[236:239], a[52:55], v[136:139]
    s_mov_b32 m0, s79
    v_exp_f32 v31, v31
    v_mfma_f32_32x32x16_bf16 v[84:99], a[164:167], v[64:67], v[84:99]
    buffer_load_dwordx4 v2, s[44:47], s68 offen offset:2048 sc1 lds
    v_exp_f32 v32, v32
    v_exp_f32 v33, v33
    v_exp_f32 v34, v34
    v_mfma_f32_16x16x32_bf16 v[168:171], a[240:243], a[52:55], v[168:171]
    ds_read_b64_tr_b16 a[230:231], v247 offset:10240
    v_exp_f32 v35, v35
    v_mfma_f32_16x16x32_bf16 v[200:203], a[244:247], a[52:55], v[200:203]
    v_cvt_pk_bf16_f32 v57, v30, v31
    v_cvt_pk_bf16_f32 v58, v32, v33
    v_mfma_f32_16x16x32_bf16 v[232:235], a[248:251], a[52:55], v[232:235]
    buffer_load_dwordx4 a[52:55], v17, s[36:39], s74 offen offset:2048 sc1
    v_cvt_pk_bf16_f32 v59, v34, v35
    v_mfma_f32_32x32x16_bf16 v[68:83], a[168:171], v[52:55], v[68:83]
    s_waitcnt lgkmcnt(2)
    v_exp_f32 v36, v36
    v_exp_f32 v37, v37
    v_exp_f32 v38, v38
    v_mfma_f32_16x16x32_bf16 v[140:143], a[236:239], a[56:59], v[140:143]
    ds_read_b128 a[160:163], v3 offset:18432
    v_exp_f32 v39, v39
    v_mfma_f32_32x32x16_bf16 v[20:35], a[144:147], a[128:131], 0
    s_add_u32 m0, s78, 4096
    v_exp_f32 v40, v40
    v_exp_f32 v41, v41
    v_exp_f32 v42, v42
    v_mfma_f32_16x16x32_bf16 v[172:175], a[240:243], a[56:59], v[172:175]
    buffer_load_dwordx4 v244, s[40:43], s77 offen offset:3072 sc1 lds
    v_cvt_pk_bf16_f32 v60, v36, v37
    v_cvt_pk_bf16_f32 v61, v38, v39
    v_mfma_f32_16x16x32_bf16 v[204:207], a[244:247], a[56:59], v[204:207]
    ds_read_b128 a[164:167], v3 offset:19456
    v_exp_f32 v43, v43
    v_mfma_f32_32x32x16_bf16 v[20:35], a[148:151], a[132:135], v[20:35]
    ds_read_b64_tr_b16 a[232:233], v248 offset:8192
    v_exp_f32 v44, v44
    v_exp_f32 v45, v45
    v_exp_f32 v46, v46
    v_mfma_f32_16x16x32_bf16 v[236:239], a[248:251], a[56:59], v[236:239]
    ds_read_b64_tr_b16 a[234:235], v248 offset:10240
    v_cvt_pk_bf16_f32 v62, v40, v41
    v_cvt_pk_bf16_f32 v63, v42, v43
    v_smfmac_f32_16x16x64_bf16 v[100:103], a[176:179], v[52:59], v18
    buffer_load_dwordx4 a[56:59], v17, s[36:39], s16 offen offset:0 sc1
    v_cvt_pk_bf16_f32 v64, v44, v45
    v_mfma_f32_16x16x32_bf16 v[144:147], a[236:239], a[60:63], v[144:147]
    s_mov_b32 m0, s79
    v_exp_f32 v47, v47
    v_mfma_f32_32x32x16_bf16 v[68:83], a[172:175], v[56:59], v[68:83]
    buffer_load_dwordx4 v2, s[44:47], s68 offen offset:3072 sc1 lds
    v_exp_f32 v48, v48
    v_exp_f32 v49, v49
    v_exp_f32 v50, v50
    v_mfma_f32_16x16x32_bf16 v[176:179], a[240:243], a[60:63], v[176:179]
    v_exp_f32 v51, v51
    v_mfma_f32_16x16x32_bf16 v[208:211], a[244:247], a[60:63], v[208:211]
    v_add_u32 v244, s18, v244
    v_cvt_pk_bf16_f32 v65, v46, v47
    v_cvt_pk_bf16_f32 v66, v48, v49
    v_mfma_f32_16x16x32_bf16 v[240:243], a[248:251], a[60:63], v[240:243]
    buffer_load_dwordx4 a[60:63], v17, s[36:39], s16 offen offset:2048 sc1
    v_cvt_pk_bf16_f32 v67, v50, v51
    v_mfma_f32_32x32x16_bf16 v[84:99], a[168:171], v[60:63], v[84:99]
    s_waitcnt vmcnt(34) lgkmcnt(0)
    v_exp_f32 v20, v20
    v_exp_f32 v21, v21
    v_exp_f32 v22, v22
    v_mfma_f32_16x16x32_bf16 v[116:119], a[220:223], a[64:67], v[116:119]
    s_add_u32 s68, s68, 28672
    ds_read_b128 a[152:155], v3 offset:20480
    v_exp_f32 v23, v23
    v_mfma_f32_32x32x16_bf16 v[36:51], a[144:147], a[136:139], 0
    s_add_u32 m0, s78, 8192
    v_exp_f32 v24, v24
    v_exp_f32 v25, v25
    v_exp_f32 v26, v26
    v_mfma_f32_16x16x32_bf16 v[148:151], a[224:227], a[64:67], v[148:151]
    buffer_load_dwordx4 v244, s[40:43], 0 offen offset:0 sc1 lds
    v_cvt_pk_bf16_f32 v52, v20, v21
    v_cvt_pk_bf16_f32 v53, v22, v23
    v_mfma_f32_16x16x32_bf16 v[180:183], a[228:231], a[64:67], v[180:183]
    ds_read_b128 a[156:159], v3 offset:21504
    v_exp_f32 v27, v27
    v_mfma_f32_32x32x16_bf16 v[36:51], a[148:151], a[140:143], v[36:51]
    ds_read_b64_tr_b16 a[236:237], v245 offset:12288
    v_exp_f32 v28, v28
    v_exp_f32 v29, v29
    v_exp_f32 v30, v30
    v_mfma_f32_16x16x32_bf16 v[212:215], a[232:235], a[64:67], v[212:215]
    s_add_u32 s36, s36, 1064960
    s_addc_u32 s37, s37, 0
    v_cvt_pk_bf16_f32 v54, v24, v25
    v_cvt_pk_bf16_f32 v55, v26, v27
    v_smfmac_f32_16x16x64_bf16 v[104:107], a[176:179], v[60:67], v18
    buffer_load_dwordx4 a[64:67], v17, s[36:39], 0 offen offset:0 sc1
    v_cvt_pk_bf16_f32 v56, v28, v29
    v_mfma_f32_16x16x32_bf16 v[120:123], a[220:223], a[68:71], v[120:123]
    v_exp_f32 v31, v31
    v_mfma_f32_32x32x16_bf16 v[84:99], a[172:175], v[64:67], v[84:99]
    v_exp_f32 v32, v32
    v_exp_f32 v33, v33
    v_exp_f32 v34, v34
    v_mfma_f32_16x16x32_bf16 v[152:155], a[224:227], a[68:71], v[152:155]
    ds_read_b64_tr_b16 a[238:239], v245 offset:14336
    v_exp_f32 v35, v35
    v_mfma_f32_16x16x32_bf16 v[184:187], a[228:231], a[68:71], v[184:187]
    v_cvt_pk_bf16_f32 v57, v30, v31
    v_cvt_pk_bf16_f32 v58, v32, v33
    v_mfma_f32_16x16x32_bf16 v[216:219], a[232:235], a[68:71], v[216:219]
    buffer_load_dwordx4 a[68:71], v17, s[36:39], 0 offen offset:2048 sc1
    v_cvt_pk_bf16_f32 v59, v34, v35
    v_mfma_f32_32x32x16_bf16 v[68:83], a[160:163], v[52:55], v[68:83]
    s_waitcnt lgkmcnt(2)
    v_exp_f32 v36, v36
    v_exp_f32 v37, v37
    v_exp_f32 v38, v38
    v_mfma_f32_16x16x32_bf16 v[124:127], a[220:223], a[72:75], v[124:127]
    ds_read_b128 a[168:171], v3 offset:22528
    v_exp_f32 v39, v39
    v_mfma_f32_32x32x16_bf16 v[20:35], a[152:155], a[128:131], 0
    s_add_u32 m0, s78, 8192
    v_exp_f32 v40, v40
    v_exp_f32 v41, v41
    v_exp_f32 v42, v42
    v_mfma_f32_16x16x32_bf16 v[156:159], a[224:227], a[72:75], v[156:159]
    buffer_load_dwordx4 v244, s[40:43], s75 offen offset:1024 sc1 lds
    v_cvt_pk_bf16_f32 v60, v36, v37
    v_cvt_pk_bf16_f32 v61, v38, v39
    v_mfma_f32_16x16x32_bf16 v[188:191], a[228:231], a[72:75], v[188:191]
    ds_read_b128 a[172:175], v3 offset:23552
    v_exp_f32 v43, v43
    v_mfma_f32_32x32x16_bf16 v[20:35], a[156:159], a[132:135], v[20:35]
    ds_read_b64_tr_b16 a[240:241], v246 offset:12288
    v_exp_f32 v44, v44
    v_exp_f32 v45, v45
    v_exp_f32 v46, v46
    v_mfma_f32_16x16x32_bf16 v[220:223], a[232:235], a[72:75], v[220:223]
    s_cmp_eq_u32 s62, 6
    s_cselect_b32 s8, 0, s8
    s_cselect_b32 s52, s12, s52
    s_cselect_b32 s53, s13, s53
    s_cselect_b32 s54, 0x200000, s54
    v_cvt_pk_bf16_f32 v62, v40, v41
    v_cvt_pk_bf16_f32 v63, v42, v43
    v_smfmac_f32_16x16x64_bf16 v[100:103], a[176:179], v[52:59], v18
    buffer_load_dwordx4 a[72:75], v17, s[36:39], s73 offen offset:0 sc1
    v_cvt_pk_bf16_f32 v64, v44, v45
    v_mfma_f32_16x16x32_bf16 v[128:131], a[220:223], a[76:79], v[128:131]
    v_exp_f32 v47, v47
    v_mfma_f32_32x32x16_bf16 v[68:83], a[164:167], v[56:59], v[68:83]
    buffer_load_dword a252, v249, s[52:55], s8 offen
    v_exp_f32 v48, v48
    v_exp_f32 v49, v49
    v_exp_f32 v50, v50
    v_mfma_f32_16x16x32_bf16 v[160:163], a[224:227], a[76:79], v[160:163]
    ds_read_b64_tr_b16 a[242:243], v246 offset:14336
    v_exp_f32 v51, v51
    v_mfma_f32_16x16x32_bf16 v[192:195], a[228:231], a[76:79], v[192:195]
    v_cvt_pk_bf16_f32 v65, v46, v47
    v_cvt_pk_bf16_f32 v66, v48, v49
    v_mfma_f32_16x16x32_bf16 v[224:227], a[232:235], a[76:79], v[224:227]
    buffer_load_dwordx4 a[76:79], v17, s[36:39], s73 offen offset:2048 sc1
    v_cvt_pk_bf16_f32 v67, v50, v51
    v_mfma_f32_32x32x16_bf16 v[84:99], a[160:163], v[60:63], v[84:99]
    s_waitcnt lgkmcnt(2)
    v_exp_f32 v20, v20
    v_exp_f32 v21, v21
    v_exp_f32 v22, v22
    v_mfma_f32_16x16x32_bf16 v[132:135], a[220:223], a[80:83], v[132:135]
    s_add_u32 s8, s8, 0x100000
    ds_read_b128 a[144:147], v3 offset:24576
    v_exp_f32 v23, v23
    v_mfma_f32_32x32x16_bf16 v[36:51], a[152:155], a[136:139], 0
    s_add_u32 m0, s78, 8192
    v_exp_f32 v24, v24
    v_exp_f32 v25, v25
    v_exp_f32 v26, v26
    v_mfma_f32_16x16x32_bf16 v[164:167], a[224:227], a[80:83], v[164:167]
    buffer_load_dwordx4 v244, s[40:43], s76 offen offset:2048 sc1 lds
    v_cvt_pk_bf16_f32 v52, v20, v21
    v_cvt_pk_bf16_f32 v53, v22, v23
    v_mfma_f32_16x16x32_bf16 v[196:199], a[228:231], a[80:83], v[196:199]
    ds_read_b128 a[148:151], v3 offset:25600
    v_exp_f32 v27, v27
    v_mfma_f32_32x32x16_bf16 v[36:51], a[156:159], a[140:143], v[36:51]
    ds_read_b64_tr_b16 a[244:245], v247 offset:12288
    v_exp_f32 v28, v28
    v_exp_f32 v29, v29
    v_exp_f32 v30, v30
    v_mfma_f32_16x16x32_bf16 v[228:231], a[232:235], a[80:83], v[228:231]
    v_cvt_pk_bf16_f32 v54, v24, v25
    v_cvt_pk_bf16_f32 v55, v26, v27
    v_smfmac_f32_16x16x64_bf16 v[104:107], a[176:179], v[60:67], v18
    buffer_load_dwordx4 a[80:83], v17, s[36:39], s74 offen offset:0 sc1
    v_cvt_pk_bf16_f32 v56, v28, v29
    v_mfma_f32_16x16x32_bf16 v[136:139], a[220:223], a[84:87], v[136:139]
    v_exp_f32 v31, v31
    v_mfma_f32_32x32x16_bf16 v[84:99], a[164:167], v[64:67], v[84:99]
    v_exp_f32 v32, v32
    v_exp_f32 v33, v33
    v_exp_f32 v34, v34
    v_mfma_f32_16x16x32_bf16 v[168:171], a[224:227], a[84:87], v[168:171]
    ds_read_b64_tr_b16 a[246:247], v247 offset:14336
    v_exp_f32 v35, v35
    v_mfma_f32_16x16x32_bf16 v[200:203], a[228:231], a[84:87], v[200:203]
    v_cvt_pk_bf16_f32 v57, v30, v31
    v_cvt_pk_bf16_f32 v58, v32, v33
    v_mfma_f32_16x16x32_bf16 v[232:235], a[232:235], a[84:87], v[232:235]
    buffer_load_dwordx4 a[84:87], v17, s[36:39], s74 offen offset:2048 sc1
    v_cvt_pk_bf16_f32 v59, v34, v35
    v_mfma_f32_32x32x16_bf16 v[68:83], a[168:171], v[52:55], v[68:83]
    s_waitcnt lgkmcnt(2)
    v_exp_f32 v36, v36
    v_exp_f32 v37, v37
    v_exp_f32 v38, v38
    v_mfma_f32_16x16x32_bf16 v[140:143], a[220:223], a[88:91], v[140:143]
    ds_read_b128 a[160:163], v3 offset:26624
    v_exp_f32 v39, v39
    v_mfma_f32_32x32x16_bf16 v[20:35], a[144:147], a[128:131], 0
    s_add_u32 m0, s78, 8192
    v_exp_f32 v40, v40
    v_exp_f32 v41, v41
    v_exp_f32 v42, v42
    v_mfma_f32_16x16x32_bf16 v[172:175], a[224:227], a[88:91], v[172:175]
    buffer_load_dwordx4 v244, s[40:43], s77 offen offset:3072 sc1 lds
    v_cvt_pk_bf16_f32 v60, v36, v37
    v_cvt_pk_bf16_f32 v61, v38, v39
    v_mfma_f32_16x16x32_bf16 v[204:207], a[228:231], a[88:91], v[204:207]
    ds_read_b128 a[164:167], v3 offset:27648
    v_exp_f32 v43, v43
    v_mfma_f32_32x32x16_bf16 v[20:35], a[148:151], a[132:135], v[20:35]
    ds_read_b64_tr_b16 a[248:249], v248 offset:12288
    v_exp_f32 v44, v44
    v_exp_f32 v45, v45
    v_exp_f32 v46, v46
    v_mfma_f32_16x16x32_bf16 v[236:239], a[232:235], a[88:91], v[236:239]
    ds_read_b64_tr_b16 a[250:251], v248 offset:14336
    v_cvt_pk_bf16_f32 v62, v40, v41
    v_cvt_pk_bf16_f32 v63, v42, v43
    v_smfmac_f32_16x16x64_bf16 v[100:103], a[176:179], v[52:59], v18
    buffer_load_dwordx4 a[88:91], v17, s[36:39], s16 offen offset:0 sc1
    v_cvt_pk_bf16_f32 v64, v44, v45
    v_mfma_f32_16x16x32_bf16 v[144:147], a[220:223], a[92:95], v[144:147]
    v_exp_f32 v47, v47
    v_mfma_f32_32x32x16_bf16 v[68:83], a[172:175], v[56:59], v[68:83]
    v_exp_f32 v48, v48
    v_exp_f32 v49, v49
    v_exp_f32 v50, v50
    v_mfma_f32_16x16x32_bf16 v[176:179], a[224:227], a[92:95], v[176:179]
    v_exp_f32 v51, v51
    v_mfma_f32_16x16x32_bf16 v[208:211], a[228:231], a[92:95], v[208:211]
    v_add_u32 v244, s18, v244
    v_cvt_pk_bf16_f32 v65, v46, v47
    v_cvt_pk_bf16_f32 v66, v48, v49
    v_mfma_f32_16x16x32_bf16 v[240:243], a[232:235], a[92:95], v[240:243]
    buffer_load_dwordx4 a[92:95], v17, s[36:39], s16 offen offset:2048 sc1
    v_cvt_pk_bf16_f32 v67, v50, v51
    v_mfma_f32_32x32x16_bf16 v[84:99], a[168:171], v[60:63], v[84:99]
    s_waitcnt vmcnt(32) lgkmcnt(0)
    v_exp_f32 v20, v20
    v_exp_f32 v21, v21
    v_exp_f32 v22, v22
    v_mfma_f32_16x16x32_bf16 v[116:119], a[236:239], a[96:99], v[116:119]
    ds_read_b128 a[152:155], v3 offset:28672
    v_exp_f32 v23, v23
    v_mfma_f32_32x32x16_bf16 v[36:51], a[144:147], a[136:139], 0
    s_add_u32 m0, s78, 12288
    v_exp_f32 v24, v24
    v_exp_f32 v25, v25
    v_exp_f32 v26, v26
    v_mfma_f32_16x16x32_bf16 v[148:151], a[240:243], a[96:99], v[148:151]
    buffer_load_dwordx4 v244, s[40:43], 0 offen offset:0 sc1 lds
    v_cvt_pk_bf16_f32 v52, v20, v21
    v_cvt_pk_bf16_f32 v53, v22, v23
    v_mfma_f32_16x16x32_bf16 v[180:183], a[244:247], a[96:99], v[180:183]
    ds_read_b128 a[156:159], v3 offset:29696
    v_exp_f32 v27, v27
    v_mfma_f32_32x32x16_bf16 v[36:51], a[148:151], a[140:143], v[36:51]
    ds_read_b64_tr_b16 a[220:221], v245 offset:0
    v_exp_f32 v28, v28
    v_exp_f32 v29, v29
    v_exp_f32 v30, v30
    v_mfma_f32_16x16x32_bf16 v[212:215], a[248:251], a[96:99], v[212:215]
    s_add_u32 s36, s36, 1064960
    s_addc_u32 s37, s37, 0
    v_cvt_pk_bf16_f32 v54, v24, v25
    v_cvt_pk_bf16_f32 v55, v26, v27
    v_smfmac_f32_16x16x64_bf16 v[104:107], a[176:179], v[60:67], v18
    buffer_load_dwordx4 a[96:99], v17, s[36:39], 0 offen offset:0 sc1
    v_cvt_pk_bf16_f32 v56, v28, v29
    v_mfma_f32_16x16x32_bf16 v[120:123], a[236:239], a[100:103], v[120:123]
    v_exp_f32 v31, v31
    v_mfma_f32_32x32x16_bf16 v[84:99], a[172:175], v[64:67], v[84:99]
    global_load_dword a253, v0, s[100:101]
    v_exp_f32 v32, v32
    v_exp_f32 v33, v33
    v_exp_f32 v34, v34
    v_mfma_f32_16x16x32_bf16 v[152:155], a[240:243], a[100:103], v[152:155]
    ds_read_b64_tr_b16 a[222:223], v245 offset:2048
    v_exp_f32 v35, v35
    v_mfma_f32_16x16x32_bf16 v[184:187], a[244:247], a[100:103], v[184:187]
    v_cvt_pk_bf16_f32 v57, v30, v31
    v_cvt_pk_bf16_f32 v58, v32, v33
    v_mfma_f32_16x16x32_bf16 v[216:219], a[248:251], a[100:103], v[216:219]
    buffer_load_dwordx4 a[100:103], v17, s[36:39], 0 offen offset:2048 sc1
    v_cvt_pk_bf16_f32 v59, v34, v35
    v_mfma_f32_32x32x16_bf16 v[68:83], a[160:163], v[52:55], v[68:83]
    s_waitcnt lgkmcnt(2)
    v_exp_f32 v36, v36
    v_exp_f32 v37, v37
    v_exp_f32 v38, v38
    v_mfma_f32_16x16x32_bf16 v[124:127], a[236:239], a[104:107], v[124:127]
    ds_read_b128 a[168:171], v3 offset:30720
    v_exp_f32 v39, v39
    v_mfma_f32_32x32x16_bf16 v[20:35], a[152:155], a[128:131], 0
    s_add_u32 m0, s78, 12288
    v_exp_f32 v40, v40
    v_exp_f32 v41, v41
    v_exp_f32 v42, v42
    v_mfma_f32_16x16x32_bf16 v[156:159], a[240:243], a[104:107], v[156:159]
    buffer_load_dwordx4 v244, s[40:43], s75 offen offset:1024 sc1 lds
    v_cvt_pk_bf16_f32 v60, v36, v37
    v_cvt_pk_bf16_f32 v61, v38, v39
    v_mfma_f32_16x16x32_bf16 v[188:191], a[244:247], a[104:107], v[188:191]
    ds_read_b128 a[172:175], v3 offset:31744
    v_exp_f32 v43, v43
    v_mfma_f32_32x32x16_bf16 v[20:35], a[156:159], a[132:135], v[20:35]
    ds_read_b64_tr_b16 a[224:225], v246 offset:0
    v_exp_f32 v44, v44
    v_exp_f32 v45, v45
    v_exp_f32 v46, v46
    v_mfma_f32_16x16x32_bf16 v[220:223], a[248:251], a[104:107], v[220:223]
    v_cvt_pk_bf16_f32 v62, v40, v41
    v_cvt_pk_bf16_f32 v63, v42, v43
    v_smfmac_f32_16x16x64_bf16 v[100:103], a[176:179], v[52:59], v18
    buffer_load_dwordx4 a[104:107], v17, s[36:39], s73 offen offset:0 sc1
    v_cvt_pk_bf16_f32 v64, v44, v45
    v_mfma_f32_16x16x32_bf16 v[128:131], a[236:239], a[108:111], v[128:131]
    v_exp_f32 v47, v47
    v_mfma_f32_32x32x16_bf16 v[68:83], a[164:167], v[56:59], v[68:83]
    v_exp_f32 v48, v48
    v_exp_f32 v49, v49
    v_exp_f32 v50, v50
    v_mfma_f32_16x16x32_bf16 v[160:163], a[240:243], a[108:111], v[160:163]
    ds_read_b64_tr_b16 a[226:227], v246 offset:2048
    v_exp_f32 v51, v51
    v_mfma_f32_16x16x32_bf16 v[192:195], a[244:247], a[108:111], v[192:195]
    v_cvt_pk_bf16_f32 v65, v46, v47
    v_cvt_pk_bf16_f32 v66, v48, v49
    v_mfma_f32_16x16x32_bf16 v[224:227], a[248:251], a[108:111], v[224:227]
    buffer_load_dwordx4 a[108:111], v17, s[36:39], s73 offen offset:2048 sc1
    v_cvt_pk_bf16_f32 v67, v50, v51
    v_mfma_f32_32x32x16_bf16 v[84:99], a[160:163], v[60:63], v[84:99]
    s_waitcnt vmcnt(63) lgkmcnt(0)
    s_barrier
    v_exp_f32 v20, v20
    v_exp_f32 v21, v21
    v_exp_f32 v22, v22
    v_mfma_f32_16x16x32_bf16 v[132:135], a[236:239], a[112:115], v[132:135]
    ds_read_b128 a[144:147], v4 offset:0
    v_exp_f32 v23, v23
    v_mfma_f32_32x32x16_bf16 v[36:51], a[152:155], a[136:139], 0
    s_add_u32 m0, s78, 12288
    v_exp_f32 v24, v24
    v_exp_f32 v25, v25
    v_exp_f32 v26, v26
    v_mfma_f32_16x16x32_bf16 v[164:167], a[240:243], a[112:115], v[164:167]
    buffer_load_dwordx4 v244, s[40:43], s76 offen offset:2048 sc1 lds
    v_cvt_pk_bf16_f32 v52, v20, v21
    v_cvt_pk_bf16_f32 v53, v22, v23
    v_mfma_f32_16x16x32_bf16 v[196:199], a[244:247], a[112:115], v[196:199]
    ds_read_b128 a[148:151], v4 offset:1024
    v_exp_f32 v27, v27
    v_mfma_f32_32x32x16_bf16 v[36:51], a[156:159], a[140:143], v[36:51]
    ds_read_b64_tr_b16 a[228:229], v247 offset:0
    v_exp_f32 v28, v28
    v_exp_f32 v29, v29
    v_exp_f32 v30, v30
    v_mfma_f32_16x16x32_bf16 v[228:231], a[248:251], a[112:115], v[228:231]
    v_cvt_pk_bf16_f32 v54, v24, v25
    v_cvt_pk_bf16_f32 v55, v26, v27
    v_smfmac_f32_16x16x64_bf16 v[104:107], a[176:179], v[60:67], v18
    buffer_load_dwordx4 a[112:115], v17, s[36:39], s74 offen offset:0 sc1
    v_cvt_pk_bf16_f32 v56, v28, v29
    v_mfma_f32_16x16x32_bf16 v[136:139], a[236:239], a[116:119], v[136:139]
    v_exp_f32 v31, v31
    v_mfma_f32_32x32x16_bf16 v[84:99], a[164:167], v[64:67], v[84:99]
    v_exp_f32 v32, v32
    v_exp_f32 v33, v33
    v_exp_f32 v34, v34
    v_mfma_f32_16x16x32_bf16 v[168:171], a[240:243], a[116:119], v[168:171]
    ds_read_b64_tr_b16 a[230:231], v247 offset:2048
    v_exp_f32 v35, v35
    v_mfma_f32_16x16x32_bf16 v[200:203], a[244:247], a[116:119], v[200:203]
    v_cvt_pk_bf16_f32 v57, v30, v31
    v_cvt_pk_bf16_f32 v58, v32, v33
    v_mfma_f32_16x16x32_bf16 v[232:235], a[248:251], a[116:119], v[232:235]
    buffer_load_dwordx4 a[116:119], v17, s[36:39], s74 offen offset:2048 sc1
    v_cvt_pk_bf16_f32 v59, v34, v35
    v_mfma_f32_32x32x16_bf16 v[68:83], a[168:171], v[52:55], v[68:83]
    s_waitcnt lgkmcnt(2)
    v_exp_f32 v36, v36
    v_exp_f32 v37, v37
    v_exp_f32 v38, v38
    v_mfma_f32_16x16x32_bf16 v[140:143], a[236:239], a[120:123], v[140:143]
    ds_read_b128 a[160:163], v4 offset:2048
    v_exp_f32 v39, v39
    v_mfma_f32_32x32x16_bf16 v[20:35], a[144:147], a[128:131], 0
    s_add_u32 m0, s78, 12288
    v_exp_f32 v40, v40
    v_exp_f32 v41, v41
    v_exp_f32 v42, v42
    v_mfma_f32_16x16x32_bf16 v[172:175], a[240:243], a[120:123], v[172:175]
    buffer_load_dwordx4 v244, s[40:43], s77 offen offset:3072 sc1 lds
    v_cvt_pk_bf16_f32 v60, v36, v37
    v_cvt_pk_bf16_f32 v61, v38, v39
    v_mfma_f32_16x16x32_bf16 v[204:207], a[244:247], a[120:123], v[204:207]
    s_mov_b32 s58, s65
    ds_read_b128 a[164:167], v4 offset:3072
    v_exp_f32 v43, v43
    v_mfma_f32_32x32x16_bf16 v[20:35], a[148:151], a[132:135], v[20:35]
    s_mov_b32 s65, s66
    ds_read_b64_tr_b16 a[232:233], v248 offset:0
    v_exp_f32 v44, v44
    v_exp_f32 v45, v45
    v_exp_f32 v46, v46
    v_mfma_f32_16x16x32_bf16 v[236:239], a[248:251], a[120:123], v[236:239]
    s_mov_b32 s66, s67
    ds_read_b64_tr_b16 a[234:235], v248 offset:2048
    v_cvt_pk_bf16_f32 v62, v40, v41
    v_cvt_pk_bf16_f32 v63, v42, v43
    v_smfmac_f32_16x16x64_bf16 v[100:103], a[176:179], v[52:59], v18
    s_mov_b32 s67, s58
    buffer_load_dwordx4 a[120:123], v17, s[36:39], s16 offen offset:0 sc1
    v_cvt_pk_bf16_f32 v64, v44, v45
    v_mfma_f32_16x16x32_bf16 v[144:147], a[236:239], a[124:127], v[144:147]
    s_add_u32 s79, s58, s69
    v_exp_f32 v47, v47
    v_mfma_f32_32x32x16_bf16 v[68:83], a[172:175], v[56:59], v[68:83]
    s_add_u32 s62, s62, 1
    v_exp_f32 v48, v48
    v_exp_f32 v49, v49
    v_exp_f32 v50, v50
    v_mfma_f32_16x16x32_bf16 v[176:179], a[240:243], a[124:127], v[176:179]
    v_exp_f32 v51, v51
    v_mfma_f32_16x16x32_bf16 v[208:211], a[244:247], a[124:127], v[208:211]
    v_add_u32 v244, s18, v244
    v_cvt_pk_bf16_f32 v65, v46, v47
    v_cvt_pk_bf16_f32 v66, v48, v49
    v_mfma_f32_16x16x32_bf16 v[240:243], a[248:251], a[124:127], v[240:243]
    buffer_load_dwordx4 a[124:127], v17, s[36:39], s16 offen offset:2048 sc1
    v_cvt_pk_bf16_f32 v67, v50, v51
    s_add_u32 s36, s36, 1064960
    s_addc_u32 s37, s37, 0
    v_add_u32 v3, s65, v2
    v_add_u32 v4, s66, v2
    s_cmp_lt_u32 s62, 6
    s_cbranch_scc1 P2_MLOOP
    s_mov_b32 s44, s30
    s_mov_b32 s45, s31
    s_mov_b32 s46, s15
    v_add_u32 v0, 0x2000, v0
P2_MWLOOP:
    v_mfma_f32_32x32x16_bf16 v[84:99], a[168:171], v[60:63], v[84:99]
    s_waitcnt vmcnt(29) lgkmcnt(0)
    v_exp_f32 v20, v20
    v_exp_f32 v21, v21
    v_exp_f32 v22, v22
    v_mfma_f32_16x16x32_bf16 v[116:119], a[220:223], a[0:3], v[116:119]
    ds_read_b128 a[152:155], v3 offset:4096
    v_exp_f32 v23, v23
    v_mfma_f32_32x32x16_bf16 v[36:51], a[144:147], a[136:139], 0
    s_add_u32 m0, s78, 0
    v_exp_f32 v24, v24
    v_exp_f32 v25, v25
    v_exp_f32 v26, v26
    v_mfma_f32_16x16x32_bf16 v[148:151], a[224:227], a[0:3], v[148:151]
    buffer_load_dwordx4 v244, s[40:43], 0 offen offset:0 sc1 lds
    v_cvt_pk_bf16_f32 v52, v20, v21
    v_cvt_pk_bf16_f32 v53, v22, v23
    v_mfma_f32_16x16x32_bf16 v[180:183], a[228:231], a[0:3], v[180:183]
    ds_read_b128 a[156:159], v3 offset:5120
    v_exp_f32 v27, v27
    v_mfma_f32_32x32x16_bf16 v[36:51], a[148:151], a[140:143], v[36:51]
    ds_read_b64_tr_b16 a[236:237], v245 offset:4096
    v_exp_f32 v28, v28
    v_exp_f32 v29, v29
    v_exp_f32 v30, v30
    v_mfma_f32_16x16x32_bf16 v[212:215], a[232:235], a[0:3], v[212:215]
    v_cvt_pk_bf16_f32 v54, v24, v25
    v_cvt_pk_bf16_f32 v55, v26, v27
    v_smfmac_f32_16x16x64_bf16 v[104:107], a[176:179], v[60:67], v18
    buffer_load_dwordx4 a[0:3], v17, s[36:39], 0 offen offset:0 sc1
    v_cvt_pk_bf16_f32 v56, v28, v29
    v_mfma_f32_16x16x32_bf16 v[120:123], a[220:223], a[4:7], v[120:123]
    s_mov_b32 m0, s79
    v_exp_f32 v31, v31
    v_mfma_f32_32x32x16_bf16 v[84:99], a[172:175], v[64:67], v[84:99]
    buffer_load_dwordx4 v19, s[44:47], 0 offen offset:0 sc1 lds
    v_exp_f32 v32, v32
    v_exp_f32 v33, v33
    v_exp_f32 v34, v34
    v_mfma_f32_16x16x32_bf16 v[152:155], a[224:227], a[4:7], v[152:155]
    ds_read_b64_tr_b16 a[238:239], v245 offset:6144
    v_exp_f32 v35, v35
    v_mfma_f32_16x16x32_bf16 v[184:187], a[228:231], a[4:7], v[184:187]
    v_cvt_pk_bf16_f32 v57, v30, v31
    v_cvt_pk_bf16_f32 v58, v32, v33
    v_mfma_f32_16x16x32_bf16 v[216:219], a[232:235], a[4:7], v[216:219]
    buffer_load_dwordx4 a[4:7], v17, s[36:39], 0 offen offset:2048 sc1
    v_cvt_pk_bf16_f32 v59, v34, v35
    v_mfma_f32_32x32x16_bf16 v[68:83], a[160:163], v[52:55], v[68:83]
    s_waitcnt lgkmcnt(2)
    v_exp_f32 v36, v36
    v_exp_f32 v37, v37
    v_exp_f32 v38, v38
    v_mfma_f32_16x16x32_bf16 v[124:127], a[220:223], a[8:11], v[124:127]
    ds_read_b128 a[168:171], v3 offset:6144
    v_exp_f32 v39, v39
    v_mfma_f32_32x32x16_bf16 v[20:35], a[152:155], a[128:131], 0
    s_add_u32 m0, s78, 0
    v_exp_f32 v40, v40
    v_exp_f32 v41, v41
    v_exp_f32 v42, v42
    v_mfma_f32_16x16x32_bf16 v[156:159], a[224:227], a[8:11], v[156:159]
    buffer_load_dwordx4 v244, s[40:43], s75 offen offset:1024 sc1 lds
    v_cvt_pk_bf16_f32 v60, v36, v37
    v_cvt_pk_bf16_f32 v61, v38, v39
    v_mfma_f32_16x16x32_bf16 v[188:191], a[228:231], a[8:11], v[188:191]
    ds_read_b128 a[172:175], v3 offset:7168
    v_exp_f32 v43, v43
    v_mfma_f32_32x32x16_bf16 v[20:35], a[156:159], a[132:135], v[20:35]
    ds_read_b64_tr_b16 a[240:241], v246 offset:4096
    v_exp_f32 v44, v44
    v_exp_f32 v45, v45
    v_exp_f32 v46, v46
    v_mfma_f32_16x16x32_bf16 v[220:223], a[232:235], a[8:11], v[220:223]
    v_cvt_pk_bf16_f32 v62, v40, v41
    v_cvt_pk_bf16_f32 v63, v42, v43
    v_smfmac_f32_16x16x64_bf16 v[100:103], a[176:179], v[52:59], v18
    buffer_load_dwordx4 a[8:11], v17, s[36:39], s73 offen offset:0 sc1
    v_cvt_pk_bf16_f32 v64, v44, v45
    v_mfma_f32_16x16x32_bf16 v[128:131], a[220:223], a[12:15], v[128:131]
    s_mov_b32 m0, s79
    v_exp_f32 v47, v47
    v_mfma_f32_32x32x16_bf16 v[68:83], a[164:167], v[56:59], v[68:83]
    buffer_load_dwordx4 v19, s[44:47], s75 offen offset:1024 sc1 lds
    v_exp_f32 v48, v48
    v_exp_f32 v49, v49
    v_exp_f32 v50, v50
    v_mfma_f32_16x16x32_bf16 v[160:163], a[224:227], a[12:15], v[160:163]
    ds_read_b64_tr_b16 a[242:243], v246 offset:6144
    v_exp_f32 v51, v51
    v_mfma_f32_16x16x32_bf16 v[192:195], a[228:231], a[12:15], v[192:195]
    v_cvt_pk_bf16_f32 v65, v46, v47
    v_cvt_pk_bf16_f32 v66, v48, v49
    v_mfma_f32_16x16x32_bf16 v[224:227], a[232:235], a[12:15], v[224:227]
    buffer_load_dwordx4 a[12:15], v17, s[36:39], s73 offen offset:2048 sc1
    v_cvt_pk_bf16_f32 v67, v50, v51
    v_mfma_f32_32x32x16_bf16 v[84:99], a[160:163], v[60:63], v[84:99]
    s_waitcnt lgkmcnt(2)
    v_exp_f32 v20, v20
    v_exp_f32 v21, v21
    v_exp_f32 v22, v22
    v_mfma_f32_16x16x32_bf16 v[132:135], a[220:223], a[16:19], v[132:135]
    ds_read_b128 a[144:147], v3 offset:8192
    v_exp_f32 v23, v23
    v_mfma_f32_32x32x16_bf16 v[36:51], a[152:155], a[136:139], 0
    s_add_u32 m0, s78, 0
    v_exp_f32 v24, v24
    v_exp_f32 v25, v25
    v_exp_f32 v26, v26
    v_mfma_f32_16x16x32_bf16 v[164:167], a[224:227], a[16:19], v[164:167]
    buffer_load_dwordx4 v244, s[40:43], s76 offen offset:2048 sc1 lds
    v_cvt_pk_bf16_f32 v52, v20, v21
    v_cvt_pk_bf16_f32 v53, v22, v23
    v_mfma_f32_16x16x32_bf16 v[196:199], a[228:231], a[16:19], v[196:199]
    ds_read_b128 a[148:151], v3 offset:9216
    v_exp_f32 v27, v27
    v_mfma_f32_32x32x16_bf16 v[36:51], a[156:159], a[140:143], v[36:51]
    ds_read_b64_tr_b16 a[244:245], v247 offset:4096
    v_exp_f32 v28, v28
    v_exp_f32 v29, v29
    v_exp_f32 v30, v30
    v_mfma_f32_16x16x32_bf16 v[228:231], a[232:235], a[16:19], v[228:231]
    v_cvt_pk_bf16_f32 v54, v24, v25
    v_cvt_pk_bf16_f32 v55, v26, v27
    v_smfmac_f32_16x16x64_bf16 v[104:107], a[176:179], v[60:67], v18
    buffer_load_dwordx4 a[16:19], v17, s[36:39], s74 offen offset:0 sc1
    v_cvt_pk_bf16_f32 v56, v28, v29
    v_mfma_f32_16x16x32_bf16 v[136:139], a[220:223], a[20:23], v[136:139]
    s_mov_b32 m0, s79
    v_exp_f32 v31, v31
    v_mfma_f32_32x32x16_bf16 v[84:99], a[164:167], v[64:67], v[84:99]
    buffer_load_dwordx4 v19, s[44:47], s76 offen offset:2048 sc1 lds
    v_exp_f32 v32, v32
    v_exp_f32 v33, v33
    v_exp_f32 v34, v34
    v_mfma_f32_16x16x32_bf16 v[168:171], a[224:227], a[20:23], v[168:171]
    ds_read_b64_tr_b16 a[246:247], v247 offset:6144
    v_exp_f32 v35, v35
    v_mfma_f32_16x16x32_bf16 v[200:203], a[228:231], a[20:23], v[200:203]
    v_cvt_pk_bf16_f32 v57, v30, v31
    v_cvt_pk_bf16_f32 v58, v32, v33
    v_mfma_f32_16x16x32_bf16 v[232:235], a[232:235], a[20:23], v[232:235]
    buffer_load_dwordx4 a[20:23], v17, s[36:39], s74 offen offset:2048 sc1
    v_cvt_pk_bf16_f32 v59, v34, v35
    v_mfma_f32_32x32x16_bf16 v[68:83], a[168:171], v[52:55], v[68:83]
    s_waitcnt lgkmcnt(2)
    v_exp_f32 v36, v36
    v_exp_f32 v37, v37
    v_exp_f32 v38, v38
    v_mfma_f32_16x16x32_bf16 v[140:143], a[220:223], a[24:27], v[140:143]
    ds_read_b128 a[160:163], v3 offset:10240
    v_exp_f32 v39, v39
    v_mfma_f32_32x32x16_bf16 v[20:35], a[144:147], a[128:131], 0
    s_add_u32 m0, s78, 0
    v_exp_f32 v40, v40
    v_exp_f32 v41, v41
    v_exp_f32 v42, v42
    v_mfma_f32_16x16x32_bf16 v[172:175], a[224:227], a[24:27], v[172:175]
    buffer_load_dwordx4 v244, s[40:43], s77 offen offset:3072 sc1 lds
    v_cvt_pk_bf16_f32 v60, v36, v37
    v_cvt_pk_bf16_f32 v61, v38, v39
    v_mfma_f32_16x16x32_bf16 v[204:207], a[228:231], a[24:27], v[204:207]
    ds_read_b128 a[164:167], v3 offset:11264
    v_exp_f32 v43, v43
    v_mfma_f32_32x32x16_bf16 v[20:35], a[148:151], a[132:135], v[20:35]
    ds_read_b64_tr_b16 a[248:249], v248 offset:4096
    v_exp_f32 v44, v44
    v_exp_f32 v45, v45
    v_exp_f32 v46, v46
    v_mfma_f32_16x16x32_bf16 v[236:239], a[232:235], a[24:27], v[236:239]
    ds_read_b64_tr_b16 a[250:251], v248 offset:6144
    v_cvt_pk_bf16_f32 v62, v40, v41
    v_cvt_pk_bf16_f32 v63, v42, v43
    v_smfmac_f32_16x16x64_bf16 v[100:103], a[176:179], v[52:59], v18
    buffer_load_dwordx4 a[24:27], v17, s[36:39], s16 offen offset:0 sc1
    v_cvt_pk_bf16_f32 v64, v44, v45
    v_mfma_f32_16x16x32_bf16 v[144:147], a[220:223], a[28:31], v[144:147]
    s_mov_b32 m0, s79
    v_exp_f32 v47, v47
    v_mfma_f32_32x32x16_bf16 v[68:83], a[172:175], v[56:59], v[68:83]
    buffer_load_dwordx4 v19, s[44:47], s77 offen offset:3072 sc1 lds
    v_exp_f32 v48, v48
    v_exp_f32 v49, v49
    v_exp_f32 v50, v50
    v_mfma_f32_16x16x32_bf16 v[176:179], a[224:227], a[28:31], v[176:179]
    v_exp_f32 v51, v51
    v_mfma_f32_16x16x32_bf16 v[208:211], a[228:231], a[28:31], v[208:211]
    v_add_u32 v244, s18, v244
    v_cvt_pk_bf16_f32 v65, v46, v47
    v_cvt_pk_bf16_f32 v66, v48, v49
    v_mfma_f32_16x16x32_bf16 v[240:243], a[232:235], a[28:31], v[240:243]
    buffer_load_dwordx4 a[28:31], v17, s[36:39], s16 offen offset:2048 sc1
    v_cvt_pk_bf16_f32 v67, v50, v51
    v_mfma_f32_32x32x16_bf16 v[84:99], a[168:171], v[60:63], v[84:99]
    s_waitcnt vmcnt(31) lgkmcnt(0)
    v_exp_f32 v20, v20
    v_exp_f32 v21, v21
    v_exp_f32 v22, v22
    v_mfma_f32_16x16x32_bf16 v[116:119], a[236:239], a[32:35], v[116:119]
    s_add_u32 s68, s68, 4096
    ds_read_b128 a[152:155], v3 offset:12288
    v_exp_f32 v23, v23
    v_mfma_f32_32x32x16_bf16 v[36:51], a[144:147], a[136:139], 0
    s_add_u32 m0, s78, 4096
    v_exp_f32 v24, v24
    v_exp_f32 v25, v25
    v_exp_f32 v26, v26
    v_mfma_f32_16x16x32_bf16 v[148:151], a[240:243], a[32:35], v[148:151]
    buffer_load_dwordx4 v244, s[40:43], 0 offen offset:0 sc1 lds
    v_cvt_pk_bf16_f32 v52, v20, v21
    v_cvt_pk_bf16_f32 v53, v22, v23
    v_mfma_f32_16x16x32_bf16 v[180:183], a[244:247], a[32:35], v[180:183]
    s_add_u32 s79, s79, 4096
    ds_read_b128 a[156:159], v3 offset:13312
    v_exp_f32 v27, v27
    v_mfma_f32_32x32x16_bf16 v[36:51], a[148:151], a[140:143], v[36:51]
    ds_read_b64_tr_b16 a[220:221], v245 offset:8192
    v_exp_f32 v28, v28
    v_exp_f32 v29, v29
    v_exp_f32 v30, v30
    v_mfma_f32_16x16x32_bf16 v[212:215], a[248:251], a[32:35], v[212:215]
    s_add_u32 s36, s36, 1064960
    s_addc_u32 s37, s37, 0
    v_add_u32 v19, s18, v19
    v_cvt_pk_bf16_f32 v54, v24, v25
    v_cvt_pk_bf16_f32 v55, v26, v27
    v_smfmac_f32_16x16x64_bf16 v[104:107], a[176:179], v[60:67], v18
    buffer_load_dwordx4 a[32:35], v17, s[36:39], 0 offen offset:0 sc1
    v_cvt_pk_bf16_f32 v56, v28, v29
    v_mfma_f32_16x16x32_bf16 v[120:123], a[236:239], a[36:39], v[120:123]
    s_mov_b32 m0, s79
    v_exp_f32 v31, v31
    v_mfma_f32_32x32x16_bf16 v[84:99], a[172:175], v[64:67], v[84:99]
    buffer_load_dwordx4 v19, s[44:47], 0 offen offset:0 sc1 lds
    v_exp_f32 v32, v32
    v_exp_f32 v33, v33
    v_exp_f32 v34, v34
    v_mfma_f32_16x16x32_bf16 v[152:155], a[240:243], a[36:39], v[152:155]
    ds_read_b64_tr_b16 a[222:223], v245 offset:10240
    v_exp_f32 v35, v35
    v_mfma_f32_16x16x32_bf16 v[184:187], a[244:247], a[36:39], v[184:187]
    v_cvt_pk_bf16_f32 v57, v30, v31
    v_cvt_pk_bf16_f32 v58, v32, v33
    v_mfma_f32_16x16x32_bf16 v[216:219], a[248:251], a[36:39], v[216:219]
    buffer_load_dwordx4 a[36:39], v17, s[36:39], 0 offen offset:2048 sc1
    v_cvt_pk_bf16_f32 v59, v34, v35
    v_mfma_f32_32x32x16_bf16 v[68:83], a[160:163], v[52:55], v[68:83]
    s_waitcnt lgkmcnt(2)
    v_exp_f32 v36, v36
    v_exp_f32 v37, v37
    v_exp_f32 v38, v38
    v_mfma_f32_16x16x32_bf16 v[124:127], a[236:239], a[40:43], v[124:127]
    ds_read_b128 a[168:171], v3 offset:14336
    v_exp_f32 v39, v39
    v_mfma_f32_32x32x16_bf16 v[20:35], a[152:155], a[128:131], 0
    s_add_u32 m0, s78, 4096
    v_exp_f32 v40, v40
    v_exp_f32 v41, v41
    v_exp_f32 v42, v42
    v_mfma_f32_16x16x32_bf16 v[156:159], a[240:243], a[40:43], v[156:159]
    buffer_load_dwordx4 v244, s[40:43], s75 offen offset:1024 sc1 lds
    v_cvt_pk_bf16_f32 v60, v36, v37
    v_cvt_pk_bf16_f32 v61, v38, v39
    v_mfma_f32_16x16x32_bf16 v[188:191], a[244:247], a[40:43], v[188:191]
    ds_read_b128 a[172:175], v3 offset:15360
    v_exp_f32 v43, v43
    v_mfma_f32_32x32x16_bf16 v[20:35], a[156:159], a[132:135], v[20:35]
    ds_read_b64_tr_b16 a[224:225], v246 offset:8192
    v_exp_f32 v44, v44
    v_exp_f32 v45, v45
    v_exp_f32 v46, v46
    v_mfma_f32_16x16x32_bf16 v[220:223], a[248:251], a[40:43], v[220:223]
    v_cvt_pk_bf16_f32 v62, v40, v41
    v_cvt_pk_bf16_f32 v63, v42, v43
    v_smfmac_f32_16x16x64_bf16 v[100:103], a[176:179], v[52:59], v18
    buffer_load_dwordx4 a[40:43], v17, s[36:39], s73 offen offset:0 sc1
    v_cvt_pk_bf16_f32 v64, v44, v45
    v_mfma_f32_16x16x32_bf16 v[128:131], a[236:239], a[44:47], v[128:131]
    s_mov_b32 m0, s79
    v_exp_f32 v47, v47
    v_mfma_f32_32x32x16_bf16 v[68:83], a[164:167], v[56:59], v[68:83]
    buffer_load_dwordx4 v19, s[44:47], s75 offen offset:1024 sc1 lds
    v_exp_f32 v48, v48
    v_exp_f32 v49, v49
    v_exp_f32 v50, v50
    v_mfma_f32_16x16x32_bf16 v[160:163], a[240:243], a[44:47], v[160:163]
    ds_read_b64_tr_b16 a[226:227], v246 offset:10240
    v_exp_f32 v51, v51
    v_mfma_f32_16x16x32_bf16 v[192:195], a[244:247], a[44:47], v[192:195]
    v_cvt_pk_bf16_f32 v65, v46, v47
    v_cvt_pk_bf16_f32 v66, v48, v49
    v_mfma_f32_16x16x32_bf16 v[224:227], a[248:251], a[44:47], v[224:227]
    buffer_load_dwordx4 a[44:47], v17, s[36:39], s73 offen offset:2048 sc1
    v_cvt_pk_bf16_f32 v67, v50, v51
    v_mfma_f32_32x32x16_bf16 v[84:99], a[160:163], v[60:63], v[84:99]
    s_waitcnt lgkmcnt(2)
    v_exp_f32 v20, v20
    v_exp_f32 v21, v21
    v_exp_f32 v22, v22
    v_mfma_f32_16x16x32_bf16 v[132:135], a[236:239], a[48:51], v[132:135]
    ds_read_b128 a[144:147], v3 offset:16384
    v_exp_f32 v23, v23
    v_mfma_f32_32x32x16_bf16 v[36:51], a[152:155], a[136:139], 0
    s_add_u32 m0, s78, 4096
    v_exp_f32 v24, v24
    v_exp_f32 v25, v25
    v_exp_f32 v26, v26
    v_mfma_f32_16x16x32_bf16 v[164:167], a[240:243], a[48:51], v[164:167]
    buffer_load_dwordx4 v244, s[40:43], s76 offen offset:2048 sc1 lds
    v_cvt_pk_bf16_f32 v52, v20, v21
    v_cvt_pk_bf16_f32 v53, v22, v23
    v_mfma_f32_16x16x32_bf16 v[196:199], a[244:247], a[48:51], v[196:199]
    ds_read_b128 a[148:151], v3 offset:17408
    v_exp_f32 v27, v27
    v_mfma_f32_32x32x16_bf16 v[36:51], a[156:159], a[140:143], v[36:51]
    ds_read_b64_tr_b16 a[228:229], v247 offset:8192
    v_exp_f32 v28, v28
    v_exp_f32 v29, v29
    v_exp_f32 v30, v30
    v_mfma_f32_16x16x32_bf16 v[228:231], a[248:251], a[48:51], v[228:231]
    v_cvt_pk_bf16_f32 v54, v24, v25
    v_cvt_pk_bf16_f32 v55, v26, v27
    v_smfmac_f32_16x16x64_bf16 v[104:107], a[176:179], v[60:67], v18
    buffer_load_dwordx4 a[48:51], v17, s[36:39], s74 offen offset:0 sc1
    v_cvt_pk_bf16_f32 v56, v28, v29
    v_mfma_f32_16x16x32_bf16 v[136:139], a[236:239], a[52:55], v[136:139]
    s_mov_b32 m0, s79
    v_exp_f32 v31, v31
    v_mfma_f32_32x32x16_bf16 v[84:99], a[164:167], v[64:67], v[84:99]
    buffer_load_dwordx4 v19, s[44:47], s76 offen offset:2048 sc1 lds
    v_exp_f32 v32, v32
    v_exp_f32 v33, v33
    v_exp_f32 v34, v34
    v_mfma_f32_16x16x32_bf16 v[168:171], a[240:243], a[52:55], v[168:171]
    ds_read_b64_tr_b16 a[230:231], v247 offset:10240
    v_exp_f32 v35, v35
    v_mfma_f32_16x16x32_bf16 v[200:203], a[244:247], a[52:55], v[200:203]
    v_cvt_pk_bf16_f32 v57, v30, v31
    v_cvt_pk_bf16_f32 v58, v32, v33
    v_mfma_f32_16x16x32_bf16 v[232:235], a[248:251], a[52:55], v[232:235]
    buffer_load_dwordx4 a[52:55], v17, s[36:39], s74 offen offset:2048 sc1
    v_cvt_pk_bf16_f32 v59, v34, v35
    v_mfma_f32_32x32x16_bf16 v[68:83], a[168:171], v[52:55], v[68:83]
    s_waitcnt lgkmcnt(2)
    v_exp_f32 v36, v36
    v_exp_f32 v37, v37
    v_exp_f32 v38, v38
    v_mfma_f32_16x16x32_bf16 v[140:143], a[236:239], a[56:59], v[140:143]
    ds_read_b128 a[160:163], v3 offset:18432
    v_exp_f32 v39, v39
    v_mfma_f32_32x32x16_bf16 v[20:35], a[144:147], a[128:131], 0
    s_add_u32 m0, s78, 4096
    v_exp_f32 v40, v40
    v_exp_f32 v41, v41
    v_exp_f32 v42, v42
    v_mfma_f32_16x16x32_bf16 v[172:175], a[240:243], a[56:59], v[172:175]
    buffer_load_dwordx4 v244, s[40:43], s77 offen offset:3072 sc1 lds
    v_cvt_pk_bf16_f32 v60, v36, v37
    v_cvt_pk_bf16_f32 v61, v38, v39
    v_mfma_f32_16x16x32_bf16 v[204:207], a[244:247], a[56:59], v[204:207]
    ds_read_b128 a[164:167], v3 offset:19456
    v_exp_f32 v43, v43
    v_mfma_f32_32x32x16_bf16 v[20:35], a[148:151], a[132:135], v[20:35]
    ds_read_b64_tr_b16 a[232:233], v248 offset:8192
    v_exp_f32 v44, v44
    v_exp_f32 v45, v45
    v_exp_f32 v46, v46
    v_mfma_f32_16x16x32_bf16 v[236:239], a[248:251], a[56:59], v[236:239]
    ds_read_b64_tr_b16 a[234:235], v248 offset:10240
    v_cvt_pk_bf16_f32 v62, v40, v41
    v_cvt_pk_bf16_f32 v63, v42, v43
    v_smfmac_f32_16x16x64_bf16 v[100:103], a[176:179], v[52:59], v18
    buffer_load_dwordx4 a[56:59], v17, s[36:39], s16 offen offset:0 sc1
    v_cvt_pk_bf16_f32 v64, v44, v45
    v_mfma_f32_16x16x32_bf16 v[144:147], a[236:239], a[60:63], v[144:147]
    s_mov_b32 m0, s79
    v_exp_f32 v47, v47
    v_mfma_f32_32x32x16_bf16 v[68:83], a[172:175], v[56:59], v[68:83]
    buffer_load_dwordx4 v19, s[44:47], s77 offen offset:3072 sc1 lds
    v_exp_f32 v48, v48
    v_exp_f32 v49, v49
    v_exp_f32 v50, v50
    v_mfma_f32_16x16x32_bf16 v[176:179], a[240:243], a[60:63], v[176:179]
    v_exp_f32 v51, v51
    v_mfma_f32_16x16x32_bf16 v[208:211], a[244:247], a[60:63], v[208:211]
    v_add_u32 v244, s18, v244
    v_cvt_pk_bf16_f32 v65, v46, v47
    v_cvt_pk_bf16_f32 v66, v48, v49
    v_mfma_f32_16x16x32_bf16 v[240:243], a[248:251], a[60:63], v[240:243]
    buffer_load_dwordx4 a[60:63], v17, s[36:39], s16 offen offset:2048 sc1
    v_cvt_pk_bf16_f32 v67, v50, v51
    v_mfma_f32_32x32x16_bf16 v[84:99], a[168:171], v[60:63], v[84:99]
    s_waitcnt vmcnt(34) lgkmcnt(0)
    v_exp_f32 v20, v20
    v_exp_f32 v21, v21
    v_exp_f32 v22, v22
    v_mfma_f32_16x16x32_bf16 v[116:119], a[220:223], a[64:67], v[116:119]
    s_add_u32 s68, s68, 28672
    ds_read_b128 a[152:155], v3 offset:20480
    v_exp_f32 v23, v23
    v_mfma_f32_32x32x16_bf16 v[36:51], a[144:147], a[136:139], 0
    s_add_u32 m0, s78, 8192
    v_exp_f32 v24, v24
    v_exp_f32 v25, v25
    v_exp_f32 v26, v26
    v_mfma_f32_16x16x32_bf16 v[148:151], a[224:227], a[64:67], v[148:151]
    buffer_load_dwordx4 v244, s[40:43], 0 offen offset:0 sc1 lds
    v_cvt_pk_bf16_f32 v52, v20, v21
    v_cvt_pk_bf16_f32 v53, v22, v23
    v_mfma_f32_16x16x32_bf16 v[180:183], a[228:231], a[64:67], v[180:183]
    ds_read_b128 a[156:159], v3 offset:21504
    v_exp_f32 v27, v27
    v_mfma_f32_32x32x16_bf16 v[36:51], a[148:151], a[140:143], v[36:51]
    ds_read_b64_tr_b16 a[236:237], v245 offset:12288
    v_exp_f32 v28, v28
    v_exp_f32 v29, v29
    v_exp_f32 v30, v30
    v_mfma_f32_16x16x32_bf16 v[212:215], a[232:235], a[64:67], v[212:215]
    s_add_u32 s36, s36, 1064960
    s_addc_u32 s37, s37, 0
    v_add_u32 v19, s18, v19
    v_cvt_pk_bf16_f32 v54, v24, v25
    v_cvt_pk_bf16_f32 v55, v26, v27
    v_smfmac_f32_16x16x64_bf16 v[104:107], a[176:179], v[60:67], v18
    buffer_load_dwordx4 a[64:67], v17, s[36:39], 0 offen offset:0 sc1
    v_cvt_pk_bf16_f32 v56, v28, v29
    v_mfma_f32_16x16x32_bf16 v[120:123], a[220:223], a[68:71], v[120:123]
    v_exp_f32 v31, v31
    v_mfma_f32_32x32x16_bf16 v[84:99], a[172:175], v[64:67], v[84:99]
    v_exp_f32 v32, v32
    v_exp_f32 v33, v33
    v_exp_f32 v34, v34
    v_mfma_f32_16x16x32_bf16 v[152:155], a[224:227], a[68:71], v[152:155]
    ds_read_b64_tr_b16 a[238:239], v245 offset:14336
    v_exp_f32 v35, v35
    v_mfma_f32_16x16x32_bf16 v[184:187], a[228:231], a[68:71], v[184:187]
    v_cvt_pk_bf16_f32 v57, v30, v31
    v_cvt_pk_bf16_f32 v58, v32, v33
    v_mfma_f32_16x16x32_bf16 v[216:219], a[232:235], a[68:71], v[216:219]
    buffer_load_dwordx4 a[68:71], v17, s[36:39], 0 offen offset:2048 sc1
    v_cvt_pk_bf16_f32 v59, v34, v35
    v_mfma_f32_32x32x16_bf16 v[68:83], a[160:163], v[52:55], v[68:83]
    s_waitcnt lgkmcnt(2)
    v_exp_f32 v36, v36
    v_exp_f32 v37, v37
    v_exp_f32 v38, v38
    v_mfma_f32_16x16x32_bf16 v[124:127], a[220:223], a[72:75], v[124:127]
    ds_read_b128 a[168:171], v3 offset:22528
    v_exp_f32 v39, v39
    v_mfma_f32_32x32x16_bf16 v[20:35], a[152:155], a[128:131], 0
    s_add_u32 m0, s78, 8192
    v_exp_f32 v40, v40
    v_exp_f32 v41, v41
    v_exp_f32 v42, v42
    v_mfma_f32_16x16x32_bf16 v[156:159], a[224:227], a[72:75], v[156:159]
    buffer_load_dwordx4 v244, s[40:43], s75 offen offset:1024 sc1 lds
    v_cvt_pk_bf16_f32 v60, v36, v37
    v_cvt_pk_bf16_f32 v61, v38, v39
    v_mfma_f32_16x16x32_bf16 v[188:191], a[228:231], a[72:75], v[188:191]
    ds_read_b128 a[172:175], v3 offset:23552
    v_exp_f32 v43, v43
    v_mfma_f32_32x32x16_bf16 v[20:35], a[156:159], a[132:135], v[20:35]
    ds_read_b64_tr_b16 a[240:241], v246 offset:12288
    v_exp_f32 v44, v44
    v_exp_f32 v45, v45
    v_exp_f32 v46, v46
    v_mfma_f32_16x16x32_bf16 v[220:223], a[232:235], a[72:75], v[220:223]
    s_cmp_eq_u32 s62, 6
    s_cselect_b32 s8, 0, s8
    s_cselect_b32 s52, s12, s52
    s_cselect_b32 s53, s13, s53
    s_cselect_b32 s54, 0x200000, s54
    v_cvt_pk_bf16_f32 v62, v40, v41
    v_cvt_pk_bf16_f32 v63, v42, v43
    v_smfmac_f32_16x16x64_bf16 v[100:103], a[176:179], v[52:59], v18
    buffer_load_dwordx4 a[72:75], v17, s[36:39], s73 offen offset:0 sc1
    v_cvt_pk_bf16_f32 v64, v44, v45
    v_mfma_f32_16x16x32_bf16 v[128:131], a[220:223], a[76:79], v[128:131]
    v_exp_f32 v47, v47
    v_mfma_f32_32x32x16_bf16 v[68:83], a[164:167], v[56:59], v[68:83]
    buffer_load_dword a252, v249, s[52:55], s8 offen
    v_exp_f32 v48, v48
    v_exp_f32 v49, v49
    v_exp_f32 v50, v50
    v_mfma_f32_16x16x32_bf16 v[160:163], a[224:227], a[76:79], v[160:163]
    ds_read_b64_tr_b16 a[242:243], v246 offset:14336
    v_exp_f32 v51, v51
    v_mfma_f32_16x16x32_bf16 v[192:195], a[228:231], a[76:79], v[192:195]
    v_cvt_pk_bf16_f32 v65, v46, v47
    v_cvt_pk_bf16_f32 v66, v48, v49
    v_mfma_f32_16x16x32_bf16 v[224:227], a[232:235], a[76:79], v[224:227]
    buffer_load_dwordx4 a[76:79], v17, s[36:39], s73 offen offset:2048 sc1
    v_cvt_pk_bf16_f32 v67, v50, v51
    v_mfma_f32_32x32x16_bf16 v[84:99], a[160:163], v[60:63], v[84:99]
    s_waitcnt lgkmcnt(2)
    v_exp_f32 v20, v20
    v_exp_f32 v21, v21
    v_exp_f32 v22, v22
    v_mfma_f32_16x16x32_bf16 v[132:135], a[220:223], a[80:83], v[132:135]
    s_add_u32 s8, s8, 0x100000
    ds_read_b128 a[144:147], v3 offset:24576
    v_exp_f32 v23, v23
    v_mfma_f32_32x32x16_bf16 v[36:51], a[152:155], a[136:139], 0
    s_add_u32 m0, s78, 8192
    v_exp_f32 v24, v24
    v_exp_f32 v25, v25
    v_exp_f32 v26, v26
    v_mfma_f32_16x16x32_bf16 v[164:167], a[224:227], a[80:83], v[164:167]
    buffer_load_dwordx4 v244, s[40:43], s76 offen offset:2048 sc1 lds
    v_cvt_pk_bf16_f32 v52, v20, v21
    v_cvt_pk_bf16_f32 v53, v22, v23
    v_mfma_f32_16x16x32_bf16 v[196:199], a[228:231], a[80:83], v[196:199]
    ds_read_b128 a[148:151], v3 offset:25600
    v_exp_f32 v27, v27
    v_mfma_f32_32x32x16_bf16 v[36:51], a[156:159], a[140:143], v[36:51]
    ds_read_b64_tr_b16 a[244:245], v247 offset:12288
    v_exp_f32 v28, v28
    v_exp_f32 v29, v29
    v_exp_f32 v30, v30
    v_mfma_f32_16x16x32_bf16 v[228:231], a[232:235], a[80:83], v[228:231]
    v_cvt_pk_bf16_f32 v54, v24, v25
    v_cvt_pk_bf16_f32 v55, v26, v27
    v_smfmac_f32_16x16x64_bf16 v[104:107], a[176:179], v[60:67], v18
    buffer_load_dwordx4 a[80:83], v17, s[36:39], s74 offen offset:0 sc1
    v_cvt_pk_bf16_f32 v56, v28, v29
    v_mfma_f32_16x16x32_bf16 v[136:139], a[220:223], a[84:87], v[136:139]
    v_exp_f32 v31, v31
    v_mfma_f32_32x32x16_bf16 v[84:99], a[164:167], v[64:67], v[84:99]
    v_exp_f32 v32, v32
    v_exp_f32 v33, v33
    v_exp_f32 v34, v34
    v_mfma_f32_16x16x32_bf16 v[168:171], a[224:227], a[84:87], v[168:171]
    ds_read_b64_tr_b16 a[246:247], v247 offset:14336
    v_exp_f32 v35, v35
    v_mfma_f32_16x16x32_bf16 v[200:203], a[228:231], a[84:87], v[200:203]
    v_cvt_pk_bf16_f32 v57, v30, v31
    v_cvt_pk_bf16_f32 v58, v32, v33
    v_mfma_f32_16x16x32_bf16 v[232:235], a[232:235], a[84:87], v[232:235]
    buffer_load_dwordx4 a[84:87], v17, s[36:39], s74 offen offset:2048 sc1
    v_cvt_pk_bf16_f32 v59, v34, v35
    v_mfma_f32_32x32x16_bf16 v[68:83], a[168:171], v[52:55], v[68:83]
    s_waitcnt lgkmcnt(2)
    v_exp_f32 v36, v36
    v_exp_f32 v37, v37
    v_exp_f32 v38, v38
    v_mfma_f32_16x16x32_bf16 v[140:143], a[220:223], a[88:91], v[140:143]
    ds_read_b128 a[160:163], v3 offset:26624
    v_exp_f32 v39, v39
    v_mfma_f32_32x32x16_bf16 v[20:35], a[144:147], a[128:131], 0
    s_add_u32 m0, s78, 8192
    v_exp_f32 v40, v40
    v_exp_f32 v41, v41
    v_exp_f32 v42, v42
    v_mfma_f32_16x16x32_bf16 v[172:175], a[224:227], a[88:91], v[172:175]
    buffer_load_dwordx4 v244, s[40:43], s77 offen offset:3072 sc1 lds
    v_cvt_pk_bf16_f32 v60, v36, v37
    v_cvt_pk_bf16_f32 v61, v38, v39
    v_mfma_f32_16x16x32_bf16 v[204:207], a[228:231], a[88:91], v[204:207]
    ds_read_b128 a[164:167], v3 offset:27648
    v_exp_f32 v43, v43
    v_mfma_f32_32x32x16_bf16 v[20:35], a[148:151], a[132:135], v[20:35]
    ds_read_b64_tr_b16 a[248:249], v248 offset:12288
    v_exp_f32 v44, v44
    v_exp_f32 v45, v45
    v_exp_f32 v46, v46
    v_mfma_f32_16x16x32_bf16 v[236:239], a[232:235], a[88:91], v[236:239]
    ds_read_b64_tr_b16 a[250:251], v248 offset:14336
    v_cvt_pk_bf16_f32 v62, v40, v41
    v_cvt_pk_bf16_f32 v63, v42, v43
    v_smfmac_f32_16x16x64_bf16 v[100:103], a[176:179], v[52:59], v18
    buffer_load_dwordx4 a[88:91], v17, s[36:39], s16 offen offset:0 sc1
    v_cvt_pk_bf16_f32 v64, v44, v45
    v_mfma_f32_16x16x32_bf16 v[144:147], a[220:223], a[92:95], v[144:147]
    v_exp_f32 v47, v47
    v_mfma_f32_32x32x16_bf16 v[68:83], a[172:175], v[56:59], v[68:83]
    v_exp_f32 v48, v48
    v_exp_f32 v49, v49
    v_exp_f32 v50, v50
    v_mfma_f32_16x16x32_bf16 v[176:179], a[224:227], a[92:95], v[176:179]
    v_exp_f32 v51, v51
    v_mfma_f32_16x16x32_bf16 v[208:211], a[228:231], a[92:95], v[208:211]
    v_add_u32 v244, s18, v244
    v_cvt_pk_bf16_f32 v65, v46, v47
    v_cvt_pk_bf16_f32 v66, v48, v49
    v_mfma_f32_16x16x32_bf16 v[240:243], a[232:235], a[92:95], v[240:243]
    buffer_load_dwordx4 a[92:95], v17, s[36:39], s16 offen offset:2048 sc1
    v_cvt_pk_bf16_f32 v67, v50, v51
    v_mfma_f32_32x32x16_bf16 v[84:99], a[168:171], v[60:63], v[84:99]
    s_waitcnt vmcnt(32) lgkmcnt(0)
    v_exp_f32 v20, v20
    v_exp_f32 v21, v21
    v_exp_f32 v22, v22
    v_mfma_f32_16x16x32_bf16 v[116:119], a[236:239], a[96:99], v[116:119]
    ds_read_b128 a[152:155], v3 offset:28672
    v_exp_f32 v23, v23
    v_mfma_f32_32x32x16_bf16 v[36:51], a[144:147], a[136:139], 0
    s_add_u32 m0, s78, 12288
    v_exp_f32 v24, v24
    v_exp_f32 v25, v25
    v_exp_f32 v26, v26
    v_mfma_f32_16x16x32_bf16 v[148:151], a[240:243], a[96:99], v[148:151]
    buffer_load_dwordx4 v244, s[40:43], 0 offen offset:0 sc1 lds
    v_cvt_pk_bf16_f32 v52, v20, v21
    v_cvt_pk_bf16_f32 v53, v22, v23
    v_mfma_f32_16x16x32_bf16 v[180:183], a[244:247], a[96:99], v[180:183]
    ds_read_b128 a[156:159], v3 offset:29696
    v_exp_f32 v27, v27
    v_mfma_f32_32x32x16_bf16 v[36:51], a[148:151], a[140:143], v[36:51]
    ds_read_b64_tr_b16 a[220:221], v245 offset:0
    v_exp_f32 v28, v28
    v_exp_f32 v29, v29
    v_exp_f32 v30, v30
    v_mfma_f32_16x16x32_bf16 v[212:215], a[248:251], a[96:99], v[212:215]
    s_add_u32 s36, s36, 1064960
    s_addc_u32 s37, s37, 0
    v_cvt_pk_bf16_f32 v54, v24, v25
    v_cvt_pk_bf16_f32 v55, v26, v27
    v_smfmac_f32_16x16x64_bf16 v[104:107], a[176:179], v[60:67], v18
    buffer_load_dwordx4 a[96:99], v17, s[36:39], 0 offen offset:0 sc1
    v_cvt_pk_bf16_f32 v56, v28, v29
    v_mfma_f32_16x16x32_bf16 v[120:123], a[236:239], a[100:103], v[120:123]
    v_exp_f32 v31, v31
    v_mfma_f32_32x32x16_bf16 v[84:99], a[172:175], v[64:67], v[84:99]
    global_load_dword a253, v0, s[100:101]
    v_exp_f32 v32, v32
    v_exp_f32 v33, v33
    v_exp_f32 v34, v34
    v_mfma_f32_16x16x32_bf16 v[152:155], a[240:243], a[100:103], v[152:155]
    ds_read_b64_tr_b16 a[222:223], v245 offset:2048
    v_exp_f32 v35, v35
    v_mfma_f32_16x16x32_bf16 v[184:187], a[244:247], a[100:103], v[184:187]
    v_cvt_pk_bf16_f32 v57, v30, v31
    v_cvt_pk_bf16_f32 v58, v32, v33
    v_mfma_f32_16x16x32_bf16 v[216:219], a[248:251], a[100:103], v[216:219]
    buffer_load_dwordx4 a[100:103], v17, s[36:39], 0 offen offset:2048 sc1
    v_cvt_pk_bf16_f32 v59, v34, v35
    v_mfma_f32_32x32x16_bf16 v[68:83], a[160:163], v[52:55], v[68:83]
    s_waitcnt lgkmcnt(2)
    v_exp_f32 v36, v36
    v_exp_f32 v37, v37
    v_exp_f32 v38, v38
    v_mfma_f32_16x16x32_bf16 v[124:127], a[236:239], a[104:107], v[124:127]
    ds_read_b128 a[168:171], v3 offset:30720
    v_exp_f32 v39, v39
    v_mfma_f32_32x32x16_bf16 v[20:35], a[152:155], a[128:131], 0
    s_add_u32 m0, s78, 12288
    v_exp_f32 v40, v40
    v_exp_f32 v41, v41
    v_exp_f32 v42, v42
    v_mfma_f32_16x16x32_bf16 v[156:159], a[240:243], a[104:107], v[156:159]
    buffer_load_dwordx4 v244, s[40:43], s75 offen offset:1024 sc1 lds
    v_cvt_pk_bf16_f32 v60, v36, v37
    v_cvt_pk_bf16_f32 v61, v38, v39
    v_mfma_f32_16x16x32_bf16 v[188:191], a[244:247], a[104:107], v[188:191]
    ds_read_b128 a[172:175], v3 offset:31744
    v_exp_f32 v43, v43
    v_mfma_f32_32x32x16_bf16 v[20:35], a[156:159], a[132:135], v[20:35]
    ds_read_b64_tr_b16 a[224:225], v246 offset:0
    v_exp_f32 v44, v44
    v_exp_f32 v45, v45
    v_exp_f32 v46, v46
    v_mfma_f32_16x16x32_bf16 v[220:223], a[248:251], a[104:107], v[220:223]
    v_cvt_pk_bf16_f32 v62, v40, v41
    v_cvt_pk_bf16_f32 v63, v42, v43
    v_smfmac_f32_16x16x64_bf16 v[100:103], a[176:179], v[52:59], v18
    buffer_load_dwordx4 a[104:107], v17, s[36:39], s73 offen offset:0 sc1
    v_cvt_pk_bf16_f32 v64, v44, v45
    v_mfma_f32_16x16x32_bf16 v[128:131], a[236:239], a[108:111], v[128:131]
    v_exp_f32 v47, v47
    v_mfma_f32_32x32x16_bf16 v[68:83], a[164:167], v[56:59], v[68:83]
    v_exp_f32 v48, v48
    v_exp_f32 v49, v49
    v_exp_f32 v50, v50
    v_mfma_f32_16x16x32_bf16 v[160:163], a[240:243], a[108:111], v[160:163]
    ds_read_b64_tr_b16 a[226:227], v246 offset:2048
    v_exp_f32 v51, v51
    v_mfma_f32_16x16x32_bf16 v[192:195], a[244:247], a[108:111], v[192:195]
    v_cvt_pk_bf16_f32 v65, v46, v47
    v_cvt_pk_bf16_f32 v66, v48, v49
    v_mfma_f32_16x16x32_bf16 v[224:227], a[248:251], a[108:111], v[224:227]
    buffer_load_dwordx4 a[108:111], v17, s[36:39], s73 offen offset:2048 sc1
    v_cvt_pk_bf16_f32 v67, v50, v51
    v_mfma_f32_32x32x16_bf16 v[84:99], a[160:163], v[60:63], v[84:99]
    s_waitcnt vmcnt(63) lgkmcnt(0)
    s_barrier
    v_exp_f32 v20, v20
    v_exp_f32 v21, v21
    v_exp_f32 v22, v22
    v_mfma_f32_16x16x32_bf16 v[132:135], a[236:239], a[112:115], v[132:135]
    ds_read_b128 a[144:147], v4 offset:0
    v_exp_f32 v23, v23
    v_mfma_f32_32x32x16_bf16 v[36:51], a[152:155], a[136:139], 0
    s_add_u32 m0, s78, 12288
    v_exp_f32 v24, v24
    v_exp_f32 v25, v25
    v_exp_f32 v26, v26
    v_mfma_f32_16x16x32_bf16 v[164:167], a[240:243], a[112:115], v[164:167]
    buffer_load_dwordx4 v244, s[40:43], s76 offen offset:2048 sc1 lds
    v_cvt_pk_bf16_f32 v52, v20, v21
    v_cvt_pk_bf16_f32 v53, v22, v23
    v_mfma_f32_16x16x32_bf16 v[196:199], a[244:247], a[112:115], v[196:199]
    ds_read_b128 a[148:151], v4 offset:1024
    v_exp_f32 v27, v27
    v_mfma_f32_32x32x16_bf16 v[36:51], a[156:159], a[140:143], v[36:51]
    ds_read_b64_tr_b16 a[228:229], v247 offset:0
    v_exp_f32 v28, v28
    v_exp_f32 v29, v29
    v_exp_f32 v30, v30
    v_mfma_f32_16x16x32_bf16 v[228:231], a[248:251], a[112:115], v[228:231]
    v_cvt_pk_bf16_f32 v54, v24, v25
    v_cvt_pk_bf16_f32 v55, v26, v27
    v_smfmac_f32_16x16x64_bf16 v[104:107], a[176:179], v[60:67], v18
    buffer_load_dwordx4 a[112:115], v17, s[36:39], s74 offen offset:0 sc1
    v_cvt_pk_bf16_f32 v56, v28, v29
    v_mfma_f32_16x16x32_bf16 v[136:139], a[236:239], a[116:119], v[136:139]
    v_exp_f32 v31, v31
    v_mfma_f32_32x32x16_bf16 v[84:99], a[164:167], v[64:67], v[84:99]
    v_exp_f32 v32, v32
    v_exp_f32 v33, v33
    v_exp_f32 v34, v34
    v_mfma_f32_16x16x32_bf16 v[168:171], a[240:243], a[116:119], v[168:171]
    ds_read_b64_tr_b16 a[230:231], v247 offset:2048
    v_exp_f32 v35, v35
    v_mfma_f32_16x16x32_bf16 v[200:203], a[244:247], a[116:119], v[200:203]
    v_cvt_pk_bf16_f32 v57, v30, v31
    v_cvt_pk_bf16_f32 v58, v32, v33
    v_mfma_f32_16x16x32_bf16 v[232:235], a[248:251], a[116:119], v[232:235]
    buffer_load_dwordx4 a[116:119], v17, s[36:39], s74 offen offset:2048 sc1
    v_cvt_pk_bf16_f32 v59, v34, v35
    v_mfma_f32_32x32x16_bf16 v[68:83], a[168:171], v[52:55], v[68:83]
    s_waitcnt lgkmcnt(2)
    v_exp_f32 v36, v36
    v_exp_f32 v37, v37
    v_exp_f32 v38, v38
    v_mfma_f32_16x16x32_bf16 v[140:143], a[236:239], a[120:123], v[140:143]
    ds_read_b128 a[160:163], v4 offset:2048
    v_exp_f32 v39, v39
    v_mfma_f32_32x32x16_bf16 v[20:35], a[144:147], a[128:131], 0
    s_add_u32 m0, s78, 12288
    v_exp_f32 v40, v40
    v_exp_f32 v41, v41
    v_exp_f32 v42, v42
    v_mfma_f32_16x16x32_bf16 v[172:175], a[240:243], a[120:123], v[172:175]
    buffer_load_dwordx4 v244, s[40:43], s77 offen offset:3072 sc1 lds
    v_cvt_pk_bf16_f32 v60, v36, v37
    v_cvt_pk_bf16_f32 v61, v38, v39
    v_mfma_f32_16x16x32_bf16 v[204:207], a[244:247], a[120:123], v[204:207]
    s_mov_b32 s58, s65
    ds_read_b128 a[164:167], v4 offset:3072
    v_exp_f32 v43, v43
    v_mfma_f32_32x32x16_bf16 v[20:35], a[148:151], a[132:135], v[20:35]
    s_mov_b32 s65, s66
    ds_read_b64_tr_b16 a[232:233], v248 offset:0
    v_exp_f32 v44, v44
    v_exp_f32 v45, v45
    v_exp_f32 v46, v46
    v_mfma_f32_16x16x32_bf16 v[236:239], a[248:251], a[120:123], v[236:239]
    s_mov_b32 s66, s67
    ds_read_b64_tr_b16 a[234:235], v248 offset:2048
    v_cvt_pk_bf16_f32 v62, v40, v41
    v_cvt_pk_bf16_f32 v63, v42, v43
    v_smfmac_f32_16x16x64_bf16 v[100:103], a[176:179], v[52:59], v18
    s_mov_b32 s67, s58
    buffer_load_dwordx4 a[120:123], v17, s[36:39], s16 offen offset:0 sc1
    v_cvt_pk_bf16_f32 v64, v44, v45
    v_mfma_f32_16x16x32_bf16 v[144:147], a[236:239], a[124:127], v[144:147]
    s_add_u32 s79, s58, s69
    v_exp_f32 v47, v47
    v_mfma_f32_32x32x16_bf16 v[68:83], a[172:175], v[56:59], v[68:83]
    s_add_u32 s62, s62, 1
    v_exp_f32 v48, v48
    v_exp_f32 v49, v49
    v_exp_f32 v50, v50
    v_mfma_f32_16x16x32_bf16 v[176:179], a[240:243], a[124:127], v[176:179]
    v_exp_f32 v51, v51
    v_mfma_f32_16x16x32_bf16 v[208:211], a[244:247], a[124:127], v[208:211]
    v_add_u32 v244, s18, v244
    v_cvt_pk_bf16_f32 v65, v46, v47
    v_cvt_pk_bf16_f32 v66, v48, v49
    v_mfma_f32_16x16x32_bf16 v[240:243], a[248:251], a[124:127], v[240:243]
    buffer_load_dwordx4 a[124:127], v17, s[36:39], s16 offen offset:2048 sc1
    v_cvt_pk_bf16_f32 v67, v50, v51
    s_add_u32 s36, s36, 1064960
    s_addc_u32 s37, s37, 0
    v_add_u32 v3, s65, v2
    v_add_u32 v4, s66, v2
    s_cmp_lt_u32 s62, 8
    s_cbranch_scc1 P2_MWLOOP
    v_mfma_f32_32x32x16_bf16 v[84:99], a[168:171], v[60:63], v[84:99]
    v_smfmac_f32_16x16x64_bf16 v[104:107], a[176:179], v[60:67], v18
    v_mfma_f32_32x32x16_bf16 v[84:99], a[172:175], v[64:67], v[84:99]
    s_waitcnt vmcnt(50) lgkmcnt(0)
    s_add_u32 m0, s78, 0
    v_mfma_f32_16x16x32_bf16 v[116:119], a[220:223], a[0:3], v[116:119]
    buffer_load_dwordx4 v244, s[40:43], 0 offen offset:0 sc1 lds
    v_mfma_f32_16x16x32_bf16 v[148:151], a[224:227], a[0:3], v[148:151]
    v_mfma_f32_16x16x32_bf16 v[180:183], a[228:231], a[0:3], v[180:183]
    buffer_load_dwordx4 v244, s[40:43], s75 offen offset:1024 sc1 lds
    v_mov_b32 v9, 0
    v_fmac_f32 v9, 0, v68
    v_fmac_f32 v9, 0, v69
    v_mfma_f32_16x16x32_bf16 v[212:215], a[232:235], a[0:3], v[212:215]
    v_fmac_f32 v9, 0, v70
    v_fmac_f32 v9, 0, v71
    v_fmac_f32 v9, 0, v72
    v_mfma_f32_16x16x32_bf16 v[120:123], a[220:223], a[4:7], v[120:123]
    buffer_load_dwordx4 a[0:3], v17, s[36:39], 0 offen offset:0 sc1
    v_fmac_f32 v9, 0, v73
    v_fmac_f32 v9, 0, v74
    v_fmac_f32 v9, 0, v75
    v_mfma_f32_16x16x32_bf16 v[152:155], a[224:227], a[4:7], v[152:155]
    v_fmac_f32 v9, 0, v76
    v_fmac_f32 v9, 0, v77
    v_fmac_f32 v9, 0, v78
    v_mfma_f32_16x16x32_bf16 v[184:187], a[228:231], a[4:7], v[184:187]
    buffer_load_dwordx4 v244, s[40:43], s76 offen offset:2048 sc1 lds
    v_fmac_f32 v9, 0, v79
    v_fmac_f32 v9, 0, v80
    v_fmac_f32 v9, 0, v81
    v_mfma_f32_16x16x32_bf16 v[216:219], a[232:235], a[4:7], v[216:219]
    v_fmac_f32 v9, 0, v82
    v_fmac_f32 v9, 0, v83
    v_fmac_f32 v9, 0, v84
    v_mfma_f32_16x16x32_bf16 v[124:127], a[220:223], a[8:11], v[124:127]
    buffer_load_dwordx4 a[4:7], v17, s[36:39], 0 offen offset:2048 sc1
    v_fmac_f32 v9, 0, v85
    v_fmac_f32 v9, 0, v86
    v_fmac_f32 v9, 0, v87
    v_mfma_f32_16x16x32_bf16 v[156:159], a[224:227], a[8:11], v[156:159]
    v_fmac_f32 v9, 0, v88
    v_fmac_f32 v9, 0, v89
    v_fmac_f32 v9, 0, v90
    v_mfma_f32_16x16x32_bf16 v[188:191], a[228:231], a[8:11], v[188:191]
    buffer_load_dwordx4 v244, s[40:43], s77 offen offset:3072 sc1 lds
    v_fmac_f32 v9, 0, v91
    v_fmac_f32 v9, 0, v92
    v_fmac_f32 v9, 0, v93
    v_mfma_f32_16x16x32_bf16 v[220:223], a[232:235], a[8:11], v[220:223]
    v_fmac_f32 v9, 0, v94
    v_fmac_f32 v9, 0, v95
    v_fmac_f32 v9, 0, v96
    v_mfma_f32_16x16x32_bf16 v[128:131], a[220:223], a[12:15], v[128:131]
    buffer_load_dwordx4 a[8:11], v17, s[36:39], s73 offen offset:0 sc1
    v_fmac_f32 v9, 0, v97
    v_fmac_f32 v9, 0, v98
    v_fmac_f32 v9, 0, v99
    v_mfma_f32_16x16x32_bf16 v[160:163], a[224:227], a[12:15], v[160:163]
    v_add_f32 v100, v100, v101
    v_add_f32 v104, v104, v105
    s_mov_b32 s58, 0x35800000
    s_mov_b32 s59, 0x71800000
    v_cmp_le_f32 vcc, s58, v100
    v_cmp_le_f32 s[44:45], s58, v104
    s_nop 1
    s_and_b64 vcc, vcc, s[44:45]
    v_cmp_ge_f32 s[44:45], s59, v100
    v_cmp_ge_f32 s[60:61], s59, v104
    s_nop 1
    s_and_b64 vcc, vcc, s[44:45]
    s_and_b64 vcc, vcc, s[60:61]
    v_cmp_eq_f32 s[44:45], 0, v9
    s_nop 1
    s_and_b64 vcc, vcc, s[44:45]
    s_cmp_eq_u64 vcc, -1
    s_cbranch_scc0 P2_FALLBACK
P2_FINISH:
    v_mfma_f32_16x16x32_bf16 v[192:195], a[228:231], a[12:15], v[192:195]
    v_rcp_f32 v8, v100
    v_rcp_f32 v10, v104
    s_add_u32 s58, s64, 112
    v_mfma_f32_16x16x32_bf16 v[224:227], a[232:235], a[12:15], v[224:227]
    s_waitcnt vmcnt(49)
    s_mul_i32 s58, s58, 266240
    s_lshl_b32 s59, s63, 15
    s_add_u32 s58, s58, s59
    v_mfma_f32_16x16x32_bf16 v[132:135], a[220:223], a[16:19], v[132:135]
    buffer_load_dwordx4 a[12:15], v17, s[36:39], s73 offen offset:2048 sc1
    s_lshl_b32 s59, s56, 13
    s_add_u32 s58, s58, s59
    s_add_u32 s58, s58, 33554432
    v_mfma_f32_16x16x32_bf16 v[164:167], a[224:227], a[16:19], v[164:167]
    s_waitcnt vmcnt(37)
    s_add_u32 s59, s58, 4096
    v_and_b32 v254, 40, v1
    v_cmp_eq_u32 vcc, 40, v254
    v_mfma_f32_16x16x32_bf16 v[196:199], a[228:231], a[16:19], v[196:199]
    ds_read_b64_tr_b16 a[236:237], v245 offset:4096
    v_add_u32 v254, 128, v7
    s_nop 0
    v_cndmask_b32 v253, v7, v254, vcc
    v_mfma_f32_16x16x32_bf16 v[228:231], a[232:235], a[16:19], v[228:231]
    ds_read_b64_tr_b16 a[238:239], v245 offset:6144
    v_mul_f32 v8, v8, v250
    v_mul_f32 v10, v10, v251
    v_pk_mul_f32 v[68:69], v[68:69], v[8:9] op_sel_hi:[1,0]
    v_mfma_f32_16x16x32_bf16 v[136:139], a[220:223], a[20:23], v[136:139]
    buffer_load_dwordx4 a[16:19], v17, s[36:39], s74 offen offset:0 sc1
    v_pk_mul_f32 v[70:71], v[70:71], v[8:9] op_sel_hi:[1,0]
    v_pk_mul_f32 v[72:73], v[72:73], v[8:9] op_sel_hi:[1,0]
    v_pk_mul_f32 v[74:75], v[74:75], v[8:9] op_sel_hi:[1,0]
    v_mfma_f32_16x16x32_bf16 v[168:171], a[224:227], a[20:23], v[168:171]
    ds_read_b64_tr_b16 a[240:241], v246 offset:4096
    v_pk_mul_f32 v[76:77], v[76:77], v[8:9] op_sel_hi:[1,0]
    v_pk_mul_f32 v[78:79], v[78:79], v[8:9] op_sel_hi:[1,0]
    v_pk_mul_f32 v[80:81], v[80:81], v[8:9] op_sel_hi:[1,0]
    v_mfma_f32_16x16x32_bf16 v[200:203], a[228:231], a[20:23], v[200:203]
    ds_read_b64_tr_b16 a[242:243], v246 offset:6144
    v_pk_mul_f32 v[82:83], v[82:83], v[8:9] op_sel_hi:[1,0]
    v_cvt_pk_bf16_f32 v20, v68, v69
    v_cvt_pk_bf16_f32 v21, v70, v71
    v_mfma_f32_16x16x32_bf16 v[232:235], a[232:235], a[20:23], v[232:235]
    ds_read_b64_tr_b16 a[244:245], v247 offset:4096
    v_cvt_pk_bf16_f32 v22, v72, v73
    v_cvt_pk_bf16_f32 v23, v74, v75
    v_cvt_pk_bf16_f32 v24, v76, v77
    v_mfma_f32_16x16x32_bf16 v[140:143], a[220:223], a[24:27], v[140:143]
    buffer_load_dwordx4 a[20:23], v17, s[36:39], s74 offen offset:2048 sc1
    v_cvt_pk_bf16_f32 v25, v78, v79
    v_cvt_pk_bf16_f32 v26, v80, v81
    v_cvt_pk_bf16_f32 v27, v82, v83
    v_mfma_f32_16x16x32_bf16 v[172:175], a[224:227], a[24:27], v[172:175]
    ds_read_b64_tr_b16 a[246:247], v247 offset:6144
    buffer_store_dwordx4 v[20:23], v253, s[32:35], s58 offen offset:0 sc1
    buffer_store_dwordx4 v[24:27], v254, s[32:35], s58 offen offset:512 sc1
    v_pk_mul_f32 v[84:85], v[84:85], v[10:11] op_sel_hi:[1,0]
    v_mfma_f32_16x16x32_bf16 v[204:207], a[228:231], a[24:27], v[204:207]
    ds_read_b64_tr_b16 a[248:249], v248 offset:4096
    v_pk_mul_f32 v[86:87], v[86:87], v[10:11] op_sel_hi:[1,0]
    v_pk_mul_f32 v[88:89], v[88:89], v[10:11] op_sel_hi:[1,0]
    v_pk_mul_f32 v[90:91], v[90:91], v[10:11] op_sel_hi:[1,0]
    v_mfma_f32_16x16x32_bf16 v[236:239], a[232:235], a[24:27], v[236:239]
    ds_read_b64_tr_b16 a[250:251], v248 offset:6144
    v_pk_mul_f32 v[92:93], v[92:93], v[10:11] op_sel_hi:[1,0]
    v_pk_mul_f32 v[94:95], v[94:95], v[10:11] op_sel_hi:[1,0]
    v_pk_mul_f32 v[96:97], v[96:97], v[10:11] op_sel_hi:[1,0]
    v_mfma_f32_16x16x32_bf16 v[144:147], a[220:223], a[28:31], v[144:147]
    buffer_load_dwordx4 a[24:27], v17, s[36:39], s16 offen offset:0 sc1
    v_pk_mul_f32 v[98:99], v[98:99], v[10:11] op_sel_hi:[1,0]
    v_cvt_pk_bf16_f32 v36, v84, v85
    v_cvt_pk_bf16_f32 v37, v86, v87
    v_mfma_f32_16x16x32_bf16 v[176:179], a[224:227], a[28:31], v[176:179]
    v_cvt_pk_bf16_f32 v38, v88, v89
    v_cvt_pk_bf16_f32 v39, v90, v91
    v_cvt_pk_bf16_f32 v40, v92, v93
    v_mfma_f32_16x16x32_bf16 v[208:211], a[228:231], a[28:31], v[208:211]
    v_cvt_pk_bf16_f32 v41, v94, v95
    v_cvt_pk_bf16_f32 v42, v96, v97
    v_cvt_pk_bf16_f32 v43, v98, v99
    v_mfma_f32_16x16x32_bf16 v[240:243], a[232:235], a[28:31], v[240:243]
    buffer_load_dwordx4 a[28:31], v17, s[36:39], s16 offen offset:2048 sc1
    v_add_u32 v244, s18, v244
    s_add_u32 s36, s36, 1064960
    s_addc_u32 s37, s37, 0
    s_waitcnt vmcnt(48) lgkmcnt(0)
    s_add_u32 m0, s78, 4096
    v_mfma_f32_16x16x32_bf16 v[116:119], a[236:239], a[32:35], v[116:119]
    buffer_load_dwordx4 v244, s[40:43], 0 offen offset:0 sc1 lds
    buffer_store_dwordx4 v[36:39], v253, s[32:35], s59 offen offset:0 sc1
    buffer_store_dwordx4 v[40:43], v254, s[32:35], s59 offen offset:512 sc1
    v_sub_f32 v108, 1.0, v108
    v_mfma_f32_16x16x32_bf16 v[148:151], a[240:243], a[32:35], v[148:151]
    v_sub_f32 v109, 1.0, v109
    v_sub_f32 v110, 1.0, v110
    v_sub_f32 v111, 1.0, v111
    v_mfma_f32_16x16x32_bf16 v[180:183], a[244:247], a[32:35], v[180:183]
    buffer_load_dwordx4 v244, s[40:43], s75 offen offset:1024 sc1 lds
    v_sub_f32 v112, 1.0, v112
    v_sub_f32 v113, 1.0, v113
    v_sub_f32 v114, 1.0, v114
    v_mfma_f32_16x16x32_bf16 v[212:215], a[248:251], a[32:35], v[212:215]
    v_sub_f32 v115, 1.0, v115
    v_cvt_pk_bf16_f32 v108, v108, v108
    v_cvt_pk_bf16_f32 v109, v109, v109
    v_mfma_f32_16x16x32_bf16 v[120:123], a[236:239], a[36:39], v[120:123]
    buffer_load_dwordx4 a[32:35], v17, s[36:39], 0 offen offset:0 sc1
    v_cvt_pk_bf16_f32 v110, v110, v110
    v_cvt_pk_bf16_f32 v111, v111, v111
    v_cvt_pk_bf16_f32 v112, v112, v112
    v_mfma_f32_16x16x32_bf16 v[152:155], a[240:243], a[36:39], v[152:155]
    v_cvt_pk_bf16_f32 v113, v113, v113
    v_cvt_pk_bf16_f32 v114, v114, v114
    v_cvt_pk_bf16_f32 v115, v115, v115
    v_mfma_f32_16x16x32_bf16 v[184:187], a[244:247], a[36:39], v[184:187]
    buffer_load_dwordx4 v244, s[40:43], s76 offen offset:2048 sc1 lds
    v_and_b32 v108, 0xffff0000, v108
    v_and_b32 v109, 0xffff0000, v109
    v_and_b32 v110, 0xffff0000, v110
    v_mfma_f32_16x16x32_bf16 v[216:219], a[248:251], a[36:39], v[216:219]
    v_and_b32 v111, 0xffff0000, v111
    v_and_b32 v112, 0xffff0000, v112
    v_and_b32 v113, 0xffff0000, v113
    v_mfma_f32_16x16x32_bf16 v[124:127], a[236:239], a[40:43], v[124:127]
    buffer_load_dwordx4 a[36:39], v17, s[36:39], 0 offen offset:2048 sc1
    v_and_b32 v114, 0xffff0000, v114
    v_and_b32 v115, 0xffff0000, v115
    s_lshl_b32 s65, s71, 9
    v_mfma_f32_16x16x32_bf16 v[156:159], a[240:243], a[40:43], v[156:159]
    s_add_u32 s65, s65, 23535616
    s_add_u32 s70, s70, 8192
    v_mfma_f32_16x16x32_bf16 v[188:191], a[244:247], a[40:43], v[188:191]
    buffer_load_dwordx4 v244, s[40:43], s77 offen offset:3072 sc1 lds
    v_mfma_f32_16x16x32_bf16 v[220:223], a[248:251], a[40:43], v[220:223]
    v_mfma_f32_16x16x32_bf16 v[128:131], a[236:239], a[44:47], v[128:131]
    buffer_load_dwordx4 a[40:43], v17, s[36:39], s73 offen offset:0 sc1
    v_mfma_f32_16x16x32_bf16 v[160:163], a[240:243], a[44:47], v[160:163]
    v_mfma_f32_16x16x32_bf16 v[192:195], a[244:247], a[44:47], v[192:195]
    v_add_u32 v0, 0x2000, v0
    v_min_u32 v0, L_END-gated_mix__grouped_kv_mqa__glu_gated_reglu__prompt_kernel-4, v0
    global_load_dword a253, v0, s[100:101]
    v_mfma_f32_16x16x32_bf16 v[224:227], a[248:251], a[44:47], v[224:227]
    s_waitcnt vmcnt(50)
    v_mfma_f32_16x16x32_bf16 v[132:135], a[236:239], a[48:51], v[132:135]
    buffer_load_dwordx4 a[44:47], v17, s[36:39], s73 offen offset:2048 sc1
    v_mfma_f32_16x16x32_bf16 v[164:167], a[240:243], a[48:51], v[164:167]
    s_waitcnt vmcnt(40)
    v_mfma_f32_16x16x32_bf16 v[196:199], a[244:247], a[48:51], v[196:199]
    ds_read_b64_tr_b16 a[220:221], v245 offset:8192
    v_mfma_f32_16x16x32_bf16 v[228:231], a[248:251], a[48:51], v[228:231]
    ds_read_b64_tr_b16 a[222:223], v245 offset:10240
    v_mfma_f32_16x16x32_bf16 v[136:139], a[236:239], a[52:55], v[136:139]
    buffer_load_dwordx4 a[48:51], v17, s[36:39], s74 offen offset:0 sc1
    v_mfma_f32_16x16x32_bf16 v[168:171], a[240:243], a[52:55], v[168:171]
    ds_read_b64_tr_b16 a[224:225], v246 offset:8192
    v_mfma_f32_16x16x32_bf16 v[200:203], a[244:247], a[52:55], v[200:203]
    ds_read_b64_tr_b16 a[226:227], v246 offset:10240
    v_mfma_f32_16x16x32_bf16 v[232:235], a[248:251], a[52:55], v[232:235]
    ds_read_b64_tr_b16 a[228:229], v247 offset:8192
    v_mfma_f32_16x16x32_bf16 v[140:143], a[236:239], a[56:59], v[140:143]
    buffer_load_dwordx4 a[52:55], v17, s[36:39], s74 offen offset:2048 sc1
    v_mfma_f32_16x16x32_bf16 v[172:175], a[240:243], a[56:59], v[172:175]
    ds_read_b64_tr_b16 a[230:231], v247 offset:10240
    v_mfma_f32_16x16x32_bf16 v[204:207], a[244:247], a[56:59], v[204:207]
    ds_read_b64_tr_b16 a[232:233], v248 offset:8192
    v_mfma_f32_16x16x32_bf16 v[236:239], a[248:251], a[56:59], v[236:239]
    ds_read_b64_tr_b16 a[234:235], v248 offset:10240
    v_mfma_f32_16x16x32_bf16 v[144:147], a[236:239], a[60:63], v[144:147]
    buffer_load_dwordx4 a[56:59], v17, s[36:39], s16 offen offset:0 sc1
    v_mfma_f32_16x16x32_bf16 v[176:179], a[240:243], a[60:63], v[176:179]
    v_mfma_f32_16x16x32_bf16 v[208:211], a[244:247], a[60:63], v[208:211]
    v_mfma_f32_16x16x32_bf16 v[240:243], a[248:251], a[60:63], v[240:243]
    buffer_load_dwordx4 a[60:63], v17, s[36:39], s16 offen offset:2048 sc1
    v_add_u32 v244, s18, v244
    s_add_u32 s36, s36, 1064960
    s_addc_u32 s37, s37, 0
    s_waitcnt vmcnt(48) lgkmcnt(0)
    s_add_u32 m0, s78, 8192
    v_mfma_f32_16x16x32_bf16 v[116:119], a[220:223], a[64:67], v[116:119]
    buffer_load_dwordx4 v244, s[40:43], 0 offen offset:0 sc1 lds
    v_mfma_f32_16x16x32_bf16 v[148:151], a[224:227], a[64:67], v[148:151]
    v_mfma_f32_16x16x32_bf16 v[180:183], a[228:231], a[64:67], v[180:183]
    buffer_load_dwordx4 v244, s[40:43], s75 offen offset:1024 sc1 lds
    v_mfma_f32_16x16x32_bf16 v[212:215], a[232:235], a[64:67], v[212:215]
    v_mfma_f32_16x16x32_bf16 v[120:123], a[220:223], a[68:71], v[120:123]
    buffer_load_dwordx4 a[64:67], v17, s[36:39], 0 offen offset:0 sc1
    v_mfma_f32_16x16x32_bf16 v[152:155], a[224:227], a[68:71], v[152:155]
    v_mfma_f32_16x16x32_bf16 v[184:187], a[228:231], a[68:71], v[184:187]
    buffer_load_dwordx4 v244, s[40:43], s76 offen offset:2048 sc1 lds
    v_mfma_f32_16x16x32_bf16 v[216:219], a[232:235], a[68:71], v[216:219]
    v_mfma_f32_16x16x32_bf16 v[124:127], a[220:223], a[72:75], v[124:127]
    buffer_load_dwordx4 a[68:71], v17, s[36:39], 0 offen offset:2048 sc1
    v_mfma_f32_16x16x32_bf16 v[156:159], a[224:227], a[72:75], v[156:159]
    v_mfma_f32_16x16x32_bf16 v[188:191], a[228:231], a[72:75], v[188:191]
    buffer_load_dwordx4 v244, s[40:43], s77 offen offset:3072 sc1 lds
    s_waitcnt vmcnt(18)
    s_mov_b64 exec, 1
    buffer_store_dword v6, v5, s[32:35], s70 offen sc1
    s_mov_b64 exec, -1
    s_nop 2
    v_mfma_f32_16x16x32_bf16 v[220:223], a[232:235], a[72:75], v[220:223]
    v_mfma_f32_16x16x32_bf16 v[128:131], a[220:223], a[76:79], v[128:131]
    buffer_load_dwordx4 a[72:75], v17, s[36:39], s73 offen offset:0 sc1
    v_mfma_f32_16x16x32_bf16 v[160:163], a[224:227], a[76:79], v[160:163]
    v_mfma_f32_16x16x32_bf16 v[192:195], a[228:231], a[76:79], v[192:195]
    v_mfma_f32_16x16x32_bf16 v[224:227], a[232:235], a[76:79], v[224:227]
    s_waitcnt vmcnt(50)
    v_mfma_f32_16x16x32_bf16 v[132:135], a[220:223], a[80:83], v[132:135]
    buffer_load_dwordx4 a[76:79], v17, s[36:39], s73 offen offset:2048 sc1
    v_mfma_f32_16x16x32_bf16 v[164:167], a[224:227], a[80:83], v[164:167]
    s_waitcnt vmcnt(40)
    v_mfma_f32_16x16x32_bf16 v[196:199], a[228:231], a[80:83], v[196:199]
    ds_read_b64_tr_b16 a[236:237], v245 offset:12288
    v_mfma_f32_16x16x32_bf16 v[228:231], a[232:235], a[80:83], v[228:231]
    ds_read_b64_tr_b16 a[238:239], v245 offset:14336
    v_mfma_f32_16x16x32_bf16 v[136:139], a[220:223], a[84:87], v[136:139]
    buffer_load_dwordx4 a[80:83], v17, s[36:39], s74 offen offset:0 sc1
    v_mfma_f32_16x16x32_bf16 v[168:171], a[224:227], a[84:87], v[168:171]
    ds_read_b64_tr_b16 a[240:241], v246 offset:12288
    v_mfma_f32_16x16x32_bf16 v[200:203], a[228:231], a[84:87], v[200:203]
    ds_read_b64_tr_b16 a[242:243], v246 offset:14336
    v_mfma_f32_16x16x32_bf16 v[232:235], a[232:235], a[84:87], v[232:235]
    ds_read_b64_tr_b16 a[244:245], v247 offset:12288
    v_mfma_f32_16x16x32_bf16 v[140:143], a[220:223], a[88:91], v[140:143]
    buffer_load_dwordx4 a[84:87], v17, s[36:39], s74 offen offset:2048 sc1
    v_mfma_f32_16x16x32_bf16 v[172:175], a[224:227], a[88:91], v[172:175]
    ds_read_b64_tr_b16 a[246:247], v247 offset:14336
    v_mfma_f32_16x16x32_bf16 v[204:207], a[228:231], a[88:91], v[204:207]
    ds_read_b64_tr_b16 a[248:249], v248 offset:12288
    v_mfma_f32_16x16x32_bf16 v[236:239], a[232:235], a[88:91], v[236:239]
    ds_read_b64_tr_b16 a[250:251], v248 offset:14336
    v_mfma_f32_16x16x32_bf16 v[144:147], a[220:223], a[92:95], v[144:147]
    buffer_load_dwordx4 a[88:91], v17, s[36:39], s16 offen offset:0 sc1
    v_mfma_f32_16x16x32_bf16 v[176:179], a[224:227], a[92:95], v[176:179]
    v_mfma_f32_16x16x32_bf16 v[208:211], a[228:231], a[92:95], v[208:211]
    v_mfma_f32_16x16x32_bf16 v[240:243], a[232:235], a[92:95], v[240:243]
    buffer_load_dwordx4 a[92:95], v17, s[36:39], s16 offen offset:2048 sc1
    v_add_u32 v244, s18, v244
    s_add_u32 s36, s36, 1064960
    s_addc_u32 s37, s37, 0
    s_waitcnt vmcnt(48) lgkmcnt(0)
    s_add_u32 m0, s78, 12288
    v_mfma_f32_16x16x32_bf16 v[116:119], a[236:239], a[96:99], v[116:119]
    buffer_load_dwordx4 v244, s[40:43], 0 offen offset:0 sc1 lds
    v_mfma_f32_16x16x32_bf16 v[148:151], a[240:243], a[96:99], v[148:151]
    v_mfma_f32_16x16x32_bf16 v[180:183], a[244:247], a[96:99], v[180:183]
    buffer_load_dwordx4 v244, s[40:43], s75 offen offset:1024 sc1 lds
    v_mfma_f32_16x16x32_bf16 v[212:215], a[248:251], a[96:99], v[212:215]
    v_mfma_f32_16x16x32_bf16 v[120:123], a[236:239], a[100:103], v[120:123]
    buffer_load_dwordx4 a[96:99], v17, s[36:39], 0 offen offset:0 sc1
    v_mfma_f32_16x16x32_bf16 v[152:155], a[240:243], a[100:103], v[152:155]
    v_mfma_f32_16x16x32_bf16 v[184:187], a[244:247], a[100:103], v[184:187]
    buffer_load_dwordx4 v244, s[40:43], s76 offen offset:2048 sc1 lds
    v_mfma_f32_16x16x32_bf16 v[216:219], a[248:251], a[100:103], v[216:219]
    v_mfma_f32_16x16x32_bf16 v[124:127], a[236:239], a[104:107], v[124:127]
    buffer_load_dwordx4 a[100:103], v17, s[36:39], 0 offen offset:2048 sc1
    v_mfma_f32_16x16x32_bf16 v[156:159], a[240:243], a[104:107], v[156:159]
    v_mfma_f32_16x16x32_bf16 v[188:191], a[244:247], a[104:107], v[188:191]
    buffer_load_dwordx4 v244, s[40:43], s77 offen offset:3072 sc1 lds
    v_mfma_f32_16x16x32_bf16 v[220:223], a[248:251], a[104:107], v[220:223]
    v_mfma_f32_16x16x32_bf16 v[128:131], a[236:239], a[108:111], v[128:131]
    buffer_load_dwordx4 a[104:107], v17, s[36:39], s73 offen offset:0 sc1
    v_mfma_f32_16x16x32_bf16 v[160:163], a[240:243], a[108:111], v[160:163]
    v_mfma_f32_16x16x32_bf16 v[192:195], a[244:247], a[108:111], v[192:195]
    v_mfma_f32_16x16x32_bf16 v[224:227], a[248:251], a[108:111], v[224:227]
    s_waitcnt vmcnt(49)
    v_mfma_f32_16x16x32_bf16 v[132:135], a[236:239], a[112:115], v[132:135]
    buffer_load_dwordx4 a[108:111], v17, s[36:39], s73 offen offset:2048 sc1
    v_mfma_f32_16x16x32_bf16 v[164:167], a[240:243], a[112:115], v[164:167]
    s_waitcnt vmcnt(44)
    v_mfma_f32_16x16x32_bf16 v[196:199], a[244:247], a[112:115], v[196:199]
    ds_read_b64_tr_b16 a[220:221], v245 offset:0
    v_mfma_f32_16x16x32_bf16 v[228:231], a[248:251], a[112:115], v[228:231]
    ds_read_b64_tr_b16 a[222:223], v245 offset:2048
    v_mfma_f32_16x16x32_bf16 v[136:139], a[236:239], a[116:119], v[136:139]
    buffer_load_dwordx4 a[112:115], v17, s[36:39], s74 offen offset:0 sc1
    v_mfma_f32_16x16x32_bf16 v[168:171], a[240:243], a[116:119], v[168:171]
    ds_read_b64_tr_b16 a[224:225], v246 offset:0
    v_mfma_f32_16x16x32_bf16 v[200:203], a[244:247], a[116:119], v[200:203]
    ds_read_b64_tr_b16 a[226:227], v246 offset:2048
    v_mfma_f32_16x16x32_bf16 v[232:235], a[248:251], a[116:119], v[232:235]
    ds_read_b64_tr_b16 a[228:229], v247 offset:0
    v_mfma_f32_16x16x32_bf16 v[140:143], a[236:239], a[120:123], v[140:143]
    buffer_load_dwordx4 a[116:119], v17, s[36:39], s74 offen offset:2048 sc1
    v_mfma_f32_16x16x32_bf16 v[172:175], a[240:243], a[120:123], v[172:175]
    ds_read_b64_tr_b16 a[230:231], v247 offset:2048
    v_mfma_f32_16x16x32_bf16 v[204:207], a[244:247], a[120:123], v[204:207]
    ds_read_b64_tr_b16 a[232:233], v248 offset:0
    v_mfma_f32_16x16x32_bf16 v[236:239], a[248:251], a[120:123], v[236:239]
    ds_read_b64_tr_b16 a[234:235], v248 offset:2048
    v_mfma_f32_16x16x32_bf16 v[144:147], a[236:239], a[124:127], v[144:147]
    buffer_load_dwordx4 a[120:123], v17, s[36:39], s16 offen offset:0 sc1
    v_mfma_f32_16x16x32_bf16 v[176:179], a[240:243], a[124:127], v[176:179]
    v_mfma_f32_16x16x32_bf16 v[208:211], a[244:247], a[124:127], v[208:211]
    v_mfma_f32_16x16x32_bf16 v[240:243], a[248:251], a[124:127], v[240:243]
    buffer_load_dwordx4 a[124:127], v17, s[36:39], s16 offen offset:2048 sc1
    v_add_u32 v244, s18, v244
    s_add_u32 s36, s36, 1064960
    s_addc_u32 s37, s37, 0
    s_waitcnt vmcnt(46) lgkmcnt(0)
    s_add_u32 m0, s78, 0
    v_mfma_f32_16x16x32_bf16 v[116:119], a[220:223], a[0:3], v[116:119]
    buffer_load_dwordx4 v244, s[40:43], 0 offen offset:0 sc1 lds
    v_mfma_f32_16x16x32_bf16 v[148:151], a[224:227], a[0:3], v[148:151]
    v_mfma_f32_16x16x32_bf16 v[180:183], a[228:231], a[0:3], v[180:183]
    buffer_load_dwordx4 v244, s[40:43], s75 offen offset:1024 sc1 lds
    v_mfma_f32_16x16x32_bf16 v[212:215], a[232:235], a[0:3], v[212:215]
    v_mfma_f32_16x16x32_bf16 v[120:123], a[220:223], a[4:7], v[120:123]
    buffer_load_dwordx4 a[0:3], v17, s[36:39], 0 offen offset:0 sc1
    v_mfma_f32_16x16x32_bf16 v[152:155], a[224:227], a[4:7], v[152:155]
    v_mfma_f32_16x16x32_bf16 v[184:187], a[228:231], a[4:7], v[184:187]
    buffer_load_dwordx4 v244, s[40:43], s76 offen offset:2048 sc1 lds
    v_mfma_f32_16x16x32_bf16 v[216:219], a[232:235], a[4:7], v[216:219]
    v_mfma_f32_16x16x32_bf16 v[124:127], a[220:223], a[8:11], v[124:127]
    buffer_load_dwordx4 a[4:7], v17, s[36:39], 0 offen offset:2048 sc1
    v_mfma_f32_16x16x32_bf16 v[156:159], a[224:227], a[8:11], v[156:159]
    v_mfma_f32_16x16x32_bf16 v[188:191], a[228:231], a[8:11], v[188:191]
    buffer_load_dwordx4 v244, s[40:43], s77 offen offset:3072 sc1 lds
    v_mfma_f32_16x16x32_bf16 v[220:223], a[232:235], a[8:11], v[220:223]
    v_mfma_f32_16x16x32_bf16 v[128:131], a[220:223], a[12:15], v[128:131]
    buffer_load_dwordx4 a[8:11], v17, s[36:39], s73 offen offset:0 sc1
    v_mfma_f32_16x16x32_bf16 v[160:163], a[224:227], a[12:15], v[160:163]
    v_mfma_f32_16x16x32_bf16 v[192:195], a[228:231], a[12:15], v[192:195]
    v_mfma_f32_16x16x32_bf16 v[224:227], a[232:235], a[12:15], v[224:227]
    s_waitcnt vmcnt(47)
    v_mfma_f32_16x16x32_bf16 v[132:135], a[220:223], a[16:19], v[132:135]
    buffer_load_dwordx4 a[12:15], v17, s[36:39], s73 offen offset:2048 sc1
    v_mfma_f32_16x16x32_bf16 v[164:167], a[224:227], a[16:19], v[164:167]
    s_waitcnt vmcnt(40)
    v_mfma_f32_16x16x32_bf16 v[196:199], a[228:231], a[16:19], v[196:199]
    ds_read_b64_tr_b16 a[236:237], v245 offset:4096
    v_mfma_f32_16x16x32_bf16 v[228:231], a[232:235], a[16:19], v[228:231]
    ds_read_b64_tr_b16 a[238:239], v245 offset:6144
    v_mfma_f32_16x16x32_bf16 v[136:139], a[220:223], a[20:23], v[136:139]
    buffer_load_dwordx4 a[16:19], v17, s[36:39], s74 offen offset:0 sc1
    v_mfma_f32_16x16x32_bf16 v[168:171], a[224:227], a[20:23], v[168:171]
    ds_read_b64_tr_b16 a[240:241], v246 offset:4096
    v_mfma_f32_16x16x32_bf16 v[200:203], a[228:231], a[20:23], v[200:203]
    ds_read_b64_tr_b16 a[242:243], v246 offset:6144
    v_mfma_f32_16x16x32_bf16 v[232:235], a[232:235], a[20:23], v[232:235]
    ds_read_b64_tr_b16 a[244:245], v247 offset:4096
    v_mfma_f32_16x16x32_bf16 v[140:143], a[220:223], a[24:27], v[140:143]
    buffer_load_dwordx4 a[20:23], v17, s[36:39], s74 offen offset:2048 sc1
    v_mfma_f32_16x16x32_bf16 v[172:175], a[224:227], a[24:27], v[172:175]
    ds_read_b64_tr_b16 a[246:247], v247 offset:6144
    v_mfma_f32_16x16x32_bf16 v[204:207], a[228:231], a[24:27], v[204:207]
    ds_read_b64_tr_b16 a[248:249], v248 offset:4096
    v_mfma_f32_16x16x32_bf16 v[236:239], a[232:235], a[24:27], v[236:239]
    ds_read_b64_tr_b16 a[250:251], v248 offset:6144
    v_mfma_f32_16x16x32_bf16 v[144:147], a[220:223], a[28:31], v[144:147]
    buffer_load_dwordx4 a[24:27], v17, s[36:39], s16 offen offset:0 sc1
    v_mfma_f32_16x16x32_bf16 v[176:179], a[224:227], a[28:31], v[176:179]
    v_mfma_f32_16x16x32_bf16 v[208:211], a[228:231], a[28:31], v[208:211]
    v_mfma_f32_16x16x32_bf16 v[240:243], a[232:235], a[28:31], v[240:243]
    buffer_load_dwordx4 a[28:31], v17, s[36:39], s16 offen offset:2048 sc1
    v_add_u32 v244, s18, v244
    s_add_u32 s36, s36, 1064960
    s_addc_u32 s37, s37, 0
    s_waitcnt vmcnt(41) lgkmcnt(0)
    s_add_u32 m0, s78, 4096
    v_mfma_f32_16x16x32_bf16 v[116:119], a[236:239], a[32:35], v[116:119]
    buffer_load_dwordx4 v244, s[40:43], 0 offen offset:0 sc1 lds
    v_mfma_f32_16x16x32_bf16 v[148:151], a[240:243], a[32:35], v[148:151]
    v_mfma_f32_16x16x32_bf16 v[180:183], a[244:247], a[32:35], v[180:183]
    buffer_load_dwordx4 v244, s[40:43], s75 offen offset:1024 sc1 lds
    v_mfma_f32_16x16x32_bf16 v[212:215], a[248:251], a[32:35], v[212:215]
    v_mfma_f32_16x16x32_bf16 v[120:123], a[236:239], a[36:39], v[120:123]
    buffer_load_dwordx4 a[32:35], v17, s[36:39], 0 offen offset:0 sc1
    v_mfma_f32_16x16x32_bf16 v[152:155], a[240:243], a[36:39], v[152:155]
    v_mfma_f32_16x16x32_bf16 v[184:187], a[244:247], a[36:39], v[184:187]
    buffer_load_dwordx4 v244, s[40:43], s76 offen offset:2048 sc1 lds
    v_mfma_f32_16x16x32_bf16 v[216:219], a[248:251], a[36:39], v[216:219]
    v_mfma_f32_16x16x32_bf16 v[124:127], a[236:239], a[40:43], v[124:127]
    buffer_load_dwordx4 a[36:39], v17, s[36:39], 0 offen offset:2048 sc1
    v_mfma_f32_16x16x32_bf16 v[156:159], a[240:243], a[40:43], v[156:159]
    v_mfma_f32_16x16x32_bf16 v[188:191], a[244:247], a[40:43], v[188:191]
    buffer_load_dwordx4 v244, s[40:43], s77 offen offset:3072 sc1 lds
    v_mfma_f32_16x16x32_bf16 v[220:223], a[248:251], a[40:43], v[220:223]
    v_mfma_f32_16x16x32_bf16 v[128:131], a[236:239], a[44:47], v[128:131]
    buffer_load_dwordx4 a[40:43], v17, s[36:39], s73 offen offset:0 sc1
    v_mfma_f32_16x16x32_bf16 v[160:163], a[240:243], a[44:47], v[160:163]
    v_mfma_f32_16x16x32_bf16 v[192:195], a[244:247], a[44:47], v[192:195]
    v_mfma_f32_16x16x32_bf16 v[224:227], a[248:251], a[44:47], v[224:227]
    s_waitcnt vmcnt(44)
    v_mfma_f32_16x16x32_bf16 v[132:135], a[236:239], a[48:51], v[132:135]
    buffer_load_dwordx4 a[44:47], v17, s[36:39], s73 offen offset:2048 sc1
    v_mfma_f32_16x16x32_bf16 v[164:167], a[240:243], a[48:51], v[164:167]
    s_waitcnt vmcnt(39)
    v_mfma_f32_16x16x32_bf16 v[196:199], a[244:247], a[48:51], v[196:199]
    ds_read_b64_tr_b16 a[220:221], v245 offset:8192
    v_mfma_f32_16x16x32_bf16 v[228:231], a[248:251], a[48:51], v[228:231]
    ds_read_b64_tr_b16 a[222:223], v245 offset:10240
    v_mfma_f32_16x16x32_bf16 v[136:139], a[236:239], a[52:55], v[136:139]
    buffer_load_dwordx4 a[48:51], v17, s[36:39], s74 offen offset:0 sc1
    v_mfma_f32_16x16x32_bf16 v[168:171], a[240:243], a[52:55], v[168:171]
    ds_read_b64_tr_b16 a[224:225], v246 offset:8192
    v_mfma_f32_16x16x32_bf16 v[200:203], a[244:247], a[52:55], v[200:203]
    ds_read_b64_tr_b16 a[226:227], v246 offset:10240
    v_mfma_f32_16x16x32_bf16 v[232:235], a[248:251], a[52:55], v[232:235]
    ds_read_b64_tr_b16 a[228:229], v247 offset:8192
    v_mfma_f32_16x16x32_bf16 v[140:143], a[236:239], a[56:59], v[140:143]
    buffer_load_dwordx4 a[52:55], v17, s[36:39], s74 offen offset:2048 sc1
    v_mfma_f32_16x16x32_bf16 v[172:175], a[240:243], a[56:59], v[172:175]
    ds_read_b64_tr_b16 a[230:231], v247 offset:10240
    v_mfma_f32_16x16x32_bf16 v[204:207], a[244:247], a[56:59], v[204:207]
    ds_read_b64_tr_b16 a[232:233], v248 offset:8192
    v_mfma_f32_16x16x32_bf16 v[236:239], a[248:251], a[56:59], v[236:239]
    ds_read_b64_tr_b16 a[234:235], v248 offset:10240
    v_mfma_f32_16x16x32_bf16 v[144:147], a[236:239], a[60:63], v[144:147]
    buffer_load_dwordx4 a[56:59], v17, s[36:39], s16 offen offset:0 sc1
    v_mfma_f32_16x16x32_bf16 v[176:179], a[240:243], a[60:63], v[176:179]
    v_mfma_f32_16x16x32_bf16 v[208:211], a[244:247], a[60:63], v[208:211]
    v_mfma_f32_16x16x32_bf16 v[240:243], a[248:251], a[60:63], v[240:243]
    buffer_load_dwordx4 a[60:63], v17, s[36:39], s16 offen offset:2048 sc1
    v_add_u32 v244, s18, v244
    s_add_u32 s36, s36, 1064960
    s_addc_u32 s37, s37, 0
    s_waitcnt vmcnt(40) lgkmcnt(0)
    s_add_u32 m0, s78, 8192
    v_mfma_f32_16x16x32_bf16 v[116:119], a[220:223], a[64:67], v[116:119]
    buffer_load_dwordx4 v244, s[40:43], 0 offen offset:0 sc1 lds
    v_mfma_f32_16x16x32_bf16 v[148:151], a[224:227], a[64:67], v[148:151]
    v_mfma_f32_16x16x32_bf16 v[180:183], a[228:231], a[64:67], v[180:183]
    buffer_load_dwordx4 v244, s[40:43], s75 offen offset:1024 sc1 lds
    v_mfma_f32_16x16x32_bf16 v[212:215], a[232:235], a[64:67], v[212:215]
    v_mfma_f32_16x16x32_bf16 v[120:123], a[220:223], a[68:71], v[120:123]
    buffer_load_dwordx4 a[64:67], v17, s[36:39], 0 offen offset:0 sc1
    v_mfma_f32_16x16x32_bf16 v[152:155], a[224:227], a[68:71], v[152:155]
    v_mfma_f32_16x16x32_bf16 v[184:187], a[228:231], a[68:71], v[184:187]
    buffer_load_dwordx4 v244, s[40:43], s76 offen offset:2048 sc1 lds
    v_mfma_f32_16x16x32_bf16 v[216:219], a[232:235], a[68:71], v[216:219]
    v_mfma_f32_16x16x32_bf16 v[124:127], a[220:223], a[72:75], v[124:127]
    buffer_load_dwordx4 a[68:71], v17, s[36:39], 0 offen offset:2048 sc1
    v_mfma_f32_16x16x32_bf16 v[156:159], a[224:227], a[72:75], v[156:159]
    v_mfma_f32_16x16x32_bf16 v[188:191], a[228:231], a[72:75], v[188:191]
    buffer_load_dwordx4 v244, s[40:43], s77 offen offset:3072 sc1 lds
    v_mfma_f32_16x16x32_bf16 v[220:223], a[232:235], a[72:75], v[220:223]
    v_mfma_f32_16x16x32_bf16 v[128:131], a[220:223], a[76:79], v[128:131]
    buffer_load_dwordx4 a[72:75], v17, s[36:39], s73 offen offset:0 sc1
    v_mfma_f32_16x16x32_bf16 v[160:163], a[224:227], a[76:79], v[160:163]
    v_mfma_f32_16x16x32_bf16 v[192:195], a[228:231], a[76:79], v[192:195]
    v_mfma_f32_16x16x32_bf16 v[224:227], a[232:235], a[76:79], v[224:227]
    s_waitcnt vmcnt(43)
    v_mfma_f32_16x16x32_bf16 v[132:135], a[220:223], a[80:83], v[132:135]
    buffer_load_dwordx4 a[76:79], v17, s[36:39], s73 offen offset:2048 sc1
    v_mfma_f32_16x16x32_bf16 v[164:167], a[224:227], a[80:83], v[164:167]
    s_waitcnt vmcnt(38)
    v_mfma_f32_16x16x32_bf16 v[196:199], a[228:231], a[80:83], v[196:199]
    ds_read_b64_tr_b16 a[236:237], v245 offset:12288
    v_mfma_f32_16x16x32_bf16 v[228:231], a[232:235], a[80:83], v[228:231]
    ds_read_b64_tr_b16 a[238:239], v245 offset:14336
    v_mfma_f32_16x16x32_bf16 v[136:139], a[220:223], a[84:87], v[136:139]
    buffer_load_dwordx4 a[80:83], v17, s[36:39], s74 offen offset:0 sc1
    v_mfma_f32_16x16x32_bf16 v[168:171], a[224:227], a[84:87], v[168:171]
    ds_read_b64_tr_b16 a[240:241], v246 offset:12288
    v_mfma_f32_16x16x32_bf16 v[200:203], a[228:231], a[84:87], v[200:203]
    ds_read_b64_tr_b16 a[242:243], v246 offset:14336
    v_mfma_f32_16x16x32_bf16 v[232:235], a[232:235], a[84:87], v[232:235]
    ds_read_b64_tr_b16 a[244:245], v247 offset:12288
    v_mfma_f32_16x16x32_bf16 v[140:143], a[220:223], a[88:91], v[140:143]
    buffer_load_dwordx4 a[84:87], v17, s[36:39], s74 offen offset:2048 sc1
    v_mfma_f32_16x16x32_bf16 v[172:175], a[224:227], a[88:91], v[172:175]
    ds_read_b64_tr_b16 a[246:247], v247 offset:14336
    v_mfma_f32_16x16x32_bf16 v[204:207], a[228:231], a[88:91], v[204:207]
    ds_read_b64_tr_b16 a[248:249], v248 offset:12288
    buffer_load_dword v252, v13, s[32:35], s65 offen sc1
    v_mfma_f32_16x16x32_bf16 v[236:239], a[232:235], a[88:91], v[236:239]
    ds_read_b64_tr_b16 a[250:251], v248 offset:14336
    v_mfma_f32_16x16x32_bf16 v[144:147], a[220:223], a[92:95], v[144:147]
    buffer_load_dwordx4 a[88:91], v17, s[36:39], s16 offen offset:0 sc1
    v_mfma_f32_16x16x32_bf16 v[176:179], a[224:227], a[92:95], v[176:179]
    v_mfma_f32_16x16x32_bf16 v[208:211], a[228:231], a[92:95], v[208:211]
    v_mfma_f32_16x16x32_bf16 v[240:243], a[232:235], a[92:95], v[240:243]
    buffer_load_dwordx4 a[92:95], v17, s[36:39], s16 offen offset:2048 sc1
    v_add_u32 v244, s18, v244
    s_add_u32 s36, s36, 1064960
    s_addc_u32 s37, s37, 0
    s_waitcnt vmcnt(41) lgkmcnt(0)
    s_add_u32 m0, s78, 12288
    v_mfma_f32_16x16x32_bf16 v[116:119], a[236:239], a[96:99], v[116:119]
    buffer_load_dwordx4 v244, s[40:43], 0 offen offset:0 sc1 lds
    v_mfma_f32_16x16x32_bf16 v[148:151], a[240:243], a[96:99], v[148:151]
    v_mfma_f32_16x16x32_bf16 v[180:183], a[244:247], a[96:99], v[180:183]
    buffer_load_dwordx4 v244, s[40:43], s75 offen offset:1024 sc1 lds
    v_mfma_f32_16x16x32_bf16 v[212:215], a[248:251], a[96:99], v[212:215]
    v_mfma_f32_16x16x32_bf16 v[120:123], a[236:239], a[100:103], v[120:123]
    buffer_load_dwordx4 a[96:99], v17, s[36:39], 0 offen offset:0 sc1
    v_mfma_f32_16x16x32_bf16 v[152:155], a[240:243], a[100:103], v[152:155]
    v_mfma_f32_16x16x32_bf16 v[184:187], a[244:247], a[100:103], v[184:187]
    buffer_load_dwordx4 v244, s[40:43], s76 offen offset:2048 sc1 lds
    v_mfma_f32_16x16x32_bf16 v[216:219], a[248:251], a[100:103], v[216:219]
    v_mfma_f32_16x16x32_bf16 v[124:127], a[236:239], a[104:107], v[124:127]
    buffer_load_dwordx4 a[100:103], v17, s[36:39], 0 offen offset:2048 sc1
    v_mfma_f32_16x16x32_bf16 v[156:159], a[240:243], a[104:107], v[156:159]
    v_mfma_f32_16x16x32_bf16 v[188:191], a[244:247], a[104:107], v[188:191]
    buffer_load_dwordx4 v244, s[40:43], s77 offen offset:3072 sc1 lds
    v_mfma_f32_16x16x32_bf16 v[220:223], a[248:251], a[104:107], v[220:223]
    v_mfma_f32_16x16x32_bf16 v[128:131], a[236:239], a[108:111], v[128:131]
    buffer_load_dwordx4 a[104:107], v17, s[36:39], s73 offen offset:0 sc1
    v_mfma_f32_16x16x32_bf16 v[160:163], a[240:243], a[108:111], v[160:163]
    v_mfma_f32_16x16x32_bf16 v[192:195], a[244:247], a[108:111], v[192:195]
    v_mfma_f32_16x16x32_bf16 v[224:227], a[248:251], a[108:111], v[224:227]
    s_waitcnt vmcnt(44)
    v_mfma_f32_16x16x32_bf16 v[132:135], a[236:239], a[112:115], v[132:135]
    buffer_load_dwordx4 a[108:111], v17, s[36:39], s73 offen offset:2048 sc1
    v_mfma_f32_16x16x32_bf16 v[164:167], a[240:243], a[112:115], v[164:167]
    s_waitcnt vmcnt(39)
    v_mfma_f32_16x16x32_bf16 v[196:199], a[244:247], a[112:115], v[196:199]
    ds_read_b64_tr_b16 a[220:221], v245 offset:0
    v_mfma_f32_16x16x32_bf16 v[228:231], a[248:251], a[112:115], v[228:231]
    ds_read_b64_tr_b16 a[222:223], v245 offset:2048
    v_mfma_f32_16x16x32_bf16 v[136:139], a[236:239], a[116:119], v[136:139]
    buffer_load_dwordx4 a[112:115], v17, s[36:39], s74 offen offset:0 sc1
    v_mfma_f32_16x16x32_bf16 v[168:171], a[240:243], a[116:119], v[168:171]
    ds_read_b64_tr_b16 a[224:225], v246 offset:0
    v_mfma_f32_16x16x32_bf16 v[200:203], a[244:247], a[116:119], v[200:203]
    ds_read_b64_tr_b16 a[226:227], v246 offset:2048
    v_mfma_f32_16x16x32_bf16 v[232:235], a[248:251], a[116:119], v[232:235]
    ds_read_b64_tr_b16 a[228:229], v247 offset:0
    v_mfma_f32_16x16x32_bf16 v[140:143], a[236:239], a[120:123], v[140:143]
    buffer_load_dwordx4 a[116:119], v17, s[36:39], s74 offen offset:2048 sc1
    v_mfma_f32_16x16x32_bf16 v[172:175], a[240:243], a[120:123], v[172:175]
    ds_read_b64_tr_b16 a[230:231], v247 offset:2048
    v_mfma_f32_16x16x32_bf16 v[204:207], a[244:247], a[120:123], v[204:207]
    ds_read_b64_tr_b16 a[232:233], v248 offset:0
    v_mfma_f32_16x16x32_bf16 v[236:239], a[248:251], a[120:123], v[236:239]
    ds_read_b64_tr_b16 a[234:235], v248 offset:2048
    v_mfma_f32_16x16x32_bf16 v[144:147], a[236:239], a[124:127], v[144:147]
    buffer_load_dwordx4 a[120:123], v17, s[36:39], s16 offen offset:0 sc1
    v_mfma_f32_16x16x32_bf16 v[176:179], a[240:243], a[124:127], v[176:179]
    v_mfma_f32_16x16x32_bf16 v[208:211], a[244:247], a[124:127], v[208:211]
    v_mfma_f32_16x16x32_bf16 v[240:243], a[248:251], a[124:127], v[240:243]
    buffer_load_dwordx4 a[124:127], v17, s[36:39], s16 offen offset:2048 sc1
    v_add_u32 v244, s18, v244
    s_add_u32 s36, s36, 1064960
    s_addc_u32 s37, s37, 0
    s_waitcnt vmcnt(14)
    v_cmp_eq_u32 vcc, s57, v252
    s_nop 0
    s_cmp_eq_u64 vcc, -1
    s_cbranch_scc0 P3_SLOWO
P3_OOK:
    s_mov_b32 s40, s30
    s_mov_b32 s41, s31
    s_mov_b32 s42, s15
    v_subrev_u32 v244, s19, v244
    s_mov_b32 s62, 6
    s_barrier
    v_add_u32 v8, 0x10000, v2
    v_and_b32 v9, 15, v1
    v_lshlrev_b32 v9, 11, v9
    v_bfe_u32 v10, v1, 4, 1
    v_lshl_add_u32 v9, v10, 5, v9
    v_lshrrev_b32 v10, 5, v1
    v_lshl_add_u32 v9, v10, 4, v9
    s_lshl_b32 s58, s71, 18
    s_lshl_b32 s59, s56, 16
    s_add_u32 s58, s58, s59
    s_lshl_b32 s59, s72, 7
    s_add_u32 s58, s58, s59
    s_add_u32 s59, s58, 32768
    s_lshl_b32 s60, s56, 13
    s_add_u32 s60, s60, 98304
    v_subrev_u32 v68, s60, v245
    v_subrev_u32 v69, s60, v246
    v_subrev_u32 v70, s60, v247
    v_subrev_u32 v71, s60, v248
    v_add_u32 v72, 0x10000, v68
    v_add_u32 v73, 0x10000, v69
    v_add_u32 v74, 0x10000, v70
    v_add_u32 v75, 0x10000, v71
    s_waitcnt vmcnt(40) lgkmcnt(0)
    s_add_u32 m0, s78, 0
    v_mfma_f32_16x16x32_bf16 v[116:119], a[220:223], a[0:3], v[116:119]
    buffer_load_dwordx4 v244, s[40:43], 0 offen offset:0 sc1 lds
    v_mfma_f32_16x16x32_bf16 v[148:151], a[224:227], a[0:3], v[148:151]
    v_mfma_f32_16x16x32_bf16 v[180:183], a[228:231], a[0:3], v[180:183]
    buffer_load_dwordx4 v244, s[40:43], s75 offen offset:1024 sc1 lds
    v_mfma_f32_16x16x32_bf16 v[212:215], a[232:235], a[0:3], v[212:215]
    v_mfma_f32_16x16x32_bf16 v[120:123], a[220:223], a[4:7], v[120:123]
    buffer_load_dwordx4 a[0:3], v17, s[36:39], 0 offen offset:0 sc1
    v_mfma_f32_16x16x32_bf16 v[152:155], a[224:227], a[4:7], v[152:155]
    v_mfma_f32_16x16x32_bf16 v[184:187], a[228:231], a[4:7], v[184:187]
    buffer_load_dwordx4 v244, s[40:43], s76 offen offset:2048 sc1 lds
    v_mfma_f32_16x16x32_bf16 v[216:219], a[232:235], a[4:7], v[216:219]
    v_mfma_f32_16x16x32_bf16 v[124:127], a[220:223], a[8:11], v[124:127]
    buffer_load_dwordx4 a[4:7], v17, s[36:39], 0 offen offset:2048 sc1
    v_mfma_f32_16x16x32_bf16 v[156:159], a[224:227], a[8:11], v[156:159]
    v_mfma_f32_16x16x32_bf16 v[188:191], a[228:231], a[8:11], v[188:191]
    buffer_load_dwordx4 v244, s[40:43], s77 offen offset:3072 sc1 lds
    v_mfma_f32_16x16x32_bf16 v[220:223], a[232:235], a[8:11], v[220:223]
    v_mfma_f32_16x16x32_bf16 v[128:131], a[220:223], a[12:15], v[128:131]
    buffer_load_dwordx4 a[8:11], v17, s[36:39], s73 offen offset:0 sc1
    v_mfma_f32_16x16x32_bf16 v[160:163], a[224:227], a[12:15], v[160:163]
    v_mfma_f32_16x16x32_bf16 v[192:195], a[228:231], a[12:15], v[192:195]
    v_mfma_f32_16x16x32_bf16 v[224:227], a[232:235], a[12:15], v[224:227]
    s_waitcnt vmcnt(43)
    v_mfma_f32_16x16x32_bf16 v[132:135], a[220:223], a[16:19], v[132:135]
    buffer_load_dwordx4 a[12:15], v17, s[36:39], s73 offen offset:2048 sc1
    v_mfma_f32_16x16x32_bf16 v[164:167], a[224:227], a[16:19], v[164:167]
    s_waitcnt vmcnt(38)
    v_mfma_f32_16x16x32_bf16 v[196:199], a[228:231], a[16:19], v[196:199]
    ds_read_b64_tr_b16 a[236:237], v245 offset:4096
    v_mfma_f32_16x16x32_bf16 v[228:231], a[232:235], a[16:19], v[228:231]
    ds_read_b64_tr_b16 a[238:239], v245 offset:6144
    v_mfma_f32_16x16x32_bf16 v[136:139], a[220:223], a[20:23], v[136:139]
    buffer_load_dwordx4 a[16:19], v17, s[36:39], s74 offen offset:0 sc1
    v_mfma_f32_16x16x32_bf16 v[168:171], a[224:227], a[20:23], v[168:171]
    ds_read_b64_tr_b16 a[240:241], v246 offset:4096
    v_mfma_f32_16x16x32_bf16 v[200:203], a[228:231], a[20:23], v[200:203]
    ds_read_b64_tr_b16 a[242:243], v246 offset:6144
    v_mfma_f32_16x16x32_bf16 v[232:235], a[232:235], a[20:23], v[232:235]
    ds_read_b64_tr_b16 a[244:245], v247 offset:4096
    v_mfma_f32_16x16x32_bf16 v[140:143], a[220:223], a[24:27], v[140:143]
    buffer_load_dwordx4 a[20:23], v17, s[36:39], s74 offen offset:2048 sc1
    v_mfma_f32_16x16x32_bf16 v[172:175], a[224:227], a[24:27], v[172:175]
    ds_read_b64_tr_b16 a[246:247], v247 offset:6144
    v_mfma_f32_16x16x32_bf16 v[204:207], a[228:231], a[24:27], v[204:207]
    ds_read_b64_tr_b16 a[248:249], v248 offset:4096
    v_mfma_f32_16x16x32_bf16 v[236:239], a[232:235], a[24:27], v[236:239]
    ds_read_b64_tr_b16 a[250:251], v248 offset:6144
    v_mfma_f32_16x16x32_bf16 v[144:147], a[220:223], a[28:31], v[144:147]
    buffer_load_dwordx4 a[24:27], v17, s[36:39], s16 offen offset:0 sc1
    v_mfma_f32_16x16x32_bf16 v[176:179], a[224:227], a[28:31], v[176:179]
    v_mfma_f32_16x16x32_bf16 v[208:211], a[228:231], a[28:31], v[208:211]
    v_mfma_f32_16x16x32_bf16 v[240:243], a[232:235], a[28:31], v[240:243]
    buffer_load_dwordx4 a[28:31], v17, s[36:39], s16 offen offset:2048 sc1
    v_add_u32 v244, s18, v244
    s_add_u32 s36, s36, 1064960
    s_addc_u32 s37, s37, 0
    s_waitcnt vmcnt(40) lgkmcnt(0)
    s_add_u32 m0, s78, 4096
    v_mfma_f32_16x16x32_bf16 v[116:119], a[236:239], a[32:35], v[116:119]
    buffer_load_dwordx4 v244, s[40:43], 0 offen offset:0 sc1 lds
    v_mfma_f32_16x16x32_bf16 v[148:151], a[240:243], a[32:35], v[148:151]
    v_mfma_f32_16x16x32_bf16 v[180:183], a[244:247], a[32:35], v[180:183]
    buffer_load_dwordx4 v244, s[40:43], s75 offen offset:1024 sc1 lds
    v_mfma_f32_16x16x32_bf16 v[212:215], a[248:251], a[32:35], v[212:215]
    v_mfma_f32_16x16x32_bf16 v[120:123], a[236:239], a[36:39], v[120:123]
    buffer_load_dwordx4 a[32:35], v17, s[36:39], 0 offen offset:0 sc1
    v_mfma_f32_16x16x32_bf16 v[152:155], a[240:243], a[36:39], v[152:155]
    v_mfma_f32_16x16x32_bf16 v[184:187], a[244:247], a[36:39], v[184:187]
    buffer_load_dwordx4 v244, s[40:43], s76 offen offset:2048 sc1 lds
    v_mfma_f32_16x16x32_bf16 v[216:219], a[248:251], a[36:39], v[216:219]
    v_mfma_f32_16x16x32_bf16 v[124:127], a[236:239], a[40:43], v[124:127]
    buffer_load_dwordx4 a[36:39], v17, s[36:39], 0 offen offset:2048 sc1
    v_mfma_f32_16x16x32_bf16 v[156:159], a[240:243], a[40:43], v[156:159]
    v_mfma_f32_16x16x32_bf16 v[188:191], a[244:247], a[40:43], v[188:191]
    buffer_load_dwordx4 v244, s[40:43], s77 offen offset:3072 sc1 lds
    v_mfma_f32_16x16x32_bf16 v[220:223], a[248:251], a[40:43], v[220:223]
    v_mfma_f32_16x16x32_bf16 v[128:131], a[236:239], a[44:47], v[128:131]
    buffer_load_dwordx4 a[40:43], v17, s[36:39], s73 offen offset:0 sc1
    v_mfma_f32_16x16x32_bf16 v[160:163], a[240:243], a[44:47], v[160:163]
    v_mfma_f32_16x16x32_bf16 v[192:195], a[244:247], a[44:47], v[192:195]
    v_mfma_f32_16x16x32_bf16 v[224:227], a[248:251], a[44:47], v[224:227]
    s_waitcnt vmcnt(43)
    v_mfma_f32_16x16x32_bf16 v[132:135], a[236:239], a[48:51], v[132:135]
    buffer_load_dwordx4 a[44:47], v17, s[36:39], s73 offen offset:2048 sc1
    v_mfma_f32_16x16x32_bf16 v[164:167], a[240:243], a[48:51], v[164:167]
    s_waitcnt vmcnt(38)
    v_mfma_f32_16x16x32_bf16 v[196:199], a[244:247], a[48:51], v[196:199]
    ds_read_b64_tr_b16 a[220:221], v245 offset:8192
    v_mfma_f32_16x16x32_bf16 v[228:231], a[248:251], a[48:51], v[228:231]
    ds_read_b64_tr_b16 a[222:223], v245 offset:10240
    v_mfma_f32_16x16x32_bf16 v[136:139], a[236:239], a[52:55], v[136:139]
    buffer_load_dwordx4 a[48:51], v17, s[36:39], s74 offen offset:0 sc1
    v_mfma_f32_16x16x32_bf16 v[168:171], a[240:243], a[52:55], v[168:171]
    ds_read_b64_tr_b16 a[224:225], v246 offset:8192
    v_mfma_f32_16x16x32_bf16 v[200:203], a[244:247], a[52:55], v[200:203]
    ds_read_b64_tr_b16 a[226:227], v246 offset:10240
    v_mfma_f32_16x16x32_bf16 v[232:235], a[248:251], a[52:55], v[232:235]
    ds_read_b64_tr_b16 a[228:229], v247 offset:8192
    v_mfma_f32_16x16x32_bf16 v[140:143], a[236:239], a[56:59], v[140:143]
    buffer_load_dwordx4 a[52:55], v17, s[36:39], s74 offen offset:2048 sc1
    v_mfma_f32_16x16x32_bf16 v[172:175], a[240:243], a[56:59], v[172:175]
    ds_read_b64_tr_b16 a[230:231], v247 offset:10240
    v_mfma_f32_16x16x32_bf16 v[204:207], a[244:247], a[56:59], v[204:207]
    ds_read_b64_tr_b16 a[232:233], v248 offset:8192
    v_mfma_f32_16x16x32_bf16 v[236:239], a[248:251], a[56:59], v[236:239]
    ds_read_b64_tr_b16 a[234:235], v248 offset:10240
    v_mfma_f32_16x16x32_bf16 v[144:147], a[236:239], a[60:63], v[144:147]
    buffer_load_dwordx4 a[56:59], v17, s[36:39], s16 offen offset:0 sc1
    v_mfma_f32_16x16x32_bf16 v[176:179], a[240:243], a[60:63], v[176:179]
    v_mfma_f32_16x16x32_bf16 v[208:211], a[244:247], a[60:63], v[208:211]
    v_mfma_f32_16x16x32_bf16 v[240:243], a[248:251], a[60:63], v[240:243]
    buffer_load_dwordx4 a[60:63], v17, s[36:39], s16 offen offset:2048 sc1
    v_add_u32 v244, s18, v244
    s_add_u32 s36, s36, 1064960
    s_addc_u32 s37, s37, 0
    s_waitcnt vmcnt(40) lgkmcnt(0)
    s_add_u32 m0, s78, 8192
    v_mfma_f32_16x16x32_bf16 v[116:119], a[220:223], a[64:67], v[116:119]
    buffer_load_dwordx4 v244, s[40:43], 0 offen offset:0 sc1 lds
    v_mfma_f32_16x16x32_bf16 v[148:151], a[224:227], a[64:67], v[148:151]
    v_mfma_f32_16x16x32_bf16 v[180:183], a[228:231], a[64:67], v[180:183]
    buffer_load_dwordx4 v244, s[40:43], s75 offen offset:1024 sc1 lds
    v_mfma_f32_16x16x32_bf16 v[212:215], a[232:235], a[64:67], v[212:215]
    v_mfma_f32_16x16x32_bf16 v[120:123], a[220:223], a[68:71], v[120:123]
    buffer_load_dwordx4 a[64:67], v17, s[36:39], 0 offen offset:0 sc1
    v_mfma_f32_16x16x32_bf16 v[152:155], a[224:227], a[68:71], v[152:155]
    v_mfma_f32_16x16x32_bf16 v[184:187], a[228:231], a[68:71], v[184:187]
    buffer_load_dwordx4 v244, s[40:43], s76 offen offset:2048 sc1 lds
    v_mfma_f32_16x16x32_bf16 v[216:219], a[232:235], a[68:71], v[216:219]
    v_mfma_f32_16x16x32_bf16 v[124:127], a[220:223], a[72:75], v[124:127]
    buffer_load_dwordx4 a[68:71], v17, s[36:39], 0 offen offset:2048 sc1
    v_mfma_f32_16x16x32_bf16 v[156:159], a[224:227], a[72:75], v[156:159]
    v_mfma_f32_16x16x32_bf16 v[188:191], a[228:231], a[72:75], v[188:191]
    buffer_load_dwordx4 v244, s[40:43], s77 offen offset:3072 sc1 lds
    v_mfma_f32_16x16x32_bf16 v[220:223], a[232:235], a[72:75], v[220:223]
    v_mfma_f32_16x16x32_bf16 v[128:131], a[220:223], a[76:79], v[128:131]
    buffer_load_dwordx4 a[72:75], v17, s[36:39], s73 offen offset:0 sc1
    v_mfma_f32_16x16x32_bf16 v[160:163], a[224:227], a[76:79], v[160:163]
    v_mfma_f32_16x16x32_bf16 v[192:195], a[228:231], a[76:79], v[192:195]
    v_mfma_f32_16x16x32_bf16 v[224:227], a[232:235], a[76:79], v[224:227]
    s_waitcnt vmcnt(43)
    v_mfma_f32_16x16x32_bf16 v[132:135], a[220:223], a[80:83], v[132:135]
    buffer_load_dwordx4 a[76:79], v17, s[36:39], s73 offen offset:2048 sc1
    v_mfma_f32_16x16x32_bf16 v[164:167], a[224:227], a[80:83], v[164:167]
    s_waitcnt vmcnt(38)
    v_mfma_f32_16x16x32_bf16 v[196:199], a[228:231], a[80:83], v[196:199]
    ds_read_b64_tr_b16 a[236:237], v245 offset:12288
    v_mfma_f32_16x16x32_bf16 v[228:231], a[232:235], a[80:83], v[228:231]
    ds_read_b64_tr_b16 a[238:239], v245 offset:14336
    v_mfma_f32_16x16x32_bf16 v[136:139], a[220:223], a[84:87], v[136:139]
    buffer_load_dwordx4 a[80:83], v17, s[36:39], s74 offen offset:0 sc1
    v_mfma_f32_16x16x32_bf16 v[168:171], a[224:227], a[84:87], v[168:171]
    ds_read_b64_tr_b16 a[240:241], v246 offset:12288
    v_mfma_f32_16x16x32_bf16 v[200:203], a[228:231], a[84:87], v[200:203]
    ds_read_b64_tr_b16 a[242:243], v246 offset:14336
    v_mfma_f32_16x16x32_bf16 v[232:235], a[232:235], a[84:87], v[232:235]
    ds_read_b64_tr_b16 a[244:245], v247 offset:12288
    v_mfma_f32_16x16x32_bf16 v[140:143], a[220:223], a[88:91], v[140:143]
    buffer_load_dwordx4 a[84:87], v17, s[36:39], s74 offen offset:2048 sc1
    v_mfma_f32_16x16x32_bf16 v[172:175], a[224:227], a[88:91], v[172:175]
    ds_read_b64_tr_b16 a[246:247], v247 offset:14336
    v_mfma_f32_16x16x32_bf16 v[204:207], a[228:231], a[88:91], v[204:207]
    ds_read_b64_tr_b16 a[248:249], v248 offset:12288
    v_mfma_f32_16x16x32_bf16 v[236:239], a[232:235], a[88:91], v[236:239]
    ds_read_b64_tr_b16 a[250:251], v248 offset:14336
    v_mfma_f32_16x16x32_bf16 v[144:147], a[220:223], a[92:95], v[144:147]
    buffer_load_dwordx4 a[88:91], v17, s[36:39], s16 offen offset:0 sc1
    v_mfma_f32_16x16x32_bf16 v[176:179], a[224:227], a[92:95], v[176:179]
    v_mfma_f32_16x16x32_bf16 v[208:211], a[228:231], a[92:95], v[208:211]
    v_mfma_f32_16x16x32_bf16 v[240:243], a[232:235], a[92:95], v[240:243]
    buffer_load_dwordx4 a[92:95], v17, s[36:39], s16 offen offset:2048 sc1
    v_add_u32 v244, s18, v244
    s_add_u32 s36, s36, 1064960
    s_addc_u32 s37, s37, 0
    s_waitcnt vmcnt(40) lgkmcnt(0)
    s_add_u32 m0, s78, 12288
    v_mfma_f32_16x16x32_bf16 v[116:119], a[236:239], a[96:99], v[116:119]
    buffer_load_dwordx4 v244, s[40:43], 0 offen offset:0 sc1 lds
    v_mfma_f32_16x16x32_bf16 v[148:151], a[240:243], a[96:99], v[148:151]
    v_mfma_f32_16x16x32_bf16 v[180:183], a[244:247], a[96:99], v[180:183]
    buffer_load_dwordx4 v244, s[40:43], s75 offen offset:1024 sc1 lds
    v_mfma_f32_16x16x32_bf16 v[212:215], a[248:251], a[96:99], v[212:215]
    v_mfma_f32_16x16x32_bf16 v[120:123], a[236:239], a[100:103], v[120:123]
    buffer_load_dwordx4 a[96:99], v17, s[36:39], 0 offen offset:0 sc1
    v_mfma_f32_16x16x32_bf16 v[152:155], a[240:243], a[100:103], v[152:155]
    v_mfma_f32_16x16x32_bf16 v[184:187], a[244:247], a[100:103], v[184:187]
    buffer_load_dwordx4 v244, s[40:43], s76 offen offset:2048 sc1 lds
    v_mfma_f32_16x16x32_bf16 v[216:219], a[248:251], a[100:103], v[216:219]
    v_mfma_f32_16x16x32_bf16 v[124:127], a[236:239], a[104:107], v[124:127]
    buffer_load_dwordx4 a[100:103], v17, s[36:39], 0 offen offset:2048 sc1
    v_mfma_f32_16x16x32_bf16 v[156:159], a[240:243], a[104:107], v[156:159]
    v_mfma_f32_16x16x32_bf16 v[188:191], a[244:247], a[104:107], v[188:191]
    buffer_load_dwordx4 v244, s[40:43], s77 offen offset:3072 sc1 lds
    v_mfma_f32_16x16x32_bf16 v[220:223], a[248:251], a[104:107], v[220:223]
    v_mfma_f32_16x16x32_bf16 v[128:131], a[236:239], a[108:111], v[128:131]
    buffer_load_dwordx4 a[104:107], v17, s[36:39], s73 offen offset:0 sc1
    v_mfma_f32_16x16x32_bf16 v[160:163], a[240:243], a[108:111], v[160:163]
    v_mfma_f32_16x16x32_bf16 v[192:195], a[244:247], a[108:111], v[192:195]
    v_mfma_f32_16x16x32_bf16 v[224:227], a[248:251], a[108:111], v[224:227]
    s_waitcnt vmcnt(43)
    v_mfma_f32_16x16x32_bf16 v[132:135], a[236:239], a[112:115], v[132:135]
    buffer_load_dwordx4 a[108:111], v17, s[36:39], s73 offen offset:2048 sc1
    v_mfma_f32_16x16x32_bf16 v[164:167], a[240:243], a[112:115], v[164:167]
    s_waitcnt vmcnt(38)
    v_mfma_f32_16x16x32_bf16 v[196:199], a[244:247], a[112:115], v[196:199]
    ds_read_b64_tr_b16 a[220:221], v245 offset:0
    v_mfma_f32_16x16x32_bf16 v[228:231], a[248:251], a[112:115], v[228:231]
    ds_read_b64_tr_b16 a[222:223], v245 offset:2048
    v_mfma_f32_16x16x32_bf16 v[136:139], a[236:239], a[116:119], v[136:139]
    buffer_load_dwordx4 a[112:115], v17, s[36:39], s74 offen offset:0 sc1
    v_mfma_f32_16x16x32_bf16 v[168:171], a[240:243], a[116:119], v[168:171]
    ds_read_b64_tr_b16 a[224:225], v246 offset:0
    v_mfma_f32_16x16x32_bf16 v[200:203], a[244:247], a[116:119], v[200:203]
    ds_read_b64_tr_b16 a[226:227], v246 offset:2048
    v_mfma_f32_16x16x32_bf16 v[232:235], a[248:251], a[116:119], v[232:235]
    ds_read_b64_tr_b16 a[228:229], v247 offset:0
    v_mfma_f32_16x16x32_bf16 v[140:143], a[236:239], a[120:123], v[140:143]
    buffer_load_dwordx4 a[116:119], v17, s[36:39], s74 offen offset:2048 sc1
    v_mfma_f32_16x16x32_bf16 v[172:175], a[240:243], a[120:123], v[172:175]
    ds_read_b64_tr_b16 a[230:231], v247 offset:2048
    v_mfma_f32_16x16x32_bf16 v[204:207], a[244:247], a[120:123], v[204:207]
    ds_read_b64_tr_b16 a[232:233], v248 offset:0
    v_mfma_f32_16x16x32_bf16 v[236:239], a[248:251], a[120:123], v[236:239]
    ds_read_b64_tr_b16 a[234:235], v248 offset:2048
    v_mfma_f32_16x16x32_bf16 v[144:147], a[236:239], a[124:127], v[144:147]
    buffer_load_dwordx4 a[120:123], v17, s[36:39], s16 offen offset:0 sc1
    v_mfma_f32_16x16x32_bf16 v[176:179], a[240:243], a[124:127], v[176:179]
    v_mfma_f32_16x16x32_bf16 v[208:211], a[244:247], a[124:127], v[208:211]
    v_mfma_f32_16x16x32_bf16 v[240:243], a[248:251], a[124:127], v[240:243]
    buffer_load_dwordx4 a[124:127], v17, s[36:39], s16 offen offset:2048 sc1
    v_add_u32 v244, s18, v244
    s_add_u32 s36, s36, 1064960
    s_addc_u32 s37, s37, 0
    s_waitcnt vmcnt(40) lgkmcnt(0)
    v_pk_mul_f32 v[116:117], v[116:117], v[108:109] op_sel:[0,0] op_sel_hi:[1,0]
    v_pk_mul_f32 v[118:119], v[118:119], v[108:109] op_sel:[0,0] op_sel_hi:[1,0]
    v_pk_mul_f32 v[148:149], v[148:149], v[108:109] op_sel:[0,0] op_sel_hi:[1,0]
    v_pk_mul_f32 v[150:151], v[150:151], v[108:109] op_sel:[0,0] op_sel_hi:[1,0]
    v_pk_mul_f32 v[180:181], v[180:181], v[108:109] op_sel:[0,0] op_sel_hi:[1,0]
    v_pk_mul_f32 v[182:183], v[182:183], v[108:109] op_sel:[0,0] op_sel_hi:[1,0]
    v_pk_mul_f32 v[212:213], v[212:213], v[108:109] op_sel:[0,0] op_sel_hi:[1,0]
    v_pk_mul_f32 v[214:215], v[214:215], v[108:109] op_sel:[0,0] op_sel_hi:[1,0]
    s_nop 1
    v_mfma_f32_16x16x32_bf16 v[116:119], a[220:223], a[0:3], v[116:119]
    v_pk_mul_f32 v[120:121], v[120:121], v[108:109] op_sel:[0,1] op_sel_hi:[1,1]
    v_pk_mul_f32 v[122:123], v[122:123], v[108:109] op_sel:[0,1] op_sel_hi:[1,1]
    v_pk_mul_f32 v[152:153], v[152:153], v[108:109] op_sel:[0,1] op_sel_hi:[1,1]
    v_mfma_f32_16x16x32_bf16 v[148:151], a[224:227], a[0:3], v[148:151]
    v_pk_mul_f32 v[154:155], v[154:155], v[108:109] op_sel:[0,1] op_sel_hi:[1,1]
    v_pk_mul_f32 v[184:185], v[184:185], v[108:109] op_sel:[0,1] op_sel_hi:[1,1]
    v_pk_mul_f32 v[186:187], v[186:187], v[108:109] op_sel:[0,1] op_sel_hi:[1,1]
    v_mfma_f32_16x16x32_bf16 v[180:183], a[228:231], a[0:3], v[180:183]
    v_pk_mul_f32 v[216:217], v[216:217], v[108:109] op_sel:[0,1] op_sel_hi:[1,1]
    v_pk_mul_f32 v[218:219], v[218:219], v[108:109] op_sel:[0,1] op_sel_hi:[1,1]
    v_mfma_f32_16x16x32_bf16 v[212:215], a[232:235], a[0:3], v[212:215]
    v_mfma_f32_16x16x32_bf16 v[120:123], a[220:223], a[4:7], v[120:123]
    buffer_load_dwordx4 a[0:3], v17, s[36:39], 0 offen offset:0 sc1
    v_pk_mul_f32 v[124:125], v[124:125], v[110:111] op_sel:[0,0] op_sel_hi:[1,0]
    v_pk_mul_f32 v[126:127], v[126:127], v[110:111] op_sel:[0,0] op_sel_hi:[1,0]
    v_pk_mul_f32 v[156:157], v[156:157], v[110:111] op_sel:[0,0] op_sel_hi:[1,0]
    v_mfma_f32_16x16x32_bf16 v[152:155], a[224:227], a[4:7], v[152:155]
    v_pk_mul_f32 v[158:159], v[158:159], v[110:111] op_sel:[0,0] op_sel_hi:[1,0]
    v_pk_mul_f32 v[188:189], v[188:189], v[110:111] op_sel:[0,0] op_sel_hi:[1,0]
    v_pk_mul_f32 v[190:191], v[190:191], v[110:111] op_sel:[0,0] op_sel_hi:[1,0]
    v_mfma_f32_16x16x32_bf16 v[184:187], a[228:231], a[4:7], v[184:187]
    v_pk_mul_f32 v[220:221], v[220:221], v[110:111] op_sel:[0,0] op_sel_hi:[1,0]
    v_pk_mul_f32 v[222:223], v[222:223], v[110:111] op_sel:[0,0] op_sel_hi:[1,0]
    v_mfma_f32_16x16x32_bf16 v[216:219], a[232:235], a[4:7], v[216:219]
    v_mfma_f32_16x16x32_bf16 v[124:127], a[220:223], a[8:11], v[124:127]
    buffer_load_dwordx4 a[4:7], v17, s[36:39], 0 offen offset:2048 sc1
    v_pk_mul_f32 v[128:129], v[128:129], v[110:111] op_sel:[0,1] op_sel_hi:[1,1]
    v_pk_mul_f32 v[130:131], v[130:131], v[110:111] op_sel:[0,1] op_sel_hi:[1,1]
    v_pk_mul_f32 v[160:161], v[160:161], v[110:111] op_sel:[0,1] op_sel_hi:[1,1]
    v_mfma_f32_16x16x32_bf16 v[156:159], a[224:227], a[8:11], v[156:159]
    v_pk_mul_f32 v[162:163], v[162:163], v[110:111] op_sel:[0,1] op_sel_hi:[1,1]
    v_pk_mul_f32 v[192:193], v[192:193], v[110:111] op_sel:[0,1] op_sel_hi:[1,1]
    v_pk_mul_f32 v[194:195], v[194:195], v[110:111] op_sel:[0,1] op_sel_hi:[1,1]
    v_mfma_f32_16x16x32_bf16 v[188:191], a[228:231], a[8:11], v[188:191]
    v_pk_mul_f32 v[224:225], v[224:225], v[110:111] op_sel:[0,1] op_sel_hi:[1,1]
    v_pk_mul_f32 v[226:227], v[226:227], v[110:111] op_sel:[0,1] op_sel_hi:[1,1]
    v_mfma_f32_16x16x32_bf16 v[220:223], a[232:235], a[8:11], v[220:223]
    v_mfma_f32_16x16x32_bf16 v[128:131], a[220:223], a[12:15], v[128:131]
    buffer_load_dwordx4 a[8:11], v17, s[36:39], s73 offen offset:0 sc1
    v_pk_mul_f32 v[132:133], v[132:133], v[112:113] op_sel:[0,0] op_sel_hi:[1,0]
    v_pk_mul_f32 v[134:135], v[134:135], v[112:113] op_sel:[0,0] op_sel_hi:[1,0]
    v_pk_mul_f32 v[164:165], v[164:165], v[112:113] op_sel:[0,0] op_sel_hi:[1,0]
    v_mfma_f32_16x16x32_bf16 v[160:163], a[224:227], a[12:15], v[160:163]
    v_pk_mul_f32 v[166:167], v[166:167], v[112:113] op_sel:[0,0] op_sel_hi:[1,0]
    v_pk_mul_f32 v[196:197], v[196:197], v[112:113] op_sel:[0,0] op_sel_hi:[1,0]
    v_pk_mul_f32 v[198:199], v[198:199], v[112:113] op_sel:[0,0] op_sel_hi:[1,0]
    v_mfma_f32_16x16x32_bf16 v[192:195], a[228:231], a[12:15], v[192:195]
    v_pk_mul_f32 v[228:229], v[228:229], v[112:113] op_sel:[0,0] op_sel_hi:[1,0]
    v_pk_mul_f32 v[230:231], v[230:231], v[112:113] op_sel:[0,0] op_sel_hi:[1,0]
    v_mfma_f32_16x16x32_bf16 v[224:227], a[232:235], a[12:15], v[224:227]
    s_waitcnt vmcnt(39)
    v_mfma_f32_16x16x32_bf16 v[132:135], a[220:223], a[16:19], v[132:135]
    buffer_load_dwordx4 a[12:15], v17, s[36:39], s73 offen offset:2048 sc1
    v_pk_mul_f32 v[136:137], v[136:137], v[112:113] op_sel:[0,1] op_sel_hi:[1,1]
    v_pk_mul_f32 v[138:139], v[138:139], v[112:113] op_sel:[0,1] op_sel_hi:[1,1]
    v_pk_mul_f32 v[168:169], v[168:169], v[112:113] op_sel:[0,1] op_sel_hi:[1,1]
    v_mfma_f32_16x16x32_bf16 v[164:167], a[224:227], a[16:19], v[164:167]
    s_waitcnt vmcnt(34)
    v_pk_mul_f32 v[170:171], v[170:171], v[112:113] op_sel:[0,1] op_sel_hi:[1,1]
    v_pk_mul_f32 v[200:201], v[200:201], v[112:113] op_sel:[0,1] op_sel_hi:[1,1]
    v_pk_mul_f32 v[202:203], v[202:203], v[112:113] op_sel:[0,1] op_sel_hi:[1,1]
    v_mfma_f32_16x16x32_bf16 v[196:199], a[228:231], a[16:19], v[196:199]
    ds_read_b64_tr_b16 a[236:237], v245 offset:4096
    v_pk_mul_f32 v[232:233], v[232:233], v[112:113] op_sel:[0,1] op_sel_hi:[1,1]
    v_pk_mul_f32 v[234:235], v[234:235], v[112:113] op_sel:[0,1] op_sel_hi:[1,1]
    v_mfma_f32_16x16x32_bf16 v[228:231], a[232:235], a[16:19], v[228:231]
    ds_read_b64_tr_b16 a[238:239], v245 offset:6144
    v_mfma_f32_16x16x32_bf16 v[136:139], a[220:223], a[20:23], v[136:139]
    buffer_load_dwordx4 a[16:19], v17, s[36:39], s74 offen offset:0 sc1
    v_pk_mul_f32 v[140:141], v[140:141], v[114:115] op_sel:[0,0] op_sel_hi:[1,0]
    v_pk_mul_f32 v[142:143], v[142:143], v[114:115] op_sel:[0,0] op_sel_hi:[1,0]
    v_pk_mul_f32 v[172:173], v[172:173], v[114:115] op_sel:[0,0] op_sel_hi:[1,0]
    v_mfma_f32_16x16x32_bf16 v[168:171], a[224:227], a[20:23], v[168:171]
    ds_read_b64_tr_b16 a[240:241], v246 offset:4096
    v_pk_mul_f32 v[174:175], v[174:175], v[114:115] op_sel:[0,0] op_sel_hi:[1,0]
    v_pk_mul_f32 v[204:205], v[204:205], v[114:115] op_sel:[0,0] op_sel_hi:[1,0]
    v_pk_mul_f32 v[206:207], v[206:207], v[114:115] op_sel:[0,0] op_sel_hi:[1,0]
    v_mfma_f32_16x16x32_bf16 v[200:203], a[228:231], a[20:23], v[200:203]
    ds_read_b64_tr_b16 a[242:243], v246 offset:6144
    v_pk_mul_f32 v[236:237], v[236:237], v[114:115] op_sel:[0,0] op_sel_hi:[1,0]
    v_pk_mul_f32 v[238:239], v[238:239], v[114:115] op_sel:[0,0] op_sel_hi:[1,0]
    v_mfma_f32_16x16x32_bf16 v[232:235], a[232:235], a[20:23], v[232:235]
    ds_read_b64_tr_b16 a[244:245], v247 offset:4096
    v_mfma_f32_16x16x32_bf16 v[140:143], a[220:223], a[24:27], v[140:143]
    buffer_load_dwordx4 a[20:23], v17, s[36:39], s74 offen offset:2048 sc1
    v_pk_mul_f32 v[144:145], v[144:145], v[114:115] op_sel:[0,1] op_sel_hi:[1,1]
    v_pk_mul_f32 v[146:147], v[146:147], v[114:115] op_sel:[0,1] op_sel_hi:[1,1]
    v_pk_mul_f32 v[176:177], v[176:177], v[114:115] op_sel:[0,1] op_sel_hi:[1,1]
    v_mfma_f32_16x16x32_bf16 v[172:175], a[224:227], a[24:27], v[172:175]
    ds_read_b64_tr_b16 a[246:247], v247 offset:6144
    v_pk_mul_f32 v[178:179], v[178:179], v[114:115] op_sel:[0,1] op_sel_hi:[1,1]
    v_pk_mul_f32 v[208:209], v[208:209], v[114:115] op_sel:[0,1] op_sel_hi:[1,1]
    v_pk_mul_f32 v[210:211], v[210:211], v[114:115] op_sel:[0,1] op_sel_hi:[1,1]
    v_mfma_f32_16x16x32_bf16 v[204:207], a[228:231], a[24:27], v[204:207]
    ds_read_b64_tr_b16 a[248:249], v248 offset:4096
    v_pk_mul_f32 v[240:241], v[240:241], v[114:115] op_sel:[0,1] op_sel_hi:[1,1]
    v_pk_mul_f32 v[242:243], v[242:243], v[114:115] op_sel:[0,1] op_sel_hi:[1,1]
    v_mfma_f32_16x16x32_bf16 v[236:239], a[232:235], a[24:27], v[236:239]
    ds_read_b64_tr_b16 a[250:251], v248 offset:6144
    v_mfma_f32_16x16x32_bf16 v[144:147], a[220:223], a[28:31], v[144:147]
    buffer_load_dwordx4 a[24:27], v17, s[36:39], s16 offen offset:0 sc1
    v_mfma_f32_16x16x32_bf16 v[176:179], a[224:227], a[28:31], v[176:179]
    v_mfma_f32_16x16x32_bf16 v[208:211], a[228:231], a[28:31], v[208:211]
    v_mfma_f32_16x16x32_bf16 v[240:243], a[232:235], a[28:31], v[240:243]
    buffer_load_dwordx4 a[28:31], v17, s[36:39], s16 offen offset:2048 sc1
    v_add_u32 v244, s18, v244
    s_add_u32 s36, s36, 1064960
    s_addc_u32 s37, s37, 0
    s_waitcnt vmcnt(36) lgkmcnt(0)
    v_mfma_f32_16x16x32_bf16 v[116:119], a[236:239], a[32:35], v[116:119]
    v_mfma_f32_16x16x32_bf16 v[148:151], a[240:243], a[32:35], v[148:151]
    v_mfma_f32_16x16x32_bf16 v[180:183], a[244:247], a[32:35], v[180:183]
    v_mfma_f32_16x16x32_bf16 v[212:215], a[248:251], a[32:35], v[212:215]
    v_mfma_f32_16x16x32_bf16 v[120:123], a[236:239], a[36:39], v[120:123]
    buffer_load_dwordx4 a[32:35], v17, s[36:39], 0 offen offset:0 sc1
    v_mfma_f32_16x16x32_bf16 v[152:155], a[240:243], a[36:39], v[152:155]
    v_mfma_f32_16x16x32_bf16 v[184:187], a[244:247], a[36:39], v[184:187]
    v_mfma_f32_16x16x32_bf16 v[216:219], a[248:251], a[36:39], v[216:219]
    v_mfma_f32_16x16x32_bf16 v[124:127], a[236:239], a[40:43], v[124:127]
    buffer_load_dwordx4 a[36:39], v17, s[36:39], 0 offen offset:2048 sc1
    v_mfma_f32_16x16x32_bf16 v[156:159], a[240:243], a[40:43], v[156:159]
    v_mfma_f32_16x16x32_bf16 v[188:191], a[244:247], a[40:43], v[188:191]
    v_mfma_f32_16x16x32_bf16 v[220:223], a[248:251], a[40:43], v[220:223]
    v_mfma_f32_16x16x32_bf16 v[128:131], a[236:239], a[44:47], v[128:131]
    buffer_load_dwordx4 a[40:43], v17, s[36:39], s73 offen offset:0 sc1
    v_mfma_f32_16x16x32_bf16 v[160:163], a[240:243], a[44:47], v[160:163]
    v_mfma_f32_16x16x32_bf16 v[192:195], a[244:247], a[44:47], v[192:195]
    v_mfma_f32_16x16x32_bf16 v[224:227], a[248:251], a[44:47], v[224:227]
    s_waitcnt vmcnt(35)
    v_mfma_f32_16x16x32_bf16 v[132:135], a[236:239], a[48:51], v[132:135]
    buffer_load_dwordx4 a[44:47], v17, s[36:39], s73 offen offset:2048 sc1
    v_mfma_f32_16x16x32_bf16 v[164:167], a[240:243], a[48:51], v[164:167]
    s_waitcnt vmcnt(30)
    v_mfma_f32_16x16x32_bf16 v[196:199], a[244:247], a[48:51], v[196:199]
    ds_read_b64_tr_b16 a[220:221], v245 offset:8192
    v_mfma_f32_16x16x32_bf16 v[228:231], a[248:251], a[48:51], v[228:231]
    ds_read_b64_tr_b16 a[222:223], v245 offset:10240
    v_mfma_f32_16x16x32_bf16 v[136:139], a[236:239], a[52:55], v[136:139]
    buffer_load_dwordx4 a[48:51], v17, s[36:39], s74 offen offset:0 sc1
    v_mfma_f32_16x16x32_bf16 v[168:171], a[240:243], a[52:55], v[168:171]
    ds_read_b64_tr_b16 a[224:225], v246 offset:8192
    v_mfma_f32_16x16x32_bf16 v[200:203], a[244:247], a[52:55], v[200:203]
    ds_read_b64_tr_b16 a[226:227], v246 offset:10240
    v_mfma_f32_16x16x32_bf16 v[232:235], a[248:251], a[52:55], v[232:235]
    ds_read_b64_tr_b16 a[228:229], v247 offset:8192
    v_mfma_f32_16x16x32_bf16 v[140:143], a[236:239], a[56:59], v[140:143]
    buffer_load_dwordx4 a[52:55], v17, s[36:39], s74 offen offset:2048 sc1
    v_mfma_f32_16x16x32_bf16 v[172:175], a[240:243], a[56:59], v[172:175]
    ds_read_b64_tr_b16 a[230:231], v247 offset:10240
    v_mfma_f32_16x16x32_bf16 v[204:207], a[244:247], a[56:59], v[204:207]
    ds_read_b64_tr_b16 a[232:233], v248 offset:8192
    v_mfma_f32_16x16x32_bf16 v[236:239], a[248:251], a[56:59], v[236:239]
    ds_read_b64_tr_b16 a[234:235], v248 offset:10240
    v_mfma_f32_16x16x32_bf16 v[144:147], a[236:239], a[60:63], v[144:147]
    buffer_load_dwordx4 a[56:59], v17, s[36:39], s16 offen offset:0 sc1
    v_mfma_f32_16x16x32_bf16 v[176:179], a[240:243], a[60:63], v[176:179]
    v_mfma_f32_16x16x32_bf16 v[208:211], a[244:247], a[60:63], v[208:211]
    v_mfma_f32_16x16x32_bf16 v[240:243], a[248:251], a[60:63], v[240:243]
    buffer_load_dwordx4 a[60:63], v17, s[36:39], s16 offen offset:2048 sc1
    v_add_u32 v244, s18, v244
    s_add_u32 s36, s36, 1064960
    s_addc_u32 s37, s37, 0
    s_waitcnt vmcnt(32) lgkmcnt(0)
    v_mfma_f32_16x16x32_bf16 v[116:119], a[220:223], a[64:67], v[116:119]
    v_mfma_f32_16x16x32_bf16 v[148:151], a[224:227], a[64:67], v[148:151]
    v_mfma_f32_16x16x32_bf16 v[180:183], a[228:231], a[64:67], v[180:183]
    v_mfma_f32_16x16x32_bf16 v[212:215], a[232:235], a[64:67], v[212:215]
    v_mfma_f32_16x16x32_bf16 v[120:123], a[220:223], a[68:71], v[120:123]
    buffer_load_dwordx4 a[64:67], v17, s[36:39], 0 offen offset:0 sc1
    v_mfma_f32_16x16x32_bf16 v[152:155], a[224:227], a[68:71], v[152:155]
    v_mfma_f32_16x16x32_bf16 v[184:187], a[228:231], a[68:71], v[184:187]
    v_mfma_f32_16x16x32_bf16 v[216:219], a[232:235], a[68:71], v[216:219]
    v_mfma_f32_16x16x32_bf16 v[124:127], a[220:223], a[72:75], v[124:127]
    buffer_load_dwordx4 a[68:71], v17, s[36:39], 0 offen offset:2048 sc1
    v_mfma_f32_16x16x32_bf16 v[156:159], a[224:227], a[72:75], v[156:159]
    v_mfma_f32_16x16x32_bf16 v[188:191], a[228:231], a[72:75], v[188:191]
    v_mfma_f32_16x16x32_bf16 v[220:223], a[232:235], a[72:75], v[220:223]
    v_mfma_f32_16x16x32_bf16 v[128:131], a[220:223], a[76:79], v[128:131]
    buffer_load_dwordx4 a[72:75], v17, s[36:39], s73 offen offset:0 sc1
    v_mfma_f32_16x16x32_bf16 v[160:163], a[224:227], a[76:79], v[160:163]
    v_mfma_f32_16x16x32_bf16 v[192:195], a[228:231], a[76:79], v[192:195]
    v_mfma_f32_16x16x32_bf16 v[224:227], a[232:235], a[76:79], v[224:227]
    s_waitcnt vmcnt(31)
    v_mfma_f32_16x16x32_bf16 v[132:135], a[220:223], a[80:83], v[132:135]
    buffer_load_dwordx4 a[76:79], v17, s[36:39], s73 offen offset:2048 sc1
    v_mfma_f32_16x16x32_bf16 v[164:167], a[224:227], a[80:83], v[164:167]
    s_waitcnt vmcnt(26)
    v_mfma_f32_16x16x32_bf16 v[196:199], a[228:231], a[80:83], v[196:199]
    ds_read_b64_tr_b16 a[236:237], v245 offset:12288
    v_mfma_f32_16x16x32_bf16 v[228:231], a[232:235], a[80:83], v[228:231]
    ds_read_b64_tr_b16 a[238:239], v245 offset:14336
    v_mfma_f32_16x16x32_bf16 v[136:139], a[220:223], a[84:87], v[136:139]
    buffer_load_dwordx4 a[80:83], v17, s[36:39], s74 offen offset:0 sc1
    v_mfma_f32_16x16x32_bf16 v[168:171], a[224:227], a[84:87], v[168:171]
    ds_read_b64_tr_b16 a[240:241], v246 offset:12288
    v_mfma_f32_16x16x32_bf16 v[200:203], a[228:231], a[84:87], v[200:203]
    ds_read_b64_tr_b16 a[242:243], v246 offset:14336
    v_mfma_f32_16x16x32_bf16 v[232:235], a[232:235], a[84:87], v[232:235]
    ds_read_b64_tr_b16 a[244:245], v247 offset:12288
    v_mfma_f32_16x16x32_bf16 v[140:143], a[220:223], a[88:91], v[140:143]
    buffer_load_dwordx4 a[84:87], v17, s[36:39], s74 offen offset:2048 sc1
    v_mfma_f32_16x16x32_bf16 v[172:175], a[224:227], a[88:91], v[172:175]
    ds_read_b64_tr_b16 a[246:247], v247 offset:14336
    v_mfma_f32_16x16x32_bf16 v[204:207], a[228:231], a[88:91], v[204:207]
    ds_read_b64_tr_b16 a[248:249], v248 offset:12288
    v_mfma_f32_16x16x32_bf16 v[236:239], a[232:235], a[88:91], v[236:239]
    ds_read_b64_tr_b16 a[250:251], v248 offset:14336
    v_mfma_f32_16x16x32_bf16 v[144:147], a[220:223], a[92:95], v[144:147]
    buffer_load_dwordx4 a[88:91], v17, s[36:39], s16 offen offset:0 sc1
    v_mfma_f32_16x16x32_bf16 v[176:179], a[224:227], a[92:95], v[176:179]
    v_mfma_f32_16x16x32_bf16 v[208:211], a[228:231], a[92:95], v[208:211]
    v_mfma_f32_16x16x32_bf16 v[240:243], a[232:235], a[92:95], v[240:243]
    buffer_load_dwordx4 a[92:95], v17, s[36:39], s16 offen offset:2048 sc1
    v_add_u32 v244, s18, v244
    s_add_u32 s36, s36, 1064960
    s_addc_u32 s37, s37, 0
    s_waitcnt vmcnt(28) lgkmcnt(0)
    v_mfma_f32_16x16x32_bf16 v[116:119], a[236:239], a[96:99], v[116:119]
    v_mfma_f32_16x16x32_bf16 v[148:151], a[240:243], a[96:99], v[148:151]
    v_mfma_f32_16x16x32_bf16 v[180:183], a[244:247], a[96:99], v[180:183]
    v_mfma_f32_16x16x32_bf16 v[212:215], a[248:251], a[96:99], v[212:215]
    v_mfma_f32_16x16x32_bf16 v[120:123], a[236:239], a[100:103], v[120:123]
    buffer_load_dwordx4 a[96:99], v17, s[36:39], 0 offen offset:0 sc1
    v_mfma_f32_16x16x32_bf16 v[152:155], a[240:243], a[100:103], v[152:155]
    v_mfma_f32_16x16x32_bf16 v[184:187], a[244:247], a[100:103], v[184:187]
    v_mfma_f32_16x16x32_bf16 v[216:219], a[248:251], a[100:103], v[216:219]
    v_mfma_f32_16x16x32_bf16 v[124:127], a[236:239], a[104:107], v[124:127]
    buffer_load_dwordx4 a[100:103], v17, s[36:39], 0 offen offset:2048 sc1
    v_mfma_f32_16x16x32_bf16 v[156:159], a[240:243], a[104:107], v[156:159]
    v_mfma_f32_16x16x32_bf16 v[188:191], a[244:247], a[104:107], v[188:191]
    v_mfma_f32_16x16x32_bf16 v[220:223], a[248:251], a[104:107], v[220:223]
    v_mfma_f32_16x16x32_bf16 v[128:131], a[236:239], a[108:111], v[128:131]
    buffer_load_dwordx4 a[104:107], v17, s[36:39], s73 offen offset:0 sc1
    v_mfma_f32_16x16x32_bf16 v[160:163], a[240:243], a[108:111], v[160:163]
    v_mfma_f32_16x16x32_bf16 v[192:195], a[244:247], a[108:111], v[192:195]
    v_mfma_f32_16x16x32_bf16 v[224:227], a[248:251], a[108:111], v[224:227]
    s_waitcnt vmcnt(27)
    v_mfma_f32_16x16x32_bf16 v[132:135], a[236:239], a[112:115], v[132:135]
    buffer_load_dwordx4 a[108:111], v17, s[36:39], s73 offen offset:2048 sc1
    v_mfma_f32_16x16x32_bf16 v[164:167], a[240:243], a[112:115], v[164:167]
    v_mfma_f32_16x16x32_bf16 v[196:199], a[244:247], a[112:115], v[196:199]
    ds_read_b64_tr_b16 a[220:221], v72 offset:0
    v_mfma_f32_16x16x32_bf16 v[228:231], a[248:251], a[112:115], v[228:231]
    ds_read_b64_tr_b16 a[222:223], v72 offset:2048
    v_mfma_f32_16x16x32_bf16 v[136:139], a[236:239], a[116:119], v[136:139]
    buffer_load_dwordx4 a[112:115], v17, s[36:39], s74 offen offset:0 sc1
    v_mfma_f32_16x16x32_bf16 v[168:171], a[240:243], a[116:119], v[168:171]
    ds_read_b64_tr_b16 a[224:225], v73 offset:0
    v_mfma_f32_16x16x32_bf16 v[200:203], a[244:247], a[116:119], v[200:203]
    ds_read_b64_tr_b16 a[226:227], v73 offset:2048
    v_mfma_f32_16x16x32_bf16 v[232:235], a[248:251], a[116:119], v[232:235]
    ds_read_b64_tr_b16 a[228:229], v74 offset:0
    v_mfma_f32_16x16x32_bf16 v[140:143], a[236:239], a[120:123], v[140:143]
    buffer_load_dwordx4 a[116:119], v17, s[36:39], s74 offen offset:2048 sc1
    v_mfma_f32_16x16x32_bf16 v[172:175], a[240:243], a[120:123], v[172:175]
    ds_read_b64_tr_b16 a[230:231], v74 offset:2048
    v_mfma_f32_16x16x32_bf16 v[204:207], a[244:247], a[120:123], v[204:207]
    ds_read_b64_tr_b16 a[232:233], v75 offset:0
    v_mfma_f32_16x16x32_bf16 v[236:239], a[248:251], a[120:123], v[236:239]
    ds_read_b64_tr_b16 a[234:235], v75 offset:2048
    v_mfma_f32_16x16x32_bf16 v[144:147], a[236:239], a[124:127], v[144:147]
    buffer_load_dwordx4 a[120:123], v17, s[36:39], s16 offen offset:0 sc1
    v_mfma_f32_16x16x32_bf16 v[176:179], a[240:243], a[124:127], v[176:179]
    v_mfma_f32_16x16x32_bf16 v[208:211], a[244:247], a[124:127], v[208:211]
    v_mfma_f32_16x16x32_bf16 v[240:243], a[248:251], a[124:127], v[240:243]
    buffer_load_dwordx4 a[124:127], v17, s[36:39], s16 offen offset:2048 sc1
    v_add_u32 v244, s18, v244
    s_add_u32 s36, s36, 1064960
    s_addc_u32 s37, s37, 0
    s_cmp_eq_u32 s56, 0
    s_cbranch_scc1 P3_FIN0
    s_cmp_eq_u32 s56, 1
    s_cbranch_scc1 P3_FIN1
    s_cmp_eq_u32 s56, 2
    s_cbranch_scc1 P3_FIN2
P3_FIN3:
    s_waitcnt vmcnt(24) lgkmcnt(0)
    v_mfma_f32_16x16x32_bf16 v[116:119], a[220:223], a[0:3], v[116:119]
    ds_read_b64_tr_b16 a[128:129], v72 offset:4096
    ds_read_b64_tr_b16 a[130:131], v72 offset:6144
    v_mfma_f32_16x16x32_bf16 v[148:151], a[224:227], a[0:3], v[148:151]
    ds_read_b64_tr_b16 a[132:133], v73 offset:4096
    v_mfma_f32_16x16x32_bf16 v[180:183], a[228:231], a[0:3], v[180:183]
    ds_read_b64_tr_b16 a[134:135], v73 offset:6144
    v_mfma_f32_16x16x32_bf16 v[212:215], a[232:235], a[0:3], v[212:215]
    ds_read_b64_tr_b16 a[136:137], v74 offset:4096
    v_mfma_f32_16x16x32_bf16 v[120:123], a[220:223], a[4:7], v[120:123]
    ds_read_b64_tr_b16 a[138:139], v74 offset:6144
    v_mfma_f32_16x16x32_bf16 v[152:155], a[224:227], a[4:7], v[152:155]
    ds_read_b64_tr_b16 a[140:141], v75 offset:4096
    ds_read_b64_tr_b16 a[142:143], v75 offset:6144
    v_mfma_f32_16x16x32_bf16 v[184:187], a[228:231], a[4:7], v[184:187]
    ds_read_b64_tr_b16 a[144:145], v68 offset:0
    v_mfma_f32_16x16x32_bf16 v[216:219], a[232:235], a[4:7], v[216:219]
    ds_read_b64_tr_b16 a[146:147], v68 offset:2048
    v_mfma_f32_16x16x32_bf16 v[124:127], a[220:223], a[8:11], v[124:127]
    ds_read_b64_tr_b16 a[148:149], v69 offset:0
    v_mfma_f32_16x16x32_bf16 v[156:159], a[224:227], a[8:11], v[156:159]
    ds_read_b64_tr_b16 a[150:151], v69 offset:2048
    v_mfma_f32_16x16x32_bf16 v[188:191], a[228:231], a[8:11], v[188:191]
    ds_read_b64_tr_b16 a[152:153], v70 offset:0
    ds_read_b64_tr_b16 a[154:155], v70 offset:2048
    v_mfma_f32_16x16x32_bf16 v[220:223], a[232:235], a[8:11], v[220:223]
    ds_read_b64_tr_b16 a[156:157], v71 offset:0
    v_mfma_f32_16x16x32_bf16 v[128:131], a[220:223], a[12:15], v[128:131]
    ds_read_b64_tr_b16 a[158:159], v71 offset:2048
    v_mfma_f32_16x16x32_bf16 v[160:163], a[224:227], a[12:15], v[160:163]
    ds_read_b64_tr_b16 a[160:161], v68 offset:4096
    v_mfma_f32_16x16x32_bf16 v[192:195], a[228:231], a[12:15], v[192:195]
    ds_read_b64_tr_b16 a[162:163], v68 offset:6144
    v_mfma_f32_16x16x32_bf16 v[224:227], a[232:235], a[12:15], v[224:227]
    ds_read_b64_tr_b16 a[164:165], v69 offset:4096
    ds_read_b64_tr_b16 a[166:167], v69 offset:6144
    v_mfma_f32_16x16x32_bf16 v[132:135], a[220:223], a[16:19], v[132:135]
    ds_read_b64_tr_b16 a[168:169], v70 offset:4096
    v_mfma_f32_16x16x32_bf16 v[164:167], a[224:227], a[16:19], v[164:167]
    ds_read_b64_tr_b16 a[170:171], v70 offset:6144
    v_mfma_f32_16x16x32_bf16 v[196:199], a[228:231], a[16:19], v[196:199]
    ds_read_b64_tr_b16 a[172:173], v71 offset:4096
    v_mfma_f32_16x16x32_bf16 v[228:231], a[232:235], a[16:19], v[228:231]
    ds_read_b64_tr_b16 a[174:175], v71 offset:6144
    v_mfma_f32_16x16x32_bf16 v[136:139], a[220:223], a[20:23], v[136:139]
    v_mfma_f32_16x16x32_bf16 v[168:171], a[224:227], a[20:23], v[168:171]
    v_mfma_f32_16x16x32_bf16 v[200:203], a[228:231], a[20:23], v[200:203]
    v_mfma_f32_16x16x32_bf16 v[232:235], a[232:235], a[20:23], v[232:235]
    s_waitcnt vmcnt(0) lgkmcnt(0)
    s_barrier
    v_mfma_f32_16x16x32_bf16 v[116:119], a[128:131], a[32:35], v[116:119]
    v_mfma_f32_16x16x32_bf16 v[148:151], a[132:135], a[32:35], v[148:151]
    v_mfma_f32_16x16x32_bf16 v[180:183], a[136:139], a[32:35], v[180:183]
    v_mfma_f32_16x16x32_bf16 v[212:215], a[140:143], a[32:35], v[212:215]
    v_mfma_f32_16x16x32_bf16 v[116:119], a[144:147], a[64:67], v[116:119]
    v_mfma_f32_16x16x32_bf16 v[148:151], a[148:151], a[64:67], v[148:151]
    v_mfma_f32_16x16x32_bf16 v[180:183], a[152:155], a[64:67], v[180:183]
    v_mfma_f32_16x16x32_bf16 v[212:215], a[156:159], a[64:67], v[212:215]
    v_mfma_f32_16x16x32_bf16 v[116:119], a[160:163], a[96:99], v[116:119]
    v_mfma_f32_16x16x32_bf16 v[148:151], a[164:167], a[96:99], v[148:151]
    v_mfma_f32_16x16x32_bf16 v[180:183], a[168:171], a[96:99], v[180:183]
    v_mfma_f32_16x16x32_bf16 v[212:215], a[172:175], a[96:99], v[212:215]
    v_mfma_f32_16x16x32_bf16 v[120:123], a[128:131], a[36:39], v[120:123]
    v_mfma_f32_16x16x32_bf16 v[152:155], a[132:135], a[36:39], v[152:155]
    v_mfma_f32_16x16x32_bf16 v[184:187], a[136:139], a[36:39], v[184:187]
    v_mfma_f32_16x16x32_bf16 v[216:219], a[140:143], a[36:39], v[216:219]
    v_mfma_f32_16x16x32_bf16 v[120:123], a[144:147], a[68:71], v[120:123]
    v_mfma_f32_16x16x32_bf16 v[152:155], a[148:151], a[68:71], v[152:155]
    ds_write_b128 v2, v[116:119] offset:16384
    v_mfma_f32_16x16x32_bf16 v[184:187], a[152:155], a[68:71], v[184:187]
    v_mfma_f32_16x16x32_bf16 v[216:219], a[156:159], a[68:71], v[216:219]
    v_mfma_f32_16x16x32_bf16 v[120:123], a[160:163], a[100:103], v[120:123]
    ds_write_b128 v2, v[148:151] offset:17408
    v_mfma_f32_16x16x32_bf16 v[152:155], a[164:167], a[100:103], v[152:155]
    v_mfma_f32_16x16x32_bf16 v[184:187], a[168:171], a[100:103], v[184:187]
    v_mfma_f32_16x16x32_bf16 v[216:219], a[172:175], a[100:103], v[216:219]
    ds_write_b128 v2, v[180:183] offset:18432
    v_mfma_f32_16x16x32_bf16 v[124:127], a[128:131], a[40:43], v[124:127]
    v_mfma_f32_16x16x32_bf16 v[156:159], a[132:135], a[40:43], v[156:159]
    v_mfma_f32_16x16x32_bf16 v[188:191], a[136:139], a[40:43], v[188:191]
    ds_write_b128 v2, v[212:215] offset:19456
    v_mfma_f32_16x16x32_bf16 v[220:223], a[140:143], a[40:43], v[220:223]
    v_mfma_f32_16x16x32_bf16 v[124:127], a[144:147], a[72:75], v[124:127]
    v_mfma_f32_16x16x32_bf16 v[156:159], a[148:151], a[72:75], v[156:159]
    ds_write_b128 v2, v[120:123] offset:20480
    v_mfma_f32_16x16x32_bf16 v[188:191], a[152:155], a[72:75], v[188:191]
    v_mfma_f32_16x16x32_bf16 v[220:223], a[156:159], a[72:75], v[220:223]
    v_mfma_f32_16x16x32_bf16 v[124:127], a[160:163], a[104:107], v[124:127]
    ds_write_b128 v2, v[152:155] offset:21504
    v_mfma_f32_16x16x32_bf16 v[156:159], a[164:167], a[104:107], v[156:159]
    v_mfma_f32_16x16x32_bf16 v[188:191], a[168:171], a[104:107], v[188:191]
    v_mfma_f32_16x16x32_bf16 v[220:223], a[172:175], a[104:107], v[220:223]
    ds_write_b128 v2, v[184:187] offset:22528
    v_mfma_f32_16x16x32_bf16 v[128:131], a[128:131], a[44:47], v[128:131]
    v_mfma_f32_16x16x32_bf16 v[160:163], a[132:135], a[44:47], v[160:163]
    v_mfma_f32_16x16x32_bf16 v[192:195], a[136:139], a[44:47], v[192:195]
    ds_write_b128 v2, v[216:219] offset:23552
    v_mfma_f32_16x16x32_bf16 v[224:227], a[140:143], a[44:47], v[224:227]
    v_mfma_f32_16x16x32_bf16 v[128:131], a[144:147], a[76:79], v[128:131]
    v_mfma_f32_16x16x32_bf16 v[160:163], a[148:151], a[76:79], v[160:163]
    ds_write_b128 v2, v[124:127] offset:32768
    v_mfma_f32_16x16x32_bf16 v[192:195], a[152:155], a[76:79], v[192:195]
    v_mfma_f32_16x16x32_bf16 v[224:227], a[156:159], a[76:79], v[224:227]
    v_mfma_f32_16x16x32_bf16 v[128:131], a[160:163], a[108:111], v[128:131]
    ds_write_b128 v2, v[156:159] offset:33792
    v_mfma_f32_16x16x32_bf16 v[160:163], a[164:167], a[108:111], v[160:163]
    v_mfma_f32_16x16x32_bf16 v[192:195], a[168:171], a[108:111], v[192:195]
    v_mfma_f32_16x16x32_bf16 v[224:227], a[172:175], a[108:111], v[224:227]
    ds_write_b128 v2, v[188:191] offset:34816
    v_mfma_f32_16x16x32_bf16 v[132:135], a[128:131], a[48:51], v[132:135]
    v_mfma_f32_16x16x32_bf16 v[164:167], a[132:135], a[48:51], v[164:167]
    v_mfma_f32_16x16x32_bf16 v[196:199], a[136:139], a[48:51], v[196:199]
    ds_write_b128 v2, v[220:223] offset:35840
    v_mfma_f32_16x16x32_bf16 v[228:231], a[140:143], a[48:51], v[228:231]
    v_mfma_f32_16x16x32_bf16 v[132:135], a[144:147], a[80:83], v[132:135]
    v_mfma_f32_16x16x32_bf16 v[164:167], a[148:151], a[80:83], v[164:167]
    ds_write_b128 v2, v[128:131] offset:36864
    v_mfma_f32_16x16x32_bf16 v[196:199], a[152:155], a[80:83], v[196:199]
    v_mfma_f32_16x16x32_bf16 v[228:231], a[156:159], a[80:83], v[228:231]
    v_mfma_f32_16x16x32_bf16 v[132:135], a[160:163], a[112:115], v[132:135]
    ds_write_b128 v2, v[160:163] offset:37888
    v_mfma_f32_16x16x32_bf16 v[164:167], a[164:167], a[112:115], v[164:167]
    v_mfma_f32_16x16x32_bf16 v[196:199], a[168:171], a[112:115], v[196:199]
    v_mfma_f32_16x16x32_bf16 v[228:231], a[172:175], a[112:115], v[228:231]
    ds_write_b128 v2, v[192:195] offset:38912
    v_mfma_f32_16x16x32_bf16 v[136:139], a[128:131], a[52:55], v[136:139]
    v_mfma_f32_16x16x32_bf16 v[168:171], a[132:135], a[52:55], v[168:171]
    v_mfma_f32_16x16x32_bf16 v[200:203], a[136:139], a[52:55], v[200:203]
    ds_write_b128 v2, v[224:227] offset:39936
    v_mfma_f32_16x16x32_bf16 v[232:235], a[140:143], a[52:55], v[232:235]
    v_mfma_f32_16x16x32_bf16 v[136:139], a[144:147], a[84:87], v[136:139]
    v_mfma_f32_16x16x32_bf16 v[168:171], a[148:151], a[84:87], v[168:171]
    ds_write_b128 v2, v[132:135] offset:49152
    v_mfma_f32_16x16x32_bf16 v[200:203], a[152:155], a[84:87], v[200:203]
    v_mfma_f32_16x16x32_bf16 v[232:235], a[156:159], a[84:87], v[232:235]
    v_mfma_f32_16x16x32_bf16 v[136:139], a[160:163], a[116:119], v[136:139]
    ds_write_b128 v2, v[164:167] offset:50176
    v_mfma_f32_16x16x32_bf16 v[168:171], a[164:167], a[116:119], v[168:171]
    v_mfma_f32_16x16x32_bf16 v[200:203], a[168:171], a[116:119], v[200:203]
    v_mfma_f32_16x16x32_bf16 v[232:235], a[172:175], a[116:119], v[232:235]
    ds_write_b128 v2, v[196:199] offset:51200
    v_mfma_f32_16x16x32_bf16 v[140:143], a[220:223], a[24:27], v[140:143]
    v_mfma_f32_16x16x32_bf16 v[172:175], a[224:227], a[24:27], v[172:175]
    v_mfma_f32_16x16x32_bf16 v[204:207], a[228:231], a[24:27], v[204:207]
    ds_write_b128 v2, v[228:231] offset:52224
    v_mfma_f32_16x16x32_bf16 v[236:239], a[232:235], a[24:27], v[236:239]
    v_mfma_f32_16x16x32_bf16 v[140:143], a[128:131], a[56:59], v[140:143]
    v_mfma_f32_16x16x32_bf16 v[172:175], a[132:135], a[56:59], v[172:175]
    ds_write_b128 v2, v[136:139] offset:53248
    v_mfma_f32_16x16x32_bf16 v[204:207], a[136:139], a[56:59], v[204:207]
    ds_write_b128 v2, v[168:171] offset:54272
    v_mfma_f32_16x16x32_bf16 v[236:239], a[140:143], a[56:59], v[236:239]
    ds_write_b128 v2, v[200:203] offset:55296
    v_mfma_f32_16x16x32_bf16 v[140:143], a[144:147], a[88:91], v[140:143]
    ds_write_b128 v2, v[232:235] offset:56320
    v_mfma_f32_16x16x32_bf16 v[172:175], a[148:151], a[88:91], v[172:175]
    v_mfma_f32_16x16x32_bf16 v[204:207], a[152:155], a[88:91], v[204:207]
    v_mfma_f32_16x16x32_bf16 v[236:239], a[156:159], a[88:91], v[236:239]
    s_waitcnt lgkmcnt(0)
    s_barrier
    ds_read_b128 v[116:119], v8 offset:8192
    ds_read_b128 v[148:151], v8 offset:9216
    v_mfma_f32_16x16x32_bf16 v[140:143], a[160:163], a[120:123], v[140:143]
    ds_read_b128 v[180:183], v8 offset:10240
    v_mfma_f32_16x16x32_bf16 v[172:175], a[164:167], a[120:123], v[172:175]
    ds_read_b128 v[212:215], v8 offset:11264
    v_mfma_f32_16x16x32_bf16 v[204:207], a[168:171], a[120:123], v[204:207]
    ds_read_b128 v[120:123], v8 offset:12288
    ds_read_b128 v[152:155], v8 offset:13312
    v_mfma_f32_16x16x32_bf16 v[236:239], a[172:175], a[120:123], v[236:239]
    ds_read_b128 v[184:187], v8 offset:14336
    v_mfma_f32_16x16x32_bf16 v[144:147], a[220:223], a[28:31], v[144:147]
    ds_read_b128 v[216:219], v8 offset:15360
    v_mfma_f32_16x16x32_bf16 v[176:179], a[224:227], a[28:31], v[176:179]
    ds_read_b128 v[124:127], v8 offset:16384
    ds_read_b128 v[156:159], v8 offset:17408
    v_mfma_f32_16x16x32_bf16 v[208:211], a[228:231], a[28:31], v[208:211]
    ds_read_b128 v[188:191], v8 offset:18432
    v_mfma_f32_16x16x32_bf16 v[240:243], a[232:235], a[28:31], v[240:243]
    ds_read_b128 v[220:223], v8 offset:19456
    v_mfma_f32_16x16x32_bf16 v[144:147], a[128:131], a[60:63], v[144:147]
    ds_read_b128 v[128:131], v8 offset:20480
    ds_read_b128 v[160:163], v8 offset:21504
    v_mfma_f32_16x16x32_bf16 v[176:179], a[132:135], a[60:63], v[176:179]
    ds_read_b128 v[192:195], v8 offset:22528
    v_mfma_f32_16x16x32_bf16 v[208:211], a[136:139], a[60:63], v[208:211]
    ds_read_b128 v[224:227], v8 offset:23552
    v_mfma_f32_16x16x32_bf16 v[240:243], a[140:143], a[60:63], v[240:243]
    ds_read_b128 v[132:135], v8 offset:24576
    ds_read_b128 v[164:167], v8 offset:25600
    v_mfma_f32_16x16x32_bf16 v[144:147], a[144:147], a[92:95], v[144:147]
    ds_read_b128 v[196:199], v8 offset:26624
    v_mfma_f32_16x16x32_bf16 v[176:179], a[148:151], a[92:95], v[176:179]
    ds_read_b128 v[228:231], v8 offset:27648
    v_mfma_f32_16x16x32_bf16 v[208:211], a[152:155], a[92:95], v[208:211]
    ds_read_b128 v[136:139], v8 offset:28672
    ds_read_b128 v[168:171], v8 offset:29696
    v_mfma_f32_16x16x32_bf16 v[240:243], a[156:159], a[92:95], v[240:243]
    ds_read_b128 v[200:203], v8 offset:30720
    v_mfma_f32_16x16x32_bf16 v[144:147], a[160:163], a[124:127], v[144:147]
    ds_read_b128 v[232:235], v8 offset:31744
    v_mfma_f32_16x16x32_bf16 v[176:179], a[164:167], a[124:127], v[176:179]
    v_mfma_f32_16x16x32_bf16 v[208:211], a[168:171], a[124:127], v[208:211]
    v_mfma_f32_16x16x32_bf16 v[240:243], a[172:175], a[124:127], v[240:243]
    s_nop 3
    s_waitcnt lgkmcnt(15)
    v_pk_add_f32 v[140:141], v[140:141], v[116:117]
    v_pk_add_f32 v[142:143], v[142:143], v[118:119]
    v_pk_add_f32 v[172:173], v[172:173], v[148:149]
    v_pk_add_f32 v[174:175], v[174:175], v[150:151]
    v_pk_add_f32 v[204:205], v[204:205], v[180:181]
    v_pk_add_f32 v[206:207], v[206:207], v[182:183]
    v_pk_add_f32 v[236:237], v[236:237], v[212:213]
    v_pk_add_f32 v[238:239], v[238:239], v[214:215]
    v_pk_add_f32 v[144:145], v[144:145], v[120:121]
    v_pk_add_f32 v[146:147], v[146:147], v[122:123]
    v_pk_add_f32 v[176:177], v[176:177], v[152:153]
    v_pk_add_f32 v[178:179], v[178:179], v[154:155]
    v_pk_add_f32 v[208:209], v[208:209], v[184:185]
    v_pk_add_f32 v[210:211], v[210:211], v[186:187]
    v_pk_add_f32 v[240:241], v[240:241], v[216:217]
    v_pk_add_f32 v[242:243], v[242:243], v[218:219]
    s_waitcnt lgkmcnt(8)
    v_pk_add_f32 v[140:141], v[140:141], v[124:125]
    v_pk_add_f32 v[142:143], v[142:143], v[126:127]
    v_pk_add_f32 v[172:173], v[172:173], v[156:157]
    v_pk_add_f32 v[174:175], v[174:175], v[158:159]
    v_pk_add_f32 v[204:205], v[204:205], v[188:189]
    v_pk_add_f32 v[206:207], v[206:207], v[190:191]
    v_pk_add_f32 v[236:237], v[236:237], v[220:221]
    v_pk_add_f32 v[238:239], v[238:239], v[222:223]
    v_pk_add_f32 v[144:145], v[144:145], v[128:129]
    v_pk_add_f32 v[146:147], v[146:147], v[130:131]
    v_pk_add_f32 v[176:177], v[176:177], v[160:161]
    v_pk_add_f32 v[178:179], v[178:179], v[162:163]
    v_pk_add_f32 v[208:209], v[208:209], v[192:193]
    v_pk_add_f32 v[210:211], v[210:211], v[194:195]
    v_pk_add_f32 v[240:241], v[240:241], v[224:225]
    v_pk_add_f32 v[242:243], v[242:243], v[226:227]
    s_waitcnt lgkmcnt(0)
    v_pk_add_f32 v[140:141], v[140:141], v[132:133]
    v_pk_add_f32 v[142:143], v[142:143], v[134:135]
    v_pk_add_f32 v[172:173], v[172:173], v[164:165]
    v_pk_add_f32 v[174:175], v[174:175], v[166:167]
    v_pk_add_f32 v[204:205], v[204:205], v[196:197]
    v_pk_add_f32 v[206:207], v[206:207], v[198:199]
    v_pk_add_f32 v[236:237], v[236:237], v[228:229]
    v_pk_add_f32 v[238:239], v[238:239], v[230:231]
    v_pk_add_f32 v[144:145], v[144:145], v[136:137]
    v_pk_add_f32 v[146:147], v[146:147], v[138:139]
    v_pk_add_f32 v[176:177], v[176:177], v[168:169]
    v_pk_add_f32 v[178:179], v[178:179], v[170:171]
    v_pk_add_f32 v[208:209], v[208:209], v[200:201]
    v_pk_add_f32 v[210:211], v[210:211], v[202:203]
    v_pk_add_f32 v[240:241], v[240:241], v[232:233]
    v_pk_add_f32 v[242:243], v[242:243], v[234:235]
    v_cvt_pk_bf16_f32 v20, v140, v141
    v_cvt_pk_bf16_f32 v21, v142, v143
    v_cvt_pk_bf16_f32 v22, v172, v173
    v_cvt_pk_bf16_f32 v23, v174, v175
    s_nop 1
    v_permlane16_swap_b32 v20, v22
    v_permlane16_swap_b32 v21, v23
    buffer_store_dwordx4 v[20:23], v9, s[48:51], s58 offen offset:0
    v_cvt_pk_bf16_f32 v24, v204, v205
    v_cvt_pk_bf16_f32 v25, v206, v207
    v_cvt_pk_bf16_f32 v26, v236, v237
    v_cvt_pk_bf16_f32 v27, v238, v239
    s_nop 1
    v_permlane16_swap_b32 v24, v26
    v_permlane16_swap_b32 v25, v27
    buffer_store_dwordx4 v[24:27], v9, s[48:51], s58 offen offset:64
    v_cvt_pk_bf16_f32 v28, v144, v145
    v_cvt_pk_bf16_f32 v29, v146, v147
    v_cvt_pk_bf16_f32 v30, v176, v177
    v_cvt_pk_bf16_f32 v31, v178, v179
    s_nop 1
    v_permlane16_swap_b32 v28, v30
    v_permlane16_swap_b32 v29, v31
    buffer_store_dwordx4 v[28:31], v9, s[48:51], s59 offen offset:0
    v_cvt_pk_bf16_f32 v32, v208, v209
    v_cvt_pk_bf16_f32 v33, v210, v211
    v_cvt_pk_bf16_f32 v34, v240, v241
    v_cvt_pk_bf16_f32 v35, v242, v243
    s_nop 1
    v_permlane16_swap_b32 v32, v34
    v_permlane16_swap_b32 v33, v35
    buffer_store_dwordx4 v[32:35], v9, s[48:51], s59 offen offset:64
    s_endpgm
P3_FIN0:
    s_waitcnt vmcnt(24) lgkmcnt(0)
    v_mfma_f32_16x16x32_bf16 v[124:127], a[220:223], a[8:11], v[124:127]
    ds_read_b64_tr_b16 a[128:129], v72 offset:4096
    ds_read_b64_tr_b16 a[130:131], v72 offset:6144
    v_mfma_f32_16x16x32_bf16 v[156:159], a[224:227], a[8:11], v[156:159]
    ds_read_b64_tr_b16 a[132:133], v73 offset:4096
    v_mfma_f32_16x16x32_bf16 v[188:191], a[228:231], a[8:11], v[188:191]
    ds_read_b64_tr_b16 a[134:135], v73 offset:6144
    v_mfma_f32_16x16x32_bf16 v[220:223], a[232:235], a[8:11], v[220:223]
    ds_read_b64_tr_b16 a[136:137], v74 offset:4096
    v_mfma_f32_16x16x32_bf16 v[128:131], a[220:223], a[12:15], v[128:131]
    ds_read_b64_tr_b16 a[138:139], v74 offset:6144
    v_mfma_f32_16x16x32_bf16 v[160:163], a[224:227], a[12:15], v[160:163]
    ds_read_b64_tr_b16 a[140:141], v75 offset:4096
    ds_read_b64_tr_b16 a[142:143], v75 offset:6144
    v_mfma_f32_16x16x32_bf16 v[192:195], a[228:231], a[12:15], v[192:195]
    ds_read_b64_tr_b16 a[144:145], v68 offset:0
    v_mfma_f32_16x16x32_bf16 v[224:227], a[232:235], a[12:15], v[224:227]
    ds_read_b64_tr_b16 a[146:147], v68 offset:2048
    v_mfma_f32_16x16x32_bf16 v[132:135], a[220:223], a[16:19], v[132:135]
    ds_read_b64_tr_b16 a[148:149], v69 offset:0
    v_mfma_f32_16x16x32_bf16 v[164:167], a[224:227], a[16:19], v[164:167]
    ds_read_b64_tr_b16 a[150:151], v69 offset:2048
    v_mfma_f32_16x16x32_bf16 v[196:199], a[228:231], a[16:19], v[196:199]
    ds_read_b64_tr_b16 a[152:153], v70 offset:0
    ds_read_b64_tr_b16 a[154:155], v70 offset:2048
    v_mfma_f32_16x16x32_bf16 v[228:231], a[232:235], a[16:19], v[228:231]
    ds_read_b64_tr_b16 a[156:157], v71 offset:0
    v_mfma_f32_16x16x32_bf16 v[136:139], a[220:223], a[20:23], v[136:139]
    ds_read_b64_tr_b16 a[158:159], v71 offset:2048
    v_mfma_f32_16x16x32_bf16 v[168:171], a[224:227], a[20:23], v[168:171]
    ds_read_b64_tr_b16 a[160:161], v68 offset:4096
    v_mfma_f32_16x16x32_bf16 v[200:203], a[228:231], a[20:23], v[200:203]
    ds_read_b64_tr_b16 a[162:163], v68 offset:6144
    v_mfma_f32_16x16x32_bf16 v[232:235], a[232:235], a[20:23], v[232:235]
    ds_read_b64_tr_b16 a[164:165], v69 offset:4096
    ds_read_b64_tr_b16 a[166:167], v69 offset:6144
    v_mfma_f32_16x16x32_bf16 v[140:143], a[220:223], a[24:27], v[140:143]
    ds_read_b64_tr_b16 a[168:169], v70 offset:4096
    v_mfma_f32_16x16x32_bf16 v[172:175], a[224:227], a[24:27], v[172:175]
    ds_read_b64_tr_b16 a[170:171], v70 offset:6144
    v_mfma_f32_16x16x32_bf16 v[204:207], a[228:231], a[24:27], v[204:207]
    ds_read_b64_tr_b16 a[172:173], v71 offset:4096
    v_mfma_f32_16x16x32_bf16 v[236:239], a[232:235], a[24:27], v[236:239]
    ds_read_b64_tr_b16 a[174:175], v71 offset:6144
    v_mfma_f32_16x16x32_bf16 v[144:147], a[220:223], a[28:31], v[144:147]
    v_mfma_f32_16x16x32_bf16 v[176:179], a[224:227], a[28:31], v[176:179]
    v_mfma_f32_16x16x32_bf16 v[208:211], a[228:231], a[28:31], v[208:211]
    v_mfma_f32_16x16x32_bf16 v[240:243], a[232:235], a[28:31], v[240:243]
    s_waitcnt vmcnt(0) lgkmcnt(0)
    s_barrier
    v_mfma_f32_16x16x32_bf16 v[124:127], a[128:131], a[40:43], v[124:127]
    v_mfma_f32_16x16x32_bf16 v[156:159], a[132:135], a[40:43], v[156:159]
    v_mfma_f32_16x16x32_bf16 v[188:191], a[136:139], a[40:43], v[188:191]
    v_mfma_f32_16x16x32_bf16 v[220:223], a[140:143], a[40:43], v[220:223]
    v_mfma_f32_16x16x32_bf16 v[124:127], a[144:147], a[72:75], v[124:127]
    v_mfma_f32_16x16x32_bf16 v[156:159], a[148:151], a[72:75], v[156:159]
    v_mfma_f32_16x16x32_bf16 v[188:191], a[152:155], a[72:75], v[188:191]
    v_mfma_f32_16x16x32_bf16 v[220:223], a[156:159], a[72:75], v[220:223]
    v_mfma_f32_16x16x32_bf16 v[124:127], a[160:163], a[104:107], v[124:127]
    v_mfma_f32_16x16x32_bf16 v[156:159], a[164:167], a[104:107], v[156:159]
    v_mfma_f32_16x16x32_bf16 v[188:191], a[168:171], a[104:107], v[188:191]
    v_mfma_f32_16x16x32_bf16 v[220:223], a[172:175], a[104:107], v[220:223]
    v_mfma_f32_16x16x32_bf16 v[128:131], a[128:131], a[44:47], v[128:131]
    v_mfma_f32_16x16x32_bf16 v[160:163], a[132:135], a[44:47], v[160:163]
    v_mfma_f32_16x16x32_bf16 v[192:195], a[136:139], a[44:47], v[192:195]
    v_mfma_f32_16x16x32_bf16 v[224:227], a[140:143], a[44:47], v[224:227]
    v_mfma_f32_16x16x32_bf16 v[128:131], a[144:147], a[76:79], v[128:131]
    v_mfma_f32_16x16x32_bf16 v[160:163], a[148:151], a[76:79], v[160:163]
    ds_write_b128 v2, v[124:127] offset:40960
    v_mfma_f32_16x16x32_bf16 v[192:195], a[152:155], a[76:79], v[192:195]
    v_mfma_f32_16x16x32_bf16 v[224:227], a[156:159], a[76:79], v[224:227]
    v_mfma_f32_16x16x32_bf16 v[128:131], a[160:163], a[108:111], v[128:131]
    ds_write_b128 v2, v[156:159] offset:41984
    v_mfma_f32_16x16x32_bf16 v[160:163], a[164:167], a[108:111], v[160:163]
    v_mfma_f32_16x16x32_bf16 v[192:195], a[168:171], a[108:111], v[192:195]
    v_mfma_f32_16x16x32_bf16 v[224:227], a[172:175], a[108:111], v[224:227]
    ds_write_b128 v2, v[188:191] offset:43008
    v_mfma_f32_16x16x32_bf16 v[132:135], a[128:131], a[48:51], v[132:135]
    v_mfma_f32_16x16x32_bf16 v[164:167], a[132:135], a[48:51], v[164:167]
    v_mfma_f32_16x16x32_bf16 v[196:199], a[136:139], a[48:51], v[196:199]
    ds_write_b128 v2, v[220:223] offset:44032
    v_mfma_f32_16x16x32_bf16 v[228:231], a[140:143], a[48:51], v[228:231]
    v_mfma_f32_16x16x32_bf16 v[132:135], a[144:147], a[80:83], v[132:135]
    v_mfma_f32_16x16x32_bf16 v[164:167], a[148:151], a[80:83], v[164:167]
    ds_write_b128 v2, v[128:131] offset:45056
    v_mfma_f32_16x16x32_bf16 v[196:199], a[152:155], a[80:83], v[196:199]
    v_mfma_f32_16x16x32_bf16 v[228:231], a[156:159], a[80:83], v[228:231]
    v_mfma_f32_16x16x32_bf16 v[132:135], a[160:163], a[112:115], v[132:135]
    ds_write_b128 v2, v[160:163] offset:46080
    v_mfma_f32_16x16x32_bf16 v[164:167], a[164:167], a[112:115], v[164:167]
    v_mfma_f32_16x16x32_bf16 v[196:199], a[168:171], a[112:115], v[196:199]
    v_mfma_f32_16x16x32_bf16 v[228:231], a[172:175], a[112:115], v[228:231]
    ds_write_b128 v2, v[192:195] offset:47104
    v_mfma_f32_16x16x32_bf16 v[136:139], a[128:131], a[52:55], v[136:139]
    v_mfma_f32_16x16x32_bf16 v[168:171], a[132:135], a[52:55], v[168:171]
    v_mfma_f32_16x16x32_bf16 v[200:203], a[136:139], a[52:55], v[200:203]
    ds_write_b128 v2, v[224:227] offset:48128
    v_mfma_f32_16x16x32_bf16 v[232:235], a[140:143], a[52:55], v[232:235]
    v_mfma_f32_16x16x32_bf16 v[136:139], a[144:147], a[84:87], v[136:139]
    v_mfma_f32_16x16x32_bf16 v[168:171], a[148:151], a[84:87], v[168:171]
    ds_write_b128 v2, v[132:135] offset:57344
    v_mfma_f32_16x16x32_bf16 v[200:203], a[152:155], a[84:87], v[200:203]
    v_mfma_f32_16x16x32_bf16 v[232:235], a[156:159], a[84:87], v[232:235]
    v_mfma_f32_16x16x32_bf16 v[136:139], a[160:163], a[116:119], v[136:139]
    ds_write_b128 v2, v[164:167] offset:58368
    v_mfma_f32_16x16x32_bf16 v[168:171], a[164:167], a[116:119], v[168:171]
    v_mfma_f32_16x16x32_bf16 v[200:203], a[168:171], a[116:119], v[200:203]
    v_mfma_f32_16x16x32_bf16 v[232:235], a[172:175], a[116:119], v[232:235]
    ds_write_b128 v2, v[196:199] offset:59392
    v_mfma_f32_16x16x32_bf16 v[140:143], a[128:131], a[56:59], v[140:143]
    v_mfma_f32_16x16x32_bf16 v[172:175], a[132:135], a[56:59], v[172:175]
    v_mfma_f32_16x16x32_bf16 v[204:207], a[136:139], a[56:59], v[204:207]
    ds_write_b128 v2, v[228:231] offset:60416
    v_mfma_f32_16x16x32_bf16 v[236:239], a[140:143], a[56:59], v[236:239]
    v_mfma_f32_16x16x32_bf16 v[140:143], a[144:147], a[88:91], v[140:143]
    v_mfma_f32_16x16x32_bf16 v[172:175], a[148:151], a[88:91], v[172:175]
    ds_write_b128 v2, v[136:139] offset:61440
    v_mfma_f32_16x16x32_bf16 v[204:207], a[152:155], a[88:91], v[204:207]
    v_mfma_f32_16x16x32_bf16 v[236:239], a[156:159], a[88:91], v[236:239]
    v_mfma_f32_16x16x32_bf16 v[140:143], a[160:163], a[120:123], v[140:143]
    ds_write_b128 v2, v[168:171] offset:62464
    v_mfma_f32_16x16x32_bf16 v[172:175], a[164:167], a[120:123], v[172:175]
    v_mfma_f32_16x16x32_bf16 v[204:207], a[168:171], a[120:123], v[204:207]
    v_mfma_f32_16x16x32_bf16 v[236:239], a[172:175], a[120:123], v[236:239]
    ds_write_b128 v2, v[200:203] offset:63488
    v_mfma_f32_16x16x32_bf16 v[144:147], a[128:131], a[60:63], v[144:147]
    v_mfma_f32_16x16x32_bf16 v[176:179], a[132:135], a[60:63], v[176:179]
    v_mfma_f32_16x16x32_bf16 v[208:211], a[136:139], a[60:63], v[208:211]
    ds_write_b128 v2, v[232:235] offset:64512
    v_mfma_f32_16x16x32_bf16 v[240:243], a[140:143], a[60:63], v[240:243]
    v_mfma_f32_16x16x32_bf16 v[144:147], a[144:147], a[92:95], v[144:147]
    v_mfma_f32_16x16x32_bf16 v[176:179], a[148:151], a[92:95], v[176:179]
    ds_write_b128 v8, v[140:143] offset:8192
    v_mfma_f32_16x16x32_bf16 v[208:211], a[152:155], a[92:95], v[208:211]
    v_mfma_f32_16x16x32_bf16 v[240:243], a[156:159], a[92:95], v[240:243]
    v_mfma_f32_16x16x32_bf16 v[144:147], a[160:163], a[124:127], v[144:147]
    ds_write_b128 v8, v[172:175] offset:9216
    v_mfma_f32_16x16x32_bf16 v[176:179], a[164:167], a[124:127], v[176:179]
    v_mfma_f32_16x16x32_bf16 v[208:211], a[168:171], a[124:127], v[208:211]
    v_mfma_f32_16x16x32_bf16 v[240:243], a[172:175], a[124:127], v[240:243]
    ds_write_b128 v8, v[204:207] offset:10240
    v_mfma_f32_16x16x32_bf16 v[116:119], a[220:223], a[0:3], v[116:119]
    v_mfma_f32_16x16x32_bf16 v[148:151], a[224:227], a[0:3], v[148:151]
    v_mfma_f32_16x16x32_bf16 v[180:183], a[228:231], a[0:3], v[180:183]
    ds_write_b128 v8, v[236:239] offset:11264
    v_mfma_f32_16x16x32_bf16 v[212:215], a[232:235], a[0:3], v[212:215]
    v_mfma_f32_16x16x32_bf16 v[116:119], a[128:131], a[32:35], v[116:119]
    v_mfma_f32_16x16x32_bf16 v[148:151], a[132:135], a[32:35], v[148:151]
    ds_write_b128 v8, v[144:147] offset:12288
    v_mfma_f32_16x16x32_bf16 v[180:183], a[136:139], a[32:35], v[180:183]
    ds_write_b128 v8, v[176:179] offset:13312
    v_mfma_f32_16x16x32_bf16 v[212:215], a[140:143], a[32:35], v[212:215]
    ds_write_b128 v8, v[208:211] offset:14336
    v_mfma_f32_16x16x32_bf16 v[116:119], a[144:147], a[64:67], v[116:119]
    ds_write_b128 v8, v[240:243] offset:15360
    v_mfma_f32_16x16x32_bf16 v[148:151], a[148:151], a[64:67], v[148:151]
    v_mfma_f32_16x16x32_bf16 v[180:183], a[152:155], a[64:67], v[180:183]
    v_mfma_f32_16x16x32_bf16 v[212:215], a[156:159], a[64:67], v[212:215]
    s_waitcnt lgkmcnt(0)
    s_barrier
    ds_read_b128 v[124:127], v2 offset:0
    ds_read_b128 v[156:159], v2 offset:1024
    v_mfma_f32_16x16x32_bf16 v[116:119], a[160:163], a[96:99], v[116:119]
    ds_read_b128 v[188:191], v2 offset:2048
    v_mfma_f32_16x16x32_bf16 v[148:151], a[164:167], a[96:99], v[148:151]
    ds_read_b128 v[220:223], v2 offset:3072
    v_mfma_f32_16x16x32_bf16 v[180:183], a[168:171], a[96:99], v[180:183]
    ds_read_b128 v[128:131], v2 offset:4096
    ds_read_b128 v[160:163], v2 offset:5120
    v_mfma_f32_16x16x32_bf16 v[212:215], a[172:175], a[96:99], v[212:215]
    ds_read_b128 v[192:195], v2 offset:6144
    v_mfma_f32_16x16x32_bf16 v[120:123], a[220:223], a[4:7], v[120:123]
    ds_read_b128 v[224:227], v2 offset:7168
    v_mfma_f32_16x16x32_bf16 v[152:155], a[224:227], a[4:7], v[152:155]
    ds_read_b128 v[132:135], v2 offset:8192
    ds_read_b128 v[164:167], v2 offset:9216
    v_mfma_f32_16x16x32_bf16 v[184:187], a[228:231], a[4:7], v[184:187]
    ds_read_b128 v[196:199], v2 offset:10240
    v_mfma_f32_16x16x32_bf16 v[216:219], a[232:235], a[4:7], v[216:219]
    ds_read_b128 v[228:231], v2 offset:11264
    v_mfma_f32_16x16x32_bf16 v[120:123], a[128:131], a[36:39], v[120:123]
    ds_read_b128 v[136:139], v2 offset:12288
    ds_read_b128 v[168:171], v2 offset:13312
    v_mfma_f32_16x16x32_bf16 v[152:155], a[132:135], a[36:39], v[152:155]
    ds_read_b128 v[200:203], v2 offset:14336
    v_mfma_f32_16x16x32_bf16 v[184:187], a[136:139], a[36:39], v[184:187]
    ds_read_b128 v[232:235], v2 offset:15360
    v_mfma_f32_16x16x32_bf16 v[216:219], a[140:143], a[36:39], v[216:219]
    ds_read_b128 v[140:143], v2 offset:16384
    ds_read_b128 v[172:175], v2 offset:17408
    v_mfma_f32_16x16x32_bf16 v[120:123], a[144:147], a[68:71], v[120:123]
    ds_read_b128 v[204:207], v2 offset:18432
    v_mfma_f32_16x16x32_bf16 v[152:155], a[148:151], a[68:71], v[152:155]
    ds_read_b128 v[236:239], v2 offset:19456
    v_mfma_f32_16x16x32_bf16 v[184:187], a[152:155], a[68:71], v[184:187]
    ds_read_b128 v[144:147], v2 offset:20480
    ds_read_b128 v[176:179], v2 offset:21504
    v_mfma_f32_16x16x32_bf16 v[216:219], a[156:159], a[68:71], v[216:219]
    ds_read_b128 v[208:211], v2 offset:22528
    v_mfma_f32_16x16x32_bf16 v[120:123], a[160:163], a[100:103], v[120:123]
    ds_read_b128 v[240:243], v2 offset:23552
    v_mfma_f32_16x16x32_bf16 v[152:155], a[164:167], a[100:103], v[152:155]
    v_mfma_f32_16x16x32_bf16 v[184:187], a[168:171], a[100:103], v[184:187]
    v_mfma_f32_16x16x32_bf16 v[216:219], a[172:175], a[100:103], v[216:219]
    s_nop 3
    s_waitcnt lgkmcnt(15)
    v_pk_add_f32 v[116:117], v[116:117], v[124:125]
    v_pk_add_f32 v[118:119], v[118:119], v[126:127]
    v_pk_add_f32 v[148:149], v[148:149], v[156:157]
    v_pk_add_f32 v[150:151], v[150:151], v[158:159]
    v_pk_add_f32 v[180:181], v[180:181], v[188:189]
    v_pk_add_f32 v[182:183], v[182:183], v[190:191]
    v_pk_add_f32 v[212:213], v[212:213], v[220:221]
    v_pk_add_f32 v[214:215], v[214:215], v[222:223]
    v_pk_add_f32 v[120:121], v[120:121], v[128:129]
    v_pk_add_f32 v[122:123], v[122:123], v[130:131]
    v_pk_add_f32 v[152:153], v[152:153], v[160:161]
    v_pk_add_f32 v[154:155], v[154:155], v[162:163]
    v_pk_add_f32 v[184:185], v[184:185], v[192:193]
    v_pk_add_f32 v[186:187], v[186:187], v[194:195]
    v_pk_add_f32 v[216:217], v[216:217], v[224:225]
    v_pk_add_f32 v[218:219], v[218:219], v[226:227]
    s_waitcnt lgkmcnt(8)
    v_pk_add_f32 v[116:117], v[116:117], v[132:133]
    v_pk_add_f32 v[118:119], v[118:119], v[134:135]
    v_pk_add_f32 v[148:149], v[148:149], v[164:165]
    v_pk_add_f32 v[150:151], v[150:151], v[166:167]
    v_pk_add_f32 v[180:181], v[180:181], v[196:197]
    v_pk_add_f32 v[182:183], v[182:183], v[198:199]
    v_pk_add_f32 v[212:213], v[212:213], v[228:229]
    v_pk_add_f32 v[214:215], v[214:215], v[230:231]
    v_pk_add_f32 v[120:121], v[120:121], v[136:137]
    v_pk_add_f32 v[122:123], v[122:123], v[138:139]
    v_pk_add_f32 v[152:153], v[152:153], v[168:169]
    v_pk_add_f32 v[154:155], v[154:155], v[170:171]
    v_pk_add_f32 v[184:185], v[184:185], v[200:201]
    v_pk_add_f32 v[186:187], v[186:187], v[202:203]
    v_pk_add_f32 v[216:217], v[216:217], v[232:233]
    v_pk_add_f32 v[218:219], v[218:219], v[234:235]
    s_waitcnt lgkmcnt(0)
    v_pk_add_f32 v[116:117], v[116:117], v[140:141]
    v_pk_add_f32 v[118:119], v[118:119], v[142:143]
    v_pk_add_f32 v[148:149], v[148:149], v[172:173]
    v_pk_add_f32 v[150:151], v[150:151], v[174:175]
    v_pk_add_f32 v[180:181], v[180:181], v[204:205]
    v_pk_add_f32 v[182:183], v[182:183], v[206:207]
    v_pk_add_f32 v[212:213], v[212:213], v[236:237]
    v_pk_add_f32 v[214:215], v[214:215], v[238:239]
    v_pk_add_f32 v[120:121], v[120:121], v[144:145]
    v_pk_add_f32 v[122:123], v[122:123], v[146:147]
    v_pk_add_f32 v[152:153], v[152:153], v[176:177]
    v_pk_add_f32 v[154:155], v[154:155], v[178:179]
    v_pk_add_f32 v[184:185], v[184:185], v[208:209]
    v_pk_add_f32 v[186:187], v[186:187], v[210:211]
    v_pk_add_f32 v[216:217], v[216:217], v[240:241]
    v_pk_add_f32 v[218:219], v[218:219], v[242:243]
    v_cvt_pk_bf16_f32 v20, v116, v117
    v_cvt_pk_bf16_f32 v21, v118, v119
    v_cvt_pk_bf16_f32 v22, v148, v149
    v_cvt_pk_bf16_f32 v23, v150, v151
    s_nop 1
    v_permlane16_swap_b32 v20, v22
    v_permlane16_swap_b32 v21, v23
    buffer_store_dwordx4 v[20:23], v9, s[48:51], s58 offen offset:0
    v_cvt_pk_bf16_f32 v24, v180, v181
    v_cvt_pk_bf16_f32 v25, v182, v183
    v_cvt_pk_bf16_f32 v26, v212, v213
    v_cvt_pk_bf16_f32 v27, v214, v215
    s_nop 1
    v_permlane16_swap_b32 v24, v26
    v_permlane16_swap_b32 v25, v27
    buffer_store_dwordx4 v[24:27], v9, s[48:51], s58 offen offset:64
    v_cvt_pk_bf16_f32 v28, v120, v121
    v_cvt_pk_bf16_f32 v29, v122, v123
    v_cvt_pk_bf16_f32 v30, v152, v153
    v_cvt_pk_bf16_f32 v31, v154, v155
    s_nop 1
    v_permlane16_swap_b32 v28, v30
    v_permlane16_swap_b32 v29, v31
    buffer_store_dwordx4 v[28:31], v9, s[48:51], s59 offen offset:0
    v_cvt_pk_bf16_f32 v32, v184, v185
    v_cvt_pk_bf16_f32 v33, v186, v187
    v_cvt_pk_bf16_f32 v34, v216, v217
    v_cvt_pk_bf16_f32 v35, v218, v219
    s_nop 1
    v_permlane16_swap_b32 v32, v34
    v_permlane16_swap_b32 v33, v35
    buffer_store_dwordx4 v[32:35], v9, s[48:51], s59 offen offset:64
    s_endpgm
P3_FIN1:
    s_waitcnt vmcnt(24) lgkmcnt(0)
    v_mfma_f32_16x16x32_bf16 v[132:135], a[220:223], a[16:19], v[132:135]
    ds_read_b64_tr_b16 a[128:129], v72 offset:4096
    ds_read_b64_tr_b16 a[130:131], v72 offset:6144
    v_mfma_f32_16x16x32_bf16 v[164:167], a[224:227], a[16:19], v[164:167]
    ds_read_b64_tr_b16 a[132:133], v73 offset:4096
    v_mfma_f32_16x16x32_bf16 v[196:199], a[228:231], a[16:19], v[196:199]
    ds_read_b64_tr_b16 a[134:135], v73 offset:6144
    v_mfma_f32_16x16x32_bf16 v[228:231], a[232:235], a[16:19], v[228:231]
    ds_read_b64_tr_b16 a[136:137], v74 offset:4096
    v_mfma_f32_16x16x32_bf16 v[136:139], a[220:223], a[20:23], v[136:139]
    ds_read_b64_tr_b16 a[138:139], v74 offset:6144
    v_mfma_f32_16x16x32_bf16 v[168:171], a[224:227], a[20:23], v[168:171]
    ds_read_b64_tr_b16 a[140:141], v75 offset:4096
    ds_read_b64_tr_b16 a[142:143], v75 offset:6144
    v_mfma_f32_16x16x32_bf16 v[200:203], a[228:231], a[20:23], v[200:203]
    ds_read_b64_tr_b16 a[144:145], v68 offset:0
    v_mfma_f32_16x16x32_bf16 v[232:235], a[232:235], a[20:23], v[232:235]
    ds_read_b64_tr_b16 a[146:147], v68 offset:2048
    v_mfma_f32_16x16x32_bf16 v[140:143], a[220:223], a[24:27], v[140:143]
    ds_read_b64_tr_b16 a[148:149], v69 offset:0
    v_mfma_f32_16x16x32_bf16 v[172:175], a[224:227], a[24:27], v[172:175]
    ds_read_b64_tr_b16 a[150:151], v69 offset:2048
    v_mfma_f32_16x16x32_bf16 v[204:207], a[228:231], a[24:27], v[204:207]
    ds_read_b64_tr_b16 a[152:153], v70 offset:0
    ds_read_b64_tr_b16 a[154:155], v70 offset:2048
    v_mfma_f32_16x16x32_bf16 v[236:239], a[232:235], a[24:27], v[236:239]
    ds_read_b64_tr_b16 a[156:157], v71 offset:0
    v_mfma_f32_16x16x32_bf16 v[144:147], a[220:223], a[28:31], v[144:147]
    ds_read_b64_tr_b16 a[158:159], v71 offset:2048
    v_mfma_f32_16x16x32_bf16 v[176:179], a[224:227], a[28:31], v[176:179]
    ds_read_b64_tr_b16 a[160:161], v68 offset:4096
    v_mfma_f32_16x16x32_bf16 v[208:211], a[228:231], a[28:31], v[208:211]
    ds_read_b64_tr_b16 a[162:163], v68 offset:6144
    v_mfma_f32_16x16x32_bf16 v[240:243], a[232:235], a[28:31], v[240:243]
    ds_read_b64_tr_b16 a[164:165], v69 offset:4096
    ds_read_b64_tr_b16 a[166:167], v69 offset:6144
    v_mfma_f32_16x16x32_bf16 v[116:119], a[220:223], a[0:3], v[116:119]
    ds_read_b64_tr_b16 a[168:169], v70 offset:4096
    v_mfma_f32_16x16x32_bf16 v[148:151], a[224:227], a[0:3], v[148:151]
    ds_read_b64_tr_b16 a[170:171], v70 offset:6144
    v_mfma_f32_16x16x32_bf16 v[180:183], a[228:231], a[0:3], v[180:183]
    ds_read_b64_tr_b16 a[172:173], v71 offset:4096
    v_mfma_f32_16x16x32_bf16 v[212:215], a[232:235], a[0:3], v[212:215]
    ds_read_b64_tr_b16 a[174:175], v71 offset:6144
    v_mfma_f32_16x16x32_bf16 v[120:123], a[220:223], a[4:7], v[120:123]
    v_mfma_f32_16x16x32_bf16 v[152:155], a[224:227], a[4:7], v[152:155]
    v_mfma_f32_16x16x32_bf16 v[184:187], a[228:231], a[4:7], v[184:187]
    v_mfma_f32_16x16x32_bf16 v[216:219], a[232:235], a[4:7], v[216:219]
    s_waitcnt vmcnt(0) lgkmcnt(0)
    s_barrier
    v_mfma_f32_16x16x32_bf16 v[132:135], a[128:131], a[48:51], v[132:135]
    v_mfma_f32_16x16x32_bf16 v[164:167], a[132:135], a[48:51], v[164:167]
    v_mfma_f32_16x16x32_bf16 v[196:199], a[136:139], a[48:51], v[196:199]
    v_mfma_f32_16x16x32_bf16 v[228:231], a[140:143], a[48:51], v[228:231]
    v_mfma_f32_16x16x32_bf16 v[132:135], a[144:147], a[80:83], v[132:135]
    v_mfma_f32_16x16x32_bf16 v[164:167], a[148:151], a[80:83], v[164:167]
    v_mfma_f32_16x16x32_bf16 v[196:199], a[152:155], a[80:83], v[196:199]
    v_mfma_f32_16x16x32_bf16 v[228:231], a[156:159], a[80:83], v[228:231]
    v_mfma_f32_16x16x32_bf16 v[132:135], a[160:163], a[112:115], v[132:135]
    v_mfma_f32_16x16x32_bf16 v[164:167], a[164:167], a[112:115], v[164:167]
    v_mfma_f32_16x16x32_bf16 v[196:199], a[168:171], a[112:115], v[196:199]
    v_mfma_f32_16x16x32_bf16 v[228:231], a[172:175], a[112:115], v[228:231]
    v_mfma_f32_16x16x32_bf16 v[136:139], a[128:131], a[52:55], v[136:139]
    v_mfma_f32_16x16x32_bf16 v[168:171], a[132:135], a[52:55], v[168:171]
    v_mfma_f32_16x16x32_bf16 v[200:203], a[136:139], a[52:55], v[200:203]
    v_mfma_f32_16x16x32_bf16 v[232:235], a[140:143], a[52:55], v[232:235]
    v_mfma_f32_16x16x32_bf16 v[136:139], a[144:147], a[84:87], v[136:139]
    v_mfma_f32_16x16x32_bf16 v[168:171], a[148:151], a[84:87], v[168:171]
    ds_write_b128 v8, v[132:135] offset:0
    v_mfma_f32_16x16x32_bf16 v[200:203], a[152:155], a[84:87], v[200:203]
    v_mfma_f32_16x16x32_bf16 v[232:235], a[156:159], a[84:87], v[232:235]
    v_mfma_f32_16x16x32_bf16 v[136:139], a[160:163], a[116:119], v[136:139]
    ds_write_b128 v8, v[164:167] offset:1024
    v_mfma_f32_16x16x32_bf16 v[168:171], a[164:167], a[116:119], v[168:171]
    v_mfma_f32_16x16x32_bf16 v[200:203], a[168:171], a[116:119], v[200:203]
    v_mfma_f32_16x16x32_bf16 v[232:235], a[172:175], a[116:119], v[232:235]
    ds_write_b128 v8, v[196:199] offset:2048
    v_mfma_f32_16x16x32_bf16 v[140:143], a[128:131], a[56:59], v[140:143]
    v_mfma_f32_16x16x32_bf16 v[172:175], a[132:135], a[56:59], v[172:175]
    v_mfma_f32_16x16x32_bf16 v[204:207], a[136:139], a[56:59], v[204:207]
    ds_write_b128 v8, v[228:231] offset:3072
    v_mfma_f32_16x16x32_bf16 v[236:239], a[140:143], a[56:59], v[236:239]
    v_mfma_f32_16x16x32_bf16 v[140:143], a[144:147], a[88:91], v[140:143]
    v_mfma_f32_16x16x32_bf16 v[172:175], a[148:151], a[88:91], v[172:175]
    ds_write_b128 v8, v[136:139] offset:4096
    v_mfma_f32_16x16x32_bf16 v[204:207], a[152:155], a[88:91], v[204:207]
    v_mfma_f32_16x16x32_bf16 v[236:239], a[156:159], a[88:91], v[236:239]
    v_mfma_f32_16x16x32_bf16 v[140:143], a[160:163], a[120:123], v[140:143]
    ds_write_b128 v8, v[168:171] offset:5120
    v_mfma_f32_16x16x32_bf16 v[172:175], a[164:167], a[120:123], v[172:175]
    v_mfma_f32_16x16x32_bf16 v[204:207], a[168:171], a[120:123], v[204:207]
    v_mfma_f32_16x16x32_bf16 v[236:239], a[172:175], a[120:123], v[236:239]
    ds_write_b128 v8, v[200:203] offset:6144
    v_mfma_f32_16x16x32_bf16 v[144:147], a[128:131], a[60:63], v[144:147]
    v_mfma_f32_16x16x32_bf16 v[176:179], a[132:135], a[60:63], v[176:179]
    v_mfma_f32_16x16x32_bf16 v[208:211], a[136:139], a[60:63], v[208:211]
    ds_write_b128 v8, v[232:235] offset:7168
    v_mfma_f32_16x16x32_bf16 v[240:243], a[140:143], a[60:63], v[240:243]
    v_mfma_f32_16x16x32_bf16 v[144:147], a[144:147], a[92:95], v[144:147]
    v_mfma_f32_16x16x32_bf16 v[176:179], a[148:151], a[92:95], v[176:179]
    ds_write_b128 v8, v[140:143] offset:16384
    v_mfma_f32_16x16x32_bf16 v[208:211], a[152:155], a[92:95], v[208:211]
    v_mfma_f32_16x16x32_bf16 v[240:243], a[156:159], a[92:95], v[240:243]
    v_mfma_f32_16x16x32_bf16 v[144:147], a[160:163], a[124:127], v[144:147]
    ds_write_b128 v8, v[172:175] offset:17408
    v_mfma_f32_16x16x32_bf16 v[176:179], a[164:167], a[124:127], v[176:179]
    v_mfma_f32_16x16x32_bf16 v[208:211], a[168:171], a[124:127], v[208:211]
    v_mfma_f32_16x16x32_bf16 v[240:243], a[172:175], a[124:127], v[240:243]
    ds_write_b128 v8, v[204:207] offset:18432
    v_mfma_f32_16x16x32_bf16 v[116:119], a[128:131], a[32:35], v[116:119]
    v_mfma_f32_16x16x32_bf16 v[148:151], a[132:135], a[32:35], v[148:151]
    v_mfma_f32_16x16x32_bf16 v[180:183], a[136:139], a[32:35], v[180:183]
    ds_write_b128 v8, v[236:239] offset:19456
    v_mfma_f32_16x16x32_bf16 v[212:215], a[140:143], a[32:35], v[212:215]
    v_mfma_f32_16x16x32_bf16 v[116:119], a[144:147], a[64:67], v[116:119]
    v_mfma_f32_16x16x32_bf16 v[148:151], a[148:151], a[64:67], v[148:151]
    ds_write_b128 v8, v[144:147] offset:20480
    v_mfma_f32_16x16x32_bf16 v[180:183], a[152:155], a[64:67], v[180:183]
    v_mfma_f32_16x16x32_bf16 v[212:215], a[156:159], a[64:67], v[212:215]
    v_mfma_f32_16x16x32_bf16 v[116:119], a[160:163], a[96:99], v[116:119]
    ds_write_b128 v8, v[176:179] offset:21504
    v_mfma_f32_16x16x32_bf16 v[148:151], a[164:167], a[96:99], v[148:151]
    v_mfma_f32_16x16x32_bf16 v[180:183], a[168:171], a[96:99], v[180:183]
    v_mfma_f32_16x16x32_bf16 v[212:215], a[172:175], a[96:99], v[212:215]
    ds_write_b128 v8, v[208:211] offset:22528
    v_mfma_f32_16x16x32_bf16 v[120:123], a[128:131], a[36:39], v[120:123]
    v_mfma_f32_16x16x32_bf16 v[152:155], a[132:135], a[36:39], v[152:155]
    v_mfma_f32_16x16x32_bf16 v[184:187], a[136:139], a[36:39], v[184:187]
    ds_write_b128 v8, v[240:243] offset:23552
    v_mfma_f32_16x16x32_bf16 v[216:219], a[140:143], a[36:39], v[216:219]
    v_mfma_f32_16x16x32_bf16 v[120:123], a[144:147], a[68:71], v[120:123]
    v_mfma_f32_16x16x32_bf16 v[152:155], a[148:151], a[68:71], v[152:155]
    ds_write_b128 v2, v[116:119] offset:0
    v_mfma_f32_16x16x32_bf16 v[184:187], a[152:155], a[68:71], v[184:187]
    v_mfma_f32_16x16x32_bf16 v[216:219], a[156:159], a[68:71], v[216:219]
    v_mfma_f32_16x16x32_bf16 v[120:123], a[160:163], a[100:103], v[120:123]
    ds_write_b128 v2, v[148:151] offset:1024
    v_mfma_f32_16x16x32_bf16 v[152:155], a[164:167], a[100:103], v[152:155]
    v_mfma_f32_16x16x32_bf16 v[184:187], a[168:171], a[100:103], v[184:187]
    v_mfma_f32_16x16x32_bf16 v[216:219], a[172:175], a[100:103], v[216:219]
    ds_write_b128 v2, v[180:183] offset:2048
    v_mfma_f32_16x16x32_bf16 v[124:127], a[220:223], a[8:11], v[124:127]
    v_mfma_f32_16x16x32_bf16 v[156:159], a[224:227], a[8:11], v[156:159]
    v_mfma_f32_16x16x32_bf16 v[188:191], a[228:231], a[8:11], v[188:191]
    ds_write_b128 v2, v[212:215] offset:3072
    v_mfma_f32_16x16x32_bf16 v[220:223], a[232:235], a[8:11], v[220:223]
    v_mfma_f32_16x16x32_bf16 v[124:127], a[128:131], a[40:43], v[124:127]
    v_mfma_f32_16x16x32_bf16 v[156:159], a[132:135], a[40:43], v[156:159]
    ds_write_b128 v2, v[120:123] offset:4096
    v_mfma_f32_16x16x32_bf16 v[188:191], a[136:139], a[40:43], v[188:191]
    ds_write_b128 v2, v[152:155] offset:5120
    v_mfma_f32_16x16x32_bf16 v[220:223], a[140:143], a[40:43], v[220:223]
    ds_write_b128 v2, v[184:187] offset:6144
    v_mfma_f32_16x16x32_bf16 v[124:127], a[144:147], a[72:75], v[124:127]
    ds_write_b128 v2, v[216:219] offset:7168
    v_mfma_f32_16x16x32_bf16 v[156:159], a[148:151], a[72:75], v[156:159]
    v_mfma_f32_16x16x32_bf16 v[188:191], a[152:155], a[72:75], v[188:191]
    v_mfma_f32_16x16x32_bf16 v[220:223], a[156:159], a[72:75], v[220:223]
    s_waitcnt lgkmcnt(0)
    s_barrier
    ds_read_b128 v[132:135], v2 offset:24576
    ds_read_b128 v[164:167], v2 offset:25600
    v_mfma_f32_16x16x32_bf16 v[124:127], a[160:163], a[104:107], v[124:127]
    ds_read_b128 v[196:199], v2 offset:26624
    v_mfma_f32_16x16x32_bf16 v[156:159], a[164:167], a[104:107], v[156:159]
    ds_read_b128 v[228:231], v2 offset:27648
    v_mfma_f32_16x16x32_bf16 v[188:191], a[168:171], a[104:107], v[188:191]
    ds_read_b128 v[136:139], v2 offset:28672
    ds_read_b128 v[168:171], v2 offset:29696
    v_mfma_f32_16x16x32_bf16 v[220:223], a[172:175], a[104:107], v[220:223]
    ds_read_b128 v[200:203], v2 offset:30720
    v_mfma_f32_16x16x32_bf16 v[128:131], a[220:223], a[12:15], v[128:131]
    ds_read_b128 v[232:235], v2 offset:31744
    v_mfma_f32_16x16x32_bf16 v[160:163], a[224:227], a[12:15], v[160:163]
    ds_read_b128 v[140:143], v2 offset:32768
    ds_read_b128 v[172:175], v2 offset:33792
    v_mfma_f32_16x16x32_bf16 v[192:195], a[228:231], a[12:15], v[192:195]
    ds_read_b128 v[204:207], v2 offset:34816
    v_mfma_f32_16x16x32_bf16 v[224:227], a[232:235], a[12:15], v[224:227]
    ds_read_b128 v[236:239], v2 offset:35840
    v_mfma_f32_16x16x32_bf16 v[128:131], a[128:131], a[44:47], v[128:131]
    ds_read_b128 v[144:147], v2 offset:36864
    ds_read_b128 v[176:179], v2 offset:37888
    v_mfma_f32_16x16x32_bf16 v[160:163], a[132:135], a[44:47], v[160:163]
    ds_read_b128 v[208:211], v2 offset:38912
    v_mfma_f32_16x16x32_bf16 v[192:195], a[136:139], a[44:47], v[192:195]
    ds_read_b128 v[240:243], v2 offset:39936
    v_mfma_f32_16x16x32_bf16 v[224:227], a[140:143], a[44:47], v[224:227]
    ds_read_b128 v[116:119], v2 offset:40960
    ds_read_b128 v[148:151], v2 offset:41984
    v_mfma_f32_16x16x32_bf16 v[128:131], a[144:147], a[76:79], v[128:131]
    ds_read_b128 v[180:183], v2 offset:43008
    v_mfma_f32_16x16x32_bf16 v[160:163], a[148:151], a[76:79], v[160:163]
    ds_read_b128 v[212:215], v2 offset:44032
    v_mfma_f32_16x16x32_bf16 v[192:195], a[152:155], a[76:79], v[192:195]
    ds_read_b128 v[120:123], v2 offset:45056
    ds_read_b128 v[152:155], v2 offset:46080
    v_mfma_f32_16x16x32_bf16 v[224:227], a[156:159], a[76:79], v[224:227]
    ds_read_b128 v[184:187], v2 offset:47104
    v_mfma_f32_16x16x32_bf16 v[128:131], a[160:163], a[108:111], v[128:131]
    ds_read_b128 v[216:219], v2 offset:48128
    v_mfma_f32_16x16x32_bf16 v[160:163], a[164:167], a[108:111], v[160:163]
    v_mfma_f32_16x16x32_bf16 v[192:195], a[168:171], a[108:111], v[192:195]
    v_mfma_f32_16x16x32_bf16 v[224:227], a[172:175], a[108:111], v[224:227]
    s_nop 3
    s_waitcnt lgkmcnt(15)
    v_pk_add_f32 v[124:125], v[124:125], v[132:133]
    v_pk_add_f32 v[126:127], v[126:127], v[134:135]
    v_pk_add_f32 v[156:157], v[156:157], v[164:165]
    v_pk_add_f32 v[158:159], v[158:159], v[166:167]
    v_pk_add_f32 v[188:189], v[188:189], v[196:197]
    v_pk_add_f32 v[190:191], v[190:191], v[198:199]
    v_pk_add_f32 v[220:221], v[220:221], v[228:229]
    v_pk_add_f32 v[222:223], v[222:223], v[230:231]
    v_pk_add_f32 v[128:129], v[128:129], v[136:137]
    v_pk_add_f32 v[130:131], v[130:131], v[138:139]
    v_pk_add_f32 v[160:161], v[160:161], v[168:169]
    v_pk_add_f32 v[162:163], v[162:163], v[170:171]
    v_pk_add_f32 v[192:193], v[192:193], v[200:201]
    v_pk_add_f32 v[194:195], v[194:195], v[202:203]
    v_pk_add_f32 v[224:225], v[224:225], v[232:233]
    v_pk_add_f32 v[226:227], v[226:227], v[234:235]
    s_waitcnt lgkmcnt(8)
    v_pk_add_f32 v[124:125], v[124:125], v[140:141]
    v_pk_add_f32 v[126:127], v[126:127], v[142:143]
    v_pk_add_f32 v[156:157], v[156:157], v[172:173]
    v_pk_add_f32 v[158:159], v[158:159], v[174:175]
    v_pk_add_f32 v[188:189], v[188:189], v[204:205]
    v_pk_add_f32 v[190:191], v[190:191], v[206:207]
    v_pk_add_f32 v[220:221], v[220:221], v[236:237]
    v_pk_add_f32 v[222:223], v[222:223], v[238:239]
    v_pk_add_f32 v[128:129], v[128:129], v[144:145]
    v_pk_add_f32 v[130:131], v[130:131], v[146:147]
    v_pk_add_f32 v[160:161], v[160:161], v[176:177]
    v_pk_add_f32 v[162:163], v[162:163], v[178:179]
    v_pk_add_f32 v[192:193], v[192:193], v[208:209]
    v_pk_add_f32 v[194:195], v[194:195], v[210:211]
    v_pk_add_f32 v[224:225], v[224:225], v[240:241]
    v_pk_add_f32 v[226:227], v[226:227], v[242:243]
    s_waitcnt lgkmcnt(0)
    v_pk_add_f32 v[124:125], v[124:125], v[116:117]
    v_pk_add_f32 v[126:127], v[126:127], v[118:119]
    v_pk_add_f32 v[156:157], v[156:157], v[148:149]
    v_pk_add_f32 v[158:159], v[158:159], v[150:151]
    v_pk_add_f32 v[188:189], v[188:189], v[180:181]
    v_pk_add_f32 v[190:191], v[190:191], v[182:183]
    v_pk_add_f32 v[220:221], v[220:221], v[212:213]
    v_pk_add_f32 v[222:223], v[222:223], v[214:215]
    v_pk_add_f32 v[128:129], v[128:129], v[120:121]
    v_pk_add_f32 v[130:131], v[130:131], v[122:123]
    v_pk_add_f32 v[160:161], v[160:161], v[152:153]
    v_pk_add_f32 v[162:163], v[162:163], v[154:155]
    v_pk_add_f32 v[192:193], v[192:193], v[184:185]
    v_pk_add_f32 v[194:195], v[194:195], v[186:187]
    v_pk_add_f32 v[224:225], v[224:225], v[216:217]
    v_pk_add_f32 v[226:227], v[226:227], v[218:219]
    v_cvt_pk_bf16_f32 v20, v124, v125
    v_cvt_pk_bf16_f32 v21, v126, v127
    v_cvt_pk_bf16_f32 v22, v156, v157
    v_cvt_pk_bf16_f32 v23, v158, v159
    s_nop 1
    v_permlane16_swap_b32 v20, v22
    v_permlane16_swap_b32 v21, v23
    buffer_store_dwordx4 v[20:23], v9, s[48:51], s58 offen offset:0
    v_cvt_pk_bf16_f32 v24, v188, v189
    v_cvt_pk_bf16_f32 v25, v190, v191
    v_cvt_pk_bf16_f32 v26, v220, v221
    v_cvt_pk_bf16_f32 v27, v222, v223
    s_nop 1
    v_permlane16_swap_b32 v24, v26
    v_permlane16_swap_b32 v25, v27
    buffer_store_dwordx4 v[24:27], v9, s[48:51], s58 offen offset:64
    v_cvt_pk_bf16_f32 v28, v128, v129
    v_cvt_pk_bf16_f32 v29, v130, v131
    v_cvt_pk_bf16_f32 v30, v160, v161
    v_cvt_pk_bf16_f32 v31, v162, v163
    s_nop 1
    v_permlane16_swap_b32 v28, v30
    v_permlane16_swap_b32 v29, v31
    buffer_store_dwordx4 v[28:31], v9, s[48:51], s59 offen offset:0
    v_cvt_pk_bf16_f32 v32, v192, v193
    v_cvt_pk_bf16_f32 v33, v194, v195
    v_cvt_pk_bf16_f32 v34, v224, v225
    v_cvt_pk_bf16_f32 v35, v226, v227
    s_nop 1
    v_permlane16_swap_b32 v32, v34
    v_permlane16_swap_b32 v33, v35
    buffer_store_dwordx4 v[32:35], v9, s[48:51], s59 offen offset:64
    s_endpgm
P3_FIN2:
    s_waitcnt vmcnt(24) lgkmcnt(0)
    v_mfma_f32_16x16x32_bf16 v[140:143], a[220:223], a[24:27], v[140:143]
    ds_read_b64_tr_b16 a[128:129], v72 offset:4096
    ds_read_b64_tr_b16 a[130:131], v72 offset:6144
    v_mfma_f32_16x16x32_bf16 v[172:175], a[224:227], a[24:27], v[172:175]
    ds_read_b64_tr_b16 a[132:133], v73 offset:4096
    v_mfma_f32_16x16x32_bf16 v[204:207], a[228:231], a[24:27], v[204:207]
    ds_read_b64_tr_b16 a[134:135], v73 offset:6144
    v_mfma_f32_16x16x32_bf16 v[236:239], a[232:235], a[24:27], v[236:239]
    ds_read_b64_tr_b16 a[136:137], v74 offset:4096
    v_mfma_f32_16x16x32_bf16 v[144:147], a[220:223], a[28:31], v[144:147]
    ds_read_b64_tr_b16 a[138:139], v74 offset:6144
    v_mfma_f32_16x16x32_bf16 v[176:179], a[224:227], a[28:31], v[176:179]
    ds_read_b64_tr_b16 a[140:141], v75 offset:4096
    ds_read_b64_tr_b16 a[142:143], v75 offset:6144
    v_mfma_f32_16x16x32_bf16 v[208:211], a[228:231], a[28:31], v[208:211]
    ds_read_b64_tr_b16 a[144:145], v68 offset:0
    v_mfma_f32_16x16x32_bf16 v[240:243], a[232:235], a[28:31], v[240:243]
    ds_read_b64_tr_b16 a[146:147], v68 offset:2048
    v_mfma_f32_16x16x32_bf16 v[116:119], a[220:223], a[0:3], v[116:119]
    ds_read_b64_tr_b16 a[148:149], v69 offset:0
    v_mfma_f32_16x16x32_bf16 v[148:151], a[224:227], a[0:3], v[148:151]
    ds_read_b64_tr_b16 a[150:151], v69 offset:2048
    v_mfma_f32_16x16x32_bf16 v[180:183], a[228:231], a[0:3], v[180:183]
    ds_read_b64_tr_b16 a[152:153], v70 offset:0
    ds_read_b64_tr_b16 a[154:155], v70 offset:2048
    v_mfma_f32_16x16x32_bf16 v[212:215], a[232:235], a[0:3], v[212:215]
    ds_read_b64_tr_b16 a[156:157], v71 offset:0
    v_mfma_f32_16x16x32_bf16 v[120:123], a[220:223], a[4:7], v[120:123]
    ds_read_b64_tr_b16 a[158:159], v71 offset:2048
    v_mfma_f32_16x16x32_bf16 v[152:155], a[224:227], a[4:7], v[152:155]
    ds_read_b64_tr_b16 a[160:161], v68 offset:4096
    v_mfma_f32_16x16x32_bf16 v[184:187], a[228:231], a[4:7], v[184:187]
    ds_read_b64_tr_b16 a[162:163], v68 offset:6144
    v_mfma_f32_16x16x32_bf16 v[216:219], a[232:235], a[4:7], v[216:219]
    ds_read_b64_tr_b16 a[164:165], v69 offset:4096
    ds_read_b64_tr_b16 a[166:167], v69 offset:6144
    v_mfma_f32_16x16x32_bf16 v[124:127], a[220:223], a[8:11], v[124:127]
    ds_read_b64_tr_b16 a[168:169], v70 offset:4096
    v_mfma_f32_16x16x32_bf16 v[156:159], a[224:227], a[8:11], v[156:159]
    ds_read_b64_tr_b16 a[170:171], v70 offset:6144
    v_mfma_f32_16x16x32_bf16 v[188:191], a[228:231], a[8:11], v[188:191]
    ds_read_b64_tr_b16 a[172:173], v71 offset:4096
    v_mfma_f32_16x16x32_bf16 v[220:223], a[232:235], a[8:11], v[220:223]
    ds_read_b64_tr_b16 a[174:175], v71 offset:6144
    v_mfma_f32_16x16x32_bf16 v[128:131], a[220:223], a[12:15], v[128:131]
    v_mfma_f32_16x16x32_bf16 v[160:163], a[224:227], a[12:15], v[160:163]
    v_mfma_f32_16x16x32_bf16 v[192:195], a[228:231], a[12:15], v[192:195]
    v_mfma_f32_16x16x32_bf16 v[224:227], a[232:235], a[12:15], v[224:227]
    s_waitcnt vmcnt(0) lgkmcnt(0)
    s_barrier
    v_mfma_f32_16x16x32_bf16 v[140:143], a[128:131], a[56:59], v[140:143]
    v_mfma_f32_16x16x32_bf16 v[172:175], a[132:135], a[56:59], v[172:175]
    v_mfma_f32_16x16x32_bf16 v[204:207], a[136:139], a[56:59], v[204:207]
    v_mfma_f32_16x16x32_bf16 v[236:239], a[140:143], a[56:59], v[236:239]
    v_mfma_f32_16x16x32_bf16 v[140:143], a[144:147], a[88:91], v[140:143]
    v_mfma_f32_16x16x32_bf16 v[172:175], a[148:151], a[88:91], v[172:175]
    v_mfma_f32_16x16x32_bf16 v[204:207], a[152:155], a[88:91], v[204:207]
    v_mfma_f32_16x16x32_bf16 v[236:239], a[156:159], a[88:91], v[236:239]
    v_mfma_f32_16x16x32_bf16 v[140:143], a[160:163], a[120:123], v[140:143]
    v_mfma_f32_16x16x32_bf16 v[172:175], a[164:167], a[120:123], v[172:175]
    v_mfma_f32_16x16x32_bf16 v[204:207], a[168:171], a[120:123], v[204:207]
    v_mfma_f32_16x16x32_bf16 v[236:239], a[172:175], a[120:123], v[236:239]
    v_mfma_f32_16x16x32_bf16 v[144:147], a[128:131], a[60:63], v[144:147]
    v_mfma_f32_16x16x32_bf16 v[176:179], a[132:135], a[60:63], v[176:179]
    v_mfma_f32_16x16x32_bf16 v[208:211], a[136:139], a[60:63], v[208:211]
    v_mfma_f32_16x16x32_bf16 v[240:243], a[140:143], a[60:63], v[240:243]
    v_mfma_f32_16x16x32_bf16 v[144:147], a[144:147], a[92:95], v[144:147]
    v_mfma_f32_16x16x32_bf16 v[176:179], a[148:151], a[92:95], v[176:179]
    ds_write_b128 v8, v[140:143] offset:24576
    v_mfma_f32_16x16x32_bf16 v[208:211], a[152:155], a[92:95], v[208:211]
    v_mfma_f32_16x16x32_bf16 v[240:243], a[156:159], a[92:95], v[240:243]
    v_mfma_f32_16x16x32_bf16 v[144:147], a[160:163], a[124:127], v[144:147]
    ds_write_b128 v8, v[172:175] offset:25600
    v_mfma_f32_16x16x32_bf16 v[176:179], a[164:167], a[124:127], v[176:179]
    v_mfma_f32_16x16x32_bf16 v[208:211], a[168:171], a[124:127], v[208:211]
    v_mfma_f32_16x16x32_bf16 v[240:243], a[172:175], a[124:127], v[240:243]
    ds_write_b128 v8, v[204:207] offset:26624
    v_mfma_f32_16x16x32_bf16 v[116:119], a[128:131], a[32:35], v[116:119]
    v_mfma_f32_16x16x32_bf16 v[148:151], a[132:135], a[32:35], v[148:151]
    v_mfma_f32_16x16x32_bf16 v[180:183], a[136:139], a[32:35], v[180:183]
    ds_write_b128 v8, v[236:239] offset:27648
    v_mfma_f32_16x16x32_bf16 v[212:215], a[140:143], a[32:35], v[212:215]
    v_mfma_f32_16x16x32_bf16 v[116:119], a[144:147], a[64:67], v[116:119]
    v_mfma_f32_16x16x32_bf16 v[148:151], a[148:151], a[64:67], v[148:151]
    ds_write_b128 v8, v[144:147] offset:28672
    v_mfma_f32_16x16x32_bf16 v[180:183], a[152:155], a[64:67], v[180:183]
    v_mfma_f32_16x16x32_bf16 v[212:215], a[156:159], a[64:67], v[212:215]
    v_mfma_f32_16x16x32_bf16 v[116:119], a[160:163], a[96:99], v[116:119]
    ds_write_b128 v8, v[176:179] offset:29696
    v_mfma_f32_16x16x32_bf16 v[148:151], a[164:167], a[96:99], v[148:151]
    v_mfma_f32_16x16x32_bf16 v[180:183], a[168:171], a[96:99], v[180:183]
    v_mfma_f32_16x16x32_bf16 v[212:215], a[172:175], a[96:99], v[212:215]
    ds_write_b128 v8, v[208:211] offset:30720
    v_mfma_f32_16x16x32_bf16 v[120:123], a[128:131], a[36:39], v[120:123]
    v_mfma_f32_16x16x32_bf16 v[152:155], a[132:135], a[36:39], v[152:155]
    v_mfma_f32_16x16x32_bf16 v[184:187], a[136:139], a[36:39], v[184:187]
    ds_write_b128 v8, v[240:243] offset:31744
    v_mfma_f32_16x16x32_bf16 v[216:219], a[140:143], a[36:39], v[216:219]
    v_mfma_f32_16x16x32_bf16 v[120:123], a[144:147], a[68:71], v[120:123]
    v_mfma_f32_16x16x32_bf16 v[152:155], a[148:151], a[68:71], v[152:155]
    ds_write_b128 v2, v[116:119] offset:8192
    v_mfma_f32_16x16x32_bf16 v[184:187], a[152:155], a[68:71], v[184:187]
    v_mfma_f32_16x16x32_bf16 v[216:219], a[156:159], a[68:71], v[216:219]
    v_mfma_f32_16x16x32_bf16 v[120:123], a[160:163], a[100:103], v[120:123]
    ds_write_b128 v2, v[148:151] offset:9216
    v_mfma_f32_16x16x32_bf16 v[152:155], a[164:167], a[100:103], v[152:155]
    v_mfma_f32_16x16x32_bf16 v[184:187], a[168:171], a[100:103], v[184:187]
    v_mfma_f32_16x16x32_bf16 v[216:219], a[172:175], a[100:103], v[216:219]
    ds_write_b128 v2, v[180:183] offset:10240
    v_mfma_f32_16x16x32_bf16 v[124:127], a[128:131], a[40:43], v[124:127]
    v_mfma_f32_16x16x32_bf16 v[156:159], a[132:135], a[40:43], v[156:159]
    v_mfma_f32_16x16x32_bf16 v[188:191], a[136:139], a[40:43], v[188:191]
    ds_write_b128 v2, v[212:215] offset:11264
    v_mfma_f32_16x16x32_bf16 v[220:223], a[140:143], a[40:43], v[220:223]
    v_mfma_f32_16x16x32_bf16 v[124:127], a[144:147], a[72:75], v[124:127]
    v_mfma_f32_16x16x32_bf16 v[156:159], a[148:151], a[72:75], v[156:159]
    ds_write_b128 v2, v[120:123] offset:12288
    v_mfma_f32_16x16x32_bf16 v[188:191], a[152:155], a[72:75], v[188:191]
    v_mfma_f32_16x16x32_bf16 v[220:223], a[156:159], a[72:75], v[220:223]
    v_mfma_f32_16x16x32_bf16 v[124:127], a[160:163], a[104:107], v[124:127]
    ds_write_b128 v2, v[152:155] offset:13312
    v_mfma_f32_16x16x32_bf16 v[156:159], a[164:167], a[104:107], v[156:159]
    v_mfma_f32_16x16x32_bf16 v[188:191], a[168:171], a[104:107], v[188:191]
    v_mfma_f32_16x16x32_bf16 v[220:223], a[172:175], a[104:107], v[220:223]
    ds_write_b128 v2, v[184:187] offset:14336
    v_mfma_f32_16x16x32_bf16 v[128:131], a[128:131], a[44:47], v[128:131]
    v_mfma_f32_16x16x32_bf16 v[160:163], a[132:135], a[44:47], v[160:163]
    v_mfma_f32_16x16x32_bf16 v[192:195], a[136:139], a[44:47], v[192:195]
    ds_write_b128 v2, v[216:219] offset:15360
    v_mfma_f32_16x16x32_bf16 v[224:227], a[140:143], a[44:47], v[224:227]
    v_mfma_f32_16x16x32_bf16 v[128:131], a[144:147], a[76:79], v[128:131]
    v_mfma_f32_16x16x32_bf16 v[160:163], a[148:151], a[76:79], v[160:163]
    ds_write_b128 v2, v[124:127] offset:24576
    v_mfma_f32_16x16x32_bf16 v[192:195], a[152:155], a[76:79], v[192:195]
    v_mfma_f32_16x16x32_bf16 v[224:227], a[156:159], a[76:79], v[224:227]
    v_mfma_f32_16x16x32_bf16 v[128:131], a[160:163], a[108:111], v[128:131]
    ds_write_b128 v2, v[156:159] offset:25600
    v_mfma_f32_16x16x32_bf16 v[160:163], a[164:167], a[108:111], v[160:163]
    v_mfma_f32_16x16x32_bf16 v[192:195], a[168:171], a[108:111], v[192:195]
    v_mfma_f32_16x16x32_bf16 v[224:227], a[172:175], a[108:111], v[224:227]
    ds_write_b128 v2, v[188:191] offset:26624
    v_mfma_f32_16x16x32_bf16 v[132:135], a[220:223], a[16:19], v[132:135]
    v_mfma_f32_16x16x32_bf16 v[164:167], a[224:227], a[16:19], v[164:167]
    v_mfma_f32_16x16x32_bf16 v[196:199], a[228:231], a[16:19], v[196:199]
    ds_write_b128 v2, v[220:223] offset:27648
    v_mfma_f32_16x16x32_bf16 v[228:231], a[232:235], a[16:19], v[228:231]
    v_mfma_f32_16x16x32_bf16 v[132:135], a[128:131], a[48:51], v[132:135]
    v_mfma_f32_16x16x32_bf16 v[164:167], a[132:135], a[48:51], v[164:167]
    ds_write_b128 v2, v[128:131] offset:28672
    v_mfma_f32_16x16x32_bf16 v[196:199], a[136:139], a[48:51], v[196:199]
    ds_write_b128 v2, v[160:163] offset:29696
    v_mfma_f32_16x16x32_bf16 v[228:231], a[140:143], a[48:51], v[228:231]
    ds_write_b128 v2, v[192:195] offset:30720
    v_mfma_f32_16x16x32_bf16 v[132:135], a[144:147], a[80:83], v[132:135]
    ds_write_b128 v2, v[224:227] offset:31744
    v_mfma_f32_16x16x32_bf16 v[164:167], a[148:151], a[80:83], v[164:167]
    v_mfma_f32_16x16x32_bf16 v[196:199], a[152:155], a[80:83], v[196:199]
    v_mfma_f32_16x16x32_bf16 v[228:231], a[156:159], a[80:83], v[228:231]
    s_waitcnt lgkmcnt(0)
    s_barrier
    ds_read_b128 v[140:143], v2 offset:49152
    ds_read_b128 v[172:175], v2 offset:50176
    v_mfma_f32_16x16x32_bf16 v[132:135], a[160:163], a[112:115], v[132:135]
    ds_read_b128 v[204:207], v2 offset:51200
    v_mfma_f32_16x16x32_bf16 v[164:167], a[164:167], a[112:115], v[164:167]
    ds_read_b128 v[236:239], v2 offset:52224
    v_mfma_f32_16x16x32_bf16 v[196:199], a[168:171], a[112:115], v[196:199]
    ds_read_b128 v[144:147], v2 offset:53248
    ds_read_b128 v[176:179], v2 offset:54272
    v_mfma_f32_16x16x32_bf16 v[228:231], a[172:175], a[112:115], v[228:231]
    ds_read_b128 v[208:211], v2 offset:55296
    v_mfma_f32_16x16x32_bf16 v[136:139], a[220:223], a[20:23], v[136:139]
    ds_read_b128 v[240:243], v2 offset:56320
    v_mfma_f32_16x16x32_bf16 v[168:171], a[224:227], a[20:23], v[168:171]
    ds_read_b128 v[116:119], v2 offset:57344
    ds_read_b128 v[148:151], v2 offset:58368
    v_mfma_f32_16x16x32_bf16 v[200:203], a[228:231], a[20:23], v[200:203]
    ds_read_b128 v[180:183], v2 offset:59392
    v_mfma_f32_16x16x32_bf16 v[232:235], a[232:235], a[20:23], v[232:235]
    ds_read_b128 v[212:215], v2 offset:60416
    v_mfma_f32_16x16x32_bf16 v[136:139], a[128:131], a[52:55], v[136:139]
    ds_read_b128 v[120:123], v2 offset:61440
    ds_read_b128 v[152:155], v2 offset:62464
    v_mfma_f32_16x16x32_bf16 v[168:171], a[132:135], a[52:55], v[168:171]
    ds_read_b128 v[184:187], v2 offset:63488
    v_mfma_f32_16x16x32_bf16 v[200:203], a[136:139], a[52:55], v[200:203]
    ds_read_b128 v[216:219], v2 offset:64512
    v_mfma_f32_16x16x32_bf16 v[232:235], a[140:143], a[52:55], v[232:235]
    ds_read_b128 v[124:127], v8 offset:0
    ds_read_b128 v[156:159], v8 offset:1024
    v_mfma_f32_16x16x32_bf16 v[136:139], a[144:147], a[84:87], v[136:139]
    ds_read_b128 v[188:191], v8 offset:2048
    v_mfma_f32_16x16x32_bf16 v[168:171], a[148:151], a[84:87], v[168:171]
    ds_read_b128 v[220:223], v8 offset:3072
    v_mfma_f32_16x16x32_bf16 v[200:203], a[152:155], a[84:87], v[200:203]
    ds_read_b128 v[128:131], v8 offset:4096
    ds_read_b128 v[160:163], v8 offset:5120
    v_mfma_f32_16x16x32_bf16 v[232:235], a[156:159], a[84:87], v[232:235]
    ds_read_b128 v[192:195], v8 offset:6144
    v_mfma_f32_16x16x32_bf16 v[136:139], a[160:163], a[116:119], v[136:139]
    ds_read_b128 v[224:227], v8 offset:7168
    v_mfma_f32_16x16x32_bf16 v[168:171], a[164:167], a[116:119], v[168:171]
    v_mfma_f32_16x16x32_bf16 v[200:203], a[168:171], a[116:119], v[200:203]
    v_mfma_f32_16x16x32_bf16 v[232:235], a[172:175], a[116:119], v[232:235]
    s_nop 3
    s_waitcnt lgkmcnt(15)
    v_pk_add_f32 v[132:133], v[132:133], v[140:141]
    v_pk_add_f32 v[134:135], v[134:135], v[142:143]
    v_pk_add_f32 v[164:165], v[164:165], v[172:173]
    v_pk_add_f32 v[166:167], v[166:167], v[174:175]
    v_pk_add_f32 v[196:197], v[196:197], v[204:205]
    v_pk_add_f32 v[198:199], v[198:199], v[206:207]
    v_pk_add_f32 v[228:229], v[228:229], v[236:237]
    v_pk_add_f32 v[230:231], v[230:231], v[238:239]
    v_pk_add_f32 v[136:137], v[136:137], v[144:145]
    v_pk_add_f32 v[138:139], v[138:139], v[146:147]
    v_pk_add_f32 v[168:169], v[168:169], v[176:177]
    v_pk_add_f32 v[170:171], v[170:171], v[178:179]
    v_pk_add_f32 v[200:201], v[200:201], v[208:209]
    v_pk_add_f32 v[202:203], v[202:203], v[210:211]
    v_pk_add_f32 v[232:233], v[232:233], v[240:241]
    v_pk_add_f32 v[234:235], v[234:235], v[242:243]
    s_waitcnt lgkmcnt(8)
    v_pk_add_f32 v[132:133], v[132:133], v[116:117]
    v_pk_add_f32 v[134:135], v[134:135], v[118:119]
    v_pk_add_f32 v[164:165], v[164:165], v[148:149]
    v_pk_add_f32 v[166:167], v[166:167], v[150:151]
    v_pk_add_f32 v[196:197], v[196:197], v[180:181]
    v_pk_add_f32 v[198:199], v[198:199], v[182:183]
    v_pk_add_f32 v[228:229], v[228:229], v[212:213]
    v_pk_add_f32 v[230:231], v[230:231], v[214:215]
    v_pk_add_f32 v[136:137], v[136:137], v[120:121]
    v_pk_add_f32 v[138:139], v[138:139], v[122:123]
    v_pk_add_f32 v[168:169], v[168:169], v[152:153]
    v_pk_add_f32 v[170:171], v[170:171], v[154:155]
    v_pk_add_f32 v[200:201], v[200:201], v[184:185]
    v_pk_add_f32 v[202:203], v[202:203], v[186:187]
    v_pk_add_f32 v[232:233], v[232:233], v[216:217]
    v_pk_add_f32 v[234:235], v[234:235], v[218:219]
    s_waitcnt lgkmcnt(0)
    v_pk_add_f32 v[132:133], v[132:133], v[124:125]
    v_pk_add_f32 v[134:135], v[134:135], v[126:127]
    v_pk_add_f32 v[164:165], v[164:165], v[156:157]
    v_pk_add_f32 v[166:167], v[166:167], v[158:159]
    v_pk_add_f32 v[196:197], v[196:197], v[188:189]
    v_pk_add_f32 v[198:199], v[198:199], v[190:191]
    v_pk_add_f32 v[228:229], v[228:229], v[220:221]
    v_pk_add_f32 v[230:231], v[230:231], v[222:223]
    v_pk_add_f32 v[136:137], v[136:137], v[128:129]
    v_pk_add_f32 v[138:139], v[138:139], v[130:131]
    v_pk_add_f32 v[168:169], v[168:169], v[160:161]
    v_pk_add_f32 v[170:171], v[170:171], v[162:163]
    v_pk_add_f32 v[200:201], v[200:201], v[192:193]
    v_pk_add_f32 v[202:203], v[202:203], v[194:195]
    v_pk_add_f32 v[232:233], v[232:233], v[224:225]
    v_pk_add_f32 v[234:235], v[234:235], v[226:227]
    v_cvt_pk_bf16_f32 v20, v132, v133
    v_cvt_pk_bf16_f32 v21, v134, v135
    v_cvt_pk_bf16_f32 v22, v164, v165
    v_cvt_pk_bf16_f32 v23, v166, v167
    s_nop 1
    v_permlane16_swap_b32 v20, v22
    v_permlane16_swap_b32 v21, v23
    buffer_store_dwordx4 v[20:23], v9, s[48:51], s58 offen offset:0
    v_cvt_pk_bf16_f32 v24, v196, v197
    v_cvt_pk_bf16_f32 v25, v198, v199
    v_cvt_pk_bf16_f32 v26, v228, v229
    v_cvt_pk_bf16_f32 v27, v230, v231
    s_nop 1
    v_permlane16_swap_b32 v24, v26
    v_permlane16_swap_b32 v25, v27
    buffer_store_dwordx4 v[24:27], v9, s[48:51], s58 offen offset:64
    v_cvt_pk_bf16_f32 v28, v136, v137
    v_cvt_pk_bf16_f32 v29, v138, v139
    v_cvt_pk_bf16_f32 v30, v168, v169
    v_cvt_pk_bf16_f32 v31, v170, v171
    s_nop 1
    v_permlane16_swap_b32 v28, v30
    v_permlane16_swap_b32 v29, v31
    buffer_store_dwordx4 v[28:31], v9, s[48:51], s59 offen offset:0
    v_cvt_pk_bf16_f32 v32, v200, v201
    v_cvt_pk_bf16_f32 v33, v202, v203
    v_cvt_pk_bf16_f32 v34, v232, v233
    v_cvt_pk_bf16_f32 v35, v234, v235
    s_nop 1
    v_permlane16_swap_b32 v32, v34
    v_permlane16_swap_b32 v33, v35
    buffer_store_dwordx4 v[32:35], v9, s[48:51], s59 offen offset:64
    s_endpgm
P1_SLOWN:
    s_mov_b32 s60, 1048576
P1_SLOWN_L:
    buffer_load_dword v24, v25, s[48:51], 0 offen sc1
    s_waitcnt vmcnt(0)
    v_readfirstlane_b32 s57, v24
    s_cmp_lg_u32 s57, 0
    s_cbranch_scc1 P1_NOK
    s_sleep 4
    s_sub_u32 s60, s60, 1
    s_cmp_lg_u32 s60, 0
    s_cbranch_scc1 P1_SLOWN_L
    s_endpgm
P1_SLOWE:
    s_mov_b32 s58, 1048576
P1_SLOWE_L:
    buffer_load_dwordx4 v[28:31], v2, s[32:35], s11 offen sc1
    s_waitcnt vmcnt(0)
    v_xor_b32 v28, v28, v24
    v_xor_b32 v29, v29, v24
    v_xor_b32 v30, v30, v24
    v_xor_b32 v31, v31, v24
    v_or3_b32 v28, v28, v29, v30
    v_or_b32 v28, v28, v31
    v_cmp_eq_u32 vcc, 0, v28
    s_nop 0
    s_cmp_eq_u64 vcc, -1
    s_cbranch_scc1 P1_EOK
    s_sleep 4
    s_sub_u32 s58, s58, 1
    s_cmp_lg_u32 s58, 0
    s_cbranch_scc1 P1_SLOWE_L
    s_endpgm
P3_SLOWH:
    s_mov_b32 s58, 1048576
P3_SH_L:
    buffer_load_dwordx4 v[252:255], v12, s[32:35], s59 offen sc1
    s_waitcnt vmcnt(0)
    v_xor_b32 v252, v252, v6
    v_xor_b32 v253, v253, v6
    v_xor_b32 v254, v254, v6
    v_xor_b32 v255, v255, v6
    v_or3_b32 v252, v252, v253, v254
    v_or_b32 v252, v252, v255
    v_cmp_eq_u32 vcc, 0, v252
    s_nop 0
    s_cmp_eq_u64 vcc, -1
    s_cbranch_scc1 P3_HOK
    s_sleep 4
    s_sub_u32 s58, s58, 1
    s_cmp_lg_u32 s58, 0
    s_cbranch_scc1 P3_SH_L
    s_endpgm
P3_SLOWO:
    s_mov_b32 s58, 1048576
P3_SO_L:
    buffer_load_dword v252, v13, s[32:35], s65 offen sc1
    s_waitcnt vmcnt(0)
    v_cmp_eq_u32 vcc, s57, v252
    s_nop 0
    s_cmp_eq_u64 vcc, -1
    s_cbranch_scc1 P3_OOK
    s_sleep 4
    s_sub_u32 s58, s58, 1
    s_cmp_lg_u32 s58, 0
    s_cbranch_scc1 P3_SO_L
    s_endpgm
P2_FALLBACK:
    v_mov_b32 v8, 0xff800000
    v_mov_b32 v9, 0xff800000
    s_mov_b32 s58, 23068672
P2_FB1:
    buffer_load_dwordx4 a[144:147], v2, s[32:35], s58 offen offset:0 sc1
    buffer_load_dwordx4 a[148:151], v2, s[32:35], s58 offen offset:1024 sc1
    s_waitcnt vmcnt(0)
    v_mfma_f32_32x32x16_bf16 v[20:35], a[144:147], a[128:131], 0
    v_mfma_f32_32x32x16_bf16 v[20:35], a[148:151], a[132:135], v[20:35]
    v_mfma_f32_32x32x16_bf16 v[36:51], a[144:147], a[136:139], 0
    v_mfma_f32_32x32x16_bf16 v[36:51], a[148:151], a[140:143], v[36:51]
    s_nop 15
    v_max3_f32 v8, v20, v21, v8
    v_max3_f32 v8, v22, v23, v8
    v_max3_f32 v8, v24, v25, v8
    v_max3_f32 v8, v26, v27, v8
    v_max3_f32 v8, v28, v29, v8
    v_max3_f32 v8, v30, v31, v8
    v_max3_f32 v8, v32, v33, v8
    v_max3_f32 v8, v34, v35, v8
    v_max3_f32 v9, v36, v37, v9
    v_max3_f32 v9, v38, v39, v9
    v_max3_f32 v9, v40, v41, v9
    v_max3_f32 v9, v42, v43, v9
    v_max3_f32 v9, v44, v45, v9
    v_max3_f32 v9, v46, v47, v9
    v_max3_f32 v9, v48, v49, v9
    v_max3_f32 v9, v50, v51, v9
    s_add_u32 s58, s58, 4096
    s_cmp_lt_u32 s58, 23330816
    s_cbranch_scc1 P2_FB1
    v_mov_b32 v10, v8
    v_mov_b32 v11, v9
    s_nop 1
    v_permlane32_swap_b32 v8, v10
    v_permlane32_swap_b32 v9, v11
    v_max_f32 v252, v8, v10
    v_max_f32 v253, v9, v11
    v_mov_b32 v68, 0
    v_mov_b32 v69, 0
    v_mov_b32 v70, 0
    v_mov_b32 v71, 0
    v_mov_b32 v72, 0
    v_mov_b32 v73, 0
    v_mov_b32 v74, 0
    v_mov_b32 v75, 0
    v_mov_b32 v76, 0
    v_mov_b32 v77, 0
    v_mov_b32 v78, 0
    v_mov_b32 v79, 0
    v_mov_b32 v80, 0
    v_mov_b32 v81, 0
    v_mov_b32 v82, 0
    v_mov_b32 v83, 0
    v_mov_b32 v100, 0
    v_mov_b32 v101, 0
    v_mov_b32 v102, 0
    v_mov_b32 v103, 0
    v_mov_b32 v84, 0
    v_mov_b32 v85, 0
    v_mov_b32 v86, 0
    v_mov_b32 v87, 0
    v_mov_b32 v88, 0
    v_mov_b32 v89, 0
    v_mov_b32 v90, 0
    v_mov_b32 v91, 0
    v_mov_b32 v92, 0
    v_mov_b32 v93, 0
    v_mov_b32 v94, 0
    v_mov_b32 v95, 0
    v_mov_b32 v96, 0
    v_mov_b32 v97, 0
    v_mov_b32 v98, 0
    v_mov_b32 v99, 0
    v_mov_b32 v104, 0
    v_mov_b32 v105, 0
    v_mov_b32 v106, 0
    v_mov_b32 v107, 0
    s_mov_b32 s58, 23068672
P2_FB2:
    buffer_load_dwordx4 a[144:147], v2, s[32:35], s58 offen offset:0 sc1
    buffer_load_dwordx4 a[148:151], v2, s[32:35], s58 offen offset:1024 sc1
    buffer_load_dwordx4 a[160:163], v2, s[32:35], s58 offen offset:2048 sc1
    buffer_load_dwordx4 a[164:167], v2, s[32:35], s58 offen offset:3072 sc1
    s_waitcnt vmcnt(0)
    v_mfma_f32_32x32x16_bf16 v[20:35], a[144:147], a[128:131], 0
    v_mfma_f32_32x32x16_bf16 v[20:35], a[148:151], a[132:135], v[20:35]
    v_mfma_f32_32x32x16_bf16 v[36:51], a[144:147], a[136:139], 0
    v_mfma_f32_32x32x16_bf16 v[36:51], a[148:151], a[140:143], v[36:51]
    s_nop 15
    v_sub_f32 v20, v20, v252
    v_sub_f32 v21, v21, v252
    v_sub_f32 v22, v22, v252
    v_sub_f32 v23, v23, v252
    v_sub_f32 v24, v24, v252
    v_sub_f32 v25, v25, v252
    v_sub_f32 v26, v26, v252
    v_sub_f32 v27, v27, v252
    v_sub_f32 v28, v28, v252
    v_sub_f32 v29, v29, v252
    v_sub_f32 v30, v30, v252
    v_sub_f32 v31, v31, v252
    v_sub_f32 v32, v32, v252
    v_sub_f32 v33, v33, v252
    v_sub_f32 v34, v34, v252
    v_sub_f32 v35, v35, v252
    v_exp_f32 v20, v20
    v_exp_f32 v21, v21
    v_exp_f32 v22, v22
    v_exp_f32 v23, v23
    v_exp_f32 v24, v24
    v_exp_f32 v25, v25
    v_exp_f32 v26, v26
    v_exp_f32 v27, v27
    v_exp_f32 v28, v28
    v_exp_f32 v29, v29
    v_exp_f32 v30, v30
    v_exp_f32 v31, v31
    v_exp_f32 v32, v32
    v_exp_f32 v33, v33
    v_exp_f32 v34, v34
    v_exp_f32 v35, v35
    s_nop 0
    v_cvt_pk_bf16_f32 v52, v20, v21
    v_cvt_pk_bf16_f32 v53, v22, v23
    v_cvt_pk_bf16_f32 v54, v24, v25
    v_cvt_pk_bf16_f32 v55, v26, v27
    v_cvt_pk_bf16_f32 v56, v28, v29
    v_cvt_pk_bf16_f32 v57, v30, v31
    v_cvt_pk_bf16_f32 v58, v32, v33
    v_cvt_pk_bf16_f32 v59, v34, v35
    v_sub_f32 v36, v36, v253
    v_sub_f32 v37, v37, v253
    v_sub_f32 v38, v38, v253
    v_sub_f32 v39, v39, v253
    v_sub_f32 v40, v40, v253
    v_sub_f32 v41, v41, v253
    v_sub_f32 v42, v42, v253
    v_sub_f32 v43, v43, v253
    v_sub_f32 v44, v44, v253
    v_sub_f32 v45, v45, v253
    v_sub_f32 v46, v46, v253
    v_sub_f32 v47, v47, v253
    v_sub_f32 v48, v48, v253
    v_sub_f32 v49, v49, v253
    v_sub_f32 v50, v50, v253
    v_sub_f32 v51, v51, v253
    v_exp_f32 v36, v36
    v_exp_f32 v37, v37
    v_exp_f32 v38, v38
    v_exp_f32 v39, v39
    v_exp_f32 v40, v40
    v_exp_f32 v41, v41
    v_exp_f32 v42, v42
    v_exp_f32 v43, v43
    v_exp_f32 v44, v44
    v_exp_f32 v45, v45
    v_exp_f32 v46, v46
    v_exp_f32 v47, v47
    v_exp_f32 v48, v48
    v_exp_f32 v49, v49
    v_exp_f32 v50, v50
    v_exp_f32 v51, v51
    s_nop 0
    v_cvt_pk_bf16_f32 v60, v36, v37
    v_cvt_pk_bf16_f32 v61, v38, v39
    v_cvt_pk_bf16_f32 v62, v40, v41
    v_cvt_pk_bf16_f32 v63, v42, v43
    v_cvt_pk_bf16_f32 v64, v44, v45
    v_cvt_pk_bf16_f32 v65, v46, v47
    v_cvt_pk_bf16_f32 v66, v48, v49
    v_cvt_pk_bf16_f32 v67, v50, v51
    s_nop 1
    v_mfma_f32_32x32x16_bf16 v[68:83], a[160:163], v[52:55], v[68:83]
    v_smfmac_f32_16x16x64_bf16 v[100:103], a[176:179], v[52:59], v18
    v_mfma_f32_32x32x16_bf16 v[68:83], a[164:167], v[56:59], v[68:83]
    v_mfma_f32_32x32x16_bf16 v[84:99], a[160:163], v[60:63], v[84:99]
    v_smfmac_f32_16x16x64_bf16 v[104:107], a[176:179], v[60:67], v18
    v_mfma_f32_32x32x16_bf16 v[84:99], a[164:167], v[64:67], v[84:99]
    s_add_u32 s58, s58, 4096
    s_cmp_lt_u32 s58, 23330816
    s_cbranch_scc1 P2_FB2
    s_nop 15
    v_add_f32 v100, v100, v101
    v_add_f32 v104, v104, v105
    s_branch P2_FINISH
L_END:
    s_endpgm
.section .rodata,"a"
.p2align 6
.amdhsa_kernel gated_mix__grouped_kv_mqa__glu_gated_reglu__prompt_kernel
  .amdhsa_next_free_vgpr 512
  .amdhsa_next_free_sgpr 102
  .amdhsa_accum_offset 256
  .amdhsa_group_segment_fixed_size 0
  .amdhsa_kernarg_size 104
  .amdhsa_user_sgpr_count 2
  .amdhsa_user_sgpr_kernarg_segment_ptr 1
  .amdhsa_system_sgpr_workgroup_id_x 1
  .amdhsa_float_denorm_mode_32 3
.end_amdhsa_kernel
.text
```
